```python
import torch

def _softmax(x, axis=-1):
    return torch.softmax(x, dim=axis)
def _gelu(x):
    return torch.nn.functional.gelu(x, approximate="tanh")
def _silu(x):
    return torch.nn.functional.silu(x)
def _sigmoid(x):
    return torch.sigmoid(x)
def _layernorm(x, axis=-1, eps=1e-5):
    m = x.mean(dim=axis, keepdim=True)
    v = x.var(dim=axis, keepdim=True, unbiased=False)
    return (x - m) / torch.sqrt(v + eps)
def _scatter_add(tgt, idx, src, axis=0):
    return tgt.clone().index_add_(axis, idx, src)
def _segment_sum(src, seg, n):
    out = torch.zeros((n,) + src.shape[1:], dtype=src.dtype)
    return out.index_add_(0, seg, src)
def _pad(x, pw):
    flat = tuple(v for pair in reversed(pw) for v in pair)
    return torch.nn.functional.pad(x, flat)

kernel_name = 'parallel_sum__sliding_local_dilated__mixer_s_mlp__prompt'

def setup_inputs():

    _w = (lambda a: (lambda t: t.to(torch.bfloat16) if t.is_floating_point() else t)(torch.as_tensor(a)))
    def _A_setup():
        B, S, D = 1, 2048, 576
        return {
            "x": _w((lambda *s: torch.randn(*s, dtype=torch.bfloat16) * 0.05)(B, S, D)),
            "wqkv": _w((lambda *s: torch.randn(*s, dtype=torch.bfloat16) * 0.1)(D, 3 * D)),
            "wo": _w((lambda *s: torch.randn(*s, dtype=torch.bfloat16) * 0.05)(D, D)),
        }
    _A_in = _A_setup()

    def _B_setup():
        B, S, D, F = 1, 2048, 576, 4608
        return {
            "x":  _w((lambda *s: torch.randn(*s, dtype=torch.bfloat16) * 0.05)(B, S, D)),
            "w1": _w((lambda *s: torch.randn(*s, dtype=torch.bfloat16) * 3.2)(D, D) * (D ** -0.5)),
            "w2": _w((lambda *s: torch.randn(*s, dtype=torch.bfloat16) * 3.2)(D, D) * (D ** -0.5)),
            "w3": _w((lambda *s: torch.randn(*s, dtype=torch.bfloat16) * 3.2)(D, F) * (D ** -0.5)),
            "w4": _w((lambda *s: torch.randn(*s, dtype=torch.bfloat16) * 3.2)(F, D) * (F ** -0.5)),
        }
    _B_in = _B_setup()

    return {
        "A_x": _A_in["x"],
        "A_wqkv": _A_in["wqkv"],
        "A_wo": _A_in["wo"],
        "B_x": _B_in["x"],
        "B_w1": _B_in["w1"],
        "B_w2": _B_in["w2"],
        "B_w3": _B_in["w3"],
        "B_w4": _B_in["w4"],
    }

def reference(A_x, A_wqkv, A_wo, B_x, B_w1, B_w2, B_w3, B_w4):
    def _A_ref(x, wqkv, wo):
        B, S, D = x.shape
        H = 32; Dh = D // H
        W, dil = 8, 2
        qkv = (lambda x, *d: x.permute(*d))((x @ wqkv).reshape(B, S, 3, H, Dh), 2, 0, 3, 1, 4)
        q, k, v = qkv[0], qkv[1], qkv[2]
        scale = Dh ** -0.5
        pos = torch.arange(S)
        off = torch.arange(W) * dil
        idx = pos[:, None] - off[None, :]
        mask = idx >= 0
        idx_c = torch.where(mask, idx, 0).reshape(-1)
        kg = k[:, :, idx_c, :].reshape(B, H, S, W, Dh)
        vg = v[:, :, idx_c, :].reshape(B, H, S, W, Dh)
        logits = torch.einsum("bhsd,bhswd->bhsw", q, kg) * scale
        logits = torch.where(mask[None, None, :, :], logits, -1e9)
        attn = _softmax(logits, axis=-1)
        o = torch.einsum("bhsw,bhswd->bhsd", attn, vg)
        return (lambda x, *d: x.permute(*d))(o, 0, 2, 1, 3).reshape(B, S, D) @ wo

    def _B_ref(x, w1, w2, w3, w4):
        B, S, D = x.shape
        h = _gelu(_layernorm(x, axis=-1) @ w1)
        c = D // 4
        g0 = _pad(h[:, :, 0*c:1*c], ((0, 0), (1, 0), (0, 0)))[:, :S, :]
        g1 = _pad(h[:, :, 1*c:2*c], ((0, 0), (0, 1), (0, 0)))[:, 1:, :]
        g2 = _pad(h[:, :, 2*c:3*c], ((0, 0), (2, 0), (0, 0)))[:, :S, :]
        g3 = _pad(h[:, :, 3*c:   ], ((0, 0), (0, 2), (0, 0)))[:, 2:, :]
        hs = torch.concatenate([g0, g1, g2, g3], axis=-1) @ w2
        x1 = x + hs
        h2 = _gelu(_layernorm(x1, axis=-1) @ w3) @ w4
        return x1 + h2

    x = A_x
    xn = _layernorm(x, axis=-1)
    return x + _A_ref(xn, A_wqkv, A_wo) + _B_ref(xn, B_w1, B_w2, B_w3, B_w4)
```

```asm
; @launch grid=(256,1,1) block=(256,1,1) lds=163840
.amdgcn_target "amdgcn-amd-amdhsa--gfx950"
.text

.globl parallel_sum__sliding_local_dilated__mixer_s_mlp__prompt_kernel
.p2align 8
.type parallel_sum__sliding_local_dilated__mixer_s_mlp__prompt_kernel,@function
parallel_sum__sliding_local_dilated__mixer_s_mlp__prompt_kernel:
    s_cmp_ge_u32 s2, 256
    s_cbranch_scc1 Lend
    s_load_dwordx16 s[48:63], s[0:1], 0
    s_load_dwordx4 s[64:67], s[0:1], 64
    s_load_dwordx2 s[68:69], s[0:1], 80
    s_getpc_b64 s[28:29]
Lpc:
    s_bfe_u32 s27, s2, 0x30003
    s_lshl_b32 s27, s27, 14
    v_lshrrev_b32 v255, 1, v0
    v_lshl_add_u32 v255, v255, 7, s27
    v_min_u32 v255, Lend-Lpc, v255
    global_load_dword a255, v255, s[28:29]
    v_and_b32 v1, 63, v0
    v_lshrrev_b32 v4, 6, v0
    v_and_b32 v2, 15, v0
    v_bfe_u32 v3, v0, 4, 2
    v_readfirstlane_b32 s4, v4
    s_mov_b32 s47, s2
    s_and_b32 s5, s2, 3
    s_lshl_b32 s5, s5, 1
    s_bfe_u32 s3, s2, 0x10003
    s_add_u32 s5, s5, s3
    s_bfe_u32 s6, s2, 0x10002
    s_lshl_b32 s6, s6, 4
    s_lshr_b32 s3, s2, 4
    s_add_u32 s6, s6, s3
    s_lshl_b32 s7, s6, 2
    s_add_u32 s7, s7, s4
    s_mul_i32 s3, s4, 18432
    s_mul_i32 s44, s6, 73728
    s_mul_i32 s24, s4, 9216
    s_and_b32 s43, s5, 3
    s_lshr_b32 s46, s6, 1
    s_lshl_b32 s37, s46, 3
    s_add_u32 s37, s37, s5
    s_lshr_b32 s45, s5, 2
    s_xor_b32 s45, s45, s6
    s_and_b32 s45, s45, 1
    s_add_u32 s27, s5, s46
    s_add_u32 s98, s27, 0
    s_and_b32 s98, s98, 3
    s_add_u32 s99, s27, 1
    s_and_b32 s99, s99, 3
    s_add_u32 s100, s27, 2
    s_and_b32 s100, s100, 3
    s_add_u32 s101, s27, 3
    s_and_b32 s101, s101, 3
    v_lshrrev_b32 v5, 3, v1
    v_lshl_add_u32 v4, v4, 4, v5
    v_mul_u32_u24 v4, 1152, v4
    v_and_b32 v5, 7, v1
    v_xor_b32 v5, v5, v3
    v_lshl_add_u32 v0, v5, 4, v4
    v_xor_b32 v254, 64, v0
    v_add_u32 v254, 8192, v254
    s_mov_b32 s32, 0xc09d30fc
    s_mov_b32 s33, s32
    s_mov_b32 s34, 0x3eeff558
    s_mov_b32 s35, s34
    s_mov_b32 s36, 1
    s_mov_b32 s38, 0x3f80
    s_mov_b32 s39, 1.0
    s_mov_b32 s26, 8192
    s_mov_b32 s40, 0x3f803f80
    s_mov_b32 s41, 0xffff0000
    s_cmp_eq_u32 s45, 0
    s_cbranch_scc1 Lmix
    s_branch Latt
Lpadret:
    s_setpc_b64 s[70:71]
.p2align 12
Latt:
    s_waitcnt lgkmcnt(0)
    s_mov_b32 s8, s48
    s_and_b32 s9, s49, 0xffff
    s_mov_b32 s10, 2359296
    s_mov_b32 s11, 0x20000
    s_lshl_b32 s29, s98, 8
    s_add_u32 s29, s29, s44
    s_add_u32 m0, s3, 0
    s_nop 0
    buffer_load_dwordx4 v0, s[8:11], s29 offen lds
    buffer_load_dwordx4 v254, s[8:11], s29 offen offset:1024 lds
    s_add_u32 s29, s29, 128
    s_add_u32 m0, s3, 2048
    s_nop 0
    buffer_load_dwordx4 v0, s[8:11], s29 offen lds
    buffer_load_dwordx4 v254, s[8:11], s29 offen offset:1024 lds
    s_lshl_b32 s29, s99, 8
    s_add_u32 s29, s29, s44
    s_add_u32 m0, s3, 4096
    s_nop 0
    buffer_load_dwordx4 v0, s[8:11], s29 offen lds
    buffer_load_dwordx4 v254, s[8:11], s29 offen offset:1024 lds
    s_add_u32 s29, s29, 128
    s_add_u32 m0, s3, 6144
    s_nop 0
    buffer_load_dwordx4 v0, s[8:11], s29 offen lds
    buffer_load_dwordx4 v254, s[8:11], s29 offen offset:1024 lds
    s_lshl_b32 s29, s100, 8
    s_add_u32 s29, s29, s44
    s_add_u32 m0, s3, 8192
    s_nop 0
    buffer_load_dwordx4 v0, s[8:11], s29 offen lds
    buffer_load_dwordx4 v254, s[8:11], s29 offen offset:1024 lds
    s_mul_i32 s30, s5, 144
    s_mov_b32 s28, 3456
    v_mov_b32 v247, 2160
    v_mov_b32 v248, 110448
    v_mov_b32 v249, 1152
    v_mul_u32_u24 v245, 3641, v1
    v_lshlrev_b32 v246, 4, v1
    s_mov_b32 s31, -288
    v_add_u32 v242, 0, v245
    v_lshrrev_b32 v244, 17, v242
    v_lshrrev_b32 v242, 16, v242
    v_add_u32_e64 v243, 0, v246
    v_mad_i32_i24 v243, v242, s31, v243
    v_bitop3_b32 v244, v244, v242, 4 bitop3:0x28
    v_lshl_or_b32 v244, v244, 1, v244
    v_xor_b32_e64 v242, v244, v242
    v_cmp_lt_u32 vcc, 143, v243
    s_sub_u32 s27, s30, 0
    v_mad_u32_u24 v242, v242, s28, v243
    v_cndmask_b32 v243, v249, v247, vcc
    v_cndmask_b32_e64 v244, 0, v248, vcc
    v_add3_u32 v4, v242, v243, s27
    v_add3_u32 v228, v242, v244, s27
    v_add_u32 v242, 233024, v245
    v_lshrrev_b32 v244, 17, v242
    v_lshrrev_b32 v242, 16, v242
    v_add_u32 v243, 1024, v246
    v_mad_i32_i24 v243, v242, s31, v243
    v_bitop3_b32 v244, v244, v242, 4 bitop3:0x28
    v_lshl_or_b32 v244, v244, 1, v244
    v_xor_b32 v242, v244, v242
    v_cmp_lt_u32 vcc, 143, v243
    s_sub_u32 s27, s30, 1024
    v_mad_u32_u24 v242, v242, s28, v243
    v_cndmask_b32 v243, v249, v247, vcc
    v_cndmask_b32 v244, 0, v248, vcc
    v_add3_u32 v5, v242, v243, s27
    v_add3_u32 v229, v242, v244, s27
    v_add_u32 v242, 466048, v245
    v_lshrrev_b32 v244, 17, v242
    v_lshrrev_b32_e64 v242, 16, v242
    v_add_u32 v243, 2048, v246
    v_mad_i32_i24 v243, v242, s31, v243
    v_bitop3_b32 v244, v244, v242, 4 bitop3:0x28
    v_lshl_or_b32 v244, v244, 1, v244
    v_xor_b32_e64 v242, v244, v242
    v_cmp_lt_u32 vcc, 143, v243
    s_sub_u32 s27, s30, 2048
    v_mad_u32_u24 v242, v242, s28, v243
    v_cndmask_b32 v243, v249, v247, vcc
    v_cndmask_b32 v244, 0, v248, vcc
    v_add3_u32 v6, v242, v243, s27
    v_add3_u32 v230, v242, v244, s27
    v_add_u32 v242, 699072, v245
    v_lshrrev_b32 v244, 17, v242
    v_lshrrev_b32 v242, 16, v242
    v_add_u32 v243, 3072, v246
    v_mad_i32_i24 v243, v242, s31, v243
    v_bitop3_b32 v244, v244, v242, 4 bitop3:0x28
    v_lshl_or_b32 v244, v244, 1, v244
    v_xor_b32_e64 v242, v244, v242
    v_cmp_lt_u32 vcc, 143, v243
    s_sub_u32 s27, s30, 3072
    v_mad_u32_u24 v242, v242, s28, v243
    v_cndmask_b32 v243, v249, v247, vcc
    v_cndmask_b32 v244, 0, v248, vcc
    v_add3_u32 v7, v242, v243, s27
    v_add3_u32 v231, v242, v244, s27
    v_add_u32 v242, 932096, v245
    v_lshrrev_b32 v244, 17, v242
    v_lshrrev_b32 v242, 16, v242
    v_add_u32 v243, 4096, v246
    v_mad_i32_i24 v243, v242, s31, v243
    v_bitop3_b32 v244, v244, v242, 4 bitop3:0x28
    v_lshl_or_b32 v244, v244, 1, v244
    v_xor_b32_e64 v242, v244, v242
    v_cmp_lt_u32 vcc, 143, v243
    s_sub_u32 s27, s30, 0
    v_mad_u32_u24 v242, v242, s28, v243
    v_cndmask_b32 v243, v249, v247, vcc
    v_cndmask_b32_e64 v244, 0, v248, vcc
    v_add3_u32 v8, v242, v243, s27
    v_add3_u32 v232, v242, v244, s27
    v_add_u32 v242, 1165120, v245
    v_lshrrev_b32 v244, 17, v242
    v_lshrrev_b32 v242, 16, v242
    v_add_u32 v243, 5120, v246
    v_mad_i32_i24 v243, v242, s31, v243
    v_bitop3_b32 v244, v244, v242, 4 bitop3:0x28
    v_lshl_or_b32 v244, v244, 1, v244
    v_xor_b32 v242, v244, v242
    v_cmp_lt_u32 vcc, 143, v243
    s_sub_u32 s27, s30, 1024
    v_mad_u32_u24 v242, v242, s28, v243
    v_cndmask_b32 v243, v249, v247, vcc
    v_cndmask_b32 v244, 0, v248, vcc
    v_add3_u32 v9, v242, v243, s27
    v_add3_u32 v233, v242, v244, s27
    v_add_u32 v242, 1398144, v245
    v_lshrrev_b32 v244, 17, v242
    v_lshrrev_b32_e64 v242, 16, v242
    v_add_u32 v243, 6144, v246
    v_mad_i32_i24 v243, v242, s31, v243
    v_bitop3_b32 v244, v244, v242, 4 bitop3:0x28
    v_lshl_or_b32 v244, v244, 1, v244
    v_xor_b32_e64 v242, v244, v242
    v_cmp_lt_u32 vcc, 143, v243
    s_sub_u32 s27, s30, 2048
    v_mad_u32_u24 v242, v242, s28, v243
    v_cndmask_b32 v243, v249, v247, vcc
    v_cndmask_b32 v244, 0, v248, vcc
    v_add3_u32 v10, v242, v243, s27
    v_add3_u32 v234, v242, v244, s27
    v_add_u32 v242, 1631168, v245
    v_lshrrev_b32 v244, 17, v242
    v_lshrrev_b32 v242, 16, v242
    v_add_u32 v243, 7168, v246
    v_mad_i32_i24 v243, v242, s31, v243
    v_bitop3_b32 v244, v244, v242, 4 bitop3:0x28
    v_lshl_or_b32 v244, v244, 1, v244
    v_xor_b32_e64 v242, v244, v242
    v_cmp_lt_u32 vcc, 143, v243
    s_sub_u32 s27, s30, 3072
    v_mad_u32_u24 v242, v242, s28, v243
    v_cndmask_b32 v243, v249, v247, vcc
    v_cndmask_b32 v244, 0, v248, vcc
    v_add3_u32 v11, v242, v243, s27
    v_add3_u32 v235, v242, v244, s27
    v_add_u32 v242, 1864192, v245
    v_lshrrev_b32 v244, 17, v242
    v_lshrrev_b32 v242, 16, v242
    v_add_u32 v243, 8192, v246
    v_mad_i32_i24 v243, v242, s31, v243
    v_bitop3_b32 v244, v244, v242, 4 bitop3:0x28
    v_lshl_or_b32 v244, v244, 1, v244
    v_xor_b32_e64 v242, v244, v242
    v_cmp_lt_u32 vcc, 143, v243
    s_sub_u32 s27, s30, 0
    v_mad_u32_u24 v242, v242, s28, v243
    v_cndmask_b32 v243, v249, v247, vcc
    v_cndmask_b32_e64 v244, 0, v248, vcc
    v_add3_u32 v12, v242, v243, s27
    v_add3_u32 v236, v242, v244, s27
    s_mov_b32 s16, s68
    s_and_b32 s17, s69, 0xffff
    s_mov_b32 s18, 67108864
    s_mov_b32 s19, 0x20000
    s_mov_b32 s12, s50
    s_and_b32 s13, s51, 0xffff
    s_mov_b32 s14, 1990656
    s_mov_b32 s15, 0x20000
    v_lshrrev_b32 v242, 1, v2
    v_xor_b32 v242, v242, v3
    v_lshlrev_b32 v242, 4, v242
    v_lshl_add_u32 v242, v2, 7, v242
    s_add_u32 s27, s3, 0
    v_add_u32 v14, s27, v242
    v_xor_b32 v242, 64, v242
    v_add_u32 v15, s27, v242
    s_xor_b32 s28, s6, 1
    s_mul_i32 s28, s28, 73728
    s_and_b32 s27, s46, 7
    s_lshl_b32 s27, s27, 2
    s_add_u32 s27, s27, s4
    s_mul_i32 s27, s27, 6912
    s_and_b32 s31, s30, 0xffffff80
    s_add_u32 s27, s27, s31
    s_add_u32 s27, s27, 1769472
    v_min_u32 v242, 3, v1
    v_mul_u32_u24 v243, 32768, v242
    v_lshrrev_b32 v243, 16, v243
    v_mul_u32_u24 v243, 3200, v243
    v_lshl_add_u32 v242, v242, 7, v243
    s_mov_b64 exec, 0
    s_cmp_lt_u32 s4, 2
    s_cbranch_scc1 Li1
    s_cmp_eq_u32 s4, 2
    s_cbranch_scc1 Li2
    s_call_b64 s[70:71], Lpad0_3
    s_branch Li4
Li2:
    s_call_b64 s[70:71], Lpad0_2
    s_branch Li4
Li1:
    s_cmp_eq_u32 s4, 0
    s_cbranch_scc1 Li3
    s_call_b64 s[70:71], Lpad0_1
    s_branch Li4
Li3:
    s_call_b64 s[70:71], Lpad0_0
Li4:
    s_mov_b64 exec, -1
    s_mov_b64 exec, 0
    s_cmp_lt_u32 s4, 2
    s_cbranch_scc1 Li5
    s_cmp_eq_u32 s4, 2
    s_cbranch_scc1 Li6
    s_call_b64 s[70:71], Lpad53076_3
    s_branch Li8
Li6:
    s_call_b64 s[70:71], Lpad53076_2
    s_branch Li8
Li5:
    s_cmp_eq_u32 s4, 0
    s_cbranch_scc1 Li7
    s_call_b64 s[70:71], Lpad53076_1
    s_branch Li8
Li7:
    s_call_b64 s[70:71], Lpad53076_0
Li8:
    s_mov_b64 exec, -1
    s_add_u32 s29, s29, 128
    s_add_u32 m0, s3, 10240
    s_nop 0
    buffer_load_dwordx4 v0, s[8:11], s29 offen lds
    buffer_load_dwordx4 v254, s[8:11], s29 offen offset:1024 lds
    s_lshl_b32 s29, s101, 8
    s_add_u32 s29, s29, s44
    s_add_u32 m0, s3, 12288
    s_nop 0
    buffer_load_dwordx4 v0, s[8:11], s29 offen lds
    buffer_load_dwordx4 v254, s[8:11], s29 offen offset:1024 lds
    s_add_u32 s29, s29, 128
    s_add_u32 m0, s3, 14336
    s_nop 0
    buffer_load_dwordx4 v0, s[8:11], s29 offen lds
    buffer_load_dwordx4 v254, s[8:11], s29 offen offset:1024 lds
    s_add_u32 s29, s44, 1024
    s_add_u32 m0, s3, 16384
    s_nop 0
    buffer_load_dwordx4 v0, s[8:11], s29 offen lds
    buffer_load_dwordx4 v254, s[8:11], s29 offen offset:1024 lds
    buffer_load_dword a255, v242, s[12:15], s27 offen
    buffer_load_dword a255, v242, s[12:15], s27 offen offset:1152
    buffer_load_dword a255, v242, s[12:15], s27 offen offset:2304
    s_lshl_b32 s29, s98, 8
    s_add_u32 s29, s29, s28
    s_add_u32 m0, s3, 73728
    s_nop 0
    buffer_load_dwordx4 v0, s[8:11], s29 offen lds
    buffer_load_dwordx4 v254, s[8:11], s29 offen offset:1024 lds
    s_add_u32 s29, s29, 128
    s_add_u32 m0, s3, 75776
    s_nop 0
    buffer_load_dwordx4 v0, s[8:11], s29 offen lds
    buffer_load_dwordx4 v254, s[8:11], s29 offen offset:1024 lds
    v_mov_b32 v246, 0
    v_mov_b32_e64 v247, 0
    s_waitcnt vmcnt(23)
    ds_read_b128 v[16:19], v14 offset:0
    ds_read_b128 v[20:23], v15 offset:0
    s_waitcnt vmcnt(21)
    ds_read_b128 v[24:27], v14 offset:2048
    ds_read_b128 v[28:31], v15 offset:2048
    s_waitcnt lgkmcnt(2)
    v_dot2c_f32_bf16 v246, s40, v16
    v_dot2c_f32_bf16 v247, v16, v16
    v_dot2c_f32_bf16 v246, s40, v17
    v_dot2c_f32_bf16 v247, v17, v17
    v_dot2c_f32_bf16 v246, s40, v18
    v_dot2c_f32_bf16 v247, v18, v18
    v_dot2c_f32_bf16 v246, s40, v19
    v_dot2c_f32_bf16 v247, v19, v19
    v_dot2c_f32_bf16 v246, s40, v20
    v_dot2c_f32_bf16 v247, v20, v20
    v_dot2c_f32_bf16 v246, s40, v21
    v_dot2c_f32_bf16 v247, v21, v21
    v_dot2c_f32_bf16 v246, s40, v22
    v_dot2c_f32_bf16 v247, v22, v22
    v_dot2c_f32_bf16 v246, s40, v23
    v_dot2c_f32_bf16 v247, v23, v23
    s_waitcnt vmcnt(19)
    ds_read_b128 v[32:35], v14 offset:4096
    ds_read_b128 v[36:39], v15 offset:4096
    s_waitcnt lgkmcnt(2)
    v_dot2c_f32_bf16 v246, s40, v24
    v_dot2c_f32_bf16 v247, v24, v24
    v_dot2c_f32_bf16 v246, s40, v25
    v_dot2c_f32_bf16 v247, v25, v25
    v_dot2c_f32_bf16 v246, s40, v26
    v_dot2c_f32_bf16 v247, v26, v26
    v_dot2c_f32_bf16 v246, s40, v27
    v_dot2c_f32_bf16 v247, v27, v27
    v_dot2c_f32_bf16 v246, s40, v28
    v_dot2c_f32_bf16 v247, v28, v28
    v_dot2c_f32_bf16 v246, s40, v29
    v_dot2c_f32_bf16 v247, v29, v29
    v_dot2c_f32_bf16 v246, s40, v30
    v_dot2c_f32_bf16 v247, v30, v30
    v_dot2c_f32_bf16 v246, s40, v31
    v_dot2c_f32_bf16 v247, v31, v31
    s_lshl_b32 s29, s99, 8
    s_add_u32 s29, s29, s28
    s_add_u32 m0, s3, 77824
    s_nop 0
    buffer_load_dwordx4 v0, s[8:11], s29 offen lds
    buffer_load_dwordx4 v254, s[8:11], s29 offen offset:1024 lds
    s_add_u32 s29, s29, 128
    s_add_u32 m0, s3, 79872
    s_nop 0
    buffer_load_dwordx4 v0, s[8:11], s29 offen lds
    buffer_load_dwordx4 v254, s[8:11], s29 offen offset:1024 lds
    s_waitcnt vmcnt(21)
    ds_read_b128 v[40:43], v14 offset:6144
    ds_read_b128 v[44:47], v15 offset:6144
    s_waitcnt lgkmcnt(2)
    v_dot2c_f32_bf16 v246, s40, v32
    v_dot2c_f32_bf16 v247, v32, v32
    v_dot2c_f32_bf16 v246, s40, v33
    v_dot2c_f32_bf16 v247, v33, v33
    v_dot2c_f32_bf16 v246, s40, v34
    v_dot2c_f32_bf16 v247, v34, v34
    v_dot2c_f32_bf16 v246, s40, v35
    v_dot2c_f32_bf16 v247, v35, v35
    v_dot2c_f32_bf16 v246, s40, v36
    v_dot2c_f32_bf16 v247, v36, v36
    v_dot2c_f32_bf16 v246, s40, v37
    v_dot2c_f32_bf16 v247, v37, v37
    v_dot2c_f32_bf16 v246, s40, v38
    v_dot2c_f32_bf16 v247, v38, v38
    v_dot2c_f32_bf16 v246, s40, v39
    v_dot2c_f32_bf16 v247, v39, v39
    s_waitcnt vmcnt(19)
    ds_read_b128 v[48:51], v14 offset:8192
    ds_read_b128 v[52:55], v15 offset:8192
    s_waitcnt lgkmcnt(2)
    v_dot2c_f32_bf16 v246, s40, v40
    v_dot2c_f32_bf16 v247, v40, v40
    v_dot2c_f32_bf16 v246, s40, v41
    v_dot2c_f32_bf16 v247, v41, v41
    v_dot2c_f32_bf16 v246, s40, v42
    v_dot2c_f32_bf16 v247, v42, v42
    v_dot2c_f32_bf16 v246, s40, v43
    v_dot2c_f32_bf16 v247, v43, v43
    v_dot2c_f32_bf16 v246, s40, v44
    v_dot2c_f32_bf16 v247, v44, v44
    v_dot2c_f32_bf16 v246, s40, v45
    v_dot2c_f32_bf16 v247, v45, v45
    v_dot2c_f32_bf16 v246, s40, v46
    v_dot2c_f32_bf16 v247, v46, v46
    v_dot2c_f32_bf16 v246, s40, v47
    v_dot2c_f32_bf16 v247, v47, v47
    s_lshl_b32 s29, s100, 8
    s_add_u32 s29, s29, s28
    s_add_u32 m0, s3, 81920
    s_nop 0
    buffer_load_dwordx4 v0, s[8:11], s29 offen lds
    buffer_load_dwordx4 v254, s[8:11], s29 offen offset:1024 lds
    s_add_u32 s29, s29, 128
    s_add_u32 m0, s3, 83968
    s_nop 0
    buffer_load_dwordx4 v0, s[8:11], s29 offen lds
    buffer_load_dwordx4 v254, s[8:11], s29 offen offset:1024 lds
    s_waitcnt vmcnt(21)
    ds_read_b128 v[56:59], v14 offset:10240
    ds_read_b128 v[60:63], v15 offset:10240
    s_waitcnt lgkmcnt(2)
    v_dot2c_f32_bf16 v246, s40, v48
    v_dot2c_f32_bf16 v247, v48, v48
    v_dot2c_f32_bf16 v246, s40, v49
    v_dot2c_f32_bf16 v247, v49, v49
    v_dot2c_f32_bf16 v246, s40, v50
    v_dot2c_f32_bf16 v247, v50, v50
    v_dot2c_f32_bf16 v246, s40, v51
    v_dot2c_f32_bf16 v247, v51, v51
    v_dot2c_f32_bf16 v246, s40, v52
    v_dot2c_f32_bf16 v247, v52, v52
    v_dot2c_f32_bf16 v246, s40, v53
    v_dot2c_f32_bf16 v247, v53, v53
    v_dot2c_f32_bf16 v246, s40, v54
    v_dot2c_f32_bf16 v247, v54, v54
    v_dot2c_f32_bf16 v246, s40, v55
    v_dot2c_f32_bf16 v247, v55, v55
    s_waitcnt vmcnt(19)
    ds_read_b128 v[64:67], v14 offset:12288
    ds_read_b128 v[68:71], v15 offset:12288
    s_waitcnt lgkmcnt(2)
    v_dot2c_f32_bf16 v246, s40, v56
    v_dot2c_f32_bf16 v247, v56, v56
    v_dot2c_f32_bf16 v246, s40, v57
    v_dot2c_f32_bf16 v247, v57, v57
    v_dot2c_f32_bf16 v246, s40, v58
    v_dot2c_f32_bf16 v247, v58, v58
    v_dot2c_f32_bf16 v246, s40, v59
    v_dot2c_f32_bf16 v247, v59, v59
    v_dot2c_f32_bf16 v246, s40, v60
    v_dot2c_f32_bf16 v247, v60, v60
    v_dot2c_f32_bf16 v246, s40, v61
    v_dot2c_f32_bf16 v247, v61, v61
    v_dot2c_f32_bf16 v246, s40, v62
    v_dot2c_f32_bf16 v247, v62, v62
    v_dot2c_f32_bf16 v246, s40, v63
    v_dot2c_f32_bf16 v247, v63, v63
    s_lshl_b32 s29, s101, 8
    s_add_u32 s29, s29, s28
    s_add_u32 m0, s3, 86016
    s_nop 0
    buffer_load_dwordx4 v0, s[8:11], s29 offen lds
    buffer_load_dwordx4 v254, s[8:11], s29 offen offset:1024 lds
    s_add_u32 s29, s29, 128
    s_add_u32 m0, s3, 88064
    s_nop 0
    buffer_load_dwordx4 v0, s[8:11], s29 offen lds
    s_waitcnt vmcnt(20)
    ds_read_b128 v[72:75], v14 offset:14336
    ds_read_b128 v[76:79], v15 offset:14336
    s_waitcnt lgkmcnt(2)
    v_dot2c_f32_bf16 v246, s40, v64
    v_dot2c_f32_bf16 v247, v64, v64
    v_dot2c_f32_bf16 v246, s40, v65
    v_dot2c_f32_bf16 v247, v65, v65
    v_dot2c_f32_bf16 v246, s40, v66
    v_dot2c_f32_bf16 v247, v66, v66
    v_dot2c_f32_bf16 v246, s40, v67
    v_dot2c_f32_bf16 v247, v67, v67
    v_dot2c_f32_bf16 v246, s40, v68
    v_dot2c_f32_bf16 v247, v68, v68
    v_dot2c_f32_bf16 v246, s40, v69
    v_dot2c_f32_bf16 v247, v69, v69
    v_dot2c_f32_bf16 v246, s40, v70
    v_dot2c_f32_bf16 v247, v70, v70
    v_dot2c_f32_bf16 v246, s40, v71
    v_dot2c_f32_bf16 v247, v71, v71
    s_waitcnt vmcnt(18)
    ds_read_b128 v[80:83], v14 offset:16384
    ds_read_b128 v[84:87], v15 offset:16384
    s_waitcnt lgkmcnt(2)
    v_dot2c_f32_bf16 v246, s40, v72
    v_dot2c_f32_bf16 v247, v72, v72
    v_dot2c_f32_bf16 v246, s40, v73
    v_dot2c_f32_bf16 v247, v73, v73
    v_dot2c_f32_bf16 v246, s40, v74
    v_dot2c_f32_bf16 v247, v74, v74
    v_dot2c_f32_bf16 v246, s40, v75
    v_dot2c_f32_bf16 v247, v75, v75
    v_dot2c_f32_bf16 v246, s40, v76
    v_dot2c_f32_bf16 v247, v76, v76
    v_dot2c_f32_bf16 v246, s40, v77
    v_dot2c_f32_bf16 v247, v77, v77
    v_dot2c_f32_bf16 v246, s40, v78
    v_dot2c_f32_bf16 v247, v78, v78
    v_dot2c_f32_bf16 v246, s40, v79
    v_dot2c_f32_bf16 v247, v79, v79
    buffer_load_dwordx4 v254, s[8:11], s29 offen offset:1024 lds
    s_add_u32 s29, s28, 1024
    s_add_u32 m0, s3, 90112
    s_nop 0
    buffer_load_dwordx4 v0, s[8:11], s29 offen lds
    buffer_load_dwordx4 v254, s[8:11], s29 offen offset:1024 lds
    s_waitcnt lgkmcnt(0)
    v_dot2c_f32_bf16 v246, s40, v80
    v_dot2c_f32_bf16 v247, v80, v80
    v_dot2c_f32_bf16 v246, s40, v81
    v_dot2c_f32_bf16 v247, v81, v81
    v_dot2c_f32_bf16 v246, s40, v82
    v_dot2c_f32_bf16 v247, v82, v82
    v_dot2c_f32_bf16 v246, s40, v83
    v_dot2c_f32_bf16 v247, v83, v83
    v_dot2c_f32_bf16 v246, s40, v84
    v_dot2c_f32_bf16 v247, v84, v84
    v_dot2c_f32_bf16 v246, s40, v85
    v_dot2c_f32_bf16 v247, v85, v85
    v_dot2c_f32_bf16 v246, s40, v86
    v_dot2c_f32_bf16 v247, v86, v86
    v_dot2c_f32_bf16 v246, s40, v87
    v_dot2c_f32_bf16 v247, v87, v87
    v_add_u32 v14, 73728, v14
    v_add_u32 v15, 73728, v15
    s_barrier
    s_lshl_b32 s25, s98, 2
    s_add_u32 s25, s25, s4
    s_mul_i32 s25, s25, 110592
    s_add_u32 m0, s24, 0
    s_nop 0
    buffer_load_dwordx4 v4, s[12:15], s25 offen offset:0 lds
    buffer_load_dwordx4 v5, s[12:15], s25 offen offset:1024 lds
    v_mov_b32 v242, v246
    v_mov_b32 v243, v247
    s_nop 0
    v_permlane16_swap_b32 v242, v246
    v_permlane16_swap_b32 v243, v247
    v_add_f32 v246, v242, v246
    v_add_f32 v247, v243, v247
    v_mov_b32 v242, v246
    v_mov_b32 v243, v247
    s_nop 0
    v_permlane32_swap_b32 v242, v246
    v_permlane32_swap_b32 v243, v247
    v_add_f32 v246, v242, v246
    v_add_f32_e64 v247, v243, v247
    v_mul_f32 v246, 0x3ae38e39, v246
    v_mul_f32 v247, 0x3ae38e39, v247
    v_fma_f32 v247, -v246, v246, v247
    v_max_f32_e64 v247, 0, v247
    v_add_f32 v242, 0x3727c5ac, v247
    v_rsq_f32 v238, v242
    s_nop 0
    v_mul_f32 v239, -v246, v238
    v_lshlrev_b32 v242, 16, v16
    v_and_b32 v243, s41, v16
    v_lshlrev_b32 v244, 16, v17
    v_and_b32 v245, s41, v17
    v_pk_fma_f32 v[242:243], v[242:243], v[238:239], v[238:239] op_sel:[0,0,1] op_sel_hi:[1,0,1]
    v_pk_fma_f32 v[244:245], v[244:245], v[238:239], v[238:239] op_sel:[0,0,1] op_sel_hi:[1,0,1]
    v_cvt_pk_bf16_f32 v16, v242, v243
    v_cvt_pk_bf16_f32 v17, v244, v245
    v_lshlrev_b32 v242, 16, v18
    v_and_b32 v243, s41, v18
    v_lshlrev_b32 v244, 16, v19
    v_and_b32 v245, s41, v19
    v_pk_fma_f32 v[242:243], v[242:243], v[238:239], v[238:239] op_sel:[0,0,1] op_sel_hi:[1,0,1]
    v_pk_fma_f32 v[244:245], v[244:245], v[238:239], v[238:239] op_sel:[0,0,1] op_sel_hi:[1,0,1]
    v_cvt_pk_bf16_f32 v18, v242, v243
    v_cvt_pk_bf16_f32 v19, v244, v245
    v_lshlrev_b32 v242, 16, v20
    v_and_b32 v243, s41, v20
    v_lshlrev_b32 v244, 16, v21
    v_and_b32 v245, s41, v21
    v_pk_fma_f32 v[242:243], v[242:243], v[238:239], v[238:239] op_sel:[0,0,1] op_sel_hi:[1,0,1]
    v_pk_fma_f32 v[244:245], v[244:245], v[238:239], v[238:239] op_sel:[0,0,1] op_sel_hi:[1,0,1]
    v_cvt_pk_bf16_f32 v20, v242, v243
    v_cvt_pk_bf16_f32 v21, v244, v245
    v_lshlrev_b32 v242, 16, v22
    v_and_b32 v243, s41, v22
    v_lshlrev_b32 v244, 16, v23
    v_and_b32 v245, s41, v23
    v_pk_fma_f32 v[242:243], v[242:243], v[238:239], v[238:239] op_sel:[0,0,1] op_sel_hi:[1,0,1]
    v_pk_fma_f32 v[244:245], v[244:245], v[238:239], v[238:239] op_sel:[0,0,1] op_sel_hi:[1,0,1]
    v_cvt_pk_bf16_f32 v22, v242, v243
    v_cvt_pk_bf16_f32 v23, v244, v245
    buffer_load_dwordx4 v6, s[12:15], s25 offen offset:2048 lds
    buffer_load_dwordx4 v7, s[12:15], s25 offen offset:3072 lds
    v_lshlrev_b32 v242, 16, v24
    v_and_b32 v243, s41, v24
    v_lshlrev_b32 v244, 16, v25
    v_and_b32 v245, s41, v25
    v_pk_fma_f32 v[242:243], v[242:243], v[238:239], v[238:239] op_sel:[0,0,1] op_sel_hi:[1,0,1]
    v_pk_fma_f32 v[244:245], v[244:245], v[238:239], v[238:239] op_sel:[0,0,1] op_sel_hi:[1,0,1]
    v_cvt_pk_bf16_f32 v24, v242, v243
    v_cvt_pk_bf16_f32 v25, v244, v245
    v_lshlrev_b32 v242, 16, v26
    v_and_b32 v243, s41, v26
    v_lshlrev_b32 v244, 16, v27
    v_and_b32 v245, s41, v27
    v_pk_fma_f32 v[242:243], v[242:243], v[238:239], v[238:239] op_sel:[0,0,1] op_sel_hi:[1,0,1]
    v_pk_fma_f32 v[244:245], v[244:245], v[238:239], v[238:239] op_sel:[0,0,1] op_sel_hi:[1,0,1]
    v_cvt_pk_bf16_f32 v26, v242, v243
    v_cvt_pk_bf16_f32 v27, v244, v245
    v_lshlrev_b32 v242, 16, v28
    v_and_b32 v243, s41, v28
    v_lshlrev_b32 v244, 16, v29
    v_and_b32 v245, s41, v29
    v_pk_fma_f32 v[242:243], v[242:243], v[238:239], v[238:239] op_sel:[0,0,1] op_sel_hi:[1,0,1]
    v_pk_fma_f32 v[244:245], v[244:245], v[238:239], v[238:239] op_sel:[0,0,1] op_sel_hi:[1,0,1]
    v_cvt_pk_bf16_f32 v28, v242, v243
    v_cvt_pk_bf16_f32 v29, v244, v245
    v_lshlrev_b32 v242, 16, v30
    v_and_b32 v243, s41, v30
    v_lshlrev_b32 v244, 16, v31
    v_and_b32 v245, s41, v31
    v_pk_fma_f32 v[242:243], v[242:243], v[238:239], v[238:239] op_sel:[0,0,1] op_sel_hi:[1,0,1]
    v_pk_fma_f32 v[244:245], v[244:245], v[238:239], v[238:239] op_sel:[0,0,1] op_sel_hi:[1,0,1]
    v_cvt_pk_bf16_f32 v30, v242, v243
    v_cvt_pk_bf16_f32 v31, v244, v245
    v_lshlrev_b32 v242, 16, v32
    v_and_b32 v243, s41, v32
    v_lshlrev_b32 v244, 16, v33
    v_and_b32 v245, s41, v33
    v_pk_fma_f32 v[242:243], v[242:243], v[238:239], v[238:239] op_sel:[0,0,1] op_sel_hi:[1,0,1]
    v_pk_fma_f32 v[244:245], v[244:245], v[238:239], v[238:239] op_sel:[0,0,1] op_sel_hi:[1,0,1]
    v_cvt_pk_bf16_f32 v32, v242, v243
    v_cvt_pk_bf16_f32 v33, v244, v245
    v_lshlrev_b32 v242, 16, v34
    v_and_b32 v243, s41, v34
    v_lshlrev_b32 v244, 16, v35
    v_and_b32 v245, s41, v35
    v_pk_fma_f32 v[242:243], v[242:243], v[238:239], v[238:239] op_sel:[0,0,1] op_sel_hi:[1,0,1]
    v_pk_fma_f32 v[244:245], v[244:245], v[238:239], v[238:239] op_sel:[0,0,1] op_sel_hi:[1,0,1]
    v_cvt_pk_bf16_f32 v34, v242, v243
    v_cvt_pk_bf16_f32 v35, v244, v245
    s_add_u32 m0, s24, 4096
    s_nop 0
    buffer_load_dwordx4 v8, s[12:15], s25 offen offset:0 lds
    buffer_load_dwordx4 v9, s[12:15], s25 offen offset:1024 lds
    v_lshlrev_b32 v242, 16, v36
    v_and_b32 v243, s41, v36
    v_lshlrev_b32 v244, 16, v37
    v_and_b32_e64 v245, s41, v37
    v_pk_fma_f32 v[242:243], v[242:243], v[238:239], v[238:239] op_sel:[0,0,1] op_sel_hi:[1,0,1]
    v_pk_fma_f32 v[244:245], v[244:245], v[238:239], v[238:239] op_sel:[0,0,1] op_sel_hi:[1,0,1]
    v_cvt_pk_bf16_f32 v36, v242, v243
    v_cvt_pk_bf16_f32 v37, v244, v245
    v_lshlrev_b32 v242, 16, v38
    v_and_b32 v243, s41, v38
    v_lshlrev_b32 v244, 16, v39
    v_and_b32 v245, s41, v39
    v_pk_fma_f32 v[242:243], v[242:243], v[238:239], v[238:239] op_sel:[0,0,1] op_sel_hi:[1,0,1]
    v_pk_fma_f32 v[244:245], v[244:245], v[238:239], v[238:239] op_sel:[0,0,1] op_sel_hi:[1,0,1]
    v_cvt_pk_bf16_f32 v38, v242, v243
    v_cvt_pk_bf16_f32 v39, v244, v245
    v_lshlrev_b32 v242, 16, v40
    v_and_b32 v243, s41, v40
    v_lshlrev_b32 v244, 16, v41
    v_and_b32 v245, s41, v41
    v_pk_fma_f32 v[242:243], v[242:243], v[238:239], v[238:239] op_sel:[0,0,1] op_sel_hi:[1,0,1]
    v_pk_fma_f32 v[244:245], v[244:245], v[238:239], v[238:239] op_sel:[0,0,1] op_sel_hi:[1,0,1]
    v_cvt_pk_bf16_f32 v40, v242, v243
    v_cvt_pk_bf16_f32 v41, v244, v245
    v_lshlrev_b32 v242, 16, v42
    v_and_b32 v243, s41, v42
    v_lshlrev_b32 v244, 16, v43
    v_and_b32 v245, s41, v43
    v_pk_fma_f32 v[242:243], v[242:243], v[238:239], v[238:239] op_sel:[0,0,1] op_sel_hi:[1,0,1]
    v_pk_fma_f32 v[244:245], v[244:245], v[238:239], v[238:239] op_sel:[0,0,1] op_sel_hi:[1,0,1]
    v_cvt_pk_bf16_f32 v42, v242, v243
    v_cvt_pk_bf16_f32 v43, v244, v245
    v_lshlrev_b32 v242, 16, v44
    v_and_b32 v243, s41, v44
    v_lshlrev_b32 v244, 16, v45
    v_and_b32 v245, s41, v45
    v_pk_fma_f32 v[242:243], v[242:243], v[238:239], v[238:239] op_sel:[0,0,1] op_sel_hi:[1,0,1]
    v_pk_fma_f32 v[244:245], v[244:245], v[238:239], v[238:239] op_sel:[0,0,1] op_sel_hi:[1,0,1]
    v_cvt_pk_bf16_f32 v44, v242, v243
    v_cvt_pk_bf16_f32 v45, v244, v245
    v_lshlrev_b32 v242, 16, v46
    v_and_b32 v243, s41, v46
    v_lshlrev_b32 v244, 16, v47
    v_and_b32 v245, s41, v47
    v_pk_fma_f32 v[242:243], v[242:243], v[238:239], v[238:239] op_sel:[0,0,1] op_sel_hi:[1,0,1]
    v_pk_fma_f32 v[244:245], v[244:245], v[238:239], v[238:239] op_sel:[0,0,1] op_sel_hi:[1,0,1]
    v_cvt_pk_bf16_f32 v46, v242, v243
    v_cvt_pk_bf16_f32 v47, v244, v245
    buffer_load_dwordx4 v10, s[12:15], s25 offen offset:2048 lds
    buffer_load_dwordx4 v11, s[12:15], s25 offen offset:3072 lds
    s_add_u32 m0, s24, 8192
    s_nop 0
    buffer_load_dwordx4 v12, s[12:15], s25 offen offset:0 lds
    v_lshlrev_b32 v242, 16, v48
    v_and_b32 v243, s41, v48
    v_lshlrev_b32 v244, 16, v49
    v_and_b32_e64 v245, s41, v49
    v_pk_fma_f32 v[242:243], v[242:243], v[238:239], v[238:239] op_sel:[0,0,1] op_sel_hi:[1,0,1]
    v_pk_fma_f32 v[244:245], v[244:245], v[238:239], v[238:239] op_sel:[0,0,1] op_sel_hi:[1,0,1]
    v_cvt_pk_bf16_f32 v48, v242, v243
    v_cvt_pk_bf16_f32 v49, v244, v245
    v_lshlrev_b32 v242, 16, v50
    v_and_b32 v243, s41, v50
    v_lshlrev_b32 v244, 16, v51
    v_and_b32 v245, s41, v51
    v_pk_fma_f32 v[242:243], v[242:243], v[238:239], v[238:239] op_sel:[0,0,1] op_sel_hi:[1,0,1]
    v_pk_fma_f32 v[244:245], v[244:245], v[238:239], v[238:239] op_sel:[0,0,1] op_sel_hi:[1,0,1]
    v_cvt_pk_bf16_f32 v50, v242, v243
    v_cvt_pk_bf16_f32 v51, v244, v245
    v_lshlrev_b32 v242, 16, v52
    v_and_b32 v243, s41, v52
    v_lshlrev_b32 v244, 16, v53
    v_and_b32 v245, s41, v53
    v_pk_fma_f32 v[242:243], v[242:243], v[238:239], v[238:239] op_sel:[0,0,1] op_sel_hi:[1,0,1]
    v_pk_fma_f32 v[244:245], v[244:245], v[238:239], v[238:239] op_sel:[0,0,1] op_sel_hi:[1,0,1]
    v_cvt_pk_bf16_f32 v52, v242, v243
    v_cvt_pk_bf16_f32 v53, v244, v245
    v_lshlrev_b32 v242, 16, v54
    v_and_b32 v243, s41, v54
    v_lshlrev_b32 v244, 16, v55
    v_and_b32 v245, s41, v55
    v_pk_fma_f32 v[242:243], v[242:243], v[238:239], v[238:239] op_sel:[0,0,1] op_sel_hi:[1,0,1]
    v_pk_fma_f32 v[244:245], v[244:245], v[238:239], v[238:239] op_sel:[0,0,1] op_sel_hi:[1,0,1]
    v_cvt_pk_bf16_f32 v54, v242, v243
    v_cvt_pk_bf16_f32 v55, v244, v245
    v_lshlrev_b32 v242, 16, v56
    v_and_b32 v243, s41, v56
    v_lshlrev_b32 v244, 16, v57
    v_and_b32 v245, s41, v57
    v_pk_fma_f32 v[242:243], v[242:243], v[238:239], v[238:239] op_sel:[0,0,1] op_sel_hi:[1,0,1]
    v_pk_fma_f32 v[244:245], v[244:245], v[238:239], v[238:239] op_sel:[0,0,1] op_sel_hi:[1,0,1]
    v_cvt_pk_bf16_f32 v56, v242, v243
    v_cvt_pk_bf16_f32 v57, v244, v245
    v_lshlrev_b32 v242, 16, v58
    v_and_b32 v243, s41, v58
    v_lshlrev_b32 v244, 16, v59
    v_and_b32 v245, s41, v59
    v_pk_fma_f32 v[242:243], v[242:243], v[238:239], v[238:239] op_sel:[0,0,1] op_sel_hi:[1,0,1]
    v_pk_fma_f32 v[244:245], v[244:245], v[238:239], v[238:239] op_sel:[0,0,1] op_sel_hi:[1,0,1]
Lpad0_0:
    s_cbranch_execz Lpad0_4
    v_cvt_pk_bf16_f32 v58, v242, v243
    v_cvt_pk_bf16_f32 v59, v244, v245
    v_lshlrev_b32 v242, 16, v60
    v_and_b32 v243, s41, v60
    v_lshlrev_b32 v244, 16, v61
    v_and_b32_e64 v245, s41, v61
    v_pk_fma_f32 v[242:243], v[242:243], v[238:239], v[238:239] op_sel:[0,0,1] op_sel_hi:[1,0,1]
    v_pk_fma_f32 v[244:245], v[244:245], v[238:239], v[238:239] op_sel:[0,0,1] op_sel_hi:[1,0,1]
    v_cvt_pk_bf16_f32 v60, v242, v243
    v_cvt_pk_bf16_f32 v61, v244, v245
    v_lshlrev_b32 v242, 16, v62
    v_and_b32 v243, s41, v62
    v_lshlrev_b32 v244, 16, v63
    v_and_b32 v245, s41, v63
    v_pk_fma_f32 v[242:243], v[242:243], v[238:239], v[238:239] op_sel:[0,0,1] op_sel_hi:[1,0,1]
    v_pk_fma_f32 v[244:245], v[244:245], v[238:239], v[238:239] op_sel:[0,0,1] op_sel_hi:[1,0,1]
    v_cvt_pk_bf16_f32 v62, v242, v243
    v_cvt_pk_bf16_f32 v63, v244, v245
    v_mov_b32 v246, 0
    v_mov_b32 v247, 0
    s_waitcnt vmcnt(25)
    ds_read_b128 v[88:91], v14 offset:0
    ds_read_b128 v[92:95], v15 offset:0
    s_waitcnt vmcnt(23)
    ds_read_b128 v[96:99], v14 offset:2048
    ds_read_b128 v[100:103], v15 offset:2048
    s_waitcnt lgkmcnt(2)
    v_dot2c_f32_bf16 v246, s40, v88
    v_dot2c_f32_bf16 v247, v88, v88
    v_dot2c_f32_bf16 v246, s40, v89
    v_dot2c_f32_bf16 v247, v89, v89
    v_dot2c_f32_bf16 v246, s40, v90
    v_dot2c_f32_bf16 v247, v90, v90
    v_dot2c_f32_bf16 v246, s40, v91
    v_dot2c_f32_bf16 v247, v91, v91
    v_dot2c_f32_bf16 v246, s40, v92
    v_dot2c_f32_bf16 v247, v92, v92
    v_dot2c_f32_bf16 v246, s40, v93
    v_dot2c_f32_bf16 v247, v93, v93
    v_dot2c_f32_bf16 v246, s40, v94
    v_dot2c_f32_bf16 v247, v94, v94
    v_dot2c_f32_bf16 v246, s40, v95
    v_dot2c_f32_bf16 v247, v95, v95
    s_waitcnt vmcnt(21)
    ds_read_b128 v[104:107], v14 offset:4096
    ds_read_b128 v[108:111], v15 offset:4096
    s_waitcnt lgkmcnt(2)
    v_dot2c_f32_bf16 v246, s40, v96
    v_dot2c_f32_bf16 v247, v96, v96
    v_dot2c_f32_bf16 v246, s40, v97
    v_dot2c_f32_bf16 v247, v97, v97
    v_dot2c_f32_bf16 v246, s40, v98
    v_dot2c_f32_bf16 v247, v98, v98
    v_dot2c_f32_bf16 v246, s40, v99
    v_dot2c_f32_bf16 v247, v99, v99
    v_dot2c_f32_bf16 v246, s40, v100
    v_dot2c_f32_bf16 v247, v100, v100
    v_dot2c_f32_bf16 v246, s40, v101
    v_dot2c_f32_bf16 v247, v101, v101
    v_dot2c_f32_bf16 v246, s40, v102
    v_dot2c_f32_bf16 v247, v102, v102
    v_dot2c_f32_bf16 v246, s40, v103
    v_dot2c_f32_bf16 v247, v103, v103
    s_waitcnt vmcnt(19)
    ds_read_b128 v[112:115], v14 offset:6144
    ds_read_b128 v[116:119], v15 offset:6144
    s_waitcnt lgkmcnt(2)
    v_dot2c_f32_bf16 v246, s40, v104
    v_dot2c_f32_bf16 v247, v104, v104
    v_dot2c_f32_bf16 v246, s40, v105
    v_dot2c_f32_bf16 v247, v105, v105
    v_dot2c_f32_bf16 v246, s40, v106
    v_dot2c_f32_bf16 v247, v106, v106
    v_dot2c_f32_bf16 v246, s40, v107
    v_dot2c_f32_bf16 v247, v107, v107
    v_dot2c_f32_bf16 v246, s40, v108
    v_dot2c_f32_bf16 v247, v108, v108
    v_dot2c_f32_bf16 v246, s40, v109
    v_dot2c_f32_bf16 v247, v109, v109
    v_dot2c_f32_bf16 v246, s40, v110
    v_dot2c_f32_bf16 v247, v110, v110
    v_dot2c_f32_bf16 v246, s40, v111
    v_dot2c_f32_bf16 v247, v111, v111
    s_waitcnt vmcnt(17)
    ds_read_b128 v[120:123], v14 offset:8192
    ds_read_b128 v[124:127], v15 offset:8192
    s_waitcnt lgkmcnt(2)
    v_dot2c_f32_bf16 v246, s40, v112
    v_dot2c_f32_bf16 v247, v112, v112
    v_dot2c_f32_bf16 v246, s40, v113
    v_dot2c_f32_bf16 v247, v113, v113
    v_dot2c_f32_bf16 v246, s40, v114
    v_dot2c_f32_bf16 v247, v114, v114
    v_dot2c_f32_bf16 v246, s40, v115
    v_dot2c_f32_bf16 v247, v115, v115
    v_dot2c_f32_bf16 v246, s40, v116
    v_dot2c_f32_bf16 v247, v116, v116
    v_dot2c_f32_bf16 v246, s40, v117
    v_dot2c_f32_bf16 v247, v117, v117
    v_dot2c_f32_bf16 v246, s40, v118
    v_dot2c_f32_bf16 v247, v118, v118
    v_dot2c_f32_bf16 v246, s40, v119
    v_dot2c_f32_bf16 v247, v119, v119
    s_waitcnt vmcnt(15)
    ds_read_b128 v[128:131], v14 offset:10240
    ds_read_b128 v[132:135], v15 offset:10240
    s_waitcnt lgkmcnt(2)
    v_dot2c_f32_bf16 v246, s40, v120
    v_dot2c_f32_bf16 v247, v120, v120
    v_dot2c_f32_bf16 v246, s40, v121
    v_dot2c_f32_bf16 v247, v121, v121
    v_dot2c_f32_bf16 v246, s40, v122
    v_dot2c_f32_bf16 v247, v122, v122
    v_dot2c_f32_bf16 v246, s40, v123
    v_dot2c_f32_bf16 v247, v123, v123
    v_dot2c_f32_bf16 v246, s40, v124
    v_dot2c_f32_bf16 v247, v124, v124
    v_dot2c_f32_bf16 v246, s40, v125
    v_dot2c_f32_bf16 v247, v125, v125
    v_dot2c_f32_bf16 v246, s40, v126
    v_dot2c_f32_bf16 v247, v126, v126
    v_dot2c_f32_bf16 v246, s40, v127
    v_dot2c_f32_bf16 v247, v127, v127
    s_waitcnt vmcnt(13)
    ds_read_b128 v[136:139], v14 offset:12288
    ds_read_b128 v[140:143], v15 offset:12288
    s_waitcnt lgkmcnt(2)
    v_dot2c_f32_bf16 v246, s40, v128
    v_dot2c_f32_bf16 v247, v128, v128
    v_dot2c_f32_bf16 v246, s40, v129
    v_dot2c_f32_bf16 v247, v129, v129
    v_dot2c_f32_bf16 v246, s40, v130
    v_dot2c_f32_bf16 v247, v130, v130
    v_dot2c_f32_bf16 v246, s40, v131
    v_dot2c_f32_bf16 v247, v131, v131
    v_dot2c_f32_bf16 v246, s40, v132
    v_dot2c_f32_bf16 v247, v132, v132
    v_dot2c_f32_bf16 v246, s40, v133
    v_dot2c_f32_bf16 v247, v133, v133
    v_dot2c_f32_bf16 v246, s40, v134
    v_dot2c_f32_bf16 v247, v134, v134
    v_dot2c_f32_bf16 v246, s40, v135
    v_dot2c_f32_bf16 v247, v135, v135
    s_waitcnt vmcnt(11)
    ds_read_b128 v[144:147], v14 offset:14336
    ds_read_b128 v[148:151], v15 offset:14336
    s_waitcnt lgkmcnt(2)
    v_dot2c_f32_bf16 v246, s40, v136
    v_dot2c_f32_bf16 v247, v136, v136
    v_dot2c_f32_bf16 v246, s40, v137
    v_dot2c_f32_bf16 v247, v137, v137
    v_dot2c_f32_bf16 v246, s40, v138
    v_dot2c_f32_bf16 v247, v138, v138
    v_dot2c_f32_bf16 v246, s40, v139
    v_dot2c_f32_bf16 v247, v139, v139
    v_dot2c_f32_bf16 v246, s40, v140
    v_dot2c_f32_bf16 v247, v140, v140
    v_dot2c_f32_bf16 v246, s40, v141
    v_dot2c_f32_bf16 v247, v141, v141
    v_dot2c_f32_bf16 v246, s40, v142
    v_dot2c_f32_bf16 v247, v142, v142
    v_dot2c_f32_bf16 v246, s40, v143
    v_dot2c_f32_bf16 v247, v143, v143
    s_waitcnt vmcnt(9)
    ds_read_b128 v[152:155], v14 offset:16384
    ds_read_b128 v[156:159], v15 offset:16384
    s_waitcnt lgkmcnt(2)
    v_dot2c_f32_bf16 v246, s40, v144
    v_dot2c_f32_bf16 v247, v144, v144
    v_dot2c_f32_bf16 v246, s40, v145
    v_dot2c_f32_bf16 v247, v145, v145
    v_dot2c_f32_bf16 v246, s40, v146
    v_dot2c_f32_bf16 v247, v146, v146
    v_dot2c_f32_bf16 v246, s40, v147
    v_dot2c_f32_bf16 v247, v147, v147
    v_dot2c_f32_bf16 v246, s40, v148
    v_dot2c_f32_bf16 v247, v148, v148
    v_dot2c_f32_bf16 v246, s40, v149
    v_dot2c_f32_bf16 v247, v149, v149
    v_dot2c_f32_bf16 v246, s40, v150
    v_dot2c_f32_bf16 v247, v150, v150
    v_dot2c_f32_bf16 v246, s40, v151
    v_dot2c_f32_bf16 v247, v151, v151
    s_waitcnt lgkmcnt(0)
    v_dot2c_f32_bf16 v246, s40, v152
    v_dot2c_f32_bf16 v247, v152, v152
    v_dot2c_f32_bf16 v246, s40, v153
    v_dot2c_f32_bf16 v247, v153, v153
    v_dot2c_f32_bf16 v246, s40, v154
    v_dot2c_f32_bf16 v247, v154, v154
    v_dot2c_f32_bf16 v246, s40, v155
    v_dot2c_f32_bf16 v247, v155, v155
    v_dot2c_f32_bf16 v246, s40, v156
    v_dot2c_f32_bf16 v247, v156, v156
    v_dot2c_f32_bf16 v246, s40, v157
    v_dot2c_f32_bf16 v247, v157, v157
    v_dot2c_f32_bf16 v246, s40, v158
    v_dot2c_f32_bf16 v247, v158, v158
    v_dot2c_f32_bf16 v246, s40, v159
    v_dot2c_f32_bf16 v247, v159, v159
    s_lshl_b32 s25, s99, 2
    s_add_u32 s25, s25, s4
    s_mul_i32 s25, s25, 110592
    s_add_u32 m0, s24, 36864
    s_nop 0
    buffer_load_dwordx4 v4, s[12:15], s25 offen offset:0 lds
    buffer_load_dwordx4 v5, s[12:15], s25 offen offset:1024 lds
    buffer_load_dwordx4 v6, s[12:15], s25 offen offset:2048 lds
    v_mov_b32 v242, v246
    v_mov_b32 v243, v247
    s_nop 0
    v_permlane16_swap_b32 v242, v246
    v_permlane16_swap_b32 v243, v247
    v_add_f32 v246, v242, v246
    v_add_f32 v247, v243, v247
    v_mov_b32 v242, v246
    v_mov_b32 v243, v247
    s_nop 0
    v_permlane32_swap_b32 v242, v246
    v_permlane32_swap_b32 v243, v247
    v_add_f32 v246, v242, v246
    v_add_f32 v247, v243, v247
    v_mul_f32 v246, 0x3ae38e39, v246
    v_mul_f32 v247, 0x3ae38e39, v247
    v_fma_f32 v247, -v246, v246, v247
    v_max_f32 v247, 0, v247
    v_add_f32 v242, 0x3727c5ac, v247
    v_rsq_f32 v240, v242
    s_nop 0
    v_mul_f32 v241, -v246, v240
    v_lshrrev_b32 v246, 1, v3
    v_lshlrev_b32 v246, 2, v246
    v_and_b32 v247, 1, v3
    v_add_u32 v246, v246, v247
    v_bfe_u32 v247, v1, 2, 2
    v_lshl_add_u32 v246, v246, 2, v247
    v_mul_u32_u24 v246, 288, v246
    v_and_b32 v247, 3, v1
    v_lshl_add_u32 v13, v247, 3, v246
    v_add_u32 v14, 55296, v13
    v_add_u32 v15, 110592, v13
    v_lshlrev_b32 v246, 16, v88
    v_and_b32 v247, s41, v88
    v_lshlrev_b32 v248, 16, v89
    v_and_b32_e64 v249, s41, v89
    v_pk_fma_f32 v[246:247], v[246:247], v[240:241], v[240:241] op_sel:[0,0,1] op_sel_hi:[1,0,1]
    v_pk_fma_f32 v[248:249], v[248:249], v[240:241], v[240:241] op_sel:[0,0,1] op_sel_hi:[1,0,1]
    v_cvt_pk_bf16_f32 v88, v246, v247
    v_cvt_pk_bf16_f32 v89, v248, v249
    v_lshlrev_b32 v246, 16, v90
    v_and_b32 v247, s41, v90
    v_lshlrev_b32 v248, 16, v91
    v_and_b32 v249, s41, v91
    v_pk_fma_f32 v[246:247], v[246:247], v[240:241], v[240:241] op_sel:[0,0,1] op_sel_hi:[1,0,1]
    v_pk_fma_f32 v[248:249], v[248:249], v[240:241], v[240:241] op_sel:[0,0,1] op_sel_hi:[1,0,1]
    v_cvt_pk_bf16_f32 v90, v246, v247
    v_cvt_pk_bf16_f32 v91, v248, v249
    v_lshlrev_b32 v246, 16, v92
    v_and_b32 v247, s41, v92
    v_lshlrev_b32 v248, 16, v93
    v_and_b32 v249, s41, v93
    v_pk_fma_f32 v[246:247], v[246:247], v[240:241], v[240:241] op_sel:[0,0,1] op_sel_hi:[1,0,1]
    v_pk_fma_f32 v[248:249], v[248:249], v[240:241], v[240:241] op_sel:[0,0,1] op_sel_hi:[1,0,1]
    v_cvt_pk_bf16_f32 v92, v246, v247
    v_cvt_pk_bf16_f32 v93, v248, v249
    v_lshlrev_b32 v246, 16, v94
    v_and_b32 v247, s41, v94
    v_lshlrev_b32 v248, 16, v95
    v_and_b32 v249, s41, v95
    v_pk_fma_f32 v[246:247], v[246:247], v[240:241], v[240:241] op_sel:[0,0,1] op_sel_hi:[1,0,1]
    v_pk_fma_f32 v[248:249], v[248:249], v[240:241], v[240:241] op_sel:[0,0,1] op_sel_hi:[1,0,1]
    v_cvt_pk_bf16_f32 v94, v246, v247
    v_cvt_pk_bf16_f32 v95, v248, v249
    v_lshlrev_b32 v246, 16, v96
    v_and_b32 v247, s41, v96
    v_lshlrev_b32 v248, 16, v97
    v_and_b32 v249, s41, v97
    v_pk_fma_f32 v[246:247], v[246:247], v[240:241], v[240:241] op_sel:[0,0,1] op_sel_hi:[1,0,1]
    v_pk_fma_f32 v[248:249], v[248:249], v[240:241], v[240:241] op_sel:[0,0,1] op_sel_hi:[1,0,1]
    v_cvt_pk_bf16_f32 v96, v246, v247
    v_cvt_pk_bf16_f32 v97, v248, v249
    v_lshlrev_b32 v246, 16, v98
    v_and_b32 v247, s41, v98
    v_lshlrev_b32 v248, 16, v99
    v_and_b32 v249, s41, v99
    v_pk_fma_f32 v[246:247], v[246:247], v[240:241], v[240:241] op_sel:[0,0,1] op_sel_hi:[1,0,1]
    v_pk_fma_f32 v[248:249], v[248:249], v[240:241], v[240:241] op_sel:[0,0,1] op_sel_hi:[1,0,1]
    v_cvt_pk_bf16_f32 v98, v246, v247
    v_cvt_pk_bf16_f32 v99, v248, v249
    v_lshlrev_b32 v246, 16, v100
    v_and_b32 v247, s41, v100
    v_lshlrev_b32 v248, 16, v101
    v_and_b32 v249, s41, v101
    v_pk_fma_f32 v[246:247], v[246:247], v[240:241], v[240:241] op_sel:[0,0,1] op_sel_hi:[1,0,1]
    v_pk_fma_f32 v[248:249], v[248:249], v[240:241], v[240:241] op_sel:[0,0,1] op_sel_hi:[1,0,1]
    v_cvt_pk_bf16_f32 v100, v246, v247
    v_cvt_pk_bf16_f32 v101, v248, v249
    v_lshlrev_b32 v246, 16, v102
    v_and_b32 v247, s41, v102
    v_lshlrev_b32 v248, 16, v103
    v_and_b32 v249, s41, v103
    v_pk_fma_f32 v[246:247], v[246:247], v[240:241], v[240:241] op_sel:[0,0,1] op_sel_hi:[1,0,1]
    v_pk_fma_f32 v[248:249], v[248:249], v[240:241], v[240:241] op_sel:[0,0,1] op_sel_hi:[1,0,1]
    v_cvt_pk_bf16_f32 v102, v246, v247
    v_cvt_pk_bf16_f32 v103, v248, v249
    buffer_load_dwordx4 v7, s[12:15], s25 offen offset:3072 lds
    s_add_u32 m0, s24, 40960
    s_nop 0
    buffer_load_dwordx4 v8, s[12:15], s25 offen offset:0 lds
    buffer_load_dwordx4 v9, s[12:15], s25 offen offset:1024 lds
    v_lshlrev_b32 v246, 16, v104
    v_and_b32 v247, s41, v104
    v_lshlrev_b32 v248, 16, v105
    v_and_b32_e64 v249, s41, v105
    v_pk_fma_f32 v[246:247], v[246:247], v[240:241], v[240:241] op_sel:[0,0,1] op_sel_hi:[1,0,1]
    v_pk_fma_f32 v[248:249], v[248:249], v[240:241], v[240:241] op_sel:[0,0,1] op_sel_hi:[1,0,1]
    v_cvt_pk_bf16_f32 v104, v246, v247
    v_cvt_pk_bf16_f32 v105, v248, v249
    v_lshlrev_b32 v246, 16, v106
    v_and_b32 v247, s41, v106
    v_lshlrev_b32 v248, 16, v107
    v_and_b32 v249, s41, v107
    v_pk_fma_f32 v[246:247], v[246:247], v[240:241], v[240:241] op_sel:[0,0,1] op_sel_hi:[1,0,1]
    v_pk_fma_f32 v[248:249], v[248:249], v[240:241], v[240:241] op_sel:[0,0,1] op_sel_hi:[1,0,1]
    v_cvt_pk_bf16_f32 v106, v246, v247
    v_cvt_pk_bf16_f32 v107, v248, v249
    v_lshlrev_b32 v246, 16, v108
    v_and_b32 v247, s41, v108
    v_lshlrev_b32 v248, 16, v109
    v_and_b32 v249, s41, v109
    v_pk_fma_f32 v[246:247], v[246:247], v[240:241], v[240:241] op_sel:[0,0,1] op_sel_hi:[1,0,1]
    v_pk_fma_f32 v[248:249], v[248:249], v[240:241], v[240:241] op_sel:[0,0,1] op_sel_hi:[1,0,1]
    v_cvt_pk_bf16_f32 v108, v246, v247
    v_cvt_pk_bf16_f32 v109, v248, v249
    v_lshlrev_b32 v246, 16, v110
    v_and_b32 v247, s41, v110
    v_lshlrev_b32 v248, 16, v111
    v_and_b32 v249, s41, v111
    v_pk_fma_f32 v[246:247], v[246:247], v[240:241], v[240:241] op_sel:[0,0,1] op_sel_hi:[1,0,1]
    v_pk_fma_f32 v[248:249], v[248:249], v[240:241], v[240:241] op_sel:[0,0,1] op_sel_hi:[1,0,1]
    v_cvt_pk_bf16_f32 v110, v246, v247
    v_cvt_pk_bf16_f32 v111, v248, v249
    v_lshlrev_b32 v246, 16, v112
    v_and_b32 v247, s41, v112
    v_lshlrev_b32 v248, 16, v113
    v_and_b32 v249, s41, v113
    v_pk_fma_f32 v[246:247], v[246:247], v[240:241], v[240:241] op_sel:[0,0,1] op_sel_hi:[1,0,1]
    v_pk_fma_f32 v[248:249], v[248:249], v[240:241], v[240:241] op_sel:[0,0,1] op_sel_hi:[1,0,1]
    v_cvt_pk_bf16_f32 v112, v246, v247
    v_cvt_pk_bf16_f32 v113, v248, v249
    v_lshlrev_b32 v246, 16, v114
    v_and_b32 v247, s41, v114
    v_lshlrev_b32 v248, 16, v115
    v_and_b32 v249, s41, v115
    v_pk_fma_f32 v[246:247], v[246:247], v[240:241], v[240:241] op_sel:[0,0,1] op_sel_hi:[1,0,1]
    v_pk_fma_f32 v[248:249], v[248:249], v[240:241], v[240:241] op_sel:[0,0,1] op_sel_hi:[1,0,1]
    v_cvt_pk_bf16_f32 v114, v246, v247
    v_cvt_pk_bf16_f32 v115, v248, v249
    v_lshlrev_b32 v246, 16, v116
    v_and_b32 v247, s41, v116
    v_lshlrev_b32 v248, 16, v117
    v_and_b32 v249, s41, v117
    v_pk_fma_f32 v[246:247], v[246:247], v[240:241], v[240:241] op_sel:[0,0,1] op_sel_hi:[1,0,1]
    v_pk_fma_f32 v[248:249], v[248:249], v[240:241], v[240:241] op_sel:[0,0,1] op_sel_hi:[1,0,1]
    v_cvt_pk_bf16_f32 v116, v246, v247
    v_cvt_pk_bf16_f32 v117, v248, v249
    v_lshlrev_b32 v246, 16, v118
    v_and_b32 v247, s41, v118
    v_lshlrev_b32 v248, 16, v119
    v_and_b32 v249, s41, v119
    v_pk_fma_f32 v[246:247], v[246:247], v[240:241], v[240:241] op_sel:[0,0,1] op_sel_hi:[1,0,1]
    v_pk_fma_f32 v[248:249], v[248:249], v[240:241], v[240:241] op_sel:[0,0,1] op_sel_hi:[1,0,1]
    v_cvt_pk_bf16_f32 v118, v246, v247
    v_cvt_pk_bf16_f32 v119, v248, v249
    v_lshlrev_b32 v246, 16, v120
    v_and_b32 v247, s41, v120
    v_lshlrev_b32 v248, 16, v121
    v_and_b32 v249, s41, v121
    v_pk_fma_f32 v[246:247], v[246:247], v[240:241], v[240:241] op_sel:[0,0,1] op_sel_hi:[1,0,1]
    v_pk_fma_f32 v[248:249], v[248:249], v[240:241], v[240:241] op_sel:[0,0,1] op_sel_hi:[1,0,1]
    v_cvt_pk_bf16_f32 v120, v246, v247
    v_cvt_pk_bf16_f32 v121, v248, v249
    v_lshlrev_b32 v246, 16, v122
    v_and_b32 v247, s41, v122
    v_lshlrev_b32 v248, 16, v123
    v_and_b32 v249, s41, v123
    v_pk_fma_f32 v[246:247], v[246:247], v[240:241], v[240:241] op_sel:[0,0,1] op_sel_hi:[1,0,1]
    v_pk_fma_f32 v[248:249], v[248:249], v[240:241], v[240:241] op_sel:[0,0,1] op_sel_hi:[1,0,1]
    v_cvt_pk_bf16_f32 v122, v246, v247
    v_cvt_pk_bf16_f32 v123, v248, v249
    buffer_load_dwordx4 v10, s[12:15], s25 offen offset:2048 lds
    buffer_load_dwordx4 v11, s[12:15], s25 offen offset:3072 lds
    s_add_u32 m0, s24, 45056
    s_nop 0
    buffer_load_dwordx4 v12, s[12:15], s25 offen offset:0 lds
    v_lshlrev_b32 v246, 16, v124
    v_and_b32 v247, s41, v124
    v_lshlrev_b32 v248, 16, v125
    v_and_b32_e64 v249, s41, v125
    v_pk_fma_f32 v[246:247], v[246:247], v[240:241], v[240:241] op_sel:[0,0,1] op_sel_hi:[1,0,1]
    v_pk_fma_f32 v[248:249], v[248:249], v[240:241], v[240:241] op_sel:[0,0,1] op_sel_hi:[1,0,1]
    v_cvt_pk_bf16_f32 v124, v246, v247
    v_cvt_pk_bf16_f32 v125, v248, v249
    v_lshlrev_b32 v246, 16, v126
    v_and_b32 v247, s41, v126
    v_lshlrev_b32 v248, 16, v127
    v_and_b32 v249, s41, v127
    v_pk_fma_f32 v[246:247], v[246:247], v[240:241], v[240:241] op_sel:[0,0,1] op_sel_hi:[1,0,1]
    v_pk_fma_f32 v[248:249], v[248:249], v[240:241], v[240:241] op_sel:[0,0,1] op_sel_hi:[1,0,1]
    v_cvt_pk_bf16_f32 v126, v246, v247
    v_cvt_pk_bf16_f32 v127, v248, v249
    v_lshlrev_b32 v246, 16, v128
    v_and_b32 v247, s41, v128
    v_lshlrev_b32 v248, 16, v129
    v_and_b32 v249, s41, v129
    v_pk_fma_f32 v[246:247], v[246:247], v[240:241], v[240:241] op_sel:[0,0,1] op_sel_hi:[1,0,1]
    v_pk_fma_f32 v[248:249], v[248:249], v[240:241], v[240:241] op_sel:[0,0,1] op_sel_hi:[1,0,1]
    v_cvt_pk_bf16_f32 v128, v246, v247
    v_cvt_pk_bf16_f32 v129, v248, v249
    v_lshlrev_b32 v246, 16, v130
    v_and_b32 v247, s41, v130
    v_lshlrev_b32 v248, 16, v131
    v_and_b32 v249, s41, v131
    v_pk_fma_f32 v[246:247], v[246:247], v[240:241], v[240:241] op_sel:[0,0,1] op_sel_hi:[1,0,1]
    v_pk_fma_f32 v[248:249], v[248:249], v[240:241], v[240:241] op_sel:[0,0,1] op_sel_hi:[1,0,1]
    v_cvt_pk_bf16_f32 v130, v246, v247
    v_cvt_pk_bf16_f32 v131, v248, v249
    v_lshlrev_b32 v246, 16, v132
    v_and_b32 v247, s41, v132
    v_lshlrev_b32 v248, 16, v133
    v_and_b32 v249, s41, v133
    v_pk_fma_f32 v[246:247], v[246:247], v[240:241], v[240:241] op_sel:[0,0,1] op_sel_hi:[1,0,1]
    v_pk_fma_f32 v[248:249], v[248:249], v[240:241], v[240:241] op_sel:[0,0,1] op_sel_hi:[1,0,1]
    v_cvt_pk_bf16_f32 v132, v246, v247
    v_cvt_pk_bf16_f32 v133, v248, v249
    v_lshlrev_b32 v246, 16, v134
    v_and_b32 v247, s41, v134
    v_lshlrev_b32 v248, 16, v135
    v_and_b32 v249, s41, v135
    v_pk_fma_f32 v[246:247], v[246:247], v[240:241], v[240:241] op_sel:[0,0,1] op_sel_hi:[1,0,1]
    v_pk_fma_f32 v[248:249], v[248:249], v[240:241], v[240:241] op_sel:[0,0,1] op_sel_hi:[1,0,1]
    v_cvt_pk_bf16_f32 v134, v246, v247
    v_cvt_pk_bf16_f32 v135, v248, v249
    s_waitcnt vmcnt(9)
    s_barrier
    ds_read_b64_tr_b16 a[64:65], v13 offset:0
    ds_read_b64_tr_b16 a[66:67], v13 offset:2304
    ds_read_b64_tr_b16 a[68:69], v13 offset:9216
    ds_read_b64_tr_b16 a[70:71], v13 offset:11520
    ds_read_b64_tr_b16 a[72:73], v13 offset:32
    ds_read_b64_tr_b16 a[74:75], v13 offset:2336
    ds_read_b64_tr_b16 a[76:77], v13 offset:9248
    ds_read_b64_tr_b16 a[78:79], v13 offset:11552
    ds_read_b64_tr_b16 a[80:81], v13 offset:64
    ds_read_b64_tr_b16 a[82:83], v13 offset:2368
    ds_read_b64_tr_b16 a[84:85], v13 offset:9280
    ds_read_b64_tr_b16 a[86:87], v13 offset:11584
    s_waitcnt lgkmcnt(10)
    v_mfma_f32_16x16x32_bf16 v[160:163], a[64:67], v[16:19], 0
    s_lshl_b32 s25, s100, 2
    ds_read_b64_tr_b16 a[88:89], v13 offset:96
    v_lshlrev_b32 v242, 16, v64
    v_mfma_f32_16x16x32_bf16 v[164:167], a[64:67], v[88:91], 0
    s_waitcnt lgkmcnt(9)
    ds_read_b64_tr_b16 a[90:91], v13 offset:2400
    v_and_b32 v243, s41, v64
    v_mfma_f32_16x16x32_bf16 v[164:167], a[68:71], v[92:95], v[164:167]
    s_add_u32 s25, s25, s4
    ds_read_b64_tr_b16 a[92:93], v13 offset:9312
    v_lshlrev_b32 v244, 16, v65
    v_mfma_f32_16x16x32_bf16 v[160:163], a[68:71], v[20:23], v[160:163]
    s_waitcnt lgkmcnt(9)
    ds_read_b64_tr_b16 a[94:95], v13 offset:11616
    v_and_b32_e64 v245, s41, v65
    v_mfma_f32_16x16x32_bf16 v[168:171], a[72:75], v[16:19], 0
    s_mul_i32 s25, s25, 110592
    s_mov_b32 s20, s60
    ds_read_b64_tr_b16 a[64:65], v13 offset:128
    v_mfma_f32_16x16x32_bf16 v[172:175], a[72:75], v[88:91], 0
    s_waitcnt lgkmcnt(9)
    s_and_b32 s21, s61, 0xffff
    ds_read_b64_tr_b16 a[66:67], v13 offset:2432
    v_mfma_f32_16x16x32_bf16 v[172:175], a[76:79], v[92:95], v[172:175]
    s_add_u32 m0, s24, 73728
    s_mov_b32 s22, 5308416
    ds_read_b64_tr_b16 a[68:69], v13 offset:9344
    v_fma_f32 v242, v242, v238, v239
    v_fma_f32 v243, v243, v238, v239
    v_mfma_f32_16x16x32_bf16 v[168:171], a[76:79], v[20:23], v[168:171]
    s_waitcnt lgkmcnt(9)
    s_mov_b32 s23, 0x20000
    ds_read_b64_tr_b16 a[70:71], v13 offset:11648
    v_mfma_f32_16x16x32_bf16 v[176:179], a[80:83], v[16:19], 0
    s_lshl_b32 s28, s46, 2
    ds_read_b64_tr_b16 a[72:73], v13 offset:160
    buffer_load_dwordx4 v4, s[12:15], s25 offen offset:0 lds
    v_fma_f32 v244, v244, v238, v239
    v_mfma_f32_16x16x32_bf16 v[180:183], a[80:83], v[88:91], 0
    s_waitcnt lgkmcnt(9)
    s_add_u32 s28, s28, s4
    ds_read_b64_tr_b16 a[74:75], v13 offset:2464
    v_mfma_f32_16x16x32_bf16 v[180:183], a[84:87], v[92:95], v[180:183]
    s_mul_i32 s27, s28, 86
    s_lshr_b32 s27, s27, 8
    ds_read_b64_tr_b16 a[76:77], v13 offset:9376
    v_fma_f32 v245, v245, v238, v239
    v_cvt_pk_bf16_f32 v64, v242, v243
    v_mfma_f32_16x16x32_bf16 v[176:179], a[84:87], v[20:23], v[176:179]
    s_waitcnt lgkmcnt(9)
    s_mul_i32 s31, s27, 3
    ds_read_b64_tr_b16 a[78:79], v13 offset:11680
    v_cvt_pk_bf16_f32 v65, v244, v245
    v_mfma_f32_16x16x32_bf16 v[184:187], a[88:91], v[16:19], 0
    s_sub_u32 s28, s28, s31
    ds_read_b64_tr_b16 a[80:81], v13 offset:192
    buffer_load_dwordx4 v5, s[12:15], s25 offen offset:1024 lds
    v_lshlrev_b32 v242, 16, v66
    v_mfma_f32_16x16x32_bf16 v[188:191], a[88:91], v[88:91], 0
    s_waitcnt lgkmcnt(9)
    s_mul_i32 s64, s27, 294912
    ds_read_b64_tr_b16 a[82:83], v13 offset:2496
    v_mfma_f32_16x16x32_bf16 v[188:191], a[92:95], v[92:95], v[188:191]
    s_mul_i32 s31, s5, 3
    s_add_u32 s31, s31, s28
    ds_read_b64_tr_b16 a[84:85], v13 offset:9408
    v_and_b32 v243, s41, v66
    v_lshlrev_b32_e64 v244, 16, v67
    v_mfma_f32_16x16x32_bf16 v[184:187], a[92:95], v[20:23], v[184:187]
    s_waitcnt lgkmcnt(9)
    s_mul_i32 s31, s31, 384
    ds_read_b64_tr_b16 a[86:87], v13 offset:11712
    v_mfma_f32_16x16x32_bf16 v[192:195], a[64:67], v[16:19], 0
    s_add_u32 s64, s64, s31
    ds_read_b64_tr_b16 a[88:89], v13 offset:224
    buffer_load_dwordx4 v6, s[12:15], s25 offen offset:2048 lds
    v_and_b32_e64 v245, s41, v67
    v_mfma_f32_16x16x32_bf16 v[196:199], a[64:67], v[88:91], 0
    s_waitcnt lgkmcnt(9)
    s_mul_i32 s51, s5, 648
    ds_read_b64_tr_b16 a[90:91], v13 offset:2528
    v_mfma_f32_16x16x32_bf16 v[196:199], a[68:71], v[92:95], v[196:199]
    s_add_u32 s51, s51, s27
    s_lshl_b32 s51, s51, 10
    ds_read_b64_tr_b16 a[92:93], v13 offset:9440
    v_fma_f32 v242, v242, v238, v239
    v_fma_f32 v243, v243, v238, v239
    v_mfma_f32_16x16x32_bf16 v[192:195], a[68:71], v[20:23], v[192:195]
    s_waitcnt lgkmcnt(9)
    s_add_u32 s51, s51, 28049408
    ds_read_b64_tr_b16 a[94:95], v13 offset:11744
    v_fma_f32 v244, v244, v238, v239
    v_mfma_f32_16x16x32_bf16 a[96:99], a[72:75], v[16:19], 0
    ds_read_b64_tr_b16 a[64:65], v13 offset:256
    buffer_load_dwordx4 v7, s[12:15], s25 offen offset:3072 lds
    v_fma_f32 v245, v245, v238, v239
    v_mfma_f32_16x16x32_bf16 a[100:103], a[72:75], v[88:91], 0
    s_waitcnt lgkmcnt(9)
    ds_read_b64_tr_b16 a[66:67], v13 offset:2560
    v_cvt_pk_bf16_f32 v66, v242, v243
    v_mfma_f32_16x16x32_bf16 a[100:103], a[76:79], v[92:95], a[100:103]
    s_cmp_ge_u32 s27, 18
    s_cselect_b32 s51, 1073741824, s51
    ds_read_b64_tr_b16 a[68:69], v13 offset:9472
    v_cvt_pk_bf16_f32 v67, v244, v245
    v_mfma_f32_16x16x32_bf16 a[96:99], a[76:79], v[20:23], a[96:99]
    s_waitcnt lgkmcnt(9)
    s_lshl_b32 s27, s28, 3
    ds_read_b64_tr_b16 a[70:71], v13 offset:11776
    v_mfma_f32_16x16x32_bf16 a[104:107], a[80:83], v[16:19], 0
    s_add_u32 s27, s27, 0x80000
    s_bfe_u32 s48, 1772800, s27
    ds_read_b64_tr_b16 a[72:73], v13 offset:18432
    v_lshlrev_b32 v246, 16, v136
    v_mfma_f32_16x16x32_bf16 a[108:111], a[80:83], v[88:91], 0
    s_waitcnt lgkmcnt(9)
    s_add_u32 m0, s24, 77824
    ds_read_b64_tr_b16 a[74:75], v13 offset:20736
    v_mfma_f32_16x16x32_bf16 a[108:111], a[84:87], v[92:95], a[108:111]
    s_mul_i32 s48, s48, 18432
    s_add_u32 s48, s48, s51
    ds_read_b64_tr_b16 a[76:77], v13 offset:27648
    v_and_b32 v247, s41, v136
    v_lshlrev_b32 v248, 16, v137
    v_mfma_f32_16x16x32_bf16 a[104:107], a[84:87], v[20:23], a[104:107]
    s_waitcnt lgkmcnt(9)
    ds_read_b64_tr_b16 a[78:79], v13 offset:29952
    buffer_load_dwordx4 v8, s[12:15], s25 offen offset:0 lds
    v_and_b32_e64 v249, s41, v137
    v_mfma_f32_16x16x32_bf16 a[112:115], a[88:91], v[16:19], 0
    s_bfe_u32 s49, 2036228, s27
    s_mul_i32 s49, s49, 18432
    ds_read_b64_tr_b16 a[80:81], v13 offset:18464
    v_fma_f32 v246, v246, v240, v241
    v_mfma_f32_16x16x32_bf16 a[116:119], a[88:91], v[88:91], 0
    s_waitcnt lgkmcnt(9)
    s_add_u32 s49, s49, s51
    ds_read_b64_tr_b16 a[82:83], v13 offset:20768
    v_mfma_f32_16x16x32_bf16 a[116:119], a[92:95], v[92:95], a[116:119]
    s_bfe_u32 s50, 529929, s27
    s_mul_i32 s50, s50, 18432
    ds_read_b64_tr_b16 a[84:85], v13 offset:27680
    v_fma_f32 v247, v247, v240, v241
    v_mfma_f32_16x16x32_bf16 a[112:115], a[92:95], v[20:23], a[112:115]
    s_waitcnt lgkmcnt(9)
    ds_read_b64_tr_b16 a[86:87], v13 offset:29984
    buffer_load_dwordx4 v9, s[12:15], s25 offen offset:1024 lds
    v_fma_f32 v248, v248, v240, v241
    v_mfma_f32_16x16x32_bf16 a[120:123], a[64:67], v[16:19], 0
    s_add_u32 s50, s50, s51
    s_mov_b32 s51, 18432
    ds_read_b64_tr_b16 a[88:89], v13 offset:18496
    v_fma_f32 v249, v249, v240, v241
    v_mfma_f32_16x16x32_bf16 a[124:127], a[64:67], v[88:91], 0
    s_waitcnt lgkmcnt(9)
    ds_read_b64_tr_b16 a[90:91], v13 offset:20800
    v_cvt_pk_bf16_f32 v136, v246, v247
    v_mfma_f32_16x16x32_bf16 a[124:127], a[68:71], v[92:95], a[124:127]
    s_cmp_eq_u32 s28, 2
    s_cselect_b32 s51, 165888, s51
    ds_read_b64_tr_b16 a[92:93], v13 offset:27712
    v_cvt_pk_bf16_f32 v137, v248, v249
    v_mfma_f32_16x16x32_bf16 a[120:123], a[68:71], v[20:23], a[120:123]
    s_waitcnt lgkmcnt(9)
    ds_read_b64_tr_b16 a[94:95], v13 offset:30016
    buffer_load_dwordx4 v10, s[12:15], s25 offen offset:2048 lds
    v_lshlrev_b32 v246, 16, v138
    v_mfma_f32_16x16x32_bf16 v[160:163], a[72:75], v[24:27], v[160:163]
    ds_read_b64_tr_b16 a[64:65], v13 offset:18528
    v_and_b32 v252, 16, v1
    v_and_b32 v247, s41, v138
    v_mfma_f32_16x16x32_bf16 v[164:167], a[72:75], v[96:99], v[164:167]
    s_waitcnt lgkmcnt(9)
    ds_read_b64_tr_b16 a[66:67], v13 offset:20832
    v_and_b32 v253, 7, v1
    v_mfma_f32_16x16x32_bf16 v[164:167], a[76:79], v[100:103], v[164:167]
    ds_read_b64_tr_b16 a[68:69], v13 offset:27744
    v_lshlrev_b32 v253, 3, v253
    v_lshlrev_b32_e64 v248, 16, v139
    v_mfma_f32_16x16x32_bf16 v[160:163], a[76:79], v[28:31], v[160:163]
    s_waitcnt lgkmcnt(9)
    ds_read_b64_tr_b16 a[70:71], v13 offset:30048
    buffer_load_dwordx4 v11, s[12:15], s25 offen offset:3072 lds
    v_and_b32 v249, s41, v139
    v_mfma_f32_16x16x32_bf16 v[168:171], a[80:83], v[24:27], v[168:171]
    ds_read_b64_tr_b16 a[72:73], v13 offset:18560
    v_xor_b32 v252, v252, v253
    v_fma_f32 v246, v246, v240, v241
    v_mfma_f32_16x16x32_bf16 v[172:175], a[80:83], v[96:99], v[172:175]
    s_waitcnt lgkmcnt(9)
    ds_read_b64_tr_b16 a[74:75], v13 offset:20864
    v_lshrrev_b32 v253, 3, v1
    v_mfma_f32_16x16x32_bf16 v[172:175], a[84:87], v[100:103], v[172:175]
    ds_read_b64_tr_b16 a[76:77], v13 offset:27776
    v_mul_u32_u24 v253, 9216, v253
    v_fma_f32 v247, v247, v240, v241
    v_fma_f32 v248, v248, v240, v241
    v_mfma_f32_16x16x32_bf16 v[168:171], a[84:87], v[28:31], v[168:171]
    s_waitcnt lgkmcnt(9)
    s_add_u32 m0, s24, 81920
    ds_read_b64_tr_b16 a[78:79], v13 offset:30080
    v_fma_f32 v249, v249, v240, v241
    v_mfma_f32_16x16x32_bf16 v[176:179], a[88:91], v[24:27], v[176:179]
    ds_read_b64_tr_b16 a[80:81], v13 offset:18592
    v_lshl_add_u32 v252, v252, 1, v253
    v_cvt_pk_bf16_f32 v138, v246, v247
    v_mfma_f32_16x16x32_bf16 v[180:183], a[88:91], v[96:99], v[180:183]
    s_waitcnt lgkmcnt(9)
    ds_read_b64_tr_b16 a[82:83], v13 offset:20896
    v_xor_b32_e64 v253, 64, v252
    v_cvt_pk_bf16_f32 v139, v248, v249
    v_mfma_f32_16x16x32_bf16 v[180:183], a[92:95], v[100:103], v[180:183]
    ds_read_b64_tr_b16 a[84:85], v13 offset:27808
    buffer_load_dwordx4 v12, s[12:15], s25 offen offset:0 lds
    v_mfma_f32_16x16x32_bf16 v[176:179], a[92:95], v[28:31], v[176:179]
    s_waitcnt lgkmcnt(9)
    ds_read_b64_tr_b16 a[86:87], v13 offset:30112
    v_and_b32 v254, 31, v1
    v_lshlrev_b32 v242, 16, v68
    v_mfma_f32_16x16x32_bf16 v[184:187], a[64:67], v[24:27], v[184:187]
    ds_read_b64_tr_b16 a[88:89], v13 offset:18624
    v_mul_u32_u24 v254, 9216, v254
    v_and_b32 v243, s41, v68
    v_mfma_f32_16x16x32_bf16 v[188:191], a[64:67], v[96:99], v[188:191]
    s_waitcnt lgkmcnt(9)
    ds_read_b64_tr_b16 a[90:91], v13 offset:20928
    v_lshrrev_b32 v255, 5, v1
    v_mfma_f32_16x16x32_bf16 v[188:191], a[68:71], v[100:103], v[188:191]
    s_lshl_b32 s25, s101, 2
    ds_read_b64_tr_b16 a[92:93], v13 offset:27840
    v_lshl_add_u32 v255, v255, 7, v254
    v_lshlrev_b32 v244, 16, v69
    v_and_b32_e64 v245, s41, v69
    v_mfma_f32_16x16x32_bf16 v[184:187], a[68:71], v[28:31], v[184:187]
Lpad0_1:
    s_cbranch_execz Lpad0_5
    s_waitcnt lgkmcnt(9)
    ds_read_b64_tr_b16 a[94:95], v13 offset:30144
    v_fma_f32 v242, v242, v238, v239
    v_mfma_f32_16x16x32_bf16 v[192:195], a[72:75], v[24:27], v[192:195]
    s_add_u32 s25, s25, s4
    ds_read_b64_tr_b16 a[64:65], v13 offset:18656
    v_fma_f32 v243, v243, v238, v239
    v_mfma_f32_16x16x32_bf16 v[196:199], a[72:75], v[96:99], v[196:199]
    s_waitcnt lgkmcnt(9)
    ds_read_b64_tr_b16 a[66:67], v13 offset:20960
    v_fma_f32 v244, v244, v238, v239
    v_mfma_f32_16x16x32_bf16 v[196:199], a[76:79], v[100:103], v[196:199]
    s_mul_i32 s25, s25, 110592
    ds_read_b64_tr_b16 a[68:69], v13 offset:27872
    v_fma_f32 v245, v245, v238, v239
    v_mfma_f32_16x16x32_bf16 v[192:195], a[76:79], v[28:31], v[192:195]
    s_waitcnt lgkmcnt(9)
    ds_read_b64_tr_b16 a[70:71], v13 offset:30176
    v_cvt_pk_bf16_f32 v68, v242, v243
    v_mfma_f32_16x16x32_bf16 a[96:99], a[80:83], v[24:27], a[96:99]
    s_add_u32 m0, s24, 110592
    ds_read_b64_tr_b16 a[72:73], v13 offset:18688
    v_cvt_pk_bf16_f32 v69, v244, v245
    v_mfma_f32_16x16x32_bf16 a[100:103], a[80:83], v[96:99], a[100:103]
    s_waitcnt lgkmcnt(9)
    ds_read_b64_tr_b16 a[74:75], v13 offset:20992
    v_lshlrev_b32_e64 v242, 16, v70
    v_mfma_f32_16x16x32_bf16 a[100:103], a[84:87], v[100:103], a[100:103]
    ds_read_b64_tr_b16 a[76:77], v13 offset:27904
    buffer_load_dwordx4 v4, s[12:15], s25 offen offset:0 lds
    v_mfma_f32_16x16x32_bf16 a[96:99], a[84:87], v[28:31], a[96:99]
    s_waitcnt lgkmcnt(9)
    ds_read_b64_tr_b16 a[78:79], v13 offset:30208
    v_and_b32 v243, s41, v70
    v_mfma_f32_16x16x32_bf16 a[104:107], a[88:91], v[24:27], a[104:107]
    s_waitcnt vmcnt(10)
    s_barrier
    ds_read_b64_tr_b16 a[80:81], v13 offset:36864
    v_mfma_f32_16x16x32_bf16 a[108:111], a[88:91], v[96:99], a[108:111]
    s_waitcnt lgkmcnt(9)
    ds_read_b64_tr_b16 a[82:83], v13 offset:39168
    v_lshlrev_b32 v244, 16, v71
    v_mfma_f32_16x16x32_bf16 a[108:111], a[92:95], v[100:103], a[108:111]
    ds_read_b64_tr_b16 a[84:85], v13 offset:46080
    buffer_load_dwordx4 v5, s[12:15], s25 offen offset:1024 lds
    v_and_b32 v245, s41, v71
    v_mfma_f32_16x16x32_bf16 a[104:107], a[92:95], v[28:31], a[104:107]
    s_waitcnt lgkmcnt(9)
    ds_read_b64_tr_b16 a[86:87], v13 offset:48384
    v_fma_f32 v242, v242, v238, v239
    v_mfma_f32_16x16x32_bf16 a[112:115], a[64:67], v[24:27], a[112:115]
    ds_read_b64_tr_b16 a[88:89], v13 offset:36896
    v_fma_f32 v243, v243, v238, v239
    v_mfma_f32_16x16x32_bf16 a[116:119], a[64:67], v[96:99], a[116:119]
    s_waitcnt lgkmcnt(9)
    ds_read_b64_tr_b16 a[90:91], v13 offset:39200
    v_fma_f32 v244, v244, v238, v239
    v_mfma_f32_16x16x32_bf16 a[116:119], a[68:71], v[100:103], a[116:119]
    ds_read_b64_tr_b16 a[92:93], v13 offset:46112
    buffer_load_dwordx4 v6, s[12:15], s25 offen offset:2048 lds
    v_mfma_f32_16x16x32_bf16 a[112:115], a[68:71], v[28:31], a[112:115]
    s_waitcnt lgkmcnt(9)
    ds_read_b64_tr_b16 a[94:95], v13 offset:48416
    v_fma_f32 v245, v245, v238, v239
    v_mfma_f32_16x16x32_bf16 a[120:123], a[72:75], v[24:27], a[120:123]
    ds_read_b64_tr_b16 a[64:65], v13 offset:36928
    v_cvt_pk_bf16_f32 v70, v242, v243
    v_mfma_f32_16x16x32_bf16 a[124:127], a[72:75], v[96:99], a[124:127]
    s_waitcnt lgkmcnt(9)
    ds_read_b64_tr_b16 a[66:67], v13 offset:39232
    v_cvt_pk_bf16_f32 v71, v244, v245
    v_mfma_f32_16x16x32_bf16 a[124:127], a[76:79], v[100:103], a[124:127]
    ds_read_b64_tr_b16 a[68:69], v13 offset:46144
    buffer_load_dwordx4 v7, s[12:15], s25 offen offset:3072 lds
    v_mfma_f32_16x16x32_bf16 a[120:123], a[76:79], v[28:31], a[120:123]
    s_waitcnt lgkmcnt(9)
    ds_read_b64_tr_b16 a[70:71], v13 offset:48448
    v_lshlrev_b32_e64 v246, 16, v140
    v_mfma_f32_16x16x32_bf16 v[160:163], a[80:83], v[32:35], v[160:163]
    ds_read_b64_tr_b16 a[72:73], v13 offset:36960
    v_and_b32 v247, s41, v140
    v_mfma_f32_16x16x32_bf16 v[164:167], a[80:83], v[104:107], v[164:167]
    s_waitcnt lgkmcnt(9)
    ds_read_b64_tr_b16 a[74:75], v13 offset:39264
    v_lshlrev_b32 v248, 16, v141
    v_mfma_f32_16x16x32_bf16 v[164:167], a[84:87], v[108:111], v[164:167]
    ds_read_b64_tr_b16 a[76:77], v13 offset:46176
    v_and_b32 v249, s41, v141
    v_mfma_f32_16x16x32_bf16 v[160:163], a[84:87], v[36:39], v[160:163]
    s_waitcnt lgkmcnt(9)
    s_add_u32 m0, s24, 114688
    ds_read_b64_tr_b16 a[78:79], v13 offset:48480
    v_fma_f32 v246, v246, v240, v241
    v_mfma_f32_16x16x32_bf16 v[168:171], a[88:91], v[32:35], v[168:171]
    ds_read_b64_tr_b16 a[80:81], v13 offset:36992
    v_fma_f32 v247, v247, v240, v241
    v_mfma_f32_16x16x32_bf16 v[172:175], a[88:91], v[104:107], v[172:175]
    s_waitcnt lgkmcnt(9)
    ds_read_b64_tr_b16 a[82:83], v13 offset:39296
    v_fma_f32 v248, v248, v240, v241
    v_mfma_f32_16x16x32_bf16 v[172:175], a[92:95], v[108:111], v[172:175]
    ds_read_b64_tr_b16 a[84:85], v13 offset:46208
    buffer_load_dwordx4 v8, s[12:15], s25 offen offset:0 lds
    v_mfma_f32_16x16x32_bf16 v[168:171], a[92:95], v[36:39], v[168:171]
    s_waitcnt lgkmcnt(9)
    ds_read_b64_tr_b16 a[86:87], v13 offset:48512
    v_fma_f32 v249, v249, v240, v241
    v_mfma_f32_16x16x32_bf16 v[176:179], a[64:67], v[32:35], v[176:179]
    ds_read_b64_tr_b16 a[88:89], v13 offset:37024
    v_cvt_pk_bf16_f32 v140, v246, v247
    v_mfma_f32_16x16x32_bf16 v[180:183], a[64:67], v[104:107], v[180:183]
    s_waitcnt lgkmcnt(9)
    ds_read_b64_tr_b16 a[90:91], v13 offset:39328
    v_cvt_pk_bf16_f32 v141, v248, v249
    v_mfma_f32_16x16x32_bf16 v[180:183], a[68:71], v[108:111], v[180:183]
    ds_read_b64_tr_b16 a[92:93], v13 offset:46240
    buffer_load_dwordx4 v9, s[12:15], s25 offen offset:1024 lds
    v_mfma_f32_16x16x32_bf16 v[176:179], a[68:71], v[36:39], v[176:179]
    s_waitcnt lgkmcnt(9)
    ds_read_b64_tr_b16 a[94:95], v13 offset:48544
    v_lshlrev_b32 v246, 16, v142
    v_mfma_f32_16x16x32_bf16 v[184:187], a[72:75], v[32:35], v[184:187]
    ds_read_b64_tr_b16 a[64:65], v13 offset:37056
    v_and_b32_e64 v247, s41, v142
    v_mfma_f32_16x16x32_bf16 v[188:191], a[72:75], v[104:107], v[188:191]
    s_waitcnt lgkmcnt(9)
    ds_read_b64_tr_b16 a[66:67], v13 offset:39360
    v_lshlrev_b32 v248, 16, v143
    v_mfma_f32_16x16x32_bf16 v[188:191], a[76:79], v[108:111], v[188:191]
    ds_read_b64_tr_b16 a[68:69], v13 offset:46272
    buffer_load_dwordx4 v10, s[12:15], s25 offen offset:2048 lds
    v_and_b32 v249, s41, v143
    v_mfma_f32_16x16x32_bf16 v[184:187], a[76:79], v[36:39], v[184:187]
    s_waitcnt lgkmcnt(9)
    ds_read_b64_tr_b16 a[70:71], v13 offset:48576
    v_fma_f32 v246, v246, v240, v241
    v_mfma_f32_16x16x32_bf16 v[192:195], a[80:83], v[32:35], v[192:195]
    s_and_b32 s27, s46, 7
    s_lshl_b32 s27, s27, 2
    ds_read_b64_tr_b16 a[72:73], v13 offset:37088
    v_mfma_f32_16x16x32_bf16 v[196:199], a[80:83], v[104:107], v[196:199]
    s_waitcnt lgkmcnt(9)
    s_add_u32 s27, s27, s4
    ds_read_b64_tr_b16 a[74:75], v13 offset:39392
    v_mfma_f32_16x16x32_bf16 v[196:199], a[84:87], v[108:111], v[196:199]
    s_mul_i32 s27, s27, 55296
    ds_read_b64_tr_b16 a[76:77], v13 offset:46304
    buffer_load_dwordx4 v11, s[12:15], s25 offen offset:3072 lds
    v_fma_f32 v247, v247, v240, v241
    v_fma_f32 v248, v248, v240, v241
    v_mfma_f32_16x16x32_bf16 v[192:195], a[84:87], v[36:39], v[192:195]
    s_waitcnt lgkmcnt(9)
    s_and_b32 s31, s30, 0xffffff80
    ds_read_b64_tr_b16 a[78:79], v13 offset:48608
    v_fma_f32 v249, v249, v240, v241
    v_mfma_f32_16x16x32_bf16 a[96:99], a[88:91], v[32:35], a[96:99]
    s_add_u32 s27, s27, s31
    ds_read_b64_tr_b16 a[80:81], v13 offset:37120
    v_cvt_pk_bf16_f32 v142, v246, v247
    v_mfma_f32_16x16x32_bf16 a[100:103], a[88:91], v[104:107], a[100:103]
    s_waitcnt lgkmcnt(9)
    s_add_u32 m0, s24, 118784
    ds_read_b64_tr_b16 a[82:83], v13 offset:39424
    v_cvt_pk_bf16_f32 v143, v248, v249
    v_mfma_f32_16x16x32_bf16 a[100:103], a[92:95], v[108:111], a[100:103]
    s_add_u32 s27, s27, 0
    ds_read_b64_tr_b16 a[84:85], v13 offset:46336
    v_min_u32 v250, 31, v1
    v_mfma_f32_16x16x32_bf16 a[96:99], a[92:95], v[36:39], a[96:99]
    s_waitcnt lgkmcnt(9)
    ds_read_b64_tr_b16 a[86:87], v13 offset:48640
    buffer_load_dwordx4 v12, s[12:15], s25 offen offset:0 lds
    v_lshlrev_b32_e64 v242, 16, v72
    v_mfma_f32_16x16x32_bf16 a[104:107], a[64:67], v[32:35], a[104:107]
    ds_read_b64_tr_b16 a[88:89], v14 offset:0
    v_mul_u32_u24 v251, 32768, v250
    v_and_b32 v243, s41, v72
    v_mfma_f32_16x16x32_bf16 a[108:111], a[64:67], v[104:107], a[108:111]
    s_waitcnt lgkmcnt(9)
    ds_read_b64_tr_b16 a[90:91], v14 offset:2304
    v_lshrrev_b32 v251, 16, v251
    v_mfma_f32_16x16x32_bf16 a[108:111], a[68:71], v[108:111], a[108:111]
    ds_read_b64_tr_b16 a[92:93], v14 offset:9216
    v_mul_u32_u24 v251, 3200, v251
    v_lshlrev_b32 v244, 16, v73
    v_and_b32 v245, s41, v73
    v_mfma_f32_16x16x32_bf16 a[104:107], a[68:71], v[36:39], a[104:107]
    s_waitcnt lgkmcnt(9)
    ds_read_b64_tr_b16 a[94:95], v14 offset:11520
    v_fma_f32 v242, v242, v238, v239
    v_mfma_f32_16x16x32_bf16 a[112:115], a[72:75], v[32:35], a[112:115]
    ds_read_b64_tr_b16 a[64:65], v14 offset:32
    v_lshl_add_u32 v250, v250, 7, v251
    v_mfma_f32_16x16x32_bf16 a[116:119], a[72:75], v[104:107], a[116:119]
    s_waitcnt lgkmcnt(9)
    ds_read_b64_tr_b16 a[66:67], v14 offset:2336
    v_fma_f32 v243, v243, v238, v239
    v_mfma_f32_16x16x32_bf16 a[116:119], a[76:79], v[108:111], a[116:119]
    ds_read_b64_tr_b16 a[68:69], v14 offset:9248
    buffer_load_dword a255, v250, s[12:15], s27 offen
    v_fma_f32 v244, v244, v238, v239
    v_mfma_f32_16x16x32_bf16 a[112:115], a[76:79], v[36:39], a[112:115]
    s_waitcnt lgkmcnt(9)
    ds_read_b64_tr_b16 a[70:71], v14 offset:11552
    v_fma_f32 v245, v245, v238, v239
    v_mfma_f32_16x16x32_bf16 a[120:123], a[80:83], v[32:35], a[120:123]
    ds_read_b64_tr_b16 a[72:73], v14 offset:64
    v_cvt_pk_bf16_f32 v72, v242, v243
    v_mfma_f32_16x16x32_bf16 a[124:127], a[80:83], v[104:107], a[124:127]
    s_waitcnt lgkmcnt(9)
    ds_read_b64_tr_b16 a[74:75], v14 offset:2368
    v_cvt_pk_bf16_f32 v73, v244, v245
    v_mfma_f32_16x16x32_bf16 a[124:127], a[84:87], v[108:111], a[124:127]
    ds_read_b64_tr_b16 a[76:77], v14 offset:9280
    v_lshlrev_b32 v242, 16, v74
    v_mfma_f32_16x16x32_bf16 a[120:123], a[84:87], v[36:39], a[120:123]
    s_waitcnt lgkmcnt(9)
    ds_read_b64_tr_b16 a[78:79], v14 offset:11584
    v_and_b32 v243, s41, v74
    v_mfma_f32_16x16x32_bf16 v[160:163], a[88:91], v[40:43], v[160:163]
    ds_read_b64_tr_b16 a[80:81], v14 offset:96
    v_lshlrev_b32 v244, 16, v75
    v_mfma_f32_16x16x32_bf16 v[164:167], a[88:91], v[112:115], v[164:167]
    s_waitcnt lgkmcnt(9)
    ds_read_b64_tr_b16 a[82:83], v14 offset:2400
    v_and_b32_e64 v245, s41, v75
    v_mfma_f32_16x16x32_bf16 v[164:167], a[92:95], v[116:119], v[164:167]
    ds_read_b64_tr_b16 a[84:85], v14 offset:9312
    v_fma_f32 v242, v242, v238, v239
    v_mfma_f32_16x16x32_bf16 v[160:163], a[92:95], v[44:47], v[160:163]
    s_waitcnt lgkmcnt(9)
    ds_read_b64_tr_b16 a[86:87], v14 offset:11616
    v_fma_f32 v243, v243, v238, v239
    v_mfma_f32_16x16x32_bf16 v[168:171], a[64:67], v[40:43], v[168:171]
    ds_read_b64_tr_b16 a[88:89], v14 offset:128
    v_fma_f32 v244, v244, v238, v239
    v_mfma_f32_16x16x32_bf16 v[172:175], a[64:67], v[112:115], v[172:175]
    s_waitcnt lgkmcnt(9)
    ds_read_b64_tr_b16 a[90:91], v14 offset:2432
    v_fma_f32 v245, v245, v238, v239
    v_mfma_f32_16x16x32_bf16 v[172:175], a[68:71], v[116:119], v[172:175]
    ds_read_b64_tr_b16 a[92:93], v14 offset:9344
    v_cvt_pk_bf16_f32 v74, v242, v243
    v_mfma_f32_16x16x32_bf16 v[168:171], a[68:71], v[44:47], v[168:171]
    s_waitcnt lgkmcnt(9)
    ds_read_b64_tr_b16 a[94:95], v14 offset:11648
    v_cvt_pk_bf16_f32 v75, v244, v245
    v_mfma_f32_16x16x32_bf16 v[176:179], a[72:75], v[40:43], v[176:179]
    ds_read_b64_tr_b16 a[64:65], v14 offset:160
    v_lshlrev_b32_e64 v246, 16, v144
    v_mfma_f32_16x16x32_bf16 v[180:183], a[72:75], v[112:115], v[180:183]
    s_waitcnt lgkmcnt(9)
    ds_read_b64_tr_b16 a[66:67], v14 offset:2464
    v_and_b32 v247, s41, v144
    v_mfma_f32_16x16x32_bf16 v[180:183], a[76:79], v[116:119], v[180:183]
    ds_read_b64_tr_b16 a[68:69], v14 offset:9376
    v_lshlrev_b32 v248, 16, v145
    v_mfma_f32_16x16x32_bf16 v[176:179], a[76:79], v[44:47], v[176:179]
    s_waitcnt lgkmcnt(9)
    ds_read_b64_tr_b16 a[70:71], v14 offset:11680
    v_and_b32 v249, s41, v145
    v_mfma_f32_16x16x32_bf16 v[184:187], a[80:83], v[40:43], v[184:187]
    ds_read_b64_tr_b16 a[72:73], v14 offset:192
    v_fma_f32 v246, v246, v240, v241
    v_mfma_f32_16x16x32_bf16 v[188:191], a[80:83], v[112:115], v[188:191]
    s_waitcnt lgkmcnt(9)
    ds_read_b64_tr_b16 a[74:75], v14 offset:2496
    v_fma_f32 v247, v247, v240, v241
    v_mfma_f32_16x16x32_bf16 v[188:191], a[84:87], v[116:119], v[188:191]
    ds_read_b64_tr_b16 a[76:77], v14 offset:9408
    v_fma_f32 v248, v248, v240, v241
    v_mfma_f32_16x16x32_bf16 v[184:187], a[84:87], v[44:47], v[184:187]
    s_waitcnt lgkmcnt(9)
    ds_read_b64_tr_b16 a[78:79], v14 offset:11712
    v_fma_f32 v249, v249, v240, v241
    v_mfma_f32_16x16x32_bf16 v[192:195], a[88:91], v[40:43], v[192:195]
    ds_read_b64_tr_b16 a[80:81], v14 offset:224
    v_cvt_pk_bf16_f32 v144, v246, v247
    v_mfma_f32_16x16x32_bf16 v[196:199], a[88:91], v[112:115], v[196:199]
    s_waitcnt lgkmcnt(9)
    ds_read_b64_tr_b16 a[82:83], v14 offset:2528
    v_cvt_pk_bf16_f32 v145, v248, v249
    v_mfma_f32_16x16x32_bf16 v[196:199], a[92:95], v[116:119], v[196:199]
    ds_read_b64_tr_b16 a[84:85], v14 offset:9440
    v_lshlrev_b32 v246, 16, v146
    v_mfma_f32_16x16x32_bf16 v[192:195], a[92:95], v[44:47], v[192:195]
    s_waitcnt lgkmcnt(9)
    ds_read_b64_tr_b16 a[86:87], v14 offset:11744
    v_and_b32 v247, s41, v146
    v_mfma_f32_16x16x32_bf16 a[96:99], a[64:67], v[40:43], a[96:99]
    ds_read_b64_tr_b16 a[88:89], v14 offset:256
    v_lshlrev_b32 v248, 16, v147
    v_mfma_f32_16x16x32_bf16 a[100:103], a[64:67], v[112:115], a[100:103]
    s_waitcnt lgkmcnt(9)
    ds_read_b64_tr_b16 a[90:91], v14 offset:2560
    v_and_b32_e64 v249, s41, v147
    v_mfma_f32_16x16x32_bf16 a[100:103], a[68:71], v[116:119], a[100:103]
    ds_read_b64_tr_b16 a[92:93], v14 offset:9472
    v_fma_f32 v246, v246, v240, v241
    v_mfma_f32_16x16x32_bf16 a[96:99], a[68:71], v[44:47], a[96:99]
    s_waitcnt lgkmcnt(9)
    ds_read_b64_tr_b16 a[94:95], v14 offset:11776
    v_fma_f32 v247, v247, v240, v241
    v_mfma_f32_16x16x32_bf16 a[104:107], a[72:75], v[40:43], a[104:107]
    s_waitcnt vmcnt(10)
    s_barrier
    ds_read_b64_tr_b16 a[64:65], v14 offset:18432
    v_mfma_f32_16x16x32_bf16 a[108:111], a[72:75], v[112:115], a[108:111]
    s_waitcnt lgkmcnt(9)
    ds_read_b64_tr_b16 a[66:67], v14 offset:20736
    v_fma_f32 v248, v248, v240, v241
    v_mfma_f32_16x16x32_bf16 a[108:111], a[76:79], v[116:119], a[108:111]
    ds_read_b64_tr_b16 a[68:69], v14 offset:27648
    v_fma_f32 v249, v249, v240, v241
    v_mfma_f32_16x16x32_bf16 a[104:107], a[76:79], v[44:47], a[104:107]
    s_waitcnt lgkmcnt(9)
    ds_read_b64_tr_b16 a[70:71], v14 offset:29952
    v_cvt_pk_bf16_f32 v146, v246, v247
    v_mfma_f32_16x16x32_bf16 a[112:115], a[80:83], v[40:43], a[112:115]
    ds_read_b64_tr_b16 a[72:73], v14 offset:18464
    v_cvt_pk_bf16_f32 v147, v248, v249
    v_mfma_f32_16x16x32_bf16 a[116:119], a[80:83], v[112:115], a[116:119]
    s_waitcnt lgkmcnt(9)
    ds_read_b64_tr_b16 a[74:75], v14 offset:20768
    v_mfma_f32_16x16x32_bf16 a[116:119], a[84:87], v[116:119], a[116:119]
    ds_read_b64_tr_b16 a[76:77], v14 offset:27680
    v_mfma_f32_16x16x32_bf16 a[112:115], a[84:87], v[44:47], a[112:115]
    s_waitcnt lgkmcnt(9)
    ds_read_b64_tr_b16 a[78:79], v14 offset:29984
    v_mfma_f32_16x16x32_bf16 a[120:123], a[88:91], v[40:43], a[120:123]
    ds_read_b64_tr_b16 a[80:81], v14 offset:18496
    v_mfma_f32_16x16x32_bf16 a[124:127], a[88:91], v[112:115], a[124:127]
    s_waitcnt lgkmcnt(9)
    ds_read_b64_tr_b16 a[82:83], v14 offset:20800
    v_mfma_f32_16x16x32_bf16 a[124:127], a[92:95], v[116:119], a[124:127]
    ds_read_b64_tr_b16 a[84:85], v14 offset:27712
    v_lshlrev_b32 v242, 16, v76
    v_mfma_f32_16x16x32_bf16 a[120:123], a[92:95], v[44:47], a[120:123]
    s_waitcnt lgkmcnt(9)
    ds_read_b64_tr_b16 a[86:87], v14 offset:30016
    v_and_b32 v243, s41, v76
    v_mfma_f32_16x16x32_bf16 v[160:163], a[64:67], v[48:51], v[160:163]
    ds_read_b64_tr_b16 a[88:89], v14 offset:18528
    v_lshlrev_b32 v244, 16, v77
    v_mfma_f32_16x16x32_bf16 v[164:167], a[64:67], v[120:123], v[164:167]
    s_waitcnt lgkmcnt(9)
    ds_read_b64_tr_b16 a[90:91], v14 offset:20832
    v_and_b32 v245, s41, v77
    v_mfma_f32_16x16x32_bf16 v[164:167], a[68:71], v[124:127], v[164:167]
    ds_read_b64_tr_b16 a[92:93], v14 offset:27744
    v_fma_f32 v242, v242, v238, v239
    v_mfma_f32_16x16x32_bf16 v[160:163], a[68:71], v[52:55], v[160:163]
    s_waitcnt lgkmcnt(9)
    ds_read_b64_tr_b16 a[94:95], v14 offset:30048
    v_fma_f32 v243, v243, v238, v239
    v_mfma_f32_16x16x32_bf16 v[168:171], a[72:75], v[48:51], v[168:171]
    ds_read_b64_tr_b16 a[64:65], v14 offset:18560
    v_fma_f32 v244, v244, v238, v239
    v_mfma_f32_16x16x32_bf16 v[172:175], a[72:75], v[120:123], v[172:175]
    s_waitcnt lgkmcnt(9)
    ds_read_b64_tr_b16 a[66:67], v14 offset:20864
    v_fma_f32 v245, v245, v238, v239
    v_mfma_f32_16x16x32_bf16 v[172:175], a[76:79], v[124:127], v[172:175]
    ds_read_b64_tr_b16 a[68:69], v14 offset:27776
    v_cvt_pk_bf16_f32 v76, v242, v243
    v_mfma_f32_16x16x32_bf16 v[168:171], a[76:79], v[52:55], v[168:171]
    s_waitcnt lgkmcnt(9)
    ds_read_b64_tr_b16 a[70:71], v14 offset:30080
    v_cvt_pk_bf16_f32 v77, v244, v245
    v_mfma_f32_16x16x32_bf16 v[176:179], a[80:83], v[48:51], v[176:179]
    s_add_u32 s25, s4, 16
    s_mul_i32 s25, s25, 110592
    s_cmp_lt_u32 s4, 2
    s_cbranch_scc1 Lq9
    v_mov_b32 v4, v228
    v_mov_b32 v5, v229
    v_mov_b32 v6, v230
    v_mov_b32 v7, v231
    v_mov_b32 v8, v232
    v_mov_b32 v9, v233
    v_mov_b32 v10, v234
    v_mov_b32 v11, v235
    v_mov_b32 v12, v236
    s_lshl_b32 s25, s98, 1
    s_add_u32 s25, s25, s4
    s_add_u32 s25, s25, 6
    s_and_b32 s25, s25, 7
    s_mul_i32 s25, s25, 221184
Lq9:
    ds_read_b64_tr_b16 a[72:73], v14 offset:18592
    v_mfma_f32_16x16x32_bf16 v[180:183], a[80:83], v[120:123], v[180:183]
    s_waitcnt lgkmcnt(9)
    s_add_u32 m0, s24, 0
    ds_read_b64_tr_b16 a[74:75], v14 offset:20896
    v_mfma_f32_16x16x32_bf16 v[180:183], a[84:87], v[124:127], v[180:183]
    ds_read_b64_tr_b16 a[76:77], v14 offset:27808
    buffer_load_dwordx4 v4, s[12:15], s25 offen offset:0 lds
    v_mfma_f32_16x16x32_bf16 v[176:179], a[84:87], v[52:55], v[176:179]
    s_waitcnt lgkmcnt(9)
    ds_read_b64_tr_b16 a[78:79], v14 offset:30112
    v_lshlrev_b32_e64 v242, 16, v78
    v_mfma_f32_16x16x32_bf16 v[184:187], a[88:91], v[48:51], v[184:187]
    ds_read_b64_tr_b16 a[80:81], v14 offset:18624
    v_and_b32 v243, s41, v78
    v_mfma_f32_16x16x32_bf16 v[188:191], a[88:91], v[120:123], v[188:191]
    s_waitcnt lgkmcnt(9)
    ds_read_b64_tr_b16 a[82:83], v14 offset:20928
    v_lshlrev_b32 v244, 16, v79
    v_mfma_f32_16x16x32_bf16 v[188:191], a[92:95], v[124:127], v[188:191]
    ds_read_b64_tr_b16 a[84:85], v14 offset:27840
    v_and_b32 v245, s41, v79
    v_mfma_f32_16x16x32_bf16 v[184:187], a[92:95], v[52:55], v[184:187]
    s_waitcnt lgkmcnt(9)
    ds_read_b64_tr_b16 a[86:87], v14 offset:30144
    buffer_load_dwordx4 v5, s[12:15], s25 offen offset:1024 lds
    v_fma_f32 v242, v242, v238, v239
    v_mfma_f32_16x16x32_bf16 v[192:195], a[64:67], v[48:51], v[192:195]
    ds_read_b64_tr_b16 a[88:89], v14 offset:18656
    v_fma_f32 v243, v243, v238, v239
    v_mfma_f32_16x16x32_bf16 v[196:199], a[64:67], v[120:123], v[196:199]
    s_waitcnt lgkmcnt(9)
    ds_read_b64_tr_b16 a[90:91], v14 offset:20960
    v_fma_f32 v244, v244, v238, v239
    v_mfma_f32_16x16x32_bf16 v[196:199], a[68:71], v[124:127], v[196:199]
    ds_read_b64_tr_b16 a[92:93], v14 offset:27872
    v_fma_f32 v245, v245, v238, v239
    v_mfma_f32_16x16x32_bf16 v[192:195], a[68:71], v[52:55], v[192:195]
    s_waitcnt lgkmcnt(9)
    ds_read_b64_tr_b16 a[94:95], v14 offset:30176
    buffer_load_dwordx4 v6, s[12:15], s25 offen offset:2048 lds
    v_mfma_f32_16x16x32_bf16 a[96:99], a[72:75], v[48:51], a[96:99]
    ds_read_b64_tr_b16 a[64:65], v14 offset:18688
    v_cvt_pk_bf16_f32 v78, v242, v243
    v_mfma_f32_16x16x32_bf16 a[100:103], a[72:75], v[120:123], a[100:103]
    s_waitcnt lgkmcnt(9)
    ds_read_b64_tr_b16 a[66:67], v14 offset:20992
    v_cvt_pk_bf16_f32 v79, v244, v245
    v_mfma_f32_16x16x32_bf16 a[100:103], a[76:79], v[124:127], a[100:103]
    ds_read_b64_tr_b16 a[68:69], v14 offset:27904
    v_lshlrev_b32 v246, 16, v148
    v_mfma_f32_16x16x32_bf16 a[96:99], a[76:79], v[52:55], a[96:99]
    s_waitcnt lgkmcnt(9)
    ds_read_b64_tr_b16 a[70:71], v14 offset:30208
    v_and_b32_e64 v247, s41, v148
    v_mfma_f32_16x16x32_bf16 a[104:107], a[80:83], v[48:51], a[104:107]
    ds_read_b64_tr_b16 a[72:73], v14 offset:36864
    buffer_load_dwordx4 v7, s[12:15], s25 offen offset:3072 lds
    v_mfma_f32_16x16x32_bf16 a[108:111], a[80:83], v[120:123], a[108:111]
    s_waitcnt lgkmcnt(9)
    ds_read_b64_tr_b16 a[74:75], v14 offset:39168
    v_lshlrev_b32 v248, 16, v149
    v_mfma_f32_16x16x32_bf16 a[108:111], a[84:87], v[124:127], a[108:111]
    ds_read_b64_tr_b16 a[76:77], v14 offset:46080
    v_and_b32 v249, s41, v149
    v_mfma_f32_16x16x32_bf16 a[104:107], a[84:87], v[52:55], a[104:107]
    s_waitcnt lgkmcnt(9)
    ds_read_b64_tr_b16 a[78:79], v14 offset:48384
    v_fma_f32 v246, v246, v240, v241
    v_mfma_f32_16x16x32_bf16 a[112:115], a[88:91], v[48:51], a[112:115]
    s_add_u32 m0, s24, 4096
    ds_read_b64_tr_b16 a[80:81], v14 offset:36896
    v_fma_f32 v247, v247, v240, v241
    v_mfma_f32_16x16x32_bf16 a[116:119], a[88:91], v[120:123], a[116:119]
    s_waitcnt lgkmcnt(9)
    ds_read_b64_tr_b16 a[82:83], v14 offset:39200
    v_fma_f32 v248, v248, v240, v241
    v_mfma_f32_16x16x32_bf16 a[116:119], a[92:95], v[124:127], a[116:119]
    ds_read_b64_tr_b16 a[84:85], v14 offset:46112
    buffer_load_dwordx4 v8, s[12:15], s25 offen offset:0 lds
    v_mfma_f32_16x16x32_bf16 a[112:115], a[92:95], v[52:55], a[112:115]
    s_waitcnt lgkmcnt(9)
    ds_read_b64_tr_b16 a[86:87], v14 offset:48416
    v_fma_f32 v249, v249, v240, v241
    v_mfma_f32_16x16x32_bf16 a[120:123], a[64:67], v[48:51], a[120:123]
    ds_read_b64_tr_b16 a[88:89], v14 offset:36928
    v_cvt_pk_bf16_f32 v148, v246, v247
    v_mfma_f32_16x16x32_bf16 a[124:127], a[64:67], v[120:123], a[124:127]
    s_waitcnt lgkmcnt(9)
    ds_read_b64_tr_b16 a[90:91], v14 offset:39232
    v_cvt_pk_bf16_f32 v149, v248, v249
    v_mfma_f32_16x16x32_bf16 a[124:127], a[68:71], v[124:127], a[124:127]
    ds_read_b64_tr_b16 a[92:93], v14 offset:46144
    v_lshlrev_b32_e64 v246, 16, v150
    v_mfma_f32_16x16x32_bf16 a[120:123], a[68:71], v[52:55], a[120:123]
    s_waitcnt lgkmcnt(9)
    ds_read_b64_tr_b16 a[94:95], v14 offset:48448
    buffer_load_dwordx4 v9, s[12:15], s25 offen offset:1024 lds
    v_mfma_f32_16x16x32_bf16 v[160:163], a[72:75], v[56:59], v[160:163]
    ds_read_b64_tr_b16 a[64:65], v14 offset:36960
    v_and_b32_e64 v247, s41, v150
    v_mfma_f32_16x16x32_bf16 v[164:167], a[72:75], v[128:131], v[164:167]
    s_waitcnt lgkmcnt(9)
    ds_read_b64_tr_b16 a[66:67], v14 offset:39264
    v_lshlrev_b32 v248, 16, v151
    v_mfma_f32_16x16x32_bf16 v[164:167], a[76:79], v[132:135], v[164:167]
    ds_read_b64_tr_b16 a[68:69], v14 offset:46176
    v_and_b32 v249, s41, v151
    v_mfma_f32_16x16x32_bf16 v[160:163], a[76:79], v[60:63], v[160:163]
    s_waitcnt lgkmcnt(9)
    ds_read_b64_tr_b16 a[70:71], v14 offset:48480
    v_fma_f32 v246, v246, v240, v241
    v_mfma_f32_16x16x32_bf16 v[168:171], a[80:83], v[56:59], v[168:171]
    ds_read_b64_tr_b16 a[72:73], v14 offset:36992
    buffer_load_dwordx4 v10, s[12:15], s25 offen offset:2048 lds
    v_mfma_f32_16x16x32_bf16 v[172:175], a[80:83], v[128:131], v[172:175]
    s_waitcnt lgkmcnt(9)
    ds_read_b64_tr_b16 a[74:75], v14 offset:39296
    v_fma_f32 v247, v247, v240, v241
    v_mfma_f32_16x16x32_bf16 v[172:175], a[84:87], v[132:135], v[172:175]
    ds_read_b64_tr_b16 a[76:77], v14 offset:46208
    v_fma_f32 v248, v248, v240, v241
    v_mfma_f32_16x16x32_bf16 v[168:171], a[84:87], v[60:63], v[168:171]
    s_waitcnt lgkmcnt(9)
    ds_read_b64_tr_b16 a[78:79], v14 offset:48512
    v_fma_f32 v249, v249, v240, v241
    v_mfma_f32_16x16x32_bf16 v[176:179], a[88:91], v[56:59], v[176:179]
    ds_read_b64_tr_b16 a[80:81], v14 offset:37024
    buffer_load_dwordx4 v11, s[12:15], s25 offen offset:3072 lds
    v_cvt_pk_bf16_f32 v150, v246, v247
    v_mfma_f32_16x16x32_bf16 v[180:183], a[88:91], v[128:131], v[180:183]
    s_waitcnt lgkmcnt(9)
    ds_read_b64_tr_b16 a[82:83], v14 offset:39328
    v_cvt_pk_bf16_f32 v151, v248, v249
    v_mfma_f32_16x16x32_bf16 v[180:183], a[92:95], v[132:135], v[180:183]
    ds_read_b64_tr_b16 a[84:85], v14 offset:46240
    v_lshlrev_b32 v242, 16, v80
    v_mfma_f32_16x16x32_bf16 v[176:179], a[92:95], v[60:63], v[176:179]
    s_waitcnt lgkmcnt(9)
    ds_read_b64_tr_b16 a[86:87], v14 offset:48544
    v_and_b32 v243, s41, v80
    v_mfma_f32_16x16x32_bf16 v[184:187], a[64:67], v[56:59], v[184:187]
    ds_read_b64_tr_b16 a[88:89], v14 offset:37056
    v_lshlrev_b32 v244, 16, v81
    v_mfma_f32_16x16x32_bf16 v[188:191], a[64:67], v[128:131], v[188:191]
    s_waitcnt lgkmcnt(9)
    s_add_u32 m0, s24, 8192
    ds_read_b64_tr_b16 a[90:91], v14 offset:39360
    v_mfma_f32_16x16x32_bf16 v[188:191], a[68:71], v[132:135], v[188:191]
    ds_read_b64_tr_b16 a[92:93], v14 offset:46272
    v_and_b32_e64 v245, s41, v81
    v_mfma_f32_16x16x32_bf16 v[184:187], a[68:71], v[60:63], v[184:187]
    s_waitcnt lgkmcnt(9)
    ds_read_b64_tr_b16 a[94:95], v14 offset:48576
    buffer_load_dwordx4 v12, s[12:15], s25 offen offset:0 lds
    v_fma_f32 v242, v242, v238, v239
    v_mfma_f32_16x16x32_bf16 v[192:195], a[72:75], v[56:59], v[192:195]
    ds_read_b64_tr_b16 a[64:65], v14 offset:37088
    v_fma_f32 v243, v243, v238, v239
    v_mfma_f32_16x16x32_bf16 v[196:199], a[72:75], v[128:131], v[196:199]
    s_waitcnt lgkmcnt(9)
    ds_read_b64_tr_b16 a[66:67], v14 offset:39392
    v_fma_f32 v244, v244, v238, v239
    v_mfma_f32_16x16x32_bf16 v[196:199], a[76:79], v[132:135], v[196:199]
    ds_read_b64_tr_b16 a[68:69], v14 offset:46304
    v_fma_f32 v245, v245, v238, v239
    v_mfma_f32_16x16x32_bf16 v[192:195], a[76:79], v[60:63], v[192:195]
    s_waitcnt lgkmcnt(9)
    ds_read_b64_tr_b16 a[70:71], v14 offset:48608
    v_cvt_pk_bf16_f32 v80, v242, v243
    v_mfma_f32_16x16x32_bf16 a[96:99], a[80:83], v[56:59], a[96:99]
    ds_read_b64_tr_b16 a[72:73], v14 offset:37120
    v_lshlrev_b32 v251, 2, v1
    v_mfma_f32_16x16x32_bf16 a[100:103], a[80:83], v[128:131], a[100:103]
    s_waitcnt lgkmcnt(9)
    ds_read_b64_tr_b16 a[74:75], v14 offset:39424
    v_cvt_pk_bf16_f32 v81, v244, v245
    v_mfma_f32_16x16x32_bf16 a[100:103], a[84:87], v[132:135], a[100:103]
    ds_read_b64_tr_b16 a[76:77], v14 offset:46336
    global_load_dword v250, v251, s[66:67] sc1
    v_mfma_f32_16x16x32_bf16 a[96:99], a[84:87], v[60:63], a[96:99]
    s_waitcnt lgkmcnt(9)
    ds_read_b64_tr_b16 a[78:79], v14 offset:48640
    v_lshlrev_b32_e64 v242, 16, v82
    v_mfma_f32_16x16x32_bf16 a[104:107], a[88:91], v[56:59], a[104:107]
    s_waitcnt vmcnt(11)
    s_barrier
    ds_read_b64_tr_b16 a[80:81], v15 offset:0
    v_and_b32 v243, s41, v82
    v_mfma_f32_16x16x32_bf16 a[108:111], a[88:91], v[128:131], a[108:111]
    s_waitcnt lgkmcnt(9)
    ds_read_b64_tr_b16 a[82:83], v15 offset:2304
    v_lshlrev_b32 v244, 16, v83
    v_mfma_f32_16x16x32_bf16 a[108:111], a[92:95], v[132:135], a[108:111]
    s_lshl_b32 s25, s98, 1
    ds_read_b64_tr_b16 a[84:85], v15 offset:9216
    v_and_b32_e64 v245, s41, v83
    v_mfma_f32_16x16x32_bf16 a[104:107], a[92:95], v[60:63], a[104:107]
Lpad0_2:
    s_cbranch_execz Lpad0_6
    s_waitcnt lgkmcnt(9)
    ds_read_b64_tr_b16 a[86:87], v15 offset:11520
    v_fma_f32 v242, v242, v238, v239
    v_mfma_f32_16x16x32_bf16 a[112:115], a[64:67], v[56:59], a[112:115]
    s_add_u32 s25, s25, s4
    ds_read_b64_tr_b16 a[88:89], v15 offset:32
    v_fma_f32 v243, v243, v238, v239
    v_mfma_f32_16x16x32_bf16 a[116:119], a[64:67], v[128:131], a[116:119]
    s_waitcnt lgkmcnt(9)
    ds_read_b64_tr_b16 a[90:91], v15 offset:2336
    v_fma_f32 v244, v244, v238, v239
    v_mfma_f32_16x16x32_bf16 a[116:119], a[68:71], v[132:135], a[116:119]
    s_add_u32 s25, s25, 2
    ds_read_b64_tr_b16 a[92:93], v15 offset:9248
    v_fma_f32 v245, v245, v238, v239
    v_mfma_f32_16x16x32_bf16 a[112:115], a[68:71], v[60:63], a[112:115]
    s_waitcnt lgkmcnt(9)
    ds_read_b64_tr_b16 a[94:95], v15 offset:11552
    v_cvt_pk_bf16_f32 v82, v242, v243
    v_mfma_f32_16x16x32_bf16 a[120:123], a[72:75], v[56:59], a[120:123]
    ds_read_b64_tr_b16 a[64:65], v15 offset:64
    v_cvt_pk_bf16_f32 v83, v244, v245
    v_mfma_f32_16x16x32_bf16 a[124:127], a[72:75], v[128:131], a[124:127]
    s_waitcnt lgkmcnt(9)
    s_and_b32 s25, s25, 7
    ds_read_b64_tr_b16 a[66:67], v15 offset:2368
    v_mfma_f32_16x16x32_bf16 a[124:127], a[76:79], v[132:135], a[124:127]
    ds_read_b64_tr_b16 a[68:69], v15 offset:9280
    v_lshlrev_b32 v246, 16, v152
    v_mfma_f32_16x16x32_bf16 a[120:123], a[76:79], v[60:63], a[120:123]
    s_waitcnt lgkmcnt(9)
    s_mul_i32 s25, s25, 221184
    ds_read_b64_tr_b16 a[70:71], v15 offset:11584
    v_mfma_f32_16x16x32_bf16 v[160:163], a[80:83], v[64:67], v[160:163]
    ds_read_b64_tr_b16 a[72:73], v15 offset:96
    v_and_b32 v247, s41, v152
    v_mfma_f32_16x16x32_bf16 v[164:167], a[80:83], v[136:139], v[164:167]
    s_waitcnt lgkmcnt(9)
    s_add_u32 m0, s24, 36864
    ds_read_b64_tr_b16 a[74:75], v15 offset:2400
    v_mfma_f32_16x16x32_bf16 v[164:167], a[84:87], v[140:143], v[164:167]
    ds_read_b64_tr_b16 a[76:77], v15 offset:9312
    v_lshlrev_b32 v248, 16, v153
    v_and_b32 v249, s41, v153
    v_mfma_f32_16x16x32_bf16 v[160:163], a[84:87], v[68:71], v[160:163]
    s_waitcnt lgkmcnt(9)
    ds_read_b64_tr_b16 a[78:79], v15 offset:11616
    v_fma_f32 v246, v246, v240, v241
    v_mfma_f32_16x16x32_bf16 v[168:171], a[88:91], v[64:67], v[168:171]
    ds_read_b64_tr_b16 a[80:81], v15 offset:128
    buffer_load_dwordx4 v228, s[12:15], s25 offen offset:0 lds
    v_mfma_f32_16x16x32_bf16 v[172:175], a[88:91], v[136:139], v[172:175]
    s_waitcnt lgkmcnt(9)
    ds_read_b64_tr_b16 a[82:83], v15 offset:2432
    v_fma_f32 v247, v247, v240, v241
    v_mfma_f32_16x16x32_bf16 v[172:175], a[92:95], v[140:143], v[172:175]
    ds_read_b64_tr_b16 a[84:85], v15 offset:9344
    v_fma_f32 v248, v248, v240, v241
    v_mfma_f32_16x16x32_bf16 v[168:171], a[92:95], v[68:71], v[168:171]
    s_waitcnt lgkmcnt(9)
    ds_read_b64_tr_b16 a[86:87], v15 offset:11648
    v_fma_f32 v249, v249, v240, v241
    v_mfma_f32_16x16x32_bf16 v[176:179], a[64:67], v[64:67], v[176:179]
    ds_read_b64_tr_b16 a[88:89], v15 offset:160
    v_cvt_pk_bf16_f32 v152, v246, v247
    v_mfma_f32_16x16x32_bf16 v[180:183], a[64:67], v[136:139], v[180:183]
    s_waitcnt lgkmcnt(9)
    ds_read_b64_tr_b16 a[90:91], v15 offset:2464
    v_cvt_pk_bf16_f32 v153, v248, v249
    v_mfma_f32_16x16x32_bf16 v[180:183], a[68:71], v[140:143], v[180:183]
    ds_read_b64_tr_b16 a[92:93], v15 offset:9376
    buffer_load_dwordx4 v229, s[12:15], s25 offen offset:1024 lds
    v_mfma_f32_16x16x32_bf16 v[176:179], a[68:71], v[68:71], v[176:179]
    s_waitcnt lgkmcnt(9)
    ds_read_b64_tr_b16 a[94:95], v15 offset:11680
    v_lshlrev_b32 v246, 16, v154
    v_mfma_f32_16x16x32_bf16 v[184:187], a[72:75], v[64:67], v[184:187]
    ds_read_b64_tr_b16 a[64:65], v15 offset:192
    v_and_b32 v247, s41, v154
    v_mfma_f32_16x16x32_bf16 v[188:191], a[72:75], v[136:139], v[188:191]
    s_waitcnt lgkmcnt(9)
    ds_read_b64_tr_b16 a[66:67], v15 offset:2496
    v_lshlrev_b32_e64 v248, 16, v155
    v_mfma_f32_16x16x32_bf16 v[188:191], a[76:79], v[140:143], v[188:191]
    ds_read_b64_tr_b16 a[68:69], v15 offset:9408
    buffer_load_dwordx4 v230, s[12:15], s25 offen offset:2048 lds
    v_and_b32 v249, s41, v155
    v_mfma_f32_16x16x32_bf16 v[184:187], a[76:79], v[68:71], v[184:187]
    s_waitcnt lgkmcnt(9)
    ds_read_b64_tr_b16 a[70:71], v15 offset:11712
    v_fma_f32 v246, v246, v240, v241
    v_mfma_f32_16x16x32_bf16 v[192:195], a[80:83], v[64:67], v[192:195]
    ds_read_b64_tr_b16 a[72:73], v15 offset:224
    v_fma_f32 v247, v247, v240, v241
    v_mfma_f32_16x16x32_bf16 v[196:199], a[80:83], v[136:139], v[196:199]
    s_waitcnt lgkmcnt(9)
    ds_read_b64_tr_b16 a[74:75], v15 offset:2528
    v_fma_f32 v248, v248, v240, v241
    v_mfma_f32_16x16x32_bf16 v[196:199], a[84:87], v[140:143], v[196:199]
    ds_read_b64_tr_b16 a[76:77], v15 offset:9440
    buffer_load_dwordx4 v231, s[12:15], s25 offen offset:3072 lds
    v_mfma_f32_16x16x32_bf16 v[192:195], a[84:87], v[68:71], v[192:195]
    s_waitcnt lgkmcnt(9)
    ds_read_b64_tr_b16 a[78:79], v15 offset:11744
    v_fma_f32 v249, v249, v240, v241
    v_mfma_f32_16x16x32_bf16 a[96:99], a[88:91], v[64:67], a[96:99]
    ds_read_b64_tr_b16 a[80:81], v15 offset:256
    v_cvt_pk_bf16_f32 v154, v246, v247
    v_mfma_f32_16x16x32_bf16 a[100:103], a[88:91], v[136:139], a[100:103]
    s_waitcnt lgkmcnt(9)
    ds_read_b64_tr_b16 a[82:83], v15 offset:2560
    v_cvt_pk_bf16_f32 v155, v248, v249
    v_mfma_f32_16x16x32_bf16 a[100:103], a[92:95], v[140:143], a[100:103]
    ds_read_b64_tr_b16 a[84:85], v15 offset:9472
    v_lshlrev_b32 v242, 16, v84
    v_mfma_f32_16x16x32_bf16 a[96:99], a[92:95], v[68:71], a[96:99]
    s_waitcnt lgkmcnt(9)
    s_add_u32 m0, s24, 40960
    ds_read_b64_tr_b16 a[86:87], v15 offset:11776
    v_mfma_f32_16x16x32_bf16 a[104:107], a[64:67], v[64:67], a[104:107]
    ds_read_b64_tr_b16 a[88:89], v15 offset:18432
    v_and_b32 v243, s41, v84
    v_mfma_f32_16x16x32_bf16 a[108:111], a[64:67], v[136:139], a[108:111]
    s_waitcnt lgkmcnt(9)
    ds_read_b64_tr_b16 a[90:91], v15 offset:20736
    v_lshlrev_b32 v244, 16, v85
    v_mfma_f32_16x16x32_bf16 a[108:111], a[68:71], v[140:143], a[108:111]
    ds_read_b64_tr_b16 a[92:93], v15 offset:27648
    buffer_load_dwordx4 v232, s[12:15], s25 offen offset:0 lds
    v_and_b32_e64 v245, s41, v85
    v_mfma_f32_16x16x32_bf16 a[104:107], a[68:71], v[68:71], a[104:107]
    s_waitcnt lgkmcnt(9)
    ds_read_b64_tr_b16 a[94:95], v15 offset:29952
    v_fma_f32 v242, v242, v238, v239
    v_mfma_f32_16x16x32_bf16 a[112:115], a[72:75], v[64:67], a[112:115]
    ds_read_b64_tr_b16 a[64:65], v15 offset:18464
    v_fma_f32 v243, v243, v238, v239
    v_mfma_f32_16x16x32_bf16 a[116:119], a[72:75], v[136:139], a[116:119]
    s_waitcnt lgkmcnt(9)
    ds_read_b64_tr_b16 a[66:67], v15 offset:20768
    v_fma_f32 v244, v244, v238, v239
    v_mfma_f32_16x16x32_bf16 a[116:119], a[76:79], v[140:143], a[116:119]
    ds_read_b64_tr_b16 a[68:69], v15 offset:27680
    buffer_load_dwordx4 v233, s[12:15], s25 offen offset:1024 lds
    v_mfma_f32_16x16x32_bf16 a[112:115], a[76:79], v[68:71], a[112:115]
    s_waitcnt lgkmcnt(9)
    ds_read_b64_tr_b16 a[70:71], v15 offset:29984
    v_fma_f32 v245, v245, v238, v239
    v_mfma_f32_16x16x32_bf16 a[120:123], a[80:83], v[64:67], a[120:123]
    ds_read_b64_tr_b16 a[72:73], v15 offset:18496
    v_cvt_pk_bf16_f32 v84, v242, v243
    v_mfma_f32_16x16x32_bf16 a[124:127], a[80:83], v[136:139], a[124:127]
    s_waitcnt lgkmcnt(9)
    ds_read_b64_tr_b16 a[74:75], v15 offset:20800
    v_cvt_pk_bf16_f32 v85, v244, v245
    v_mfma_f32_16x16x32_bf16 a[124:127], a[84:87], v[140:143], a[124:127]
    ds_read_b64_tr_b16 a[76:77], v15 offset:27712
    v_lshlrev_b32 v242, 16, v86
    v_mfma_f32_16x16x32_bf16 a[120:123], a[84:87], v[68:71], a[120:123]
    s_waitcnt lgkmcnt(9)
    ds_read_b64_tr_b16 a[78:79], v15 offset:30016
    buffer_load_dwordx4 v234, s[12:15], s25 offen offset:2048 lds
    v_mfma_f32_16x16x32_bf16 v[160:163], a[88:91], v[72:75], v[160:163]
    ds_read_b64_tr_b16 a[80:81], v15 offset:18528
    v_and_b32_e64 v243, s41, v86
    v_mfma_f32_16x16x32_bf16 v[164:167], a[88:91], v[144:147], v[164:167]
    s_waitcnt lgkmcnt(9)
    ds_read_b64_tr_b16 a[82:83], v15 offset:20832
    v_lshlrev_b32 v244, 16, v87
    v_mfma_f32_16x16x32_bf16 v[164:167], a[92:95], v[148:151], v[164:167]
    ds_read_b64_tr_b16 a[84:85], v15 offset:27744
    v_and_b32 v245, s41, v87
    v_mfma_f32_16x16x32_bf16 v[160:163], a[92:95], v[76:79], v[160:163]
    s_waitcnt lgkmcnt(9)
    ds_read_b64_tr_b16 a[86:87], v15 offset:30048
    v_fma_f32 v242, v242, v238, v239
    v_mfma_f32_16x16x32_bf16 v[168:171], a[64:67], v[72:75], v[168:171]
    ds_read_b64_tr_b16 a[88:89], v15 offset:18560
    buffer_load_dwordx4 v235, s[12:15], s25 offen offset:3072 lds
    v_mfma_f32_16x16x32_bf16 v[172:175], a[64:67], v[144:147], v[172:175]
    s_waitcnt lgkmcnt(9)
    ds_read_b64_tr_b16 a[90:91], v15 offset:20864
    v_fma_f32 v243, v243, v238, v239
    v_mfma_f32_16x16x32_bf16 v[172:175], a[68:71], v[148:151], v[172:175]
    ds_read_b64_tr_b16 a[92:93], v15 offset:27776
    v_fma_f32 v244, v244, v238, v239
    v_mfma_f32_16x16x32_bf16 v[168:171], a[68:71], v[76:79], v[168:171]
    s_waitcnt lgkmcnt(9)
    ds_read_b64_tr_b16 a[94:95], v15 offset:30080
    v_fma_f32 v245, v245, v238, v239
    v_mfma_f32_16x16x32_bf16 v[176:179], a[72:75], v[72:75], v[176:179]
    s_add_u32 m0, s24, 45056
    ds_read_b64_tr_b16 a[64:65], v15 offset:18592
    v_cvt_pk_bf16_f32 v86, v242, v243
    v_mfma_f32_16x16x32_bf16 v[180:183], a[72:75], v[144:147], v[180:183]
    s_waitcnt lgkmcnt(9)
    ds_read_b64_tr_b16 a[66:67], v15 offset:20896
    v_cvt_pk_bf16_f32 v87, v244, v245
    v_mfma_f32_16x16x32_bf16 v[180:183], a[76:79], v[148:151], v[180:183]
    ds_read_b64_tr_b16 a[68:69], v15 offset:27808
    v_lshlrev_b32 v246, 16, v156
    v_mfma_f32_16x16x32_bf16 v[176:179], a[76:79], v[76:79], v[176:179]
    s_waitcnt lgkmcnt(9)
    ds_read_b64_tr_b16 a[70:71], v15 offset:30112
    buffer_load_dwordx4 v236, s[12:15], s25 offen offset:0 lds
    v_mfma_f32_16x16x32_bf16 v[184:187], a[80:83], v[72:75], v[184:187]
    ds_read_b64_tr_b16 a[72:73], v15 offset:18624
    v_and_b32_e64 v247, s41, v156
    v_mfma_f32_16x16x32_bf16 v[188:191], a[80:83], v[144:147], v[188:191]
    s_waitcnt lgkmcnt(9)
    ds_read_b64_tr_b16 a[74:75], v15 offset:20928
    v_lshlrev_b32 v248, 16, v157
    v_mfma_f32_16x16x32_bf16 v[188:191], a[84:87], v[148:151], v[188:191]
    ds_read_b64_tr_b16 a[76:77], v15 offset:27840
    v_and_b32 v249, s41, v157
    v_mfma_f32_16x16x32_bf16 v[184:187], a[84:87], v[76:79], v[184:187]
    s_waitcnt lgkmcnt(9)
    ds_read_b64_tr_b16 a[78:79], v15 offset:30144
    v_fma_f32 v246, v246, v240, v241
    v_mfma_f32_16x16x32_bf16 v[192:195], a[88:91], v[72:75], v[192:195]
    ds_read_b64_tr_b16 a[80:81], v15 offset:18656
    v_fma_f32 v247, v247, v240, v241
    v_mfma_f32_16x16x32_bf16 v[196:199], a[88:91], v[144:147], v[196:199]
    s_waitcnt lgkmcnt(9)
    ds_read_b64_tr_b16 a[82:83], v15 offset:20960
    v_fma_f32 v248, v248, v240, v241
    v_mfma_f32_16x16x32_bf16 v[196:199], a[92:95], v[148:151], v[196:199]
    ds_read_b64_tr_b16 a[84:85], v15 offset:27872
    v_fma_f32 v249, v249, v240, v241
    v_mfma_f32_16x16x32_bf16 v[192:195], a[92:95], v[76:79], v[192:195]
    s_waitcnt lgkmcnt(9)
    ds_read_b64_tr_b16 a[86:87], v15 offset:30176
    v_cvt_pk_bf16_f32 v156, v246, v247
    v_mfma_f32_16x16x32_bf16 a[96:99], a[64:67], v[72:75], a[96:99]
    ds_read_b64_tr_b16 a[88:89], v15 offset:18688
    v_cvt_pk_bf16_f32 v157, v248, v249
    v_mfma_f32_16x16x32_bf16 a[100:103], a[64:67], v[144:147], a[100:103]
    s_waitcnt lgkmcnt(9)
    ds_read_b64_tr_b16 a[90:91], v15 offset:20992
    v_lshlrev_b32_e64 v246, 16, v158
    v_mfma_f32_16x16x32_bf16 a[100:103], a[68:71], v[148:151], a[100:103]
    ds_read_b64_tr_b16 a[92:93], v15 offset:27904
    v_and_b32 v247, s41, v158
    v_mfma_f32_16x16x32_bf16 a[96:99], a[68:71], v[76:79], a[96:99]
    s_waitcnt lgkmcnt(9)
    ds_read_b64_tr_b16 a[94:95], v15 offset:30208
    v_lshlrev_b32_e64 v248, 16, v159
    v_mfma_f32_16x16x32_bf16 a[104:107], a[72:75], v[72:75], a[104:107]
    s_waitcnt vmcnt(10)
    s_barrier
    ds_read_b64_tr_b16 a[64:65], v13 offset:0
    v_mfma_f32_16x16x32_bf16 a[108:111], a[72:75], v[144:147], a[108:111]
    s_waitcnt lgkmcnt(9)
    ds_read_b64_tr_b16 a[66:67], v13 offset:2304
    v_and_b32 v249, s41, v159
    v_mfma_f32_16x16x32_bf16 a[108:111], a[76:79], v[148:151], a[108:111]
    ds_read_b64_tr_b16 a[68:69], v13 offset:9216
    v_fma_f32 v246, v246, v240, v241
    v_mfma_f32_16x16x32_bf16 a[104:107], a[76:79], v[76:79], a[104:107]
    s_waitcnt lgkmcnt(9)
    ds_read_b64_tr_b16 a[70:71], v13 offset:11520
    v_fma_f32 v247, v247, v240, v241
    v_mfma_f32_16x16x32_bf16 a[112:115], a[80:83], v[72:75], a[112:115]
    ds_read_b64_tr_b16 a[72:73], v13 offset:32
    v_fma_f32 v248, v248, v240, v241
    v_mfma_f32_16x16x32_bf16 a[116:119], a[80:83], v[144:147], a[116:119]
    s_waitcnt lgkmcnt(9)
    ds_read_b64_tr_b16 a[74:75], v13 offset:2336
    v_fma_f32 v249, v249, v240, v241
    v_mfma_f32_16x16x32_bf16 a[116:119], a[84:87], v[148:151], a[116:119]
    ds_read_b64_tr_b16 a[76:77], v13 offset:9248
    v_cvt_pk_bf16_f32 v158, v246, v247
    v_mfma_f32_16x16x32_bf16 a[112:115], a[84:87], v[76:79], a[112:115]
    s_waitcnt lgkmcnt(9)
    ds_read_b64_tr_b16 a[78:79], v13 offset:11552
    v_cvt_pk_bf16_f32 v159, v248, v249
    v_mfma_f32_16x16x32_bf16 a[120:123], a[88:91], v[72:75], a[120:123]
    ds_read_b64_tr_b16 a[80:81], v13 offset:64
    v_mfma_f32_16x16x32_bf16 a[124:127], a[88:91], v[144:147], a[124:127]
    s_waitcnt lgkmcnt(9)
    ds_read_b64_tr_b16 a[82:83], v13 offset:2368
    v_mfma_f32_16x16x32_bf16 a[124:127], a[92:95], v[148:151], a[124:127]
    ds_read_b64_tr_b16 a[84:85], v13 offset:9280
    v_mfma_f32_16x16x32_bf16 a[120:123], a[92:95], v[76:79], a[120:123]
    s_waitcnt lgkmcnt(9)
    ds_read_b64_tr_b16 a[86:87], v13 offset:11584
    v_mfma_f32_16x16x32_bf16 v[160:163], a[64:67], v[80:83], v[160:163]
    ds_read_b64_tr_b16 a[88:89], v13 offset:96
    v_mfma_f32_16x16x32_bf16 v[164:167], a[64:67], v[152:155], v[164:167]
    s_waitcnt lgkmcnt(9)
    ds_read_b64_tr_b16 a[90:91], v13 offset:2400
    v_mfma_f32_16x16x32_bf16 v[164:167], a[68:71], v[156:159], v[164:167]
    ds_read_b64_tr_b16 a[92:93], v13 offset:9312
    v_mfma_f32_16x16x32_bf16 v[160:163], a[68:71], v[84:87], v[160:163]
    s_waitcnt lgkmcnt(9)
    ds_read_b64_tr_b16 a[94:95], v13 offset:11616
    v_mfma_f32_16x16x32_bf16 v[168:171], a[72:75], v[80:83], v[168:171]
    ds_read_b64_tr_b16 a[64:65], v13 offset:128
    v_mfma_f32_16x16x32_bf16 v[172:175], a[72:75], v[152:155], v[172:175]
    s_waitcnt lgkmcnt(9)
    ds_read_b64_tr_b16 a[66:67], v13 offset:2432
    v_mfma_f32_16x16x32_bf16 v[172:175], a[76:79], v[156:159], v[172:175]
    s_lshl_b32 s25, s98, 1
    s_add_u32 s25, s25, s4
    s_add_u32 s25, s25, 6
    s_and_b32 s25, s25, 7
    s_add_u32 s54, s4, 6
    s_cmp_lt_u32 s4, 2
    s_cselect_b32 s25, s25, s54
    s_mul_i32 s25, s25, 221184
    ds_read_b64_tr_b16 a[68:69], v13 offset:9344
    v_mfma_f32_16x16x32_bf16 v[168:171], a[76:79], v[84:87], v[168:171]
    s_waitcnt lgkmcnt(9)
    s_add_u32 m0, s24, 73728
    ds_read_b64_tr_b16 a[70:71], v13 offset:11648
    v_mfma_f32_16x16x32_bf16 v[176:179], a[80:83], v[80:83], v[176:179]
    ds_read_b64_tr_b16 a[72:73], v13 offset:160
    buffer_load_dwordx4 v228, s[12:15], s25 offen offset:0 lds
    v_mfma_f32_16x16x32_bf16 v[180:183], a[80:83], v[152:155], v[180:183]
    s_waitcnt lgkmcnt(9)
    ds_read_b64_tr_b16 a[74:75], v13 offset:2464
    v_mfma_f32_16x16x32_bf16 v[180:183], a[84:87], v[156:159], v[180:183]
    ds_read_b64_tr_b16 a[76:77], v13 offset:9376
    buffer_load_dwordx4 v229, s[12:15], s25 offen offset:1024 lds
    v_mfma_f32_16x16x32_bf16 v[176:179], a[84:87], v[84:87], v[176:179]
    s_waitcnt lgkmcnt(9)
    ds_read_b64_tr_b16 a[78:79], v13 offset:11680
    v_mfma_f32_16x16x32_bf16 v[184:187], a[88:91], v[80:83], v[184:187]
    s_barrier
    ds_read_b64_tr_b16 a[80:81], v13 offset:192
    v_mfma_f32_16x16x32_bf16 v[188:191], a[88:91], v[152:155], v[188:191]
    s_waitcnt lgkmcnt(9)
    ds_read_b64_tr_b16 a[82:83], v13 offset:2496
    v_mfma_f32_16x16x32_bf16 v[188:191], a[92:95], v[156:159], v[188:191]
    ds_read_b64_tr_b16 a[84:85], v13 offset:9408
    buffer_load_dwordx4 v230, s[12:15], s25 offen offset:2048 lds
    v_mfma_f32_16x16x32_bf16 v[184:187], a[92:95], v[84:87], v[184:187]
    s_waitcnt lgkmcnt(9)
    ds_read_b64_tr_b16 a[86:87], v13 offset:11712
    v_mfma_f32_16x16x32_bf16 v[192:195], a[64:67], v[80:83], v[192:195]
    ds_read_b64_tr_b16 a[88:89], v13 offset:224
    buffer_load_dwordx4 v231, s[12:15], s25 offen offset:3072 lds
    v_mfma_f32_16x16x32_bf16 v[196:199], a[64:67], v[152:155], v[196:199]
    s_waitcnt lgkmcnt(9)
    ds_read_b64_tr_b16 a[90:91], v13 offset:2528
    v_mfma_f32_16x16x32_bf16 v[196:199], a[68:71], v[156:159], v[196:199]
    ds_read_b64_tr_b16 a[92:93], v13 offset:9440
    v_mfma_f32_16x16x32_bf16 v[192:195], a[68:71], v[84:87], v[192:195]
    s_waitcnt lgkmcnt(9)
    s_add_u32 m0, s24, 77824
    ds_read_b64_tr_b16 a[94:95], v13 offset:11744
    v_mfma_f32_16x16x32_bf16 a[96:99], a[72:75], v[80:83], a[96:99]
    ds_read_b64_tr_b16 a[64:65], v13 offset:256
    buffer_load_dwordx4 v232, s[12:15], s25 offen offset:0 lds
    v_mfma_f32_16x16x32_bf16 a[100:103], a[72:75], v[152:155], a[100:103]
    s_waitcnt lgkmcnt(9)
    ds_read_b64_tr_b16 a[66:67], v13 offset:2560
    v_mfma_f32_16x16x32_bf16 a[100:103], a[76:79], v[156:159], a[100:103]
    ds_read_b64_tr_b16 a[68:69], v13 offset:9472
    v_mfma_f32_16x16x32_bf16 a[96:99], a[76:79], v[84:87], a[96:99]
    s_waitcnt lgkmcnt(9)
    ds_read_b64_tr_b16 a[70:71], v13 offset:11776
    buffer_load_dwordx4 v233, s[12:15], s25 offen offset:1024 lds
    v_mfma_f32_16x16x32_bf16 a[104:107], a[80:83], v[80:83], a[104:107]
    v_mfma_f32_16x16x32_bf16 a[108:111], a[80:83], v[152:155], a[108:111]
    s_waitcnt lgkmcnt(8)
    v_mfma_f32_16x16x32_bf16 a[108:111], a[84:87], v[156:159], a[108:111]
    buffer_load_dwordx4 v234, s[12:15], s25 offen offset:2048 lds
    v_mfma_f32_16x16x32_bf16 a[104:107], a[84:87], v[84:87], a[104:107]
    s_waitcnt lgkmcnt(6)
    v_mfma_f32_16x16x32_bf16 a[112:115], a[88:91], v[80:83], a[112:115]
    v_mfma_f32_16x16x32_bf16 a[116:119], a[88:91], v[152:155], a[116:119]
    s_waitcnt lgkmcnt(4)
    v_mfma_f32_16x16x32_bf16 a[116:119], a[92:95], v[156:159], a[116:119]
    buffer_load_dwordx4 v235, s[12:15], s25 offen offset:3072 lds
    v_mfma_f32_16x16x32_bf16 a[112:115], a[92:95], v[84:87], a[112:115]
    s_waitcnt lgkmcnt(2)
    s_add_u32 m0, s24, 81920
    v_mfma_f32_16x16x32_bf16 a[120:123], a[64:67], v[80:83], a[120:123]
    v_mfma_f32_16x16x32_bf16 a[124:127], a[64:67], v[152:155], a[124:127]
    s_waitcnt lgkmcnt(0)
    v_mfma_f32_16x16x32_bf16 a[124:127], a[68:71], v[156:159], a[124:127]
    buffer_load_dwordx4 v236, s[12:15], s25 offen offset:0 lds
    v_mfma_f32_16x16x32_bf16 a[120:123], a[68:71], v[84:87], a[120:123]
    v_cvt_pk_bf16_f32 v200, v160, v161
    v_cvt_pk_bf16_f32 v201, v162, v163
    v_cvt_pk_bf16_f32 v202, v168, v169
    v_cvt_pk_bf16_f32 v203, v170, v171
    v_cvt_pk_bf16_f32 v204, v176, v177
    v_cvt_pk_bf16_f32 v205, v178, v179
    v_cvt_pk_bf16_f32 v206, v184, v185
    v_cvt_pk_bf16_f32 v207, v186, v187
    v_cvt_pk_bf16_f32 v208, v192, v193
    v_cvt_pk_bf16_f32 v209, v194, v195
    v_mov_b64 v[220:221], v[192:193]
    v_mov_b64 v[222:223], v[194:195]
    v_cvt_pk_bf16_f32 v210, v164, v165
    v_cvt_pk_bf16_f32 v211, v166, v167
    v_cvt_pk_bf16_f32 v212, v172, v173
    v_cvt_pk_bf16_f32 v213, v174, v175
    v_cvt_pk_bf16_f32 v214, v180, v181
    v_cvt_pk_bf16_f32 v215, v182, v183
    v_cvt_pk_bf16_f32 v216, v188, v189
    v_cvt_pk_bf16_f32 v217, v190, v191
    v_cvt_pk_bf16_f32 v218, v196, v197
    v_cvt_pk_bf16_f32 v219, v198, v199
    v_mov_b64 v[224:225], v[196:197]
    v_mov_b64 v[226:227], v[198:199]
    s_waitcnt vmcnt(18)
    v_cmp_gt_u32 vcc, 2, v250
    s_cbranch_vccnz Ls10
Lb11:
    ds_read_b64_tr_b16 a[64:65], v13 offset:18432
    ds_read_b64_tr_b16 a[66:67], v13 offset:20736
    ds_read_b64_tr_b16 a[68:69], v13 offset:18576
    ds_read_b64_tr_b16 a[70:71], v13 offset:20880
    ds_read_b64_tr_b16 a[72:73], v13 offset:18464
    ds_read_b64_tr_b16 a[74:75], v13 offset:20768
    ds_read_b64_tr_b16 a[76:77], v13 offset:18608
    ds_read_b64_tr_b16 a[78:79], v13 offset:20912
    ds_read_b64_tr_b16 a[80:81], v13 offset:18496
    ds_read_b64_tr_b16 a[82:83], v13 offset:20800
    ds_read_b64_tr_b16 a[84:85], v13 offset:18640
    ds_read_b64_tr_b16 a[86:87], v13 offset:20944
    s_waitcnt lgkmcnt(10)
    v_mfma_f32_16x16x32_bf16 v[160:163], a[64:67], v[16:19], 0
    ds_read_b64_tr_b16 a[88:89], v13 offset:18528
    v_lshlrev_b32_e64 v4, 4, v1
    v_mfma_f32_16x16x32_bf16 v[164:167], a[64:67], v[88:91], 0
    s_waitcnt lgkmcnt(9)
    s_lshl_b32 s27, s37, 13
    ds_read_b64_tr_b16 a[90:91], v13 offset:20832
    v_mfma_f32_16x16x32_bf16 v[164:167], a[68:71], v[92:95], v[164:167]
    s_add_u32 s27, s27, 4980736
    s_add_u32 s28, s27, 4096
    s_and_b32 s29, s6, 1
    s_lshl_b32 s30, s29, 2
    ds_read_b64_tr_b16 a[92:93], v13 offset:18672
    v_mfma_f32_16x16x32_bf16 v[160:163], a[68:71], v[20:23], v[160:163]
    s_waitcnt lgkmcnt(9)
    s_add_u32 s30, s30, s4
    s_lshl_b32 s30, s30, 3
    ds_read_b64_tr_b16 a[94:95], v13 offset:20976
    v_mfma_f32_16x16x32_bf16 v[168:171], a[72:75], v[16:19], 0
    ds_read_b64_tr_b16 a[64:65], v13 offset:18560
    v_bfe_u32 v242, v2, 1, 1
    v_mfma_f32_16x16x32_bf16 v[172:175], a[72:75], v[88:91], 0
    s_waitcnt lgkmcnt(9)
    ds_read_b64_tr_b16 a[66:67], v13 offset:20864
    v_mul_u32_u24 v242, 72, v242
    v_mfma_f32_16x16x32_bf16 v[172:175], a[76:79], v[92:95], v[172:175]
    ds_read_b64_tr_b16 a[68:69], v13 offset:18704
    v_lshrrev_b32 v243, 2, v2
    v_mfma_f32_16x16x32_bf16 v[168:171], a[76:79], v[20:23], v[168:171]
    s_waitcnt lgkmcnt(9)
    s_cmp_lg_u32 s4, 3
    s_cbranch_scc1 Lk13
    s_bitcmp1_b32 s6, 0
    s_cbranch_scc1 Lk12
    buffer_store_dwordx4 v[210:213], v4, s[16:19], s27 offen offset:0 sc1
    buffer_store_dwordx4 v[214:217], v4, s[16:19], s27 offen offset:1024 sc1
    buffer_store_dwordx4 v[218:221], v4, s[16:19], s27 offen offset:2048 sc1
    buffer_store_dwordx4 v[224:227], v4, s[16:19], s27 offen offset:3072 sc1
    buffer_store_dwordx4 a[100:103], v4, s[16:19], s28 offen offset:0 sc1
    buffer_store_dwordx4 a[108:111], v4, s[16:19], s28 offen offset:1024 sc1
    buffer_store_dwordx4 a[116:119], v4, s[16:19], s28 offen offset:2048 sc1
    buffer_store_dwordx4 a[124:127], v4, s[16:19], s28 offen offset:3072 sc1
    s_branch Lk13
Lk12:
    buffer_store_dwordx4 v[200:203], v4, s[16:19], s27 offen offset:0 sc1
    buffer_store_dwordx4 v[204:207], v4, s[16:19], s27 offen offset:1024 sc1
    buffer_store_dwordx4 v[208:211], v4, s[16:19], s27 offen offset:2048 sc1
    buffer_store_dwordx4 v[220:223], v4, s[16:19], s27 offen offset:3072 sc1
    buffer_store_dwordx4 a[96:99], v4, s[16:19], s28 offen offset:0 sc1
    buffer_store_dwordx4 a[104:107], v4, s[16:19], s28 offen offset:1024 sc1
    buffer_store_dwordx4 a[112:115], v4, s[16:19], s28 offen offset:2048 sc1
    buffer_store_dwordx4 a[120:123], v4, s[16:19], s28 offen offset:3072 sc1
Lk13:
    ds_read_b64_tr_b16 a[70:71], v13 offset:21008
    v_lshl_add_u32 v242, v243, 1, v242
    v_mfma_f32_16x16x32_bf16 v[176:179], a[80:83], v[16:19], 0
    ds_read_b64_tr_b16 a[72:73], v13 offset:27648
    v_and_b32_e64 v243, 1, v2
    v_mfma_f32_16x16x32_bf16 v[180:183], a[80:83], v[88:91], 0
    s_waitcnt lgkmcnt(9)
    ds_read_b64_tr_b16 a[74:75], v13 offset:29952
    v_add3_u32 v242, v242, v243, s30
    v_mfma_f32_16x16x32_bf16 v[180:183], a[84:87], v[92:95], v[180:183]
    s_lshl_b32 s31, s4, 12
    ds_read_b64_tr_b16 a[76:77], v13 offset:27792
    v_mul_u32_u24 v243, 80, v242
    v_mfma_f32_16x16x32_bf16 v[176:179], a[84:87], v[20:23], v[176:179]
    s_waitcnt lgkmcnt(9)
    ds_read_b64_tr_b16 a[78:79], v13 offset:30096
    v_mul_u32_u24_e64 v242, 48, v242
    v_mfma_f32_16x16x32_bf16 v[184:187], a[88:91], v[16:19], 0
    s_add_u32 s54, s64, 0
    ds_read_b64_tr_b16 a[80:81], v13 offset:27680
    v_lshl_add_u32 v5, v3, 3, v242
    v_mfma_f32_16x16x32_bf16 v[188:191], a[88:91], v[88:91], 0
    s_waitcnt lgkmcnt(9)
    ds_read_b64_tr_b16 a[82:83], v13 offset:29984
    v_lshl_add_u32 v9, v3, 4, v243
    v_mfma_f32_16x16x32_bf16 v[188:191], a[92:95], v[92:95], v[188:191]
    s_add_u32 m0, s31, 110592
    ds_read_b64_tr_b16 a[84:85], v13 offset:27824
    v_add_u32 v9, 27648, v9
    v_mfma_f32_16x16x32_bf16 v[184:187], a[92:95], v[20:23], v[184:187]
    s_waitcnt lgkmcnt(9)
    ds_read_b64_tr_b16 a[86:87], v13 offset:30128
    v_min_u32 v242, 1, v3
    v_mfma_f32_16x16x32_bf16 v[192:195], a[64:67], v[16:19], 0
    ds_read_b64_tr_b16 a[88:89], v13 offset:27712
    buffer_load_dwordx4 v252, s[20:23], s54 offen lds
    v_lshrrev_b32 v243, 1, v3
    v_mfma_f32_16x16x32_bf16 v[196:199], a[64:67], v[88:91], 0
    s_waitcnt lgkmcnt(9)
    ds_read_b64_tr_b16 a[90:91], v13 offset:30016
    v_add_u32_e64 v244, 1, v3
    v_mfma_f32_16x16x32_bf16 v[196:199], a[68:71], v[92:95], v[196:199]
    s_add_u32 s54, s64, 73728
    s_add_u32 m0, s31, 111616
    ds_read_b64_tr_b16 a[92:93], v13 offset:27856
    v_lshrrev_b32 v244, 2, v244
    v_mfma_f32_16x16x32_bf16 v[192:195], a[68:71], v[20:23], v[192:195]
    s_waitcnt lgkmcnt(9)
    s_mov_b32 s30, 6876
    ds_read_b64_tr_b16 a[94:95], v13 offset:30160
    v_mfma_f32_16x16x32_bf16 v[160:163], a[72:75], v[24:27], v[160:163]
    ds_read_b64_tr_b16 a[64:65], v13 offset:27744
    v_mad_u32_u24 v6, v242, s30, v5
    v_mad_u32_u24 v7, v243, s30, v5
    v_mfma_f32_16x16x32_bf16 v[164:167], a[72:75], v[96:99], v[164:167]
    s_waitcnt lgkmcnt(9)
    s_mov_b32 s30, 11448
    ds_read_b64_tr_b16 a[66:67], v13 offset:30048
    v_mfma_f32_16x16x32_bf16 v[164:167], a[76:79], v[100:103], v[164:167]
    ds_read_b64_tr_b16 a[68:69], v13 offset:27888
    buffer_load_dwordx4 v253, s[20:23], s54 offen lds
    v_mad_u32_u24 v10, v243, s30, v9
    v_mfma_f32_16x16x32_bf16 v[160:163], a[76:79], v[28:31], v[160:163]
    s_waitcnt lgkmcnt(9)
    s_add_u32 s54, s64, 147456
    s_add_u32 m0, s31, 112640
    ds_read_b64_tr_b16 a[70:71], v13 offset:30192
    v_mad_u32_u24 v11, v244, s30, v9
    v_mfma_f32_16x16x32_bf16 v[168:171], a[80:83], v[24:27], v[168:171]
    ds_read_b64_tr_b16 a[72:73], v13 offset:27776
    v_lshlrev_b32 v242, 3, v1
    v_mfma_f32_16x16x32_bf16 v[172:175], a[80:83], v[96:99], v[172:175]
    s_waitcnt lgkmcnt(9)
    ds_read_b64_tr_b16 a[74:75], v13 offset:30080
    v_add_u32 v242, 103936, v242
    v_mfma_f32_16x16x32_bf16 v[172:175], a[84:87], v[100:103], v[172:175]
    ds_read_b64_tr_b16 a[76:77], v13 offset:27920
    buffer_load_dwordx4 v252, s[20:23], s54 offen lds
    v_add_u32 v8, 20756, v5
    v_mfma_f32_16x16x32_bf16 v[168:171], a[84:87], v[28:31], v[168:171]
    s_waitcnt lgkmcnt(9)
    s_add_u32 s54, s64, 221184
    ds_read_b64_tr_b16 a[78:79], v13 offset:30224
    v_subrev_u32 v12, 32, v9
    v_mfma_f32_16x16x32_bf16 v[176:179], a[88:91], v[24:27], v[176:179]
    s_waitcnt vmcnt(12)
    s_barrier
    s_add_u32 m0, s31, 113664
    ds_read_b64_tr_b16 a[80:81], v13 offset:36864
    v_cmp_gt_u32 vcc, 2, v3
    v_mfma_f32_16x16x32_bf16 v[180:183], a[88:91], v[96:99], v[180:183]
    s_waitcnt lgkmcnt(9)
    ds_read_b64_tr_b16 a[82:83], v13 offset:39168
    v_cndmask_b32_e64 v8, v242, v8, vcc
    v_mfma_f32_16x16x32_bf16 v[180:183], a[92:95], v[100:103], v[180:183]
    ds_read_b64_tr_b16 a[84:85], v13 offset:37008
    buffer_load_dwordx4 v253, s[20:23], s54 offen lds
    v_cndmask_b32_e64 v12, v12, v242, vcc
    v_mfma_f32_16x16x32_bf16 v[176:179], a[92:95], v[28:31], v[176:179]
    s_waitcnt lgkmcnt(9)
    s_mul_i32 s30, s29, -3072
    s_add_u32 s30, s30, 1536
    ds_read_b64_tr_b16 a[86:87], v13 offset:39312
    v_mfma_f32_16x16x32_bf16 v[184:187], a[64:67], v[24:27], v[184:187]
Lpad0_3:
    s_cbranch_execz Lpadret
    s_add_u32 s54, s64, 128
    ds_read_b64_tr_b16 a[88:89], v13 offset:36896
    v_add_u32 v228, s30, v5
    v_mfma_f32_16x16x32_bf16 v[188:191], a[64:67], v[96:99], v[188:191]
    s_waitcnt lgkmcnt(9)
    ds_read_b64_tr_b16 a[90:91], v13 offset:39200
    v_add_u32_e64 v229, s30, v6
    v_mfma_f32_16x16x32_bf16 v[188:191], a[68:71], v[100:103], v[188:191]
    s_add_u32 m0, s31, 126976
    ds_read_b64_tr_b16 a[92:93], v13 offset:37040
    v_add_u32_e64 v230, s30, v7
    v_mfma_f32_16x16x32_bf16 v[184:187], a[68:71], v[28:31], v[184:187]
    s_waitcnt lgkmcnt(9)
    ds_read_b64_tr_b16 a[94:95], v13 offset:39344
    buffer_load_dwordx4 v252, s[20:23], s54 offen lds
    v_add_u32 v231, s30, v8
    v_mfma_f32_16x16x32_bf16 v[192:195], a[72:75], v[24:27], v[192:195]
    s_mul_i32 s30, s29, -5120
    s_add_u32 s30, s30, 2560
    s_add_u32 s54, s64, 73856
    ds_read_b64_tr_b16 a[64:65], v13 offset:36928
    v_mfma_f32_16x16x32_bf16 v[196:199], a[72:75], v[96:99], v[196:199]
    s_waitcnt lgkmcnt(9)
    ds_read_b64_tr_b16 a[66:67], v13 offset:39232
    v_add_u32 v232, s30, v9
    v_mfma_f32_16x16x32_bf16 v[196:199], a[76:79], v[100:103], v[196:199]
    s_add_u32 m0, s31, 128000
    ds_read_b64_tr_b16 a[68:69], v13 offset:37072
    v_add_u32_e64 v233, s30, v10
    v_mfma_f32_16x16x32_bf16 v[192:195], a[76:79], v[28:31], v[192:195]
    s_waitcnt lgkmcnt(9)
    ds_read_b64_tr_b16 a[70:71], v13 offset:39376
    v_add_u32 v234, s30, v11
    v_add_u32_e64 v235, s30, v12
    v_mfma_f32_16x16x32_bf16 v[160:163], a[80:83], v[32:35], v[160:163]
    ds_read_b64_tr_b16 a[72:73], v13 offset:36960
    buffer_load_dwordx4 v253, s[20:23], s54 offen lds
    v_mfma_f32_16x16x32_bf16 v[164:167], a[80:83], v[104:107], v[164:167]
    s_waitcnt lgkmcnt(9)
    s_add_u32 s54, s64, 147584
    ds_read_b64_tr_b16 a[74:75], v13 offset:39264
    v_mfma_f32_16x16x32_bf16 v[164:167], a[84:87], v[108:111], v[164:167]
    s_add_u32 m0, s31, 129024
    ds_read_b64_tr_b16 a[76:77], v13 offset:37104
    v_bfe_u32 v250, v1, 3, 2
    v_mfma_f32_16x16x32_bf16 v[160:163], a[84:87], v[36:39], v[160:163]
    s_waitcnt lgkmcnt(9)
    ds_read_b64_tr_b16 a[78:79], v13 offset:39408
    buffer_load_dwordx4 v252, s[20:23], s54 offen lds
    v_mfma_f32_16x16x32_bf16 v[168:171], a[88:91], v[32:35], v[168:171]
    ds_read_b64_tr_b16 a[80:81], v13 offset:36992
    v_lshlrev_b32 v250, 5, v250
    v_mfma_f32_16x16x32_bf16 v[172:175], a[88:91], v[104:107], v[172:175]
    s_waitcnt lgkmcnt(9)
    s_add_u32 s54, s64, 221312
    ds_read_b64_tr_b16 a[82:83], v13 offset:39296
    v_mfma_f32_16x16x32_bf16 v[172:175], a[92:95], v[108:111], v[172:175]
    s_add_u32 m0, s31, 130048
    ds_read_b64_tr_b16 a[84:85], v13 offset:37136
    v_and_b32_e64 v246, 3, v1
    v_mfma_f32_16x16x32_bf16 v[168:171], a[92:95], v[36:39], v[168:171]
    s_waitcnt lgkmcnt(9)
    ds_read_b64_tr_b16 a[86:87], v13 offset:39440
    buffer_load_dwordx4 v253, s[20:23], s54 offen lds
    v_mfma_f32_16x16x32_bf16 v[176:179], a[64:67], v[32:35], v[176:179]
    ds_read_b64_tr_b16 a[88:89], v13 offset:46080
    v_lshl_add_u32 v250, v246, 3, v250
    v_mfma_f32_16x16x32_bf16 v[180:183], a[64:67], v[104:107], v[180:183]
    s_waitcnt lgkmcnt(9)
    ds_read_b64_tr_b16 a[90:91], v13 offset:48384
    v_bfe_u32 v246, v1, 2, 2
    v_mfma_f32_16x16x32_bf16 v[180:183], a[68:71], v[108:111], v[180:183]
    s_add_u32 s54, s64, 256
    ds_read_b64_tr_b16 a[92:93], v13 offset:46224
    v_lshl_add_u32 v250, v246, 7, v250
    v_mfma_f32_16x16x32_bf16 v[176:179], a[68:71], v[36:39], v[176:179]
    s_waitcnt lgkmcnt(9)
    s_add_u32 m0, s31, 143360
    ds_read_b64_tr_b16 a[94:95], v13 offset:48528
    v_mfma_f32_16x16x32_bf16 v[184:187], a[72:75], v[32:35], v[184:187]
    ds_read_b64_tr_b16 a[64:65], v13 offset:46112
    buffer_load_dwordx4 v252, s[20:23], s54 offen lds
    v_mfma_f32_16x16x32_bf16 v[188:191], a[72:75], v[104:107], v[188:191]
    s_waitcnt lgkmcnt(9)
    ds_read_b64_tr_b16 a[66:67], v13 offset:48416
    v_lshl_add_u32 v250, v3, 10, v250
    v_mfma_f32_16x16x32_bf16 v[188:191], a[76:79], v[108:111], v[188:191]
    ds_read_b64_tr_b16 a[68:69], v13 offset:46256
    v_lshl_add_u32 v246, s4, 12, v250
    v_mfma_f32_16x16x32_bf16 v[184:187], a[76:79], v[36:39], v[184:187]
    s_waitcnt lgkmcnt(9)
    s_add_u32 s54, s64, 73984
    ds_read_b64_tr_b16 a[70:71], v13 offset:48560
    v_mfma_f32_16x16x32_bf16 v[192:195], a[80:83], v[32:35], v[192:195]
    s_add_u32 m0, s31, 144384
    ds_read_b64_tr_b16 a[72:73], v13 offset:46144
    v_xor_b32_e64 v247, 32, v246
    v_mfma_f32_16x16x32_bf16 v[196:199], a[80:83], v[104:107], v[196:199]
    s_waitcnt lgkmcnt(9)
    ds_read_b64_tr_b16 a[74:75], v13 offset:48448
    v_xor_b32_e64 v248, 64, v246
    v_mfma_f32_16x16x32_bf16 v[196:199], a[84:87], v[108:111], v[196:199]
    ds_read_b64_tr_b16 a[76:77], v13 offset:46288
    buffer_load_dwordx4 v253, s[20:23], s54 offen lds
    v_mfma_f32_16x16x32_bf16 v[192:195], a[84:87], v[36:39], v[192:195]
    s_waitcnt lgkmcnt(9)
    ds_read_b64_tr_b16 a[78:79], v13 offset:48592
    v_xor_b32 v249, 96, v246
    v_mfma_f32_16x16x32_bf16 v[160:163], a[88:91], v[40:43], v[160:163]
    s_add_u32 s54, s64, 147712
    ds_read_b64_tr_b16 a[80:81], v13 offset:46176
    v_add_u32 v246, 110592, v246
    v_mfma_f32_16x16x32_bf16 v[164:167], a[88:91], v[112:115], v[164:167]
    s_waitcnt lgkmcnt(9)
    s_add_u32 m0, s31, 145408
    ds_read_b64_tr_b16 a[82:83], v13 offset:48480
    v_mfma_f32_16x16x32_bf16 v[164:167], a[92:95], v[116:119], v[164:167]
    ds_read_b64_tr_b16 a[84:85], v13 offset:46320
    buffer_load_dwordx4 v252, s[20:23], s54 offen lds
    v_mfma_f32_16x16x32_bf16 v[160:163], a[92:95], v[44:47], v[160:163]
    s_waitcnt lgkmcnt(9)
    ds_read_b64_tr_b16 a[86:87], v13 offset:48624
    v_add_u32 v247, 110592, v247
    v_mfma_f32_16x16x32_bf16 v[168:171], a[64:67], v[40:43], v[168:171]
    ds_read_b64_tr_b16 a[88:89], v13 offset:46208
    v_add_u32 v248, 110592, v248
    v_mfma_f32_16x16x32_bf16 v[172:175], a[64:67], v[112:115], v[172:175]
    s_waitcnt lgkmcnt(9)
    s_add_u32 s54, s64, 221440
    ds_read_b64_tr_b16 a[90:91], v13 offset:48512
    v_mfma_f32_16x16x32_bf16 v[172:175], a[68:71], v[116:119], v[172:175]
    s_add_u32 m0, s31, 146432
    ds_read_b64_tr_b16 a[92:93], v13 offset:46352
    v_add_u32 v249, 110592, v249
    v_mfma_f32_16x16x32_bf16 v[168:171], a[68:71], v[44:47], v[168:171]
    s_waitcnt lgkmcnt(9)
    ds_read_b64_tr_b16 a[94:95], v13 offset:48656
    buffer_load_dwordx4 v253, s[20:23], s54 offen lds
    v_mfma_f32_16x16x32_bf16 v[176:179], a[72:75], v[40:43], v[176:179]
    ds_read_b64_tr_b16 a[64:65], v14 offset:0
    v_mfma_f32_16x16x32_bf16 v[180:183], a[72:75], v[112:115], v[180:183]
    s_waitcnt lgkmcnt(9)
    ds_read_b64_tr_b16 a[66:67], v14 offset:2304
    v_mfma_f32_16x16x32_bf16 v[180:183], a[76:79], v[116:119], v[180:183]
    ds_read_b64_tr_b16 a[68:69], v14 offset:144
    v_mfma_f32_16x16x32_bf16 v[176:179], a[76:79], v[44:47], v[176:179]
    s_waitcnt lgkmcnt(9)
    ds_read_b64_tr_b16 a[70:71], v14 offset:2448
    v_mfma_f32_16x16x32_bf16 v[184:187], a[80:83], v[40:43], v[184:187]
    ds_read_b64_tr_b16 a[72:73], v14 offset:32
    v_mfma_f32_16x16x32_bf16 v[188:191], a[80:83], v[112:115], v[188:191]
    s_waitcnt lgkmcnt(9)
    s_lshl_b32 s70, s37, 7
    s_add_u32 s70, s70, 65536
    s_cmp_lg_u32 s4, 3
    s_cbranch_scc1 Lk14
    s_waitcnt vmcnt(12)
    s_atomic_add s36, s[68:69], s70
Lk14:
    ds_read_b64_tr_b16 a[74:75], v14 offset:2336
    v_mfma_f32_16x16x32_bf16 v[188:191], a[84:87], v[116:119], v[188:191]
    s_nop 0
    ds_read_b64_tr_b16 a[76:77], v14 offset:176
    ds_write_b32 v5, v200 offset:384
    v_mfma_f32_16x16x32_bf16 v[184:187], a[84:87], v[44:47], v[184:187]
    s_waitcnt lgkmcnt(10)
    ds_read_b64_tr_b16 a[78:79], v14 offset:2480
    v_mfma_f32_16x16x32_bf16 v[192:195], a[88:91], v[40:43], v[192:195]
    ds_read_b64_tr_b16 a[80:81], v14 offset:64
    v_mfma_f32_16x16x32_bf16 v[196:199], a[88:91], v[112:115], v[196:199]
    s_waitcnt lgkmcnt(10)
    ds_read_b64_tr_b16 a[82:83], v14 offset:2368
    v_mfma_f32_16x16x32_bf16 v[196:199], a[92:95], v[116:119], v[196:199]
    s_nop 0
    ds_read_b64_tr_b16 a[84:85], v14 offset:208
    ds_write_b32 v5, v201 offset:388
    v_mfma_f32_16x16x32_bf16 v[192:195], a[92:95], v[44:47], v[192:195]
    s_waitcnt lgkmcnt(11)
    ds_read_b64_tr_b16 a[86:87], v14 offset:2512
    v_mfma_f32_16x16x32_bf16 v[160:163], a[64:67], v[48:51], v[160:163]
    s_nop 0
    ds_read_b64_tr_b16 a[88:89], v14 offset:96
    ds_write_b32 v6, v202 offset:416
    v_mfma_f32_16x16x32_bf16 v[164:167], a[64:67], v[120:123], v[164:167]
    s_waitcnt lgkmcnt(12)
    ds_read_b64_tr_b16 a[90:91], v14 offset:2400
    v_mfma_f32_16x16x32_bf16 v[164:167], a[68:71], v[124:127], v[164:167]
    ds_read_b64_tr_b16 a[92:93], v14 offset:240
    v_mfma_f32_16x16x32_bf16 v[160:163], a[68:71], v[52:55], v[160:163]
    s_waitcnt lgkmcnt(12)
    ds_read_b64_tr_b16 a[94:95], v14 offset:2544
    ds_write_b32 v5, v203 offset:7296
    v_mfma_f32_16x16x32_bf16 v[168:171], a[72:75], v[48:51], v[168:171]
    ds_read_b64_tr_b16 a[64:65], v14 offset:128
    v_mfma_f32_16x16x32_bf16 v[172:175], a[72:75], v[120:123], v[172:175]
    s_waitcnt lgkmcnt(12)
    ds_read_b64_tr_b16 a[66:67], v14 offset:2432
    v_mfma_f32_16x16x32_bf16 v[172:175], a[76:79], v[124:127], v[172:175]
    s_nop 0
    ds_read_b64_tr_b16 a[68:69], v14 offset:272
    ds_write_b32 v6, v204 offset:7324
    v_mfma_f32_16x16x32_bf16 v[168:171], a[76:79], v[52:55], v[168:171]
    s_waitcnt lgkmcnt(13)
    ds_read_b64_tr_b16 a[70:71], v14 offset:2576
    v_mfma_f32_16x16x32_bf16 v[176:179], a[80:83], v[48:51], v[176:179]
    s_nop 0
    ds_read_b64_tr_b16 a[72:73], v14 offset:9216
    ds_write_b32 v6, v205 offset:7328
    v_mfma_f32_16x16x32_bf16 v[180:183], a[80:83], v[120:123], v[180:183]
    s_waitcnt lgkmcnt(13)
    ds_read_b64_tr_b16 a[74:75], v14 offset:11520
    v_mfma_f32_16x16x32_bf16 v[180:183], a[84:87], v[124:127], v[180:183]
    ds_read_b64_tr_b16 a[76:77], v14 offset:9360
    v_mfma_f32_16x16x32_bf16 v[176:179], a[84:87], v[52:55], v[176:179]
    s_waitcnt lgkmcnt(12)
    ds_read_b64_tr_b16 a[78:79], v14 offset:11664
    ds_write_b32 v7, v206 offset:14232
    v_mfma_f32_16x16x32_bf16 v[184:187], a[88:91], v[48:51], v[184:187]
    ds_read_b64_tr_b16 a[80:81], v14 offset:9248
    v_mfma_f32_16x16x32_bf16 v[188:191], a[88:91], v[120:123], v[188:191]
    s_waitcnt lgkmcnt(13)
    ds_read_b64_tr_b16 a[82:83], v14 offset:11552
    v_mfma_f32_16x16x32_bf16 v[188:191], a[92:95], v[124:127], v[188:191]
    s_nop 0
    ds_read_b64_tr_b16 a[84:85], v14 offset:9392
    ds_write_b32 v6, v207 offset:14236
    v_mfma_f32_16x16x32_bf16 v[184:187], a[92:95], v[52:55], v[184:187]
    s_waitcnt lgkmcnt(13)
    ds_read_b64_tr_b16 a[86:87], v14 offset:11696
    v_mfma_f32_16x16x32_bf16 v[192:195], a[64:67], v[48:51], v[192:195]
    ds_read_b64_tr_b16 a[88:89], v14 offset:9280
    v_mfma_f32_16x16x32_bf16 v[196:199], a[64:67], v[120:123], v[196:199]
    s_waitcnt lgkmcnt(12)
    ds_read_b64_tr_b16 a[90:91], v14 offset:11584
    v_mfma_f32_16x16x32_bf16 v[196:199], a[68:71], v[124:127], v[196:199]
    s_nop 0
    ds_read_b64_tr_b16 a[92:93], v14 offset:9424
    ds_write_b32 v8, v208 offset:384
    v_mfma_f32_16x16x32_bf16 v[192:195], a[68:71], v[52:55], v[192:195]
    s_waitcnt lgkmcnt(12)
    ds_read_b64_tr_b16 a[94:95], v14 offset:11728
    ds_write_b32 v8, v209 offset:388
    v_mfma_f32_16x16x32_bf16 v[160:163], a[72:75], v[56:59], v[160:163]
    ds_read_b64_tr_b16 a[64:65], v14 offset:9312
    v_mfma_f32_16x16x32_bf16 v[164:167], a[72:75], v[128:131], v[164:167]
    s_waitcnt lgkmcnt(13)
    ds_read_b64_tr_b16 a[66:67], v14 offset:11616
    v_mfma_f32_16x16x32_bf16 v[164:167], a[76:79], v[132:135], v[164:167]
    s_nop 0
    ds_read_b64_tr_b16 a[68:69], v14 offset:9456
    ds_write_b32 v228, v210 offset:384
    v_mfma_f32_16x16x32_bf16 v[160:163], a[76:79], v[60:63], v[160:163]
    s_waitcnt lgkmcnt(13)
    ds_read_b64_tr_b16 a[70:71], v14 offset:11760
    v_mfma_f32_16x16x32_bf16 v[168:171], a[80:83], v[56:59], v[168:171]
    ds_read_b64_tr_b16 a[72:73], v14 offset:9344
    v_mfma_f32_16x16x32_bf16 v[172:175], a[80:83], v[128:131], v[172:175]
    s_waitcnt lgkmcnt(12)
    ds_read_b64_tr_b16 a[74:75], v14 offset:11648
    v_mfma_f32_16x16x32_bf16 v[172:175], a[84:87], v[132:135], v[172:175]
    s_nop 0
    ds_read_b64_tr_b16 a[76:77], v14 offset:9488
    ds_write_b32 v228, v211 offset:388
    v_mfma_f32_16x16x32_bf16 v[168:171], a[84:87], v[60:63], v[168:171]
    s_waitcnt lgkmcnt(13)
    ds_read_b64_tr_b16 a[78:79], v14 offset:11792
    v_mfma_f32_16x16x32_bf16 v[176:179], a[88:91], v[56:59], v[176:179]
    s_waitcnt vmcnt(12)
    s_barrier
    ds_read_b64_tr_b16 a[80:81], v14 offset:18432
    ds_write_b32 v229, v212 offset:416
    v_mfma_f32_16x16x32_bf16 v[180:183], a[88:91], v[128:131], v[180:183]
    s_waitcnt lgkmcnt(13)
    s_sub_u32 s27, s27, 65536
    s_cmp_eq_u32 s4, 0
    s_cselect_b32 s43, 1, 0
    s_cmp_eq_u32 s46, 0
    s_cselect_b32 s43, 0, s43
    s_cmp_eq_u32 s43, 0
    s_cselect_b32 s27, 1073741824, s27
    s_mov_b32 s71, 0
    s_cbranch_scc1 Lk15
    s_sub_u32 s70, s70, 1024
    s_atomic_add s71, s[68:69], s70 glc
Lk15:
    s_add_u32 s28, s27, 4096
    ds_read_b64_tr_b16 a[82:83], v14 offset:20736
    v_mfma_f32_16x16x32_bf16 v[180:183], a[92:95], v[132:135], v[180:183]
    ds_read_b64_tr_b16 a[84:85], v14 offset:18576
    v_mfma_f32_16x16x32_bf16 v[176:179], a[92:95], v[60:63], v[176:179]
    s_waitcnt lgkmcnt(12)
    ds_read_b64_tr_b16 a[86:87], v14 offset:20880
    ds_write_b32 v228, v213 offset:7296
    v_mfma_f32_16x16x32_bf16 v[184:187], a[64:67], v[56:59], v[184:187]
    ds_read_b64_tr_b16 a[88:89], v14 offset:18464
    v_mfma_f32_16x16x32_bf16 v[188:191], a[64:67], v[128:131], v[188:191]
    s_waitcnt lgkmcnt(12)
    ds_read_b64_tr_b16 a[90:91], v14 offset:20768
    v_mfma_f32_16x16x32_bf16 v[188:191], a[68:71], v[132:135], v[188:191]
    s_nop 0
    ds_read_b64_tr_b16 a[92:93], v14 offset:18608
    ds_write_b32 v229, v214 offset:7324
    v_mfma_f32_16x16x32_bf16 v[184:187], a[68:71], v[60:63], v[184:187]
    s_waitcnt lgkmcnt(13)
    ds_read_b64_tr_b16 a[94:95], v14 offset:20912
    v_mfma_f32_16x16x32_bf16 v[192:195], a[72:75], v[56:59], v[192:195]
    s_nop 0
    ds_read_b64_tr_b16 a[64:65], v14 offset:18496
    ds_write_b32 v229, v215 offset:7328
    v_mfma_f32_16x16x32_bf16 v[196:199], a[72:75], v[128:131], v[196:199]
    s_waitcnt lgkmcnt(13)
    ds_read_b64_tr_b16 a[66:67], v14 offset:20800
    v_mfma_f32_16x16x32_bf16 v[196:199], a[76:79], v[132:135], v[196:199]
    ds_read_b64_tr_b16 a[68:69], v14 offset:18640
    v_mfma_f32_16x16x32_bf16 v[192:195], a[76:79], v[60:63], v[192:195]
    s_waitcnt lgkmcnt(12)
    ds_read_b64_tr_b16 a[70:71], v14 offset:20944
    ds_write_b32 v230, v216 offset:14232
    v_mfma_f32_16x16x32_bf16 v[160:163], a[80:83], v[64:67], v[160:163]
    ds_read_b64_tr_b16 a[72:73], v14 offset:18528
    v_mfma_f32_16x16x32_bf16 v[164:167], a[80:83], v[136:139], v[164:167]
    s_waitcnt lgkmcnt(13)
    ds_read_b64_tr_b16 a[74:75], v14 offset:20832
    v_mfma_f32_16x16x32_bf16 v[164:167], a[84:87], v[140:143], v[164:167]
    s_nop 0
    ds_read_b64_tr_b16 a[76:77], v14 offset:18672
    ds_write_b32 v229, v217 offset:14236
    v_mfma_f32_16x16x32_bf16 v[160:163], a[84:87], v[68:71], v[160:163]
    s_waitcnt lgkmcnt(13)
    ds_read_b64_tr_b16 a[78:79], v14 offset:20976
    v_mfma_f32_16x16x32_bf16 v[168:171], a[88:91], v[64:67], v[168:171]
    s_barrier
    ds_read_b64_tr_b16 a[80:81], v14 offset:18560
    v_mfma_f32_16x16x32_bf16 v[172:175], a[88:91], v[136:139], v[172:175]
    s_waitcnt lgkmcnt(12)
    ds_read_b64_tr_b16 a[82:83], v14 offset:20864
    v_mfma_f32_16x16x32_bf16 v[172:175], a[92:95], v[140:143], v[172:175]
    s_nop 0
    ds_read_b64_tr_b16 a[84:85], v14 offset:18704
    ds_write_b32 v231, v218 offset:384
    v_mfma_f32_16x16x32_bf16 v[168:171], a[92:95], v[68:71], v[168:171]
    s_waitcnt lgkmcnt(12)
    ds_read_b64_tr_b16 a[86:87], v14 offset:21008
    ds_write_b32 v231, v219 offset:388
    v_mfma_f32_16x16x32_bf16 v[176:179], a[64:67], v[64:67], v[176:179]
    ds_read_b64_tr_b16 a[88:89], v14 offset:27648
    v_mfma_f32_16x16x32_bf16 v[180:183], a[64:67], v[136:139], v[180:183]
    s_waitcnt lgkmcnt(13)
    ds_read_b64_tr_b16 a[90:91], v14 offset:29952
    v_mfma_f32_16x16x32_bf16 v[180:183], a[68:71], v[140:143], v[180:183]
    s_nop 0
    ds_read_b64_tr_b16 a[92:93], v14 offset:27792
    ds_write_b64 v12, v[220:221] offset:640
    v_mfma_f32_16x16x32_bf16 v[176:179], a[68:71], v[68:71], v[176:179]
    s_waitcnt lgkmcnt(13)
    ds_read_b64_tr_b16 a[94:95], v14 offset:30096
    v_mfma_f32_16x16x32_bf16 v[184:187], a[72:75], v[64:67], v[184:187]
    ds_read_b64_tr_b16 a[64:65], v14 offset:27680
    v_mfma_f32_16x16x32_bf16 v[188:191], a[72:75], v[136:139], v[188:191]
    s_waitcnt lgkmcnt(12)
    ds_read_b64_tr_b16 a[66:67], v14 offset:29984
    v_mfma_f32_16x16x32_bf16 v[188:191], a[76:79], v[140:143], v[188:191]
    s_nop 0
    ds_read_b64_tr_b16 a[68:69], v14 offset:27824
    ds_write_b64 v12, v[222:223] offset:648
    v_mfma_f32_16x16x32_bf16 v[184:187], a[76:79], v[68:71], v[184:187]
    s_waitcnt lgkmcnt(13)
    ds_read_b64_tr_b16 a[70:71], v14 offset:30128
    ds_write_b64 v11, a[96:97] offset:672
    v_mfma_f32_16x16x32_bf16 v[192:195], a[80:83], v[64:67], v[192:195]
    ds_read_b64_tr_b16 a[72:73], v14 offset:27712
    v_mfma_f32_16x16x32_bf16 v[196:199], a[80:83], v[136:139], v[196:199]
    s_waitcnt lgkmcnt(13)
    ds_read_b64_tr_b16 a[74:75], v14 offset:30016
    v_mfma_f32_16x16x32_bf16 v[196:199], a[84:87], v[140:143], v[196:199]
    s_nop 0
    ds_read_b64_tr_b16 a[76:77], v14 offset:27856
    ds_write_b64 v10, a[98:99] offset:680
    v_mfma_f32_16x16x32_bf16 v[192:195], a[84:87], v[68:71], v[192:195]
    s_waitcnt lgkmcnt(13)
    ds_read_b64_tr_b16 a[78:79], v14 offset:30160
    v_mfma_f32_16x16x32_bf16 v[160:163], a[88:91], v[72:75], v[160:163]
    s_nop 0
    ds_read_b64_tr_b16 a[80:81], v14 offset:27744
    ds_write_b64 v11, a[104:105] offset:12184
    v_mfma_f32_16x16x32_bf16 v[164:167], a[88:91], v[144:147], v[164:167]
    s_waitcnt lgkmcnt(13)
    ds_read_b64_tr_b16 a[82:83], v14 offset:30048
    v_mfma_f32_16x16x32_bf16 v[164:167], a[92:95], v[148:151], v[164:167]
    ds_read_b64_tr_b16 a[84:85], v14 offset:27888
    v_mfma_f32_16x16x32_bf16 v[160:163], a[92:95], v[76:79], v[160:163]
    s_waitcnt lgkmcnt(13)
    ds_read_b64_tr_b16 a[86:87], v14 offset:30192
    ds_write_b64 v11, a[106:107] offset:12192
    v_mfma_f32_16x16x32_bf16 v[168:171], a[64:67], v[72:75], v[168:171]
    s_waitcnt vmcnt(8)
    ds_read_b64_tr_b16 a[88:89], v14 offset:27776
    v_mfma_f32_16x16x32_bf16 v[172:175], a[64:67], v[144:147], v[172:175]
    s_waitcnt lgkmcnt(13)
    ds_read_b64_tr_b16 a[90:91], v14 offset:30080
    ds_read_b64_tr_b16 a[160:161], v246 offset:0
    v_mfma_f32_16x16x32_bf16 v[172:175], a[68:71], v[148:151], v[172:175]
    s_nop 0
    ds_read_b64_tr_b16 a[92:93], v14 offset:27920
    ds_write_b64 v9, a[112:113] offset:23696
    v_mfma_f32_16x16x32_bf16 v[168:171], a[68:71], v[76:79], v[168:171]
    s_waitcnt lgkmcnt(14)
    ds_read_b64_tr_b16 a[94:95], v14 offset:30224
    v_mfma_f32_16x16x32_bf16 v[176:179], a[72:75], v[72:75], v[176:179]
    s_nop 0
    ds_read_b64_tr_b16 a[64:65], v14 offset:36864
    ds_write_b64 v11, a[114:115] offset:23704
    v_mfma_f32_16x16x32_bf16 v[180:183], a[72:75], v[144:147], v[180:183]
    s_waitcnt lgkmcnt(14)
    s_cmp_lg_u32 s4, 0
    s_cbranch_scc1 Lk16
    s_waitcnt lgkmcnt(0)
    s_add_u32 s71, s71, 1
    s_andn2_b32 s71, s43, s71
    s_cbranch_scc1 Ls17
Lb18:
    buffer_load_dwordx4 a[128:131], v4, s[16:19], s27 offen offset:0 sc1
    buffer_load_dwordx4 a[132:135], v4, s[16:19], s27 offen offset:1024 sc1
    buffer_load_dwordx4 a[136:139], v4, s[16:19], s27 offen offset:2048 sc1
    buffer_load_dwordx4 a[140:143], v4, s[16:19], s27 offen offset:3072 sc1
    buffer_load_dwordx4 a[144:147], v4, s[16:19], s28 offen offset:0 sc1
    buffer_load_dwordx4 a[148:151], v4, s[16:19], s28 offen offset:1024 sc1
    buffer_load_dwordx4 a[152:155], v4, s[16:19], s28 offen offset:2048 sc1
    buffer_load_dwordx4 a[156:159], v4, s[16:19], s28 offen offset:3072 sc1
Lk16:
    ds_read_b64_tr_b16 a[66:67], v14 offset:39168
    ds_read_b64_tr_b16 a[162:163], v246 offset:512
    v_mfma_f32_16x16x32_bf16 v[180:183], a[76:79], v[148:151], v[180:183]
    s_nop 0
    ds_read_b64_tr_b16 a[68:69], v14 offset:37008
    ds_read_b64_tr_b16 a[164:165], v247 offset:0
    v_mfma_f32_16x16x32_bf16 v[176:179], a[76:79], v[76:79], v[176:179]
    s_waitcnt lgkmcnt(15)
    ds_read_b64_tr_b16 a[70:71], v14 offset:39312
    ds_write_b64 v9, a[120:121] offset:35208
    v_mfma_f32_16x16x32_bf16 v[184:187], a[80:83], v[72:75], v[184:187]
    ds_read_b64_tr_b16 a[72:73], v14 offset:36896
    v_mfma_f32_16x16x32_bf16 v[188:191], a[80:83], v[144:147], v[188:191]
    s_waitcnt lgkmcnt(15)
    ds_read_b64_tr_b16 a[74:75], v14 offset:39200
    ds_read_b64_tr_b16 a[166:167], v247 offset:512
    v_mfma_f32_16x16x32_bf16 v[188:191], a[84:87], v[148:151], v[188:191]
    s_nop 0
    ds_read_b64_tr_b16 a[76:77], v14 offset:37040
    ds_write_b64 v9, a[122:123] offset:35216
    v_mfma_f32_16x16x32_bf16 v[184:187], a[84:87], v[76:79], v[184:187]
    s_waitcnt lgkmcnt(15)
    ds_read_b64_tr_b16 a[78:79], v14 offset:39344
    v_mfma_f32_16x16x32_bf16 v[192:195], a[88:91], v[72:75], v[192:195]
    s_nop 0
    ds_read_b64_tr_b16 a[80:81], v14 offset:36928
    ds_write_b64 v235, v[224:225] offset:640
    v_mfma_f32_16x16x32_bf16 v[196:199], a[88:91], v[144:147], v[196:199]
    s_waitcnt lgkmcnt(15)
    ds_read_b64_tr_b16 a[82:83], v14 offset:39232
    ds_read_b64_tr_b16 a[168:169], v248 offset:0
    v_mfma_f32_16x16x32_bf16 v[196:199], a[92:95], v[148:151], v[196:199]
    s_nop 0
    ds_read_b64_tr_b16 a[84:85], v14 offset:37072
    ds_read_b64_tr_b16 a[170:171], v248 offset:512
    v_mfma_f32_16x16x32_bf16 v[192:195], a[92:95], v[76:79], v[192:195]
    s_waitcnt lgkmcnt(15)
    ds_read_b64_tr_b16 a[86:87], v14 offset:39376
    ds_write_b64 v235, v[226:227] offset:648
    v_mfma_f32_16x16x32_bf16 v[160:163], a[64:67], v[80:83], v[160:163]
    ds_read_b64_tr_b16 a[88:89], v14 offset:36960
    v_mfma_f32_16x16x32_bf16 v[164:167], a[64:67], v[152:155], v[164:167]
    s_waitcnt lgkmcnt(15)
    ds_read_b64_tr_b16 a[90:91], v14 offset:39264
    ds_read_b64_tr_b16 a[172:173], v249 offset:0
    v_mfma_f32_16x16x32_bf16 v[164:167], a[68:71], v[156:159], v[164:167]
    s_nop 0
    ds_read_b64_tr_b16 a[92:93], v14 offset:37104
    ds_write_b64 v234, a[100:101] offset:672
    v_mfma_f32_16x16x32_bf16 v[160:163], a[68:71], v[84:87], v[160:163]
    s_waitcnt lgkmcnt(15)
    ds_read_b64_tr_b16 a[94:95], v14 offset:39408
    v_mfma_f32_16x16x32_bf16 v[168:171], a[72:75], v[80:83], v[168:171]
    s_nop 0
    ds_read_b64_tr_b16 a[64:65], v14 offset:36992
    ds_write_b64 v233, a[102:103] offset:680
    v_mfma_f32_16x16x32_bf16 v[172:175], a[72:75], v[152:155], v[172:175]
    s_waitcnt lgkmcnt(15)
    ds_read_b64_tr_b16 a[66:67], v14 offset:39296
    ds_read_b64_tr_b16 a[174:175], v249 offset:512
    v_mfma_f32_16x16x32_bf16 v[172:175], a[76:79], v[156:159], v[172:175]
    s_nop 0
    ds_read_b64_tr_b16 a[68:69], v14 offset:37136
    ds_write_b64 v234, a[108:109] offset:12184
    v_mfma_f32_16x16x32_bf16 v[168:171], a[76:79], v[84:87], v[168:171]
    s_waitcnt lgkmcnt(15)
    s_waitcnt lgkmcnt(2)
    ds_read_b64_tr_b16 a[70:71], v14 offset:39440
    v_mfma_f32_16x16x32_bf16 v[176:179], a[80:83], v[80:83], v[176:179]
    buffer_store_dwordx4 a[160:163], v4, s[16:19], s48 offen sc1
    v_mfma_f32_16x16x32_bf16 v[180:183], a[80:83], v[152:155], v[180:183]
    v_mfma_f32_16x16x32_bf16 v[180:183], a[84:87], v[156:159], v[180:183]
    ds_write_b64 v234, a[110:111] offset:12192
    v_mfma_f32_16x16x32_bf16 v[176:179], a[84:87], v[84:87], v[176:179]
    v_mfma_f32_16x16x32_bf16 v[184:187], a[88:91], v[80:83], v[184:187]
    ds_write_b64 v232, a[116:117] offset:23696
    v_mfma_f32_16x16x32_bf16 v[188:191], a[88:91], v[152:155], v[188:191]
    s_add_u32 s48, s48, 18432
    v_mfma_f32_16x16x32_bf16 v[188:191], a[92:95], v[156:159], v[188:191]
    ds_write_b64 v234, a[118:119] offset:23704
    v_mfma_f32_16x16x32_bf16 v[184:187], a[92:95], v[84:87], v[184:187]
    buffer_store_dwordx4 a[164:167], v4, s[16:19], s48 offen sc1
    v_mfma_f32_16x16x32_bf16 v[192:195], a[64:67], v[80:83], v[192:195]
    v_mfma_f32_16x16x32_bf16 v[196:199], a[64:67], v[152:155], v[196:199]
    s_waitcnt lgkmcnt(3)
    v_mfma_f32_16x16x32_bf16 v[196:199], a[68:71], v[156:159], v[196:199]
    ds_write_b64 v232, a[124:125] offset:35208
    v_mfma_f32_16x16x32_bf16 v[192:195], a[68:71], v[84:87], v[192:195]
    ds_write_b64 v232, a[126:127] offset:35216
    v_cvt_pk_bf16_f32 v200, v160, v161
    v_cvt_pk_bf16_f32 v201, v162, v163
    v_cvt_pk_bf16_f32 v202, v168, v169
    v_cvt_pk_bf16_f32 v203, v170, v171
    v_cvt_pk_bf16_f32 v204, v176, v177
    v_cvt_pk_bf16_f32 v205, v178, v179
    v_cvt_pk_bf16_f32 v206, v184, v185
    v_cvt_pk_bf16_f32 v207, v186, v187
    v_cvt_pk_bf16_f32 v208, v192, v193
    v_cvt_pk_bf16_f32 v209, v194, v195
    v_cvt_pk_bf16_f32 v210, v164, v165
    v_cvt_pk_bf16_f32 v211, v166, v167
    v_cvt_pk_bf16_f32 v212, v172, v173
    v_cvt_pk_bf16_f32 v213, v174, v175
    v_cvt_pk_bf16_f32 v214, v180, v181
    v_cvt_pk_bf16_f32 v215, v182, v183
    v_cvt_pk_bf16_f32 v216, v188, v189
    v_cvt_pk_bf16_f32 v217, v190, v191
    v_cvt_pk_bf16_f32 v218, v196, v197
    v_cvt_pk_bf16_f32 v219, v198, v199
    v_add_u32 v160, 73728, v5
    v_add_u32 v163, 73728, v228
    v_add_u32 v161, 73728, v6
    v_add_u32 v164, 73728, v229
    v_add_u32 v162, 73728, v7
    v_add_u32 v165, 73728, v230
    s_barrier
    ds_write_b32 v160, v200 offset:0
    ds_write_b32 v160, v201 offset:4
    ds_write_b32 v161, v202 offset:32
    ds_write_b32 v160, v203 offset:6912
    ds_write_b32 v161, v204 offset:6940
    ds_write_b32 v161, v205 offset:6944
    ds_write_b32 v162, v206 offset:13848
    ds_write_b32 v161, v207 offset:13852
    ds_write_b32 v162, v208 offset:20756
    ds_write_b32 v162, v209 offset:20760
    ds_write_b32 v163, v210 offset:0
    ds_write_b32 v163, v211 offset:4
    ds_write_b32 v164, v212 offset:32
    ds_write_b32 v163, v213 offset:6912
    ds_write_b32 v164, v214 offset:6940
    ds_write_b32 v164, v215 offset:6944
    ds_write_b32 v165, v216 offset:13848
    ds_write_b32 v164, v217 offset:13852
    ds_write_b32 v165, v218 offset:20756
    ds_write_b32 v165, v219 offset:20760
    s_waitcnt vmcnt(6)
    ds_read_b64_tr_b16 a[176:177], v246 offset:16384
    ds_read_b64_tr_b16 a[178:179], v246 offset:16896
    ds_read_b64_tr_b16 a[180:181], v247 offset:16384
    ds_read_b64_tr_b16 a[182:183], v247 offset:16896
    ds_read_b64_tr_b16 a[184:185], v248 offset:16384
    ds_read_b64_tr_b16 a[186:187], v248 offset:16896
    ds_read_b64_tr_b16 a[188:189], v249 offset:16384
    ds_read_b64_tr_b16 a[190:191], v249 offset:16896
    s_add_u32 s48, s48, 18432
    buffer_store_dwordx4 a[168:171], v4, s[16:19], s48 offen sc1
Lpad0_4:
    s_cbranch_execz Lpadret
    s_add_u32 s48, s48, 18432
    buffer_store_dwordx4 a[172:175], v4, s[16:19], s48 offen sc1
    s_cmp_lg_u32 s4, 0
    s_cbranch_scc1 Lh19
    v_min_u32 v5, v5, v228
    v_min_u32 v6, v6, v229
    v_min_u32 v7, v7, v230
    v_min_u32 v8, v8, v231
    v_min_u32 v9, v9, v232
    v_min_u32 v10, v10, v233
    v_min_u32 v11, v11, v234
    v_min_u32 v12, v12, v235
    s_waitcnt vmcnt(2)
    ds_write_b32 v5, a128 offset:0
    ds_write_b64 v12, a[140:141] offset:0
    ds_write_b32 v5, a129 offset:4
    ds_write_b64 v12, a[142:143] offset:8
    ds_write_b32 v6, a130 offset:32
    ds_write_b64 v11, a[144:145] offset:32
    ds_write_b32 v5, a131 offset:6912
    ds_write_b64 v10, a[146:147] offset:40
    ds_write_b32 v6, a132 offset:6940
    ds_write_b64 v11, a[148:149] offset:11544
    ds_write_b32 v6, a133 offset:6944
    ds_write_b64 v11, a[150:151] offset:11552
    ds_write_b32 v7, a134 offset:13848
    ds_write_b64 v9, a[152:153] offset:23056
    ds_write_b32 v6, a135 offset:13852
    ds_write_b64 v11, a[154:155] offset:23064
    ds_write_b32 v8, a136 offset:0
    ds_write_b64 v9, a[156:157] offset:34568
    ds_write_b32 v8, a137 offset:4
    ds_write_b64 v9, a[158:159] offset:34576
Lh19:
    v_mov_b32 v14, v238
    v_mov_b32 v15, v239
    s_mul_i32 s27, s4, 6912
    v_mul_u32_u24 v5, 48, v1
    v_add_u32_e64 v5, s27, v5
    s_mul_i32 s27, s4, 11520
    s_add_u32 s27, s27, 27648
    v_mul_u32_u24 v6, 80, v1
    v_add_u32 v6, s27, v6
    v_lshrrev_b32 v7, 5, v1
    v_mul_u32_u24 v7, 97792, v7
    v_add_u32 v7, v7, v4
    v_lshl_add_u32 v7, s4, 10, v7
    v_add_u32 v8, 73728, v5
    s_waitcnt lgkmcnt(0)
    s_barrier
    ds_read_b128 v[170:173], v8 offset:3456
    ds_read_b128 v[174:177], v8 offset:3472
    ds_read_b32 v178, v8 offset:3488
    ds_read_b128 v[180:183], v5 offset:3840
    ds_read_b128 v[184:187], v5 offset:3856
    ds_read_b32 v188, v5 offset:3872
    ds_read_b128 v[160:163], v8 offset:0
    ds_read_b128 v[164:167], v8 offset:16
    ds_read_b32 v168, v8 offset:32
    ds_read_b128 v[190:193], v5 offset:384
    ds_read_b128 v[194:197], v5 offset:400
    ds_read_b32 v198, v5 offset:416
    s_waitcnt lgkmcnt(6)
    v_dot2_f32_bf16 v208, v170, v180, 0
    v_dot2_f32_bf16 v208, v171, v181, v208
    v_dot2_f32_bf16 v208, v172, v182, v208
    v_dot2_f32_bf16 v208, v173, v183, v208
    v_dot2_f32_bf16 v208, v174, v184, v208
    v_dot2_f32_bf16 v208, v175, v185, v208
    v_dot2_f32_bf16 v208, v176, v186, v208
    v_dot2_f32_bf16 v208, v177, v187, v208
    v_dot2_f32_bf16 v208, v178, v188, v208
    s_waitcnt vmcnt(4)
    ds_read_b64_tr_b16 a[192:193], v246 offset:32768
    ds_read_b64_tr_b16 a[194:195], v246 offset:33280
    ds_read_b64_tr_b16 a[196:197], v247 offset:32768
    ds_read_b64_tr_b16 a[198:199], v247 offset:33280
    ds_read_b64_tr_b16 a[200:201], v248 offset:32768
    ds_read_b64_tr_b16 a[202:203], v248 offset:33280
    ds_read_b64_tr_b16 a[204:205], v249 offset:32768
    ds_read_b64_tr_b16 a[206:207], v249 offset:33280
    ds_read_b128 v[180:183], v5 offset:3744
    ds_read_b128 v[184:187], v5 offset:3760
    ds_read_b32 v188, v5 offset:3776
    s_add_u32 s48, s48, 18432
    buffer_store_dwordx4 a[176:179], v4, s[16:19], s49 offen sc1
    s_waitcnt lgkmcnt(11)
    v_dot2_f32_bf16 v209, v170, v190, 0
    v_dot2_f32_bf16 v209, v171, v191, v209
    v_dot2_f32_bf16 v209, v172, v192, v209
    v_dot2_f32_bf16 v209, v173, v193, v209
    v_dot2_f32_bf16 v209, v174, v194, v209
    v_dot2_f32_bf16 v209, v175, v195, v209
    v_dot2_f32_bf16 v209, v176, v196, v209
    v_dot2_f32_bf16 v209, v177, v197, v209
    v_dot2_f32_bf16 v209, v178, v198, v209
    v_dot2_f32_bf16 v200, v160, v190, 0
    v_dot2_f32_bf16 v200, v161, v191, v200
    v_dot2_f32_bf16 v200, v162, v192, v200
    v_dot2_f32_bf16 v200, v163, v193, v200
    v_dot2_f32_bf16 v200, v164, v194, v200
    v_dot2_f32_bf16 v200, v165, v195, v200
    v_dot2_f32_bf16 v200, v166, v196, v200
    v_dot2_f32_bf16 v200, v167, v197, v200
    v_dot2_f32_bf16 v200, v168, v198, v200
    ds_read_b128 v[190:193], v5 offset:288
    ds_read_b128 v[194:197], v5 offset:304
    ds_read_b32 v198, v5 offset:320
    s_waitcnt lgkmcnt(3)
    v_dot2_f32_bf16 v210, v170, v180, 0
    v_dot2_f32_bf16 v210, v171, v181, v210
    v_dot2_f32_bf16 v210, v172, v182, v210
    v_dot2_f32_bf16 v210, v173, v183, v210
    v_dot2_f32_bf16 v210, v174, v184, v210
    v_dot2_f32_bf16 v210, v175, v185, v210
    v_dot2_f32_bf16 v210, v176, v186, v210
    v_dot2_f32_bf16 v210, v177, v187, v210
    v_dot2_f32_bf16 v210, v178, v188, v210
    v_dot2_f32_bf16 v201, v160, v180, 0
    v_dot2_f32_bf16 v201, v161, v181, v201
    v_dot2_f32_bf16 v201, v162, v182, v201
    v_dot2_f32_bf16 v201, v163, v183, v201
    v_dot2_f32_bf16 v201, v164, v184, v201
    v_dot2_f32_bf16 v201, v165, v185, v201
    v_dot2_f32_bf16 v201, v166, v186, v201
    v_dot2_f32_bf16 v201, v167, v187, v201
    v_dot2_f32_bf16 v201, v168, v188, v201
    ds_read_b128 v[180:183], v5 offset:3648
    ds_read_b128 v[184:187], v5 offset:3664
    ds_read_b32 v188, v5 offset:3680
    s_add_u32 s49, s49, 18432
    buffer_store_dwordx4 a[180:183], v4, s[16:19], s49 offen sc1
    s_waitcnt lgkmcnt(3)
    v_dot2_f32_bf16 v211, v170, v190, 0
    v_dot2_f32_bf16 v211, v171, v191, v211
    v_dot2_f32_bf16 v211, v172, v192, v211
    v_dot2_f32_bf16 v211, v173, v193, v211
    v_dot2_f32_bf16 v211, v174, v194, v211
    v_dot2_f32_bf16 v211, v175, v195, v211
    v_dot2_f32_bf16 v211, v176, v196, v211
    v_dot2_f32_bf16 v211, v177, v197, v211
    v_dot2_f32_bf16 v211, v178, v198, v211
    v_dot2_f32_bf16 v202, v160, v190, 0
    v_dot2_f32_bf16 v202, v161, v191, v202
    v_dot2_f32_bf16 v202, v162, v192, v202
    v_dot2_f32_bf16 v202, v163, v193, v202
    v_dot2_f32_bf16 v202, v164, v194, v202
    v_dot2_f32_bf16 v202, v165, v195, v202
    v_dot2_f32_bf16 v202, v166, v196, v202
    v_dot2_f32_bf16 v202, v167, v197, v202
    v_dot2_f32_bf16 v202, v168, v198, v202
    ds_read_b128 v[190:193], v5 offset:192
    ds_read_b128 v[194:197], v5 offset:208
    ds_read_b32 v198, v5 offset:224
    s_add_u32 s49, s49, 18432
    buffer_store_dwordx4 a[184:187], v4, s[16:19], s49 offen sc1
    s_waitcnt lgkmcnt(3)
    v_dot2_f32_bf16 v212, v170, v180, 0
    v_dot2_f32_bf16 v212, v171, v181, v212
    v_dot2_f32_bf16 v212, v172, v182, v212
    v_dot2_f32_bf16 v212, v173, v183, v212
    v_dot2_f32_bf16 v212, v174, v184, v212
    v_dot2_f32_bf16 v212, v175, v185, v212
    v_dot2_f32_bf16 v212, v176, v186, v212
    v_dot2_f32_bf16 v212, v177, v187, v212
    v_dot2_f32_bf16 v212, v178, v188, v212
    v_dot2_f32_bf16 v203, v160, v180, 0
    v_dot2_f32_bf16 v203, v161, v181, v203
    v_dot2_f32_bf16 v203, v162, v182, v203
    v_dot2_f32_bf16 v203, v163, v183, v203
    v_dot2_f32_bf16 v203, v164, v184, v203
    v_dot2_f32_bf16 v203, v165, v185, v203
    v_dot2_f32_bf16 v203, v166, v186, v203
    v_dot2_f32_bf16 v203, v167, v187, v203
    v_dot2_f32_bf16 v203, v168, v188, v203
    ds_read_b128 v[180:183], v5 offset:3552
    ds_read_b128 v[184:187], v5 offset:3568
    ds_read_b32 v188, v5 offset:3584
    s_add_u32 s49, s49, 18432
    buffer_store_dwordx4 a[188:191], v4, s[16:19], s49 offen sc1
    s_waitcnt lgkmcnt(3)
    v_dot2_f32_bf16 v213, v170, v190, 0
    v_dot2_f32_bf16 v213, v171, v191, v213
    v_dot2_f32_bf16 v213, v172, v192, v213
    v_dot2_f32_bf16 v213, v173, v193, v213
    v_dot2_f32_bf16 v213, v174, v194, v213
    v_dot2_f32_bf16 v213, v175, v195, v213
    v_dot2_f32_bf16 v213, v176, v196, v213
    v_dot2_f32_bf16 v213, v177, v197, v213
    v_dot2_f32_bf16 v213, v178, v198, v213
    v_dot2_f32_bf16 v204, v160, v190, 0
    v_dot2_f32_bf16 v204, v161, v191, v204
    v_dot2_f32_bf16 v204, v162, v192, v204
    v_dot2_f32_bf16 v204, v163, v193, v204
    v_dot2_f32_bf16 v204, v164, v194, v204
    v_dot2_f32_bf16 v204, v165, v195, v204
    v_dot2_f32_bf16 v204, v166, v196, v204
    v_dot2_f32_bf16 v204, v167, v197, v204
    v_dot2_f32_bf16 v204, v168, v198, v204
    ds_read_b128 v[190:193], v5 offset:96
    ds_read_b128 v[194:197], v5 offset:112
    ds_read_b32 v198, v5 offset:128
    s_lshl_b32 s30, s4, 8
    s_add_u32 s30, s30, s44
    v_lshl_add_u32 v11, v2, 4, s30
    v_lshl_add_u32 v11, v3, 10, v11
    s_lshl_b32 s30, s7, 7
    s_add_u32 s30, s30, 49152
    s_mov_b32 s31, 0
    s_atomic_add s31, s[68:69], s30 glc
    s_waitcnt lgkmcnt(3)
    v_dot2_f32_bf16 v214, v170, v180, 0
    v_dot2_f32_bf16 v214, v171, v181, v214
    v_dot2_f32_bf16 v214, v172, v182, v214
    v_dot2_f32_bf16 v214, v173, v183, v214
    v_dot2_f32_bf16 v214, v174, v184, v214
    v_dot2_f32_bf16 v214, v175, v185, v214
    v_dot2_f32_bf16 v214, v176, v186, v214
    v_dot2_f32_bf16 v214, v177, v187, v214
    v_dot2_f32_bf16 v214, v178, v188, v214
    v_dot2_f32_bf16 v205, v160, v180, 0
    v_dot2_f32_bf16 v205, v161, v181, v205
    v_dot2_f32_bf16 v205, v162, v182, v205
    v_dot2_f32_bf16 v205, v163, v183, v205
    v_dot2_f32_bf16 v205, v164, v184, v205
    v_dot2_f32_bf16 v205, v165, v185, v205
    v_dot2_f32_bf16 v205, v166, v186, v205
    v_dot2_f32_bf16 v205, v167, v187, v205
    v_dot2_f32_bf16 v205, v168, v188, v205
    ds_read_b128 v[180:183], v5 offset:3456
    ds_read_b128 v[184:187], v5 offset:3472
    ds_read_b32 v188, v5 offset:3488
    s_add_u32 s49, s49, 18432
    buffer_store_dwordx4 a[192:195], v4, s[16:19], s50 offen sc1
    s_waitcnt lgkmcnt(3)
    v_dot2_f32_bf16 v215, v170, v190, 0
    v_dot2_f32_bf16 v215, v171, v191, v215
    v_dot2_f32_bf16 v215, v172, v192, v215
    v_dot2_f32_bf16 v215, v173, v193, v215
    v_dot2_f32_bf16 v215, v174, v194, v215
    v_dot2_f32_bf16 v215, v175, v195, v215
    v_dot2_f32_bf16 v215, v176, v196, v215
    v_dot2_f32_bf16 v215, v177, v197, v215
    v_dot2_f32_bf16 v215, v178, v198, v215
    v_dot2_f32_bf16 v206, v160, v190, 0
    v_dot2_f32_bf16 v206, v161, v191, v206
    v_dot2_f32_bf16 v206, v162, v192, v206
    v_dot2_f32_bf16 v206, v163, v193, v206
    v_dot2_f32_bf16 v206, v164, v194, v206
    v_dot2_f32_bf16 v206, v165, v195, v206
    v_dot2_f32_bf16 v206, v166, v196, v206
    v_dot2_f32_bf16 v206, v167, v197, v206
    v_dot2_f32_bf16 v206, v168, v198, v206
    ds_read_b128 v[216:219], v6 offset:6400
    ds_read_b128 v[220:223], v6 offset:6416
    ds_read_b128 v[224:227], v6 offset:6432
    ds_read_b128 v[228:231], v6 offset:6448
    ds_read_b64 v[232:233], v6 offset:6464
    s_waitcnt lgkmcnt(5)
    v_dot2_f32_bf16 v207, v160, v180, 0
    v_dot2_f32_bf16 v207, v161, v181, v207
    v_dot2_f32_bf16 v207, v162, v182, v207
    v_dot2_f32_bf16 v207, v163, v183, v207
    v_dot2_f32_bf16 v207, v164, v184, v207
    v_dot2_f32_bf16 v207, v165, v185, v207
    v_dot2_f32_bf16 v207, v166, v186, v207
    v_dot2_f32_bf16 v207, v167, v187, v207
    v_dot2_f32_bf16 v207, v168, v188, v207
    ds_read_b128 v[234:237], v6 offset:640
    ds_read_b128 v[238:241], v6 offset:656
    ds_read_b128 v[242:245], v6 offset:672
    ds_read_b128 v[246:249], v6 offset:688
    ds_read_b64 v[250:251], v6 offset:704
    s_add_u32 s50, s50, s51
    buffer_store_dwordx4 a[196:199], v4, s[16:19], s50 offen sc1
    s_mov_b32 s28, 0x3eae1a93
    s_mov_b32 s29, s28
    s_cmp_lg_u32 s46, 0
    s_cbranch_scc1 Lm20
    v_lshrrev_b32 v252, 1, v1
    v_and_b32 v253, 1, v1
    v_lshl_add_u32 v252, v252, 2, v253
    v_mov_b32 v253, 0xcf7ce18f
    v_cmp_le_u32 vcc, 2, v252
    s_nop 1
    v_cndmask_b32 v201, v253, v201, vcc
    v_cndmask_b32 v210, v253, v210, vcc
    v_cmp_le_u32 vcc, 4, v252
    s_nop 1
    v_cndmask_b32 v202, v253, v202, vcc
    v_cndmask_b32 v211, v253, v211, vcc
    v_cmp_le_u32 vcc, 6, v252
    s_nop 1
    v_cndmask_b32 v203, v253, v203, vcc
    v_cndmask_b32 v212, v253, v212, vcc
    v_cmp_le_u32 vcc, 8, v252
    s_nop 1
    v_cndmask_b32 v204, v253, v204, vcc
    v_cndmask_b32 v213, v253, v213, vcc
    v_cmp_le_u32 vcc, 10, v252
    s_nop 1
    v_cndmask_b32 v205, v253, v205, vcc
    v_cndmask_b32 v214, v253, v214, vcc
    v_cmp_le_u32 vcc, 12, v252
    s_nop 1
    v_cndmask_b32 v206, v253, v206, vcc
    v_cndmask_b32 v215, v253, v215, vcc
    v_cmp_le_u32 vcc, 14, v252
    s_nop 1
    v_cndmask_b32_e64 v207, v253, v207, vcc
Lm20:
    s_nop 1
    v_max3_f32 v252, v200, v201, v202
    v_max3_f32 v253, v203, v204, v205
    v_max3_f32 v252, v252, v206, v207
    v_max_f32_e64 v252, v252, v253
    v_pk_add_f32 v[200:201], v[200:201], v[252:253] op_sel_hi:[1,0] neg_lo:[0,1] neg_hi:[0,1]
    v_pk_add_f32 v[202:203], v[202:203], v[252:253] op_sel_hi:[1,0] neg_lo:[0,1] neg_hi:[0,1]
    v_pk_add_f32 v[204:205], v[204:205], v[252:253] op_sel_hi:[1,0] neg_lo:[0,1] neg_hi:[0,1]
    v_pk_add_f32 v[206:207], v[206:207], v[252:253] op_sel_hi:[1,0] neg_lo:[0,1] neg_hi:[0,1]
    v_pk_mul_f32 v[200:201], v[200:201], s[28:29]
    v_pk_mul_f32 v[202:203], v[202:203], s[28:29]
    v_pk_mul_f32 v[204:205], v[204:205], s[28:29]
    v_pk_mul_f32 v[206:207], v[206:207], s[28:29]
    v_exp_f32 v200, v200
    v_exp_f32 v201, v201
    v_exp_f32 v202, v202
    v_exp_f32 v203, v203
    v_exp_f32 v204, v204
    v_exp_f32 v205, v205
    v_exp_f32 v206, v206
    v_exp_f32_e64 v207, v207
    s_add_u32 s50, s50, s51
    buffer_store_dwordx4 a[200:203], v4, s[16:19], s50 offen sc1
    v_max3_f32 v254, v208, v209, v210
    v_max3_f32 v255, v211, v212, v213
    v_max3_f32 v254, v254, v214, v215
    v_max_f32_e64 v254, v254, v255
    v_pk_add_f32 v[208:209], v[208:209], v[254:255] op_sel_hi:[1,0] neg_lo:[0,1] neg_hi:[0,1]
    v_pk_add_f32 v[210:211], v[210:211], v[254:255] op_sel_hi:[1,0] neg_lo:[0,1] neg_hi:[0,1]
    v_pk_add_f32 v[212:213], v[212:213], v[254:255] op_sel_hi:[1,0] neg_lo:[0,1] neg_hi:[0,1]
    v_pk_add_f32 v[214:215], v[214:215], v[254:255] op_sel_hi:[1,0] neg_lo:[0,1] neg_hi:[0,1]
    v_pk_mul_f32 v[208:209], v[208:209], s[28:29]
    v_pk_mul_f32 v[210:211], v[210:211], s[28:29]
    v_pk_mul_f32 v[212:213], v[212:213], s[28:29]
    v_pk_mul_f32 v[214:215], v[214:215], s[28:29]
    v_exp_f32 v208, v208
    v_exp_f32 v209, v209
    v_exp_f32 v210, v210
    v_exp_f32 v211, v211
    v_exp_f32 v212, v212
    v_exp_f32 v213, v213
    v_exp_f32 v214, v214
    v_exp_f32 v215, v215
    s_add_u32 s50, s50, s51
    buffer_store_dwordx4 a[204:207], v4, s[16:19], s50 offen sc1
    v_pk_add_f32 v[252:253], v[200:201], v[202:203]
    v_pk_add_f32 v[252:253], v[252:253], v[204:205]
    v_pk_add_f32 v[252:253], v[252:253], v[206:207]
    v_add_f32 v252, v252, v253
    v_rcp_f32_e64 v252, v252
    v_pk_add_f32 v[254:255], v[208:209], v[210:211]
    v_pk_add_f32 v[254:255], v[254:255], v[212:213]
    v_pk_add_f32 v[254:255], v[254:255], v[214:215]
    v_add_f32 v254, v254, v255
    v_rcp_f32 v254, v254
    v_pk_mul_f32 v[200:201], v[200:201], v[252:253] op_sel_hi:[1,0]
    v_pk_mul_f32 v[202:203], v[202:203], v[252:253] op_sel_hi:[1,0]
    v_pk_mul_f32 v[204:205], v[204:205], v[252:253] op_sel_hi:[1,0]
    v_pk_mul_f32 v[206:207], v[206:207], v[252:253] op_sel_hi:[1,0]
    v_pk_mul_f32 v[208:209], v[208:209], v[254:255] op_sel_hi:[1,0]
    v_pk_mul_f32 v[210:211], v[210:211], v[254:255] op_sel_hi:[1,0]
    v_pk_mul_f32 v[212:213], v[212:213], v[254:255] op_sel_hi:[1,0]
    v_pk_mul_f32 v[214:215], v[214:215], v[254:255] op_sel_hi:[1,0]
    s_waitcnt lgkmcnt(0)
    s_cmp_lg_u32 s31, 3
    s_cbranch_scc1 Le21
    s_lshl_b32 s25, s98, 14
    s_add_u32 s25, s25, 2621440
    buffer_load_dwordx4 v[88:91], v11, s[16:19], s25 offen sc1
    s_add_u32 s25, s25, 4096
    buffer_load_dwordx4 v[92:95], v11, s[16:19], s25 offen sc1
    s_add_u32 s25, s25, 4096
    buffer_load_dwordx4 v[96:99], v11, s[16:19], s25 offen sc1
    s_add_u32 s25, s25, 4096
    buffer_load_dwordx4 v[100:103], v11, s[16:19], s25 offen sc1
    s_lshl_b32 s25, s99, 14
    s_add_u32 s25, s25, 2621440
    buffer_load_dwordx4 v[104:107], v11, s[16:19], s25 offen sc1
    s_add_u32 s25, s25, 4096
    buffer_load_dwordx4 v[108:111], v11, s[16:19], s25 offen sc1
    s_add_u32 s25, s25, 4096
    buffer_load_dwordx4 v[112:115], v11, s[16:19], s25 offen sc1
    s_add_u32 s25, s25, 4096
    buffer_load_dwordx4 v[116:119], v11, s[16:19], s25 offen sc1
    s_lshl_b32 s25, s100, 14
    s_add_u32 s25, s25, 2621440
    buffer_load_dwordx4 v[120:123], v11, s[16:19], s25 offen sc1
    s_add_u32 s25, s25, 4096
    buffer_load_dwordx4 v[124:127], v11, s[16:19], s25 offen sc1
Le21:
    v_pk_mul_f32 v[178:179], v[216:217], v[208:209] op_sel_hi:[1,0]
    v_pk_mul_f32 v[180:181], v[218:219], v[208:209] op_sel_hi:[1,0]
    v_pk_mul_f32 v[182:183], v[220:221], v[208:209] op_sel_hi:[1,0]
    v_pk_mul_f32 v[184:185], v[222:223], v[208:209] op_sel_hi:[1,0]
    v_pk_mul_f32 v[186:187], v[224:225], v[208:209] op_sel_hi:[1,0]
    v_pk_mul_f32 v[188:189], v[226:227], v[208:209] op_sel_hi:[1,0]
    v_pk_mul_f32 v[190:191], v[228:229], v[208:209] op_sel_hi:[1,0]
    v_pk_mul_f32 v[192:193], v[230:231], v[208:209] op_sel_hi:[1,0]
    v_pk_mul_f32 v[194:195], v[232:233], v[208:209] op_sel_hi:[1,0]
    ds_read_b128 v[216:219], v6 offset:6240
    ds_read_b128 v[220:223], v6 offset:6256
    ds_read_b128 v[224:227], v6 offset:6272
    ds_read_b128 v[228:231], v6 offset:6288
    ds_read_b64 v[232:233], v6 offset:6304
    v_pk_fma_f32 v[178:179], v[234:235], v[208:209], v[178:179] op_sel:[0,1,0] op_sel_hi:[1,1,1]
    v_pk_fma_f32 v[180:181], v[236:237], v[208:209], v[180:181] op_sel:[0,1,0] op_sel_hi:[1,1,1]
    v_pk_fma_f32 v[182:183], v[238:239], v[208:209], v[182:183] op_sel:[0,1,0] op_sel_hi:[1,1,1]
    v_pk_fma_f32 v[184:185], v[240:241], v[208:209], v[184:185] op_sel:[0,1,0] op_sel_hi:[1,1,1]
    v_pk_fma_f32 v[186:187], v[242:243], v[208:209], v[186:187] op_sel:[0,1,0] op_sel_hi:[1,1,1]
    v_pk_fma_f32 v[188:189], v[244:245], v[208:209], v[188:189] op_sel:[0,1,0] op_sel_hi:[1,1,1]
    v_pk_fma_f32 v[190:191], v[246:247], v[208:209], v[190:191] op_sel:[0,1,0] op_sel_hi:[1,1,1]
    v_pk_fma_f32 v[192:193], v[248:249], v[208:209], v[192:193] op_sel:[0,1,0] op_sel_hi:[1,1,1]
    v_pk_fma_f32 v[194:195], v[250:251], v[208:209], v[194:195] op_sel:[0,1,0] op_sel_hi:[1,1,1]
    v_pk_mul_f32 v[160:161], v[234:235], v[200:201] op_sel_hi:[1,0]
    v_pk_mul_f32 v[162:163], v[236:237], v[200:201] op_sel_hi:[1,0]
    v_pk_mul_f32 v[164:165], v[238:239], v[200:201] op_sel_hi:[1,0]
    v_pk_mul_f32 v[166:167], v[240:241], v[200:201] op_sel_hi:[1,0]
    v_pk_mul_f32 v[168:169], v[242:243], v[200:201] op_sel_hi:[1,0]
    v_pk_mul_f32 v[170:171], v[244:245], v[200:201] op_sel_hi:[1,0]
    v_pk_mul_f32 v[172:173], v[246:247], v[200:201] op_sel_hi:[1,0]
    v_pk_mul_f32 v[174:175], v[248:249], v[200:201] op_sel_hi:[1,0]
    v_pk_mul_f32 v[176:177], v[250:251], v[200:201] op_sel_hi:[1,0]
    ds_read_b128 v[234:237], v6 offset:480
    ds_read_b128 v[238:241], v6 offset:496
    ds_read_b128 v[242:245], v6 offset:512
    ds_read_b128 v[246:249], v6 offset:528
    ds_read_b64 v[250:251], v6 offset:544
    s_waitcnt lgkmcnt(5)
    v_pk_fma_f32 v[178:179], v[216:217], v[210:211], v[178:179] op_sel:[0,0,0] op_sel_hi:[1,0,1]
    v_pk_fma_f32 v[180:181], v[218:219], v[210:211], v[180:181] op_sel:[0,0,0] op_sel_hi:[1,0,1]
    v_pk_fma_f32 v[182:183], v[220:221], v[210:211], v[182:183] op_sel:[0,0,0] op_sel_hi:[1,0,1]
    v_pk_fma_f32 v[184:185], v[222:223], v[210:211], v[184:185] op_sel:[0,0,0] op_sel_hi:[1,0,1]
    v_pk_fma_f32 v[186:187], v[224:225], v[210:211], v[186:187] op_sel:[0,0,0] op_sel_hi:[1,0,1]
    v_pk_fma_f32 v[188:189], v[226:227], v[210:211], v[188:189] op_sel:[0,0,0] op_sel_hi:[1,0,1]
    v_pk_fma_f32 v[190:191], v[228:229], v[210:211], v[190:191] op_sel:[0,0,0] op_sel_hi:[1,0,1]
    v_pk_fma_f32 v[192:193], v[230:231], v[210:211], v[192:193] op_sel:[0,0,0] op_sel_hi:[1,0,1]
    v_pk_fma_f32 v[194:195], v[232:233], v[210:211], v[194:195] op_sel:[0,0,0] op_sel_hi:[1,0,1]
    v_pk_fma_f32 v[160:161], v[216:217], v[200:201], v[160:161] op_sel:[0,1,0] op_sel_hi:[1,1,1]
    v_pk_fma_f32 v[162:163], v[218:219], v[200:201], v[162:163] op_sel:[0,1,0] op_sel_hi:[1,1,1]
    v_pk_fma_f32 v[164:165], v[220:221], v[200:201], v[164:165] op_sel:[0,1,0] op_sel_hi:[1,1,1]
    v_pk_fma_f32 v[166:167], v[222:223], v[200:201], v[166:167] op_sel:[0,1,0] op_sel_hi:[1,1,1]
    v_pk_fma_f32 v[168:169], v[224:225], v[200:201], v[168:169] op_sel:[0,1,0] op_sel_hi:[1,1,1]
    v_pk_fma_f32 v[170:171], v[226:227], v[200:201], v[170:171] op_sel:[0,1,0] op_sel_hi:[1,1,1]
    v_pk_fma_f32 v[172:173], v[228:229], v[200:201], v[172:173] op_sel:[0,1,0] op_sel_hi:[1,1,1]
    v_pk_fma_f32 v[174:175], v[230:231], v[200:201], v[174:175] op_sel:[0,1,0] op_sel_hi:[1,1,1]
    v_pk_fma_f32 v[176:177], v[232:233], v[200:201], v[176:177] op_sel:[0,1,0] op_sel_hi:[1,1,1]
    ds_read_b128 v[216:219], v6 offset:6080
    ds_read_b128 v[220:223], v6 offset:6096
    ds_read_b128 v[224:227], v6 offset:6112
    ds_read_b128 v[228:231], v6 offset:6128
    ds_read_b64 v[232:233], v6 offset:6144
    s_waitcnt lgkmcnt(5)
    v_pk_fma_f32 v[178:179], v[234:235], v[210:211], v[178:179] op_sel:[0,1,0] op_sel_hi:[1,1,1]
    v_pk_fma_f32 v[180:181], v[236:237], v[210:211], v[180:181] op_sel:[0,1,0] op_sel_hi:[1,1,1]
    v_pk_fma_f32 v[182:183], v[238:239], v[210:211], v[182:183] op_sel:[0,1,0] op_sel_hi:[1,1,1]
    v_pk_fma_f32 v[184:185], v[240:241], v[210:211], v[184:185] op_sel:[0,1,0] op_sel_hi:[1,1,1]
    v_pk_fma_f32 v[186:187], v[242:243], v[210:211], v[186:187] op_sel:[0,1,0] op_sel_hi:[1,1,1]
    v_pk_fma_f32 v[188:189], v[244:245], v[210:211], v[188:189] op_sel:[0,1,0] op_sel_hi:[1,1,1]
    v_pk_fma_f32 v[190:191], v[246:247], v[210:211], v[190:191] op_sel:[0,1,0] op_sel_hi:[1,1,1]
    v_pk_fma_f32 v[192:193], v[248:249], v[210:211], v[192:193] op_sel:[0,1,0] op_sel_hi:[1,1,1]
    v_pk_fma_f32 v[194:195], v[250:251], v[210:211], v[194:195] op_sel:[0,1,0] op_sel_hi:[1,1,1]
    v_pk_fma_f32 v[160:161], v[234:235], v[202:203], v[160:161] op_sel:[0,0,0] op_sel_hi:[1,0,1]
    v_pk_fma_f32 v[162:163], v[236:237], v[202:203], v[162:163] op_sel:[0,0,0] op_sel_hi:[1,0,1]
    v_pk_fma_f32 v[164:165], v[238:239], v[202:203], v[164:165] op_sel:[0,0,0] op_sel_hi:[1,0,1]
    v_pk_fma_f32 v[166:167], v[240:241], v[202:203], v[166:167] op_sel:[0,0,0] op_sel_hi:[1,0,1]
    v_pk_fma_f32 v[168:169], v[242:243], v[202:203], v[168:169] op_sel:[0,0,0] op_sel_hi:[1,0,1]
    v_pk_fma_f32 v[170:171], v[244:245], v[202:203], v[170:171] op_sel:[0,0,0] op_sel_hi:[1,0,1]
    v_pk_fma_f32 v[172:173], v[246:247], v[202:203], v[172:173] op_sel:[0,0,0] op_sel_hi:[1,0,1]
    v_pk_fma_f32 v[174:175], v[248:249], v[202:203], v[174:175] op_sel:[0,0,0] op_sel_hi:[1,0,1]
    v_pk_fma_f32 v[176:177], v[250:251], v[202:203], v[176:177] op_sel:[0,0,0] op_sel_hi:[1,0,1]
    ds_read_b128 v[234:237], v6 offset:320
    ds_read_b128 v[238:241], v6 offset:336
    ds_read_b128 v[242:245], v6 offset:352
    ds_read_b128 v[246:249], v6 offset:368
    ds_read_b64 v[250:251], v6 offset:384
    s_waitcnt lgkmcnt(5)
    v_pk_fma_f32 v[178:179], v[216:217], v[212:213], v[178:179] op_sel:[0,0,0] op_sel_hi:[1,0,1]
    v_pk_fma_f32 v[180:181], v[218:219], v[212:213], v[180:181] op_sel:[0,0,0] op_sel_hi:[1,0,1]
    v_pk_fma_f32 v[182:183], v[220:221], v[212:213], v[182:183] op_sel:[0,0,0] op_sel_hi:[1,0,1]
    v_pk_fma_f32 v[184:185], v[222:223], v[212:213], v[184:185] op_sel:[0,0,0] op_sel_hi:[1,0,1]
    v_pk_fma_f32 v[186:187], v[224:225], v[212:213], v[186:187] op_sel:[0,0,0] op_sel_hi:[1,0,1]
    v_pk_fma_f32 v[188:189], v[226:227], v[212:213], v[188:189] op_sel:[0,0,0] op_sel_hi:[1,0,1]
    v_pk_fma_f32 v[190:191], v[228:229], v[212:213], v[190:191] op_sel:[0,0,0] op_sel_hi:[1,0,1]
    v_pk_fma_f32 v[192:193], v[230:231], v[212:213], v[192:193] op_sel:[0,0,0] op_sel_hi:[1,0,1]
    v_pk_fma_f32 v[194:195], v[232:233], v[212:213], v[194:195] op_sel:[0,0,0] op_sel_hi:[1,0,1]
    v_pk_fma_f32 v[160:161], v[216:217], v[202:203], v[160:161] op_sel:[0,1,0] op_sel_hi:[1,1,1]
    v_pk_fma_f32 v[162:163], v[218:219], v[202:203], v[162:163] op_sel:[0,1,0] op_sel_hi:[1,1,1]
    v_pk_fma_f32 v[164:165], v[220:221], v[202:203], v[164:165] op_sel:[0,1,0] op_sel_hi:[1,1,1]
    v_pk_fma_f32 v[166:167], v[222:223], v[202:203], v[166:167] op_sel:[0,1,0] op_sel_hi:[1,1,1]
    v_pk_fma_f32 v[168:169], v[224:225], v[202:203], v[168:169] op_sel:[0,1,0] op_sel_hi:[1,1,1]
    v_pk_fma_f32 v[170:171], v[226:227], v[202:203], v[170:171] op_sel:[0,1,0] op_sel_hi:[1,1,1]
    v_pk_fma_f32 v[172:173], v[228:229], v[202:203], v[172:173] op_sel:[0,1,0] op_sel_hi:[1,1,1]
    v_pk_fma_f32 v[174:175], v[230:231], v[202:203], v[174:175] op_sel:[0,1,0] op_sel_hi:[1,1,1]
    v_pk_fma_f32 v[176:177], v[232:233], v[202:203], v[176:177] op_sel:[0,1,0] op_sel_hi:[1,1,1]
    ds_read_b128 v[216:219], v6 offset:5920
    ds_read_b128 v[220:223], v6 offset:5936
    ds_read_b128 v[224:227], v6 offset:5952
    ds_read_b128 v[228:231], v6 offset:5968
    ds_read_b64 v[232:233], v6 offset:5984
    s_waitcnt lgkmcnt(5)
    v_pk_fma_f32 v[178:179], v[234:235], v[212:213], v[178:179] op_sel:[0,1,0] op_sel_hi:[1,1,1]
    v_pk_fma_f32 v[180:181], v[236:237], v[212:213], v[180:181] op_sel:[0,1,0] op_sel_hi:[1,1,1]
    v_pk_fma_f32 v[182:183], v[238:239], v[212:213], v[182:183] op_sel:[0,1,0] op_sel_hi:[1,1,1]
    v_pk_fma_f32 v[184:185], v[240:241], v[212:213], v[184:185] op_sel:[0,1,0] op_sel_hi:[1,1,1]
    v_pk_fma_f32 v[186:187], v[242:243], v[212:213], v[186:187] op_sel:[0,1,0] op_sel_hi:[1,1,1]
    v_pk_fma_f32 v[188:189], v[244:245], v[212:213], v[188:189] op_sel:[0,1,0] op_sel_hi:[1,1,1]
    v_pk_fma_f32 v[190:191], v[246:247], v[212:213], v[190:191] op_sel:[0,1,0] op_sel_hi:[1,1,1]
    v_pk_fma_f32 v[192:193], v[248:249], v[212:213], v[192:193] op_sel:[0,1,0] op_sel_hi:[1,1,1]
    v_pk_fma_f32 v[194:195], v[250:251], v[212:213], v[194:195] op_sel:[0,1,0] op_sel_hi:[1,1,1]
    v_pk_fma_f32 v[160:161], v[234:235], v[204:205], v[160:161] op_sel:[0,0,0] op_sel_hi:[1,0,1]
    v_pk_fma_f32 v[162:163], v[236:237], v[204:205], v[162:163] op_sel:[0,0,0] op_sel_hi:[1,0,1]
    v_pk_fma_f32 v[164:165], v[238:239], v[204:205], v[164:165] op_sel:[0,0,0] op_sel_hi:[1,0,1]
    v_pk_fma_f32 v[166:167], v[240:241], v[204:205], v[166:167] op_sel:[0,0,0] op_sel_hi:[1,0,1]
    v_pk_fma_f32 v[168:169], v[242:243], v[204:205], v[168:169] op_sel:[0,0,0] op_sel_hi:[1,0,1]
    v_pk_fma_f32 v[170:171], v[244:245], v[204:205], v[170:171] op_sel:[0,0,0] op_sel_hi:[1,0,1]
    v_pk_fma_f32 v[172:173], v[246:247], v[204:205], v[172:173] op_sel:[0,0,0] op_sel_hi:[1,0,1]
    v_pk_fma_f32 v[174:175], v[248:249], v[204:205], v[174:175] op_sel:[0,0,0] op_sel_hi:[1,0,1]
    v_pk_fma_f32 v[176:177], v[250:251], v[204:205], v[176:177] op_sel:[0,0,0] op_sel_hi:[1,0,1]
    ds_read_b128 v[234:237], v6 offset:160
    ds_read_b128 v[238:241], v6 offset:176
    ds_read_b128 v[242:245], v6 offset:192
    ds_read_b128 v[246:249], v6 offset:208
    ds_read_b64 v[250:251], v6 offset:224
    s_waitcnt lgkmcnt(5)
    v_pk_fma_f32 v[178:179], v[216:217], v[214:215], v[178:179] op_sel:[0,0,0] op_sel_hi:[1,0,1]
    v_pk_fma_f32 v[180:181], v[218:219], v[214:215], v[180:181] op_sel:[0,0,0] op_sel_hi:[1,0,1]
    v_pk_fma_f32 v[182:183], v[220:221], v[214:215], v[182:183] op_sel:[0,0,0] op_sel_hi:[1,0,1]
    v_pk_fma_f32 v[184:185], v[222:223], v[214:215], v[184:185] op_sel:[0,0,0] op_sel_hi:[1,0,1]
    v_pk_fma_f32 v[186:187], v[224:225], v[214:215], v[186:187] op_sel:[0,0,0] op_sel_hi:[1,0,1]
    v_pk_fma_f32 v[188:189], v[226:227], v[214:215], v[188:189] op_sel:[0,0,0] op_sel_hi:[1,0,1]
    v_pk_fma_f32 v[190:191], v[228:229], v[214:215], v[190:191] op_sel:[0,0,0] op_sel_hi:[1,0,1]
    v_pk_fma_f32 v[192:193], v[230:231], v[214:215], v[192:193] op_sel:[0,0,0] op_sel_hi:[1,0,1]
    v_pk_fma_f32 v[194:195], v[232:233], v[214:215], v[194:195] op_sel:[0,0,0] op_sel_hi:[1,0,1]
    v_pk_fma_f32 v[160:161], v[216:217], v[204:205], v[160:161] op_sel:[0,1,0] op_sel_hi:[1,1,1]
    v_pk_fma_f32 v[162:163], v[218:219], v[204:205], v[162:163] op_sel:[0,1,0] op_sel_hi:[1,1,1]
    v_pk_fma_f32 v[164:165], v[220:221], v[204:205], v[164:165] op_sel:[0,1,0] op_sel_hi:[1,1,1]
    v_pk_fma_f32 v[166:167], v[222:223], v[204:205], v[166:167] op_sel:[0,1,0] op_sel_hi:[1,1,1]
    v_pk_fma_f32 v[168:169], v[224:225], v[204:205], v[168:169] op_sel:[0,1,0] op_sel_hi:[1,1,1]
    v_pk_fma_f32 v[170:171], v[226:227], v[204:205], v[170:171] op_sel:[0,1,0] op_sel_hi:[1,1,1]
    v_pk_fma_f32 v[172:173], v[228:229], v[204:205], v[172:173] op_sel:[0,1,0] op_sel_hi:[1,1,1]
    v_pk_fma_f32 v[174:175], v[230:231], v[204:205], v[174:175] op_sel:[0,1,0] op_sel_hi:[1,1,1]
    v_pk_fma_f32 v[176:177], v[232:233], v[204:205], v[176:177] op_sel:[0,1,0] op_sel_hi:[1,1,1]
    ds_read_b128 v[216:219], v6 offset:5760
    ds_read_b128 v[220:223], v6 offset:5776
    ds_read_b128 v[224:227], v6 offset:5792
    ds_read_b128 v[228:231], v6 offset:5808
    ds_read_b64 v[232:233], v6 offset:5824
    s_waitcnt lgkmcnt(5)
    v_pk_fma_f32 v[178:179], v[234:235], v[214:215], v[178:179] op_sel:[0,1,0] op_sel_hi:[1,1,1]
    v_pk_fma_f32 v[180:181], v[236:237], v[214:215], v[180:181] op_sel:[0,1,0] op_sel_hi:[1,1,1]
    v_pk_fma_f32 v[182:183], v[238:239], v[214:215], v[182:183] op_sel:[0,1,0] op_sel_hi:[1,1,1]
    v_pk_fma_f32 v[184:185], v[240:241], v[214:215], v[184:185] op_sel:[0,1,0] op_sel_hi:[1,1,1]
Lpad0_5:
    s_cbranch_execz Lpadret
    v_pk_fma_f32 v[186:187], v[242:243], v[214:215], v[186:187] op_sel:[0,1,0] op_sel_hi:[1,1,1]
    v_pk_fma_f32 v[188:189], v[244:245], v[214:215], v[188:189] op_sel:[0,1,0] op_sel_hi:[1,1,1]
    v_pk_fma_f32 v[190:191], v[246:247], v[214:215], v[190:191] op_sel:[0,1,0] op_sel_hi:[1,1,1]
    v_pk_fma_f32 v[192:193], v[248:249], v[214:215], v[192:193] op_sel:[0,1,0] op_sel_hi:[1,1,1]
    v_pk_fma_f32 v[194:195], v[250:251], v[214:215], v[194:195] op_sel:[0,1,0] op_sel_hi:[1,1,1]
    v_pk_fma_f32 v[160:161], v[234:235], v[206:207], v[160:161] op_sel:[0,0,0] op_sel_hi:[1,0,1]
    v_pk_fma_f32 v[162:163], v[236:237], v[206:207], v[162:163] op_sel:[0,0,0] op_sel_hi:[1,0,1]
    v_pk_fma_f32 v[164:165], v[238:239], v[206:207], v[164:165] op_sel:[0,0,0] op_sel_hi:[1,0,1]
    v_pk_fma_f32 v[166:167], v[240:241], v[206:207], v[166:167] op_sel:[0,0,0] op_sel_hi:[1,0,1]
    v_pk_fma_f32 v[168:169], v[242:243], v[206:207], v[168:169] op_sel:[0,0,0] op_sel_hi:[1,0,1]
    v_pk_fma_f32 v[170:171], v[244:245], v[206:207], v[170:171] op_sel:[0,0,0] op_sel_hi:[1,0,1]
    v_pk_fma_f32 v[172:173], v[246:247], v[206:207], v[172:173] op_sel:[0,0,0] op_sel_hi:[1,0,1]
    v_pk_fma_f32 v[174:175], v[248:249], v[206:207], v[174:175] op_sel:[0,0,0] op_sel_hi:[1,0,1]
    v_pk_fma_f32 v[176:177], v[250:251], v[206:207], v[176:177] op_sel:[0,0,0] op_sel_hi:[1,0,1]
    s_cmp_eq_u32 s31, 3
    s_cbranch_scc1 Lw3a
    s_waitcnt vmcnt(0)
Lw3a:
    s_waitcnt vmcnt(10)
    s_lshl_b32 s70, s5, 10
    s_add_u32 s70, s70, 81920
    v_lshrrev_b32 v9, 2, v1
    v_lshlrev_b32 v9, 26, v9
    v_lshl_add_u32 v9, v1, 7, v9
    v_mov_b32 v10, 1
    buffer_atomic_add v10, v9, s[16:19], s70 offen sc1
    s_waitcnt lgkmcnt(0)
    v_pk_fma_f32 v[160:161], v[216:217], v[206:207], v[160:161] op_sel:[0,1,0] op_sel_hi:[1,1,1]
    v_pk_fma_f32 v[162:163], v[218:219], v[206:207], v[162:163] op_sel:[0,1,0] op_sel_hi:[1,1,1]
    v_pk_fma_f32 v[164:165], v[220:221], v[206:207], v[164:165] op_sel:[0,1,0] op_sel_hi:[1,1,1]
    v_pk_fma_f32 v[166:167], v[222:223], v[206:207], v[166:167] op_sel:[0,1,0] op_sel_hi:[1,1,1]
    v_pk_fma_f32 v[168:169], v[224:225], v[206:207], v[168:169] op_sel:[0,1,0] op_sel_hi:[1,1,1]
    v_pk_fma_f32 v[170:171], v[226:227], v[206:207], v[170:171] op_sel:[0,1,0] op_sel_hi:[1,1,1]
    v_pk_fma_f32 v[172:173], v[228:229], v[206:207], v[172:173] op_sel:[0,1,0] op_sel_hi:[1,1,1]
    v_pk_fma_f32 v[174:175], v[230:231], v[206:207], v[174:175] op_sel:[0,1,0] op_sel_hi:[1,1,1]
    v_pk_fma_f32 v[176:177], v[232:233], v[206:207], v[176:177] op_sel:[0,1,0] op_sel_hi:[1,1,1]
    s_cmp_eq_u32 s31, 3
    s_cbranch_scc1 Learly
    s_mov_b32 s31, 0
    s_atomic_add s31, s[68:69], s30 glc
    s_waitcnt lgkmcnt(0)
    s_add_u32 s31, s31, 1
    s_andn2_b32 s31, 4, s31
    s_cbranch_scc0 Lb23
Ls22:
    s_sub_u32 s26, s26, 1
    s_cselect_b32 s26, 0, s26
    s_cbranch_scc1 Lb23
    s_mov_b32 s31, 0
    s_atomic_add s31, s[68:69], s30 glc
    s_waitcnt lgkmcnt(0)
    s_add_u32 s31, s31, 1
    s_andn2_b32 s31, 4, s31
    s_cbranch_scc1 Ls22
Lb23:
    s_lshl_b32 s25, s98, 14
    s_add_u32 s25, s25, 2621440
    buffer_load_dwordx4 v[88:91], v11, s[16:19], s25 offen sc1
    s_add_u32 s25, s25, 4096
    buffer_load_dwordx4 v[92:95], v11, s[16:19], s25 offen sc1
    s_add_u32 s25, s25, 4096
    buffer_load_dwordx4 v[96:99], v11, s[16:19], s25 offen sc1
    s_add_u32 s25, s25, 4096
    buffer_load_dwordx4 v[100:103], v11, s[16:19], s25 offen sc1
    s_lshl_b32 s25, s99, 14
    s_add_u32 s25, s25, 2621440
    buffer_load_dwordx4 v[104:107], v11, s[16:19], s25 offen sc1
    s_add_u32 s25, s25, 4096
    buffer_load_dwordx4 v[108:111], v11, s[16:19], s25 offen sc1
    s_add_u32 s25, s25, 4096
    buffer_load_dwordx4 v[112:115], v11, s[16:19], s25 offen sc1
    s_add_u32 s25, s25, 4096
    buffer_load_dwordx4 v[116:119], v11, s[16:19], s25 offen sc1
    s_lshl_b32 s25, s100, 14
    s_add_u32 s25, s25, 2621440
    buffer_load_dwordx4 v[120:123], v11, s[16:19], s25 offen sc1
    s_add_u32 s25, s25, 4096
    buffer_load_dwordx4 v[124:127], v11, s[16:19], s25 offen sc1
Learly:
    s_lshl_b32 s51, s46, 4
    s_add_u32 s51, s51, s5
    s_mul_i32 s51, s51, 12288
    s_add_u32 s51, s51, 6029312
    v_cvt_pk_bf16_f32 v240, v160, v161
    v_cvt_pk_bf16_f32 v241, v162, v163
    v_cvt_pk_bf16_f32 v242, v164, v165
    v_cvt_pk_bf16_f32 v243, v166, v167
    v_cvt_pk_bf16_f32 v244, v168, v169
    v_cvt_pk_bf16_f32 v245, v170, v171
    v_cvt_pk_bf16_f32 v246, v172, v173
    v_cvt_pk_bf16_f32 v247, v174, v175
    v_cvt_pk_bf16_f32 v238, v176, v177
    v_cvt_pk_bf16_f32 v248, v178, v179
    v_cvt_pk_bf16_f32 v249, v180, v181
    v_cvt_pk_bf16_f32 v250, v182, v183
    v_cvt_pk_bf16_f32 v251, v184, v185
    v_cvt_pk_bf16_f32 v252, v186, v187
    v_cvt_pk_bf16_f32 v253, v188, v189
    v_cvt_pk_bf16_f32 v254, v190, v191
    v_cvt_pk_bf16_f32 v255, v192, v193
    v_cvt_pk_bf16_f32 v239, v194, v195
    v_lshrrev_b32_e64 v8, 5, v1
    v_mul_u32_u24 v8, 98048, v8
    v_lshl_add_u32 v8, v1, 3, v8
    v_lshl_add_u32 v8, s4, 8, v8
    v_lshlrev_b32 v228, 16, v84
    v_and_b32 v229, s41, v84
    v_lshlrev_b32 v230, 16, v85
    v_and_b32 v231, s41, v85
    v_lshlrev_b32 v224, 16, v80
    v_and_b32 v225, s41, v80
    v_lshlrev_b32 v226, 16, v81
    v_and_b32 v227, s41, v81
    v_lshlrev_b32 v220, 16, v76
    v_and_b32 v221, s41, v76
    v_lshlrev_b32 v222, 16, v77
    v_and_b32 v223, s41, v77
    v_lshlrev_b32 v216, 16, v72
    v_and_b32 v217, s41, v72
    v_lshlrev_b32 v218, 16, v73
    v_and_b32 v219, s41, v73
    v_lshlrev_b32 v212, 16, v68
    v_and_b32 v213, s41, v68
    v_lshlrev_b32 v214, 16, v69
    v_and_b32 v215, s41, v69
    v_lshlrev_b32 v208, 16, v64
    v_and_b32 v209, s41, v64
    v_lshlrev_b32 v210, 16, v65
    v_and_b32 v211, s41, v65
    v_lshlrev_b32 v204, 16, v60
    v_and_b32 v205, s41, v60
    v_lshlrev_b32 v206, 16, v61
    v_and_b32 v207, s41, v61
    v_lshlrev_b32 v200, 16, v56
    v_and_b32 v201, s41, v56
    v_lshlrev_b32 v202, 16, v57
    v_and_b32 v203, s41, v57
    v_lshlrev_b32 v196, 16, v52
    v_and_b32 v197, s41, v52
    v_lshlrev_b32 v198, 16, v53
    v_and_b32 v199, s41, v53
    v_lshlrev_b32 v192, 16, v48
    v_and_b32 v193, s41, v48
    v_lshlrev_b32 v194, 16, v49
    v_and_b32 v195, s41, v49
    v_lshlrev_b32 v188, 16, v44
    v_and_b32 v189, s41, v44
    v_lshlrev_b32 v190, 16, v45
    v_and_b32 v191, s41, v45
    v_lshlrev_b32 v184, 16, v40
    v_and_b32 v185, s41, v40
    v_lshlrev_b32 v186, 16, v41
    v_and_b32 v187, s41, v41
    v_lshlrev_b32 v180, 16, v36
    v_and_b32 v181, s41, v36
    v_lshlrev_b32 v182, 16, v37
    v_and_b32 v183, s41, v37
    v_lshlrev_b32 v176, 16, v32
    v_and_b32 v177, s41, v32
    v_lshlrev_b32 v178, 16, v33
    v_and_b32 v179, s41, v33
    v_lshlrev_b32 v172, 16, v28
    v_and_b32 v173, s41, v28
    v_lshlrev_b32 v174, 16, v29
    v_and_b32 v175, s41, v29
    v_lshlrev_b32 v168, 16, v24
    v_and_b32 v169, s41, v24
    v_lshlrev_b32 v170, 16, v25
    v_and_b32 v171, s41, v25
    v_lshlrev_b32 v164, 16, v20
    v_and_b32 v165, s41, v20
    v_lshlrev_b32 v166, 16, v21
    v_and_b32 v167, s41, v21
    v_lshlrev_b32 v160, 16, v16
    v_and_b32 v161, s41, v16
    v_lshlrev_b32 v162, 16, v17
    v_and_b32 v163, s41, v17
    v_lshlrev_b32 v4, 4, v1
    v_mov_b32 v232, 0
    v_mov_b32 v233, 0
    v_mov_b32 v234, 0
    v_mov_b32_e64 v235, 0
    s_mov_b32 s22, 2359296
    s_mov_b32 s23, 0x20000
    s_load_dwordx2 s[20:21], s[0:1], 64
    s_mov_b32 s27, 0
    s_mov_b32 s28, 0x17654321
    s_mov_b32 s29, 0x765432
    s_lshr_b64 s[28:29], s[28:29], s27
    s_mov_b32 s2, s28
    s_barrier
    s_lshl_b32 s27, s4, 7
    s_add_u32 s27, s27, 159744
    v_lshl_add_u32 v9, v2, 3, s27
    ds_write_b64 v9, v[14:15]
    s_lshl_b32 s31, s5, 3
    s_add_u32 s31, s31, s4
    s_lshl_b32 s31, s31, 7
    s_add_u32 s31, s31, 81920
    s_waitcnt vmcnt(9)
    v_dot2c_f32_bf16 v160, s38, v88
    v_dot2c_f32_bf16 v161, s39, v88
    v_dot2c_f32_bf16 v162, s38, v89
    v_dot2c_f32_bf16 v163, s39, v89
    v_lshlrev_b32 v16, 16, v18
    v_and_b32 v17, s41, v18
    v_dot2c_f32_bf16 v16, s38, v90
    v_dot2c_f32_bf16 v17, s39, v90
    v_lshlrev_b32 v88, 16, v19
    v_and_b32_e64 v89, s41, v19
    v_dot2c_f32_bf16 v88, s38, v91
    v_dot2c_f32_bf16 v89, s39, v91
    v_pk_add_f32 v[232:233], v[232:233], v[160:161]
    v_pk_fma_f32 v[234:235], v[160:161], v[160:161], v[234:235]
    v_pk_add_f32 v[232:233], v[232:233], v[162:163]
    v_pk_fma_f32 v[234:235], v[162:163], v[162:163], v[234:235]
    v_pk_add_f32 v[232:233], v[232:233], v[16:17]
    v_pk_fma_f32 v[234:235], v[16:17], v[16:17], v[234:235]
    v_pk_add_f32 v[232:233], v[232:233], v[88:89]
    v_pk_fma_f32 v[234:235], v[88:89], v[88:89], v[234:235]
    s_add_u32 s25, s25, 4096
    buffer_load_dwordx4 v[128:131], v11, s[16:19], s25 offen sc1
    s_waitcnt vmcnt(9)
    v_dot2c_f32_bf16 v164, s38, v92
    v_dot2c_f32_bf16 v165, s39, v92
    v_dot2c_f32_bf16 v166, s38, v93
    v_dot2c_f32_bf16 v167, s39, v93
    v_lshlrev_b32 v20, 16, v22
    v_and_b32 v21, s41, v22
    v_dot2c_f32_bf16 v20, s38, v94
    v_dot2c_f32_bf16 v21, s39, v94
    v_lshlrev_b32 v92, 16, v23
    v_and_b32_e64 v93, s41, v23
    v_dot2c_f32_bf16 v92, s38, v95
    v_dot2c_f32_bf16 v93, s39, v95
    v_pk_add_f32 v[232:233], v[232:233], v[164:165]
    v_pk_fma_f32 v[234:235], v[164:165], v[164:165], v[234:235]
    v_pk_add_f32 v[232:233], v[232:233], v[166:167]
    v_pk_fma_f32 v[234:235], v[166:167], v[166:167], v[234:235]
    v_pk_add_f32 v[232:233], v[232:233], v[20:21]
    v_pk_fma_f32 v[234:235], v[20:21], v[20:21], v[234:235]
    v_pk_add_f32 v[232:233], v[232:233], v[92:93]
    v_pk_fma_f32 v[234:235], v[92:93], v[92:93], v[234:235]
    s_add_u32 s25, s25, 4096
    buffer_load_dwordx4 v[132:135], v11, s[16:19], s25 offen sc1
    s_waitcnt vmcnt(9)
    v_dot2c_f32_bf16 v168, s38, v96
    v_dot2c_f32_bf16 v169, s39, v96
    v_dot2c_f32_bf16 v170, s38, v97
    v_dot2c_f32_bf16 v171, s39, v97
    v_lshlrev_b32 v24, 16, v26
    v_and_b32 v25, s41, v26
    v_dot2c_f32_bf16 v24, s38, v98
    v_dot2c_f32_bf16 v25, s39, v98
    v_lshlrev_b32 v96, 16, v27
    v_and_b32_e64 v97, s41, v27
    v_dot2c_f32_bf16 v96, s38, v99
    v_dot2c_f32_bf16 v97, s39, v99
    v_pk_add_f32 v[232:233], v[232:233], v[168:169]
    v_pk_fma_f32 v[234:235], v[168:169], v[168:169], v[234:235]
    v_pk_add_f32 v[232:233], v[232:233], v[170:171]
    v_pk_fma_f32 v[234:235], v[170:171], v[170:171], v[234:235]
    v_pk_add_f32 v[232:233], v[232:233], v[24:25]
    v_pk_fma_f32 v[234:235], v[24:25], v[24:25], v[234:235]
    v_pk_add_f32 v[232:233], v[232:233], v[96:97]
    v_pk_fma_f32 v[234:235], v[96:97], v[96:97], v[234:235]
    s_lshl_b32 s25, s101, 14
    s_add_u32 s25, s25, 2621440
    buffer_load_dwordx4 v[136:139], v11, s[16:19], s25 offen sc1
    s_waitcnt vmcnt(9)
    v_dot2c_f32_bf16 v172, s38, v100
    v_dot2c_f32_bf16 v173, s39, v100
    v_dot2c_f32_bf16 v174, s38, v101
    v_dot2c_f32_bf16 v175, s39, v101
    v_lshlrev_b32 v28, 16, v30
    v_and_b32 v29, s41, v30
    v_dot2c_f32_bf16 v28, s38, v102
    v_dot2c_f32_bf16 v29, s39, v102
    v_lshlrev_b32 v100, 16, v31
    v_and_b32 v101, s41, v31
    v_dot2c_f32_bf16 v100, s38, v103
    v_dot2c_f32_bf16 v101, s39, v103
    v_pk_add_f32 v[232:233], v[232:233], v[172:173]
    v_pk_fma_f32 v[234:235], v[172:173], v[172:173], v[234:235]
    v_pk_add_f32 v[232:233], v[232:233], v[174:175]
    v_pk_fma_f32 v[234:235], v[174:175], v[174:175], v[234:235]
    v_pk_add_f32 v[232:233], v[232:233], v[28:29]
    v_pk_fma_f32 v[234:235], v[28:29], v[28:29], v[234:235]
    v_pk_add_f32 v[232:233], v[232:233], v[100:101]
    v_pk_fma_f32 v[234:235], v[100:101], v[100:101], v[234:235]
    s_add_u32 s25, s25, 4096
    buffer_load_dwordx4 v[140:143], v11, s[16:19], s25 offen sc1
    s_waitcnt vmcnt(9)
    v_dot2c_f32_bf16 v176, s38, v104
    v_dot2c_f32_bf16 v177, s39, v104
    v_dot2c_f32_bf16 v178, s38, v105
    v_dot2c_f32_bf16 v179, s39, v105
    v_lshlrev_b32 v32, 16, v34
    v_and_b32 v33, s41, v34
    v_dot2c_f32_bf16 v32, s38, v106
    v_dot2c_f32_bf16 v33, s39, v106
    v_lshlrev_b32 v104, 16, v35
    v_and_b32_e64 v105, s41, v35
    v_dot2c_f32_bf16 v104, s38, v107
    v_dot2c_f32_bf16 v105, s39, v107
    v_pk_add_f32 v[232:233], v[232:233], v[176:177]
    v_pk_fma_f32 v[234:235], v[176:177], v[176:177], v[234:235]
    v_pk_add_f32 v[232:233], v[232:233], v[178:179]
    v_pk_fma_f32 v[234:235], v[178:179], v[178:179], v[234:235]
    v_pk_add_f32 v[232:233], v[232:233], v[32:33]
    v_pk_fma_f32 v[234:235], v[32:33], v[32:33], v[234:235]
    v_pk_add_f32 v[232:233], v[232:233], v[104:105]
    v_pk_fma_f32 v[234:235], v[104:105], v[104:105], v[234:235]
    s_add_u32 s25, s25, 4096
    buffer_load_dwordx4 v[144:147], v11, s[16:19], s25 offen sc1
    s_waitcnt vmcnt(9)
    v_dot2c_f32_bf16 v180, s38, v108
    v_dot2c_f32_bf16 v181, s39, v108
    v_dot2c_f32_bf16 v182, s38, v109
    v_dot2c_f32_bf16 v183, s39, v109
    v_lshlrev_b32 v36, 16, v38
    v_and_b32 v37, s41, v38
    v_dot2c_f32_bf16 v36, s38, v110
    v_dot2c_f32_bf16 v37, s39, v110
    v_lshlrev_b32 v108, 16, v39
    v_and_b32_e64 v109, s41, v39
    v_dot2c_f32_bf16 v108, s38, v111
    v_dot2c_f32_bf16 v109, s39, v111
    v_pk_add_f32 v[232:233], v[232:233], v[180:181]
    v_pk_fma_f32 v[234:235], v[180:181], v[180:181], v[234:235]
    v_pk_add_f32 v[232:233], v[232:233], v[182:183]
    v_pk_fma_f32 v[234:235], v[182:183], v[182:183], v[234:235]
    v_pk_add_f32 v[232:233], v[232:233], v[36:37]
    v_pk_fma_f32 v[234:235], v[36:37], v[36:37], v[234:235]
    v_pk_add_f32 v[232:233], v[232:233], v[108:109]
    v_pk_fma_f32 v[234:235], v[108:109], v[108:109], v[234:235]
    s_add_u32 s25, s25, 4096
    buffer_load_dwordx4 v[148:151], v11, s[16:19], s25 offen sc1
    s_waitcnt vmcnt(9)
    v_dot2c_f32_bf16 v184, s38, v112
    v_dot2c_f32_bf16 v185, s39, v112
    v_dot2c_f32_bf16 v186, s38, v113
    v_dot2c_f32_bf16 v187, s39, v113
    v_lshlrev_b32 v40, 16, v42
    v_and_b32 v41, s41, v42
    v_dot2c_f32_bf16 v40, s38, v114
    v_dot2c_f32_bf16 v41, s39, v114
    v_lshlrev_b32 v112, 16, v43
    v_and_b32_e64 v113, s41, v43
    v_dot2c_f32_bf16 v112, s38, v115
    v_dot2c_f32_bf16 v113, s39, v115
    v_pk_add_f32 v[232:233], v[232:233], v[184:185]
    v_pk_fma_f32 v[234:235], v[184:185], v[184:185], v[234:235]
    v_pk_add_f32 v[232:233], v[232:233], v[186:187]
    v_pk_fma_f32 v[234:235], v[186:187], v[186:187], v[234:235]
    v_pk_add_f32 v[232:233], v[232:233], v[40:41]
    v_pk_fma_f32 v[234:235], v[40:41], v[40:41], v[234:235]
    v_pk_add_f32 v[232:233], v[232:233], v[112:113]
    v_pk_fma_f32 v[234:235], v[112:113], v[112:113], v[234:235]
    s_mov_b32 s25, 2686976
    buffer_load_dwordx4 v[152:155], v11, s[16:19], s25 offen sc1
    s_waitcnt vmcnt(9)
    v_dot2c_f32_bf16 v188, s38, v116
    v_dot2c_f32_bf16 v189, s39, v116
    v_dot2c_f32_bf16 v190, s38, v117
    v_dot2c_f32_bf16 v191, s39, v117
    v_lshlrev_b32 v44, 16, v46
    v_and_b32 v45, s41, v46
    v_dot2c_f32_bf16 v44, s38, v118
    v_dot2c_f32_bf16 v45, s39, v118
    v_lshlrev_b32 v116, 16, v47
    v_and_b32 v117, s41, v47
    v_dot2c_f32_bf16 v116, s38, v119
    v_dot2c_f32_bf16 v117, s39, v119
    v_pk_add_f32 v[232:233], v[232:233], v[188:189]
    v_pk_fma_f32 v[234:235], v[188:189], v[188:189], v[234:235]
    v_pk_add_f32 v[232:233], v[232:233], v[190:191]
    v_pk_fma_f32 v[234:235], v[190:191], v[190:191], v[234:235]
    v_pk_add_f32 v[232:233], v[232:233], v[44:45]
    v_pk_fma_f32 v[234:235], v[44:45], v[44:45], v[234:235]
    v_pk_add_f32 v[232:233], v[232:233], v[116:117]
    v_pk_fma_f32 v[234:235], v[116:117], v[116:117], v[234:235]
    s_add_u32 s25, s25, 4096
    buffer_load_dwordx4 v[156:159], v11, s[16:19], s25 offen sc1
    s_waitcnt vmcnt(9)
    v_dot2c_f32_bf16 v192, s38, v120
    v_dot2c_f32_bf16 v193, s39, v120
    v_dot2c_f32_bf16 v194, s38, v121
    v_dot2c_f32_bf16 v195, s39, v121
    v_lshlrev_b32 v48, 16, v50
    v_and_b32 v49, s41, v50
    v_dot2c_f32_bf16 v48, s38, v122
    v_dot2c_f32_bf16 v49, s39, v122
    v_lshlrev_b32 v120, 16, v51
    v_and_b32 v121, s41, v51
    v_dot2c_f32_bf16 v120, s38, v123
    v_dot2c_f32_bf16 v121, s39, v123
    v_pk_add_f32 v[232:233], v[232:233], v[192:193]
    v_pk_fma_f32 v[234:235], v[192:193], v[192:193], v[234:235]
    v_pk_add_f32 v[232:233], v[232:233], v[194:195]
    v_pk_fma_f32 v[234:235], v[194:195], v[194:195], v[234:235]
    v_pk_add_f32 v[232:233], v[232:233], v[48:49]
    v_pk_fma_f32 v[234:235], v[48:49], v[48:49], v[234:235]
    v_pk_add_f32 v[232:233], v[232:233], v[120:121]
    v_pk_fma_f32 v[234:235], v[120:121], v[120:121], v[234:235]
    s_waitcnt vmcnt(8)
    v_dot2c_f32_bf16 v196, s38, v124
    v_dot2c_f32_bf16 v197, s39, v124
    v_dot2c_f32_bf16 v198, s38, v125
    v_dot2c_f32_bf16 v199, s39, v125
    v_lshlrev_b32 v52, 16, v54
    v_and_b32 v53, s41, v54
    v_dot2c_f32_bf16 v52, s38, v126
    v_dot2c_f32_bf16 v53, s39, v126
    v_lshlrev_b32 v124, 16, v55
    v_and_b32_e64 v125, s41, v55
    v_dot2c_f32_bf16 v124, s38, v127
    v_dot2c_f32_bf16 v125, s39, v127
    v_pk_add_f32 v[232:233], v[232:233], v[196:197]
    v_pk_fma_f32 v[234:235], v[196:197], v[196:197], v[234:235]
    v_pk_add_f32 v[232:233], v[232:233], v[198:199]
    v_pk_fma_f32 v[234:235], v[198:199], v[198:199], v[234:235]
    v_pk_add_f32 v[232:233], v[232:233], v[52:53]
    v_pk_fma_f32 v[234:235], v[52:53], v[52:53], v[234:235]
    v_pk_add_f32 v[232:233], v[232:233], v[124:125]
    v_pk_fma_f32 v[234:235], v[124:125], v[124:125], v[234:235]
    buffer_store_dwordx4 v[240:243], v7, s[16:19], s51 offen offset:0 sc1
    s_waitcnt vmcnt(8)
    v_dot2c_f32_bf16 v200, s38, v128
    v_dot2c_f32_bf16 v201, s39, v128
    v_dot2c_f32_bf16 v202, s38, v129
    v_dot2c_f32_bf16 v203, s39, v129
    v_lshlrev_b32 v56, 16, v58
    v_and_b32 v57, s41, v58
    v_dot2c_f32_bf16 v56, s38, v130
    v_dot2c_f32_bf16 v57, s39, v130
    v_lshlrev_b32 v128, 16, v59
    v_and_b32_e64 v129, s41, v59
    v_dot2c_f32_bf16 v128, s38, v131
    v_dot2c_f32_bf16 v129, s39, v131
    v_pk_add_f32 v[232:233], v[232:233], v[200:201]
    v_pk_fma_f32 v[234:235], v[200:201], v[200:201], v[234:235]
    v_pk_add_f32 v[232:233], v[232:233], v[202:203]
    v_pk_fma_f32 v[234:235], v[202:203], v[202:203], v[234:235]
    v_pk_add_f32 v[232:233], v[232:233], v[56:57]
    v_pk_fma_f32 v[234:235], v[56:57], v[56:57], v[234:235]
    v_pk_add_f32 v[232:233], v[232:233], v[128:129]
    v_pk_fma_f32 v[234:235], v[128:129], v[128:129], v[234:235]
    s_waitcnt vmcnt(7)
    v_dot2c_f32_bf16 v204, s38, v132
    v_dot2c_f32_bf16 v205, s39, v132
    v_dot2c_f32_bf16 v206, s38, v133
    v_dot2c_f32_bf16 v207, s39, v133
    v_lshlrev_b32 v60, 16, v62
    v_and_b32 v61, s41, v62
    v_dot2c_f32_bf16 v60, s38, v134
    v_dot2c_f32_bf16 v61, s39, v134
    v_lshlrev_b32 v132, 16, v63
    v_and_b32_e64 v133, s41, v63
    v_dot2c_f32_bf16 v132, s38, v135
    v_dot2c_f32_bf16 v133, s39, v135
    v_pk_add_f32 v[232:233], v[232:233], v[204:205]
    v_pk_fma_f32 v[234:235], v[204:205], v[204:205], v[234:235]
    v_pk_add_f32 v[232:233], v[232:233], v[206:207]
    v_pk_fma_f32 v[234:235], v[206:207], v[206:207], v[234:235]
    v_pk_add_f32 v[232:233], v[232:233], v[60:61]
    v_pk_fma_f32 v[234:235], v[60:61], v[60:61], v[234:235]
    v_pk_add_f32 v[232:233], v[232:233], v[132:133]
    v_pk_fma_f32 v[234:235], v[132:133], v[132:133], v[234:235]
    buffer_store_dwordx4 v[248:251], v7, s[16:19], s51 offen offset:512 sc1
    s_waitcnt vmcnt(7)
    v_dot2c_f32_bf16 v208, s38, v136
    v_dot2c_f32_bf16 v209, s39, v136
    v_dot2c_f32_bf16 v210, s38, v137
    v_dot2c_f32_bf16 v211, s39, v137
    v_lshlrev_b32 v64, 16, v66
    v_and_b32 v65, s41, v66
    v_dot2c_f32_bf16 v64, s38, v138
    v_dot2c_f32_bf16 v65, s39, v138
    v_lshlrev_b32 v136, 16, v67
    v_and_b32_e64 v137, s41, v67
    v_dot2c_f32_bf16 v136, s38, v139
    v_dot2c_f32_bf16 v137, s39, v139
    v_pk_add_f32 v[232:233], v[232:233], v[208:209]
    v_pk_fma_f32 v[234:235], v[208:209], v[208:209], v[234:235]
    v_pk_add_f32 v[232:233], v[232:233], v[210:211]
    v_pk_fma_f32 v[234:235], v[210:211], v[210:211], v[234:235]
    v_pk_add_f32 v[232:233], v[232:233], v[64:65]
    v_pk_fma_f32 v[234:235], v[64:65], v[64:65], v[234:235]
    v_pk_add_f32 v[232:233], v[232:233], v[136:137]
    v_pk_fma_f32 v[234:235], v[136:137], v[136:137], v[234:235]
    s_mov_b32 s53, 0
    s_atomic_add s53, s[68:69], s31 glc
    s_waitcnt vmcnt(6)
    v_dot2c_f32_bf16 v212, s38, v140
    v_dot2c_f32_bf16 v213, s39, v140
    v_dot2c_f32_bf16 v214, s38, v141
    v_dot2c_f32_bf16 v215, s39, v141
    v_lshlrev_b32 v68, 16, v70
    v_and_b32 v69, s41, v70
    v_dot2c_f32_bf16 v68, s38, v142
    v_dot2c_f32_bf16 v69, s39, v142
    v_lshlrev_b32 v140, 16, v71
    v_and_b32 v141, s41, v71
    v_dot2c_f32_bf16 v140, s38, v143
    v_dot2c_f32_bf16 v141, s39, v143
    v_pk_add_f32 v[232:233], v[232:233], v[212:213]
    v_pk_fma_f32 v[234:235], v[212:213], v[212:213], v[234:235]
    v_pk_add_f32 v[232:233], v[232:233], v[214:215]
    v_pk_fma_f32 v[234:235], v[214:215], v[214:215], v[234:235]
    v_pk_add_f32 v[232:233], v[232:233], v[68:69]
    v_pk_fma_f32 v[234:235], v[68:69], v[68:69], v[234:235]
    v_pk_add_f32 v[232:233], v[232:233], v[140:141]
    v_pk_fma_f32 v[234:235], v[140:141], v[140:141], v[234:235]
    s_add_u32 s51, s51, 4096
    buffer_store_dwordx4 v[244:247], v7, s[16:19], s51 offen offset:0 sc1
    s_waitcnt vmcnt(6)
    v_dot2c_f32_bf16 v216, s38, v144
    v_dot2c_f32_bf16 v217, s39, v144
    v_dot2c_f32_bf16 v218, s38, v145
    v_dot2c_f32_bf16 v219, s39, v145
    v_lshlrev_b32 v72, 16, v74
    v_and_b32 v73, s41, v74
    v_dot2c_f32_bf16 v72, s38, v146
    v_dot2c_f32_bf16 v73, s39, v146
    v_lshlrev_b32 v144, 16, v75
    v_and_b32_e64 v145, s41, v75
    v_dot2c_f32_bf16 v144, s38, v147
    v_dot2c_f32_bf16 v145, s39, v147
    v_pk_add_f32 v[232:233], v[232:233], v[216:217]
    v_pk_fma_f32 v[234:235], v[216:217], v[216:217], v[234:235]
    v_pk_add_f32 v[232:233], v[232:233], v[218:219]
    v_pk_fma_f32 v[234:235], v[218:219], v[218:219], v[234:235]
    v_pk_add_f32 v[232:233], v[232:233], v[72:73]
    v_pk_fma_f32 v[234:235], v[72:73], v[72:73], v[234:235]
    v_pk_add_f32 v[232:233], v[232:233], v[144:145]
    v_pk_fma_f32 v[234:235], v[144:145], v[144:145], v[234:235]
    s_waitcnt vmcnt(5)
    v_dot2c_f32_bf16 v220, s38, v148
    v_dot2c_f32_bf16 v221, s39, v148
    v_dot2c_f32_bf16 v222, s38, v149
    v_dot2c_f32_bf16 v223, s39, v149
    v_lshlrev_b32 v76, 16, v78
    v_and_b32 v77, s41, v78
    v_dot2c_f32_bf16 v76, s38, v150
    v_dot2c_f32_bf16 v77, s39, v150
    v_lshlrev_b32 v148, 16, v79
    v_and_b32_e64 v149, s41, v79
    v_dot2c_f32_bf16 v148, s38, v151
    v_dot2c_f32_bf16 v149, s39, v151
    v_pk_add_f32 v[232:233], v[232:233], v[220:221]
    v_pk_fma_f32 v[234:235], v[220:221], v[220:221], v[234:235]
    v_pk_add_f32 v[232:233], v[232:233], v[222:223]
    v_pk_fma_f32 v[234:235], v[222:223], v[222:223], v[234:235]
    v_pk_add_f32 v[232:233], v[232:233], v[76:77]
    v_pk_fma_f32 v[234:235], v[76:77], v[76:77], v[234:235]
    v_pk_add_f32 v[232:233], v[232:233], v[148:149]
    v_pk_fma_f32 v[234:235], v[148:149], v[148:149], v[234:235]
    buffer_store_dwordx4 v[252:255], v7, s[16:19], s51 offen offset:512 sc1
    s_waitcnt vmcnt(5)
    v_dot2c_f32_bf16 v224, s38, v152
    v_dot2c_f32_bf16 v225, s39, v152
    v_dot2c_f32_bf16 v226, s38, v153
    v_dot2c_f32_bf16 v227, s39, v153
    v_lshlrev_b32 v80, 16, v82
    v_and_b32 v81, s41, v82
    v_dot2c_f32_bf16 v80, s38, v154
    v_dot2c_f32_bf16 v81, s39, v154
    v_lshlrev_b32 v152, 16, v83
    v_and_b32_e64 v153, s41, v83
    v_dot2c_f32_bf16 v152, s38, v155
    v_dot2c_f32_bf16 v153, s39, v155
    v_pk_add_f32 v[232:233], v[232:233], v[224:225]
    v_pk_fma_f32 v[234:235], v[224:225], v[224:225], v[234:235]
    v_pk_add_f32 v[232:233], v[232:233], v[226:227]
    v_pk_fma_f32 v[234:235], v[226:227], v[226:227], v[234:235]
    v_pk_add_f32 v[232:233], v[232:233], v[80:81]
    v_pk_fma_f32 v[234:235], v[80:81], v[80:81], v[234:235]
    v_pk_add_f32 v[232:233], v[232:233], v[152:153]
    v_pk_fma_f32 v[234:235], v[152:153], v[152:153], v[234:235]
    s_waitcnt vmcnt(4)
    v_dot2c_f32_bf16 v228, s38, v156
    v_dot2c_f32_bf16 v229, s39, v156
    v_dot2c_f32_bf16 v230, s38, v157
    v_dot2c_f32_bf16 v231, s39, v157
    v_lshlrev_b32 v84, 16, v86
    v_and_b32 v85, s41, v86
    v_dot2c_f32_bf16 v84, s38, v158
    v_dot2c_f32_bf16 v85, s39, v158
    v_lshlrev_b32 v156, 16, v87
    v_and_b32_e64 v157, s41, v87
    v_dot2c_f32_bf16 v156, s38, v159
    v_dot2c_f32_bf16 v157, s39, v159
    v_pk_add_f32 v[232:233], v[232:233], v[228:229]
    v_pk_fma_f32 v[234:235], v[228:229], v[228:229], v[234:235]
    v_pk_add_f32 v[232:233], v[232:233], v[230:231]
    v_pk_fma_f32 v[234:235], v[230:231], v[230:231], v[234:235]
    v_pk_add_f32 v[232:233], v[232:233], v[84:85]
    v_pk_fma_f32 v[234:235], v[84:85], v[84:85], v[234:235]
    v_pk_add_f32 v[232:233], v[232:233], v[156:157]
    v_pk_fma_f32 v[234:235], v[156:157], v[156:157], v[234:235]
    v_add_f32 v232, v232, v233
    v_add_f32 v234, v234, v235
    s_add_u32 s51, s51, 4096
    buffer_store_dwordx2 v[238:239], v8, s[16:19], s51 offen sc1
    v_mov_b32 v12, v232
    v_mov_b32 v13, v234
    s_nop 0
    v_permlane16_swap_b32 v12, v232
    v_permlane16_swap_b32 v13, v234
    v_add_f32 v232, v12, v232
    v_add_f32 v234, v13, v234
    v_mov_b32 v12, v232
    v_mov_b32 v13, v234
    s_nop 0
    v_permlane32_swap_b32 v12, v232
    v_permlane32_swap_b32 v13, v234
    v_add_f32 v232, v12, v232
    v_add_f32 v234, v13, v234
    v_mul_f32 v232, 0x3ae38e39, v232
    v_mul_f32 v234, 0x3ae38e39, v234
    v_fma_f32 v234, -v232, v232, v234
    v_max_f32_e64 v234, 0, v234
    v_add_f32 v12, 0x3727c5ac, v234
    v_rsq_f32 v236, v12
    s_nop 0
    v_mul_f32 v237, -v232, v236
    v_mul_f32 v236, s34, v236
    v_mul_f32 v237, s34, v237
    s_lshl_b32 s27, s4, 10
    v_add_u32 v9, s27, v4
    v_lshl_add_u32 v10, s98, 14, v9
    v_pk_fma_f32 v[160:161], v[160:161], v[236:237], v[236:237] op_sel:[0,0,1] op_sel_hi:[1,0,1]
    v_pk_fma_f32 v[162:163], v[162:163], v[236:237], v[236:237] op_sel:[0,0,1] op_sel_hi:[1,0,1]
    v_pk_fma_f32 v[16:17], v[16:17], v[236:237], v[236:237] op_sel:[0,0,1] op_sel_hi:[1,0,1]
    v_pk_fma_f32 v[88:89], v[88:89], v[236:237], v[236:237] op_sel:[0,0,1] op_sel_hi:[1,0,1]
    v_cvt_pk_bf16_f32 v240, v160, v161
    v_cvt_pk_bf16_f32 v241, v162, v163
    v_cvt_pk_bf16_f32 v242, v16, v17
    v_cvt_pk_bf16_f32 v243, v88, v89
    ds_write_b128 v10, v[240:243] offset:0
    v_pk_fma_f32 v[164:165], v[164:165], v[236:237], v[236:237] op_sel:[0,0,1] op_sel_hi:[1,0,1]
    v_pk_fma_f32 v[166:167], v[166:167], v[236:237], v[236:237] op_sel:[0,0,1] op_sel_hi:[1,0,1]
    v_pk_fma_f32 v[20:21], v[20:21], v[236:237], v[236:237] op_sel:[0,0,1] op_sel_hi:[1,0,1]
    v_pk_fma_f32 v[92:93], v[92:93], v[236:237], v[236:237] op_sel:[0,0,1] op_sel_hi:[1,0,1]
    v_cvt_pk_bf16_f32 v244, v164, v165
    v_cvt_pk_bf16_f32 v245, v166, v167
    v_cvt_pk_bf16_f32 v246, v20, v21
    v_cvt_pk_bf16_f32 v247, v92, v93
    ds_write_b128 v10, v[244:247] offset:4096
    s_waitcnt lgkmcnt(0)
    s_add_u32 s53, s53, 1
    s_andn2_b32 s53, 64, s53
    s_cbranch_scc0 Lb25
Ls24:
    s_sub_u32 s26, s26, 1
    s_cselect_b32 s26, 0, s26
    s_cbranch_scc1 Lb25
    s_sleep 8
    s_mov_b32 s53, 0
    s_atomic_add s53, s[68:69], s31 glc
    s_waitcnt lgkmcnt(0)
    s_add_u32 s53, s53, 1
    s_andn2_b32 s53, 64, s53
    s_cbranch_scc1 Ls24
Lb25:
    s_lshl_b32 s55, s5, 2
    s_add_u32 s55, s55, s4
    s_mul_i32 s55, s55, 165888
    s_add_u32 s55, s55, 28049408
    s_mul_i32 s42, s98, 0
    s_add_u32 s42, s42, s55
    buffer_load_dwordx4 a[0:3], v4, s[16:19], s42 offen offset:0 sc1
    buffer_load_dwordx4 a[4:7], v4, s[16:19], s42 offen offset:1024 sc1
    buffer_load_dwordx4 a[8:11], v4, s[16:19], s42 offen offset:2048 sc1
    v_pk_fma_f32 v[168:169], v[168:169], v[236:237], v[236:237] op_sel:[0,0,1] op_sel_hi:[1,0,1]
    v_pk_fma_f32 v[170:171], v[170:171], v[236:237], v[236:237] op_sel:[0,0,1] op_sel_hi:[1,0,1]
    v_pk_fma_f32 v[24:25], v[24:25], v[236:237], v[236:237] op_sel:[0,0,1] op_sel_hi:[1,0,1]
    v_pk_fma_f32 v[96:97], v[96:97], v[236:237], v[236:237] op_sel:[0,0,1] op_sel_hi:[1,0,1]
    v_cvt_pk_bf16_f32 v240, v168, v169
    v_cvt_pk_bf16_f32 v241, v170, v171
    v_cvt_pk_bf16_f32 v242, v24, v25
    v_cvt_pk_bf16_f32 v243, v96, v97
    ds_write_b128 v10, v[240:243] offset:8192
    v_pk_fma_f32 v[172:173], v[172:173], v[236:237], v[236:237] op_sel:[0,0,1] op_sel_hi:[1,0,1]
    v_pk_fma_f32 v[174:175], v[174:175], v[236:237], v[236:237] op_sel:[0,0,1] op_sel_hi:[1,0,1]
    v_pk_fma_f32 v[28:29], v[28:29], v[236:237], v[236:237] op_sel:[0,0,1] op_sel_hi:[1,0,1]
    v_pk_fma_f32 v[100:101], v[100:101], v[236:237], v[236:237] op_sel:[0,0,1] op_sel_hi:[1,0,1]
    v_cvt_pk_bf16_f32 v244, v172, v173
    v_cvt_pk_bf16_f32 v245, v174, v175
    v_cvt_pk_bf16_f32 v246, v28, v29
    v_cvt_pk_bf16_f32 v247, v100, v101
    ds_write_b128 v10, v[244:247] offset:12288
    v_lshl_add_u32 v11, s99, 14, v9
    v_pk_fma_f32 v[176:177], v[176:177], v[236:237], v[236:237] op_sel:[0,0,1] op_sel_hi:[1,0,1]
    v_pk_fma_f32 v[178:179], v[178:179], v[236:237], v[236:237] op_sel:[0,0,1] op_sel_hi:[1,0,1]
    v_pk_fma_f32 v[32:33], v[32:33], v[236:237], v[236:237] op_sel:[0,0,1] op_sel_hi:[1,0,1]
    v_pk_fma_f32 v[104:105], v[104:105], v[236:237], v[236:237] op_sel:[0,0,1] op_sel_hi:[1,0,1]
    v_cvt_pk_bf16_f32 v240, v176, v177
    v_cvt_pk_bf16_f32 v241, v178, v179
    v_cvt_pk_bf16_f32 v242, v32, v33
    v_cvt_pk_bf16_f32 v243, v104, v105
    ds_write_b128 v11, v[240:243] offset:0
    buffer_load_dwordx4 a[12:15], v4, s[16:19], s42 offen offset:3072 sc1
    s_add_u32 s42, s42, 4096
Lpad0_6:
    s_cbranch_execz Lpadret
    buffer_load_dwordx4 a[16:19], v4, s[16:19], s42 offen offset:0 sc1
    v_pk_fma_f32 v[180:181], v[180:181], v[236:237], v[236:237] op_sel:[0,0,1] op_sel_hi:[1,0,1]
    v_pk_fma_f32 v[182:183], v[182:183], v[236:237], v[236:237] op_sel:[0,0,1] op_sel_hi:[1,0,1]
    v_pk_fma_f32 v[36:37], v[36:37], v[236:237], v[236:237] op_sel:[0,0,1] op_sel_hi:[1,0,1]
    v_pk_fma_f32 v[108:109], v[108:109], v[236:237], v[236:237] op_sel:[0,0,1] op_sel_hi:[1,0,1]
    v_cvt_pk_bf16_f32 v244, v180, v181
    v_cvt_pk_bf16_f32 v245, v182, v183
    v_cvt_pk_bf16_f32 v246, v36, v37
    v_cvt_pk_bf16_f32 v247, v108, v109
    ds_write_b128 v11, v[244:247] offset:4096
    v_pk_fma_f32 v[184:185], v[184:185], v[236:237], v[236:237] op_sel:[0,0,1] op_sel_hi:[1,0,1]
    v_pk_fma_f32 v[186:187], v[186:187], v[236:237], v[236:237] op_sel:[0,0,1] op_sel_hi:[1,0,1]
    v_pk_fma_f32 v[40:41], v[40:41], v[236:237], v[236:237] op_sel:[0,0,1] op_sel_hi:[1,0,1]
    v_pk_fma_f32 v[112:113], v[112:113], v[236:237], v[236:237] op_sel:[0,0,1] op_sel_hi:[1,0,1]
    v_cvt_pk_bf16_f32 v240, v184, v185
    v_cvt_pk_bf16_f32 v241, v186, v187
    v_cvt_pk_bf16_f32 v242, v40, v41
    v_cvt_pk_bf16_f32 v243, v112, v113
    ds_write_b128 v11, v[240:243] offset:8192
    v_pk_fma_f32 v[188:189], v[188:189], v[236:237], v[236:237] op_sel:[0,0,1] op_sel_hi:[1,0,1]
    v_pk_fma_f32 v[190:191], v[190:191], v[236:237], v[236:237] op_sel:[0,0,1] op_sel_hi:[1,0,1]
    v_pk_fma_f32 v[44:45], v[44:45], v[236:237], v[236:237] op_sel:[0,0,1] op_sel_hi:[1,0,1]
    v_pk_fma_f32 v[116:117], v[116:117], v[236:237], v[236:237] op_sel:[0,0,1] op_sel_hi:[1,0,1]
    v_cvt_pk_bf16_f32 v244, v188, v189
    v_cvt_pk_bf16_f32 v245, v190, v191
    v_cvt_pk_bf16_f32 v246, v44, v45
    v_cvt_pk_bf16_f32 v247, v116, v117
    ds_write_b128 v11, v[244:247] offset:12288
    buffer_load_dwordx4 a[20:23], v4, s[16:19], s42 offen offset:1024 sc1
    buffer_load_dwordx4 a[24:27], v4, s[16:19], s42 offen offset:2048 sc1
    v_lshl_add_u32 v10, s100, 14, v9
    v_pk_fma_f32 v[192:193], v[192:193], v[236:237], v[236:237] op_sel:[0,0,1] op_sel_hi:[1,0,1]
    v_pk_fma_f32 v[194:195], v[194:195], v[236:237], v[236:237] op_sel:[0,0,1] op_sel_hi:[1,0,1]
    v_pk_fma_f32 v[48:49], v[48:49], v[236:237], v[236:237] op_sel:[0,0,1] op_sel_hi:[1,0,1]
    v_pk_fma_f32 v[120:121], v[120:121], v[236:237], v[236:237] op_sel:[0,0,1] op_sel_hi:[1,0,1]
    v_cvt_pk_bf16_f32 v240, v192, v193
    v_cvt_pk_bf16_f32 v241, v194, v195
    v_cvt_pk_bf16_f32 v242, v48, v49
    v_cvt_pk_bf16_f32 v243, v120, v121
    ds_write_b128 v10, v[240:243] offset:0
    v_pk_fma_f32 v[196:197], v[196:197], v[236:237], v[236:237] op_sel:[0,0,1] op_sel_hi:[1,0,1]
    v_pk_fma_f32 v[198:199], v[198:199], v[236:237], v[236:237] op_sel:[0,0,1] op_sel_hi:[1,0,1]
    v_pk_fma_f32 v[52:53], v[52:53], v[236:237], v[236:237] op_sel:[0,0,1] op_sel_hi:[1,0,1]
    v_pk_fma_f32 v[124:125], v[124:125], v[236:237], v[236:237] op_sel:[0,0,1] op_sel_hi:[1,0,1]
    v_cvt_pk_bf16_f32 v244, v196, v197
    v_cvt_pk_bf16_f32 v245, v198, v199
    v_cvt_pk_bf16_f32 v246, v52, v53
    v_cvt_pk_bf16_f32 v247, v124, v125
    ds_write_b128 v10, v[244:247] offset:4096
    v_pk_fma_f32 v[200:201], v[200:201], v[236:237], v[236:237] op_sel:[0,0,1] op_sel_hi:[1,0,1]
    v_pk_fma_f32 v[202:203], v[202:203], v[236:237], v[236:237] op_sel:[0,0,1] op_sel_hi:[1,0,1]
    v_pk_fma_f32 v[56:57], v[56:57], v[236:237], v[236:237] op_sel:[0,0,1] op_sel_hi:[1,0,1]
    v_pk_fma_f32 v[128:129], v[128:129], v[236:237], v[236:237] op_sel:[0,0,1] op_sel_hi:[1,0,1]
    v_cvt_pk_bf16_f32 v240, v200, v201
    v_cvt_pk_bf16_f32 v241, v202, v203
    v_cvt_pk_bf16_f32 v242, v56, v57
    v_cvt_pk_bf16_f32 v243, v128, v129
    ds_write_b128 v10, v[240:243] offset:8192
    buffer_load_dwordx4 a[28:31], v4, s[16:19], s42 offen offset:3072 sc1
    s_add_u32 s42, s42, 4096
    buffer_load_dwordx4 a[32:35], v4, s[16:19], s42 offen offset:0 sc1
    v_pk_fma_f32 v[204:205], v[204:205], v[236:237], v[236:237] op_sel:[0,0,1] op_sel_hi:[1,0,1]
    v_pk_fma_f32 v[206:207], v[206:207], v[236:237], v[236:237] op_sel:[0,0,1] op_sel_hi:[1,0,1]
    v_pk_fma_f32 v[60:61], v[60:61], v[236:237], v[236:237] op_sel:[0,0,1] op_sel_hi:[1,0,1]
    v_pk_fma_f32 v[132:133], v[132:133], v[236:237], v[236:237] op_sel:[0,0,1] op_sel_hi:[1,0,1]
    v_cvt_pk_bf16_f32 v244, v204, v205
    v_cvt_pk_bf16_f32 v245, v206, v207
    v_cvt_pk_bf16_f32 v246, v60, v61
    v_cvt_pk_bf16_f32 v247, v132, v133
    ds_write_b128 v10, v[244:247] offset:12288
    v_lshl_add_u32 v11, s101, 14, v9
    v_pk_fma_f32 v[208:209], v[208:209], v[236:237], v[236:237] op_sel:[0,0,1] op_sel_hi:[1,0,1]
    v_pk_fma_f32 v[210:211], v[210:211], v[236:237], v[236:237] op_sel:[0,0,1] op_sel_hi:[1,0,1]
    v_pk_fma_f32 v[64:65], v[64:65], v[236:237], v[236:237] op_sel:[0,0,1] op_sel_hi:[1,0,1]
    v_pk_fma_f32 v[136:137], v[136:137], v[236:237], v[236:237] op_sel:[0,0,1] op_sel_hi:[1,0,1]
    v_cvt_pk_bf16_f32 v240, v208, v209
    v_cvt_pk_bf16_f32 v241, v210, v211
    v_cvt_pk_bf16_f32 v242, v64, v65
    v_cvt_pk_bf16_f32 v243, v136, v137
    ds_write_b128 v11, v[240:243] offset:0
    v_pk_fma_f32 v[212:213], v[212:213], v[236:237], v[236:237] op_sel:[0,0,1] op_sel_hi:[1,0,1]
    v_pk_fma_f32 v[214:215], v[214:215], v[236:237], v[236:237] op_sel:[0,0,1] op_sel_hi:[1,0,1]
    v_pk_fma_f32 v[68:69], v[68:69], v[236:237], v[236:237] op_sel:[0,0,1] op_sel_hi:[1,0,1]
    v_pk_fma_f32 v[140:141], v[140:141], v[236:237], v[236:237] op_sel:[0,0,1] op_sel_hi:[1,0,1]
    v_cvt_pk_bf16_f32 v244, v212, v213
    v_cvt_pk_bf16_f32 v245, v214, v215
    v_cvt_pk_bf16_f32 v246, v68, v69
    v_cvt_pk_bf16_f32 v247, v140, v141
    ds_write_b128 v11, v[244:247] offset:4096
    buffer_load_dwordx4 a[36:39], v4, s[16:19], s42 offen offset:1024 sc1
    buffer_load_dwordx4 a[40:43], v4, s[16:19], s42 offen offset:2048 sc1
    v_pk_fma_f32 v[216:217], v[216:217], v[236:237], v[236:237] op_sel:[0,0,1] op_sel_hi:[1,0,1]
    v_pk_fma_f32 v[218:219], v[218:219], v[236:237], v[236:237] op_sel:[0,0,1] op_sel_hi:[1,0,1]
    v_pk_fma_f32 v[72:73], v[72:73], v[236:237], v[236:237] op_sel:[0,0,1] op_sel_hi:[1,0,1]
    v_pk_fma_f32 v[144:145], v[144:145], v[236:237], v[236:237] op_sel:[0,0,1] op_sel_hi:[1,0,1]
    v_cvt_pk_bf16_f32 v240, v216, v217
    v_cvt_pk_bf16_f32 v241, v218, v219
    v_cvt_pk_bf16_f32 v242, v72, v73
    v_cvt_pk_bf16_f32 v243, v144, v145
    ds_write_b128 v11, v[240:243] offset:8192
    v_pk_fma_f32 v[220:221], v[220:221], v[236:237], v[236:237] op_sel:[0,0,1] op_sel_hi:[1,0,1]
    v_pk_fma_f32 v[222:223], v[222:223], v[236:237], v[236:237] op_sel:[0,0,1] op_sel_hi:[1,0,1]
    v_pk_fma_f32 v[76:77], v[76:77], v[236:237], v[236:237] op_sel:[0,0,1] op_sel_hi:[1,0,1]
    v_pk_fma_f32 v[148:149], v[148:149], v[236:237], v[236:237] op_sel:[0,0,1] op_sel_hi:[1,0,1]
    v_cvt_pk_bf16_f32 v244, v220, v221
    v_cvt_pk_bf16_f32 v245, v222, v223
    v_cvt_pk_bf16_f32 v246, v76, v77
    v_cvt_pk_bf16_f32 v247, v148, v149
    ds_write_b128 v11, v[244:247] offset:12288
    v_add_u32 v10, 0x10000, v9
    v_pk_fma_f32 v[224:225], v[224:225], v[236:237], v[236:237] op_sel:[0,0,1] op_sel_hi:[1,0,1]
    v_pk_fma_f32 v[226:227], v[226:227], v[236:237], v[236:237] op_sel:[0,0,1] op_sel_hi:[1,0,1]
    v_pk_fma_f32 v[80:81], v[80:81], v[236:237], v[236:237] op_sel:[0,0,1] op_sel_hi:[1,0,1]
    v_pk_fma_f32 v[152:153], v[152:153], v[236:237], v[236:237] op_sel:[0,0,1] op_sel_hi:[1,0,1]
    v_cvt_pk_bf16_f32 v240, v224, v225
    v_cvt_pk_bf16_f32 v241, v226, v227
    v_cvt_pk_bf16_f32 v242, v80, v81
    v_cvt_pk_bf16_f32 v243, v152, v153
    ds_write_b128 v10, v[240:243] offset:0
    buffer_load_dwordx4 a[44:47], v4, s[16:19], s42 offen offset:3072 sc1
    s_mul_i32 s28, s6, 9
    s_add_u32 s28, s28, s5
    s_lshl_b32 s28, s28, 5
    s_add_u32 s28, s28, s4
    s_lshl_b32 s28, s28, 11
    s_add_u32 s28, s28, 9175040
    v_mov_b32 v248, -1
    v_mov_b32 v249, -1
    v_mov_b32 v250, -1
    v_mov_b32 v251, -1
    s_bfe_u32 s29, s2, 196628
    s_sub_u32 s29, s5, s29
    s_and_b32 s29, s29, 7
    s_lshl_b32 s29, s29, 13
    s_add_u32 s29, s29, s28
    buffer_store_dwordx4 v[248:251], v4, s[16:19], s29 offen offset:0 sc1
    v_pk_fma_f32 v[228:229], v[228:229], v[236:237], v[236:237] op_sel:[0,0,1] op_sel_hi:[1,0,1]
    v_pk_fma_f32 v[230:231], v[230:231], v[236:237], v[236:237] op_sel:[0,0,1] op_sel_hi:[1,0,1]
    v_pk_fma_f32 v[84:85], v[84:85], v[236:237], v[236:237] op_sel:[0,0,1] op_sel_hi:[1,0,1]
    v_pk_fma_f32 v[156:157], v[156:157], v[236:237], v[236:237] op_sel:[0,0,1] op_sel_hi:[1,0,1]
    v_cvt_pk_bf16_f32 v244, v228, v229
    v_cvt_pk_bf16_f32 v245, v230, v231
    v_cvt_pk_bf16_f32 v246, v84, v85
    v_cvt_pk_bf16_f32 v247, v156, v157
    ds_write_b128 v10, v[244:247] offset:4096
    buffer_store_dwordx4 v[248:251], v4, s[16:19], s29 offen offset:1024 sc1
    s_bfe_u32 s29, s2, 196632
    s_sub_u32 s29, s5, s29
    s_and_b32 s29, s29, 7
    s_lshl_b32 s29, s29, 13
    s_add_u32 s29, s29, s28
    buffer_store_dwordx4 v[248:251], v4, s[16:19], s29 offen offset:0 sc1
    buffer_store_dwordx4 v[248:251], v4, s[16:19], s29 offen offset:1024 sc1
    s_mov_b32 s65, 1073741824
    v_add_u32 v5, 73728, v4
    v_add_u32 v6, 147456, v4
    v_add_u32 v7, 0x10000, v4
    v_add_u32 v8, 0x10000, v5
    s_waitcnt lgkmcnt(0)
    s_barrier
    s_and_b32 s21, s21, 0xffff
    s_mov_b32 s98, 0
    s_mov_b32 s99, 1
    s_mov_b32 s100, 2
    s_mov_b32 s101, 3
    s_branch Lcommon
    .p2align 5
Lmix:
    s_waitcnt lgkmcnt(0)
    s_mov_b32 s8, s48
    s_and_b32 s9, s49, 0xffff
    s_mov_b32 s10, 2359296
    s_mov_b32 s11, 0x20000
    s_lshl_b32 s29, s98, 8
    s_add_u32 s29, s29, s44
    s_add_u32 m0, s3, 73728
    s_nop 0
    buffer_load_dwordx4 v0, s[8:11], s29 offen lds
    buffer_load_dwordx4 v254, s[8:11], s29 offen offset:1024 lds
    s_add_u32 s29, s29, 128
    s_add_u32 m0, s3, 75776
    s_nop 0
    buffer_load_dwordx4 v0, s[8:11], s29 offen lds
    buffer_load_dwordx4 v254, s[8:11], s29 offen offset:1024 lds
    s_lshl_b32 s29, s99, 8
    s_add_u32 s29, s29, s44
    s_add_u32 m0, s3, 77824
    s_nop 0
    buffer_load_dwordx4 v0, s[8:11], s29 offen lds
    buffer_load_dwordx4 v254, s[8:11], s29 offen offset:1024 lds
    s_add_u32 s29, s29, 128
    s_add_u32 m0, s3, 79872
    s_nop 0
    buffer_load_dwordx4 v0, s[8:11], s29 offen lds
    buffer_load_dwordx4 v254, s[8:11], s29 offen offset:1024 lds
    s_lshl_b32 s29, s100, 8
    s_add_u32 s29, s29, s44
    s_add_u32 m0, s3, 81920
    s_nop 0
    buffer_load_dwordx4 v0, s[8:11], s29 offen lds
    buffer_load_dwordx4 v254, s[8:11], s29 offen offset:1024 lds
    s_mov_b32 s16, s68
    s_and_b32 s17, s69, 0xffff
    s_mov_b32 s18, 67108864
    s_mov_b32 s19, 0x20000
    s_lshl_b32 s27, s37, 2
    s_add_u32 s27, s27, s4
    s_lshl_b32 s27, s27, 9
    v_mov_b32 v252, -1
    v_mov_b32 v253, -1
    v_lshlrev_b32 v251, 3, v1
    buffer_store_dwordx2 v[252:253], v251, s[16:19], s27 offen sc1
    s_mul_i32 s30, s43, 288
    s_mov_b32 s28, 1152
    v_mul_u32_u24 v249, 3641, v1
    v_lshlrev_b32 v250, 4, v1
    s_mov_b32 s31, -288
    v_add_u32 v246, 0, v249
    v_lshrrev_b32 v248, 17, v246
    v_lshrrev_b32 v246, 16, v246
    v_add_u32 v247, 0, v250
    v_mad_i32_i24 v247, v246, s31, v247
    v_bitop3_b32 v248, v248, v246, 4 bitop3:0x28
    v_lshl_or_b32 v248, v248, 1, v248
    v_xor_b32 v246, v248, v246
    s_sub_u32 s27, s30, 0
    v_mad_u32_u24 v246, v246, s28, v247
    v_add_u32 v4, s27, v246
    v_add_u32 v246, 233024, v249
    v_lshrrev_b32 v248, 17, v246
    v_lshrrev_b32 v246, 16, v246
    v_add_u32 v247, 1024, v250
    v_mad_i32_i24 v247, v246, s31, v247
    v_bitop3_b32 v248, v248, v246, 4 bitop3:0x28
    v_lshl_or_b32 v248, v248, 1, v248
    v_xor_b32 v246, v248, v246
    s_sub_u32 s27, s30, 1024
    v_mad_u32_u24 v246, v246, s28, v247
    v_add_u32 v5, s27, v246
    v_add_u32 v246, 466048, v249
    v_lshrrev_b32 v248, 17, v246
    v_lshrrev_b32 v246, 16, v246
    v_add_u32 v247, 2048, v250
    v_mad_i32_i24 v247, v246, s31, v247
    v_bitop3_b32 v248, v248, v246, 4 bitop3:0x28
    v_lshl_or_b32 v248, v248, 1, v248
    v_xor_b32 v246, v248, v246
    s_sub_u32 s27, s30, 2048
    v_mad_u32_u24 v246, v246, s28, v247
    v_add_u32 v6, s27, v246
    v_add_u32 v246, 699072, v249
    v_lshrrev_b32 v248, 17, v246
    v_lshrrev_b32 v246, 16, v246
    v_add_u32 v247, 3072, v250
    v_mad_i32_i24 v247, v246, s31, v247
    v_bitop3_b32 v248, v248, v246, 4 bitop3:0x28
    v_lshl_or_b32 v248, v248, 1, v248
    v_xor_b32_e64 v246, v248, v246
    s_sub_u32 s27, s30, 3072
    v_mad_u32_u24 v246, v246, s28, v247
    v_add_u32 v7, s27, v246
    v_add_u32 v246, 932096, v249
    v_lshrrev_b32 v248, 17, v246
    v_lshrrev_b32_e64 v246, 16, v246
    v_add_u32 v247, 4096, v250
    v_mad_i32_i24 v247, v246, s31, v247
    v_bitop3_b32 v248, v248, v246, 4 bitop3:0x28
    v_lshl_or_b32 v248, v248, 1, v248
    v_xor_b32 v246, v248, v246
    s_sub_u32 s27, s30, 0
    v_mad_u32_u24 v246, v246, s28, v247
    v_add_u32 v8, s27, v246
    v_add_u32 v246, 1165120, v249
    v_lshrrev_b32 v248, 17, v246
    v_lshrrev_b32_e64 v246, 16, v246
    v_add_u32 v247, 5120, v250
    v_mad_i32_i24 v247, v246, s31, v247
    v_bitop3_b32 v248, v248, v246, 4 bitop3:0x28
    v_lshl_or_b32 v248, v248, 1, v248
    v_xor_b32 v246, v248, v246
    s_sub_u32 s27, s30, 1024
    v_mad_u32_u24 v246, v246, s28, v247
    v_add_u32 v9, s27, v246
    v_add_u32 v246, 1398144, v249
    v_lshrrev_b32 v248, 17, v246
    v_lshrrev_b32 v246, 16, v246
    v_add_u32 v247, 6144, v250
    v_mad_i32_i24 v247, v246, s31, v247
    v_bitop3_b32 v248, v248, v246, 4 bitop3:0x28
    v_lshl_or_b32 v248, v248, 1, v248
    v_xor_b32_e64 v246, v248, v246
    s_sub_u32 s27, s30, 2048
    v_mad_u32_u24 v246, v246, s28, v247
    v_add_u32 v10, s27, v246
    v_add_u32 v246, 1631168, v249
    v_lshrrev_b32 v248, 17, v246
    v_lshrrev_b32_e64 v246, 16, v246
    v_add_u32 v247, 7168, v250
    v_mad_i32_i24 v247, v246, s31, v247
    v_bitop3_b32 v248, v248, v246, 4 bitop3:0x28
    v_lshl_or_b32 v248, v248, 1, v248
    v_xor_b32 v246, v248, v246
    s_sub_u32 s27, s30, 3072
    v_mad_u32_u24 v246, v246, s28, v247
    v_add_u32 v11, s27, v246
    v_add_u32 v246, 1864192, v249
    v_lshrrev_b32 v248, 17, v246
    v_lshrrev_b32 v246, 16, v246
    v_add_u32 v247, 8192, v250
    v_mad_i32_i24 v247, v246, s31, v247
    v_bitop3_b32 v248, v248, v246, 4 bitop3:0x28
    v_lshl_or_b32 v248, v248, 1, v248
    v_xor_b32 v246, v248, v246
    s_sub_u32 s27, s30, 0
    v_mad_u32_u24 v246, v246, s28, v247
    v_add_u32 v12, s27, v246
    v_lshrrev_b32 v246, 1, v2
    v_xor_b32 v246, v246, v3
    v_lshlrev_b32 v246, 4, v246
    v_lshl_add_u32 v246, v2, 7, v246
    s_add_u32 s27, s3, 73728
    v_add_u32 v14, s27, v246
    v_xor_b32 v246, 64, v246
    v_add_u32 v15, s27, v246
    s_mov_b32 s12, s56
    s_and_b32 s13, s57, 0xffff
    s_mov_b32 s14, 663552
    s_mov_b32 s15, 0x20000
    s_lshl_b32 s27, s4, 8
    s_add_u32 s27, s27, s44
    v_lshl_add_u32 v238, v2, 4, s27
    s_mov_b32 s20, s58
    s_and_b32 s21, s59, 0xffff
    s_mov_b32 s22, 663552
    s_mov_b32 s23, 0x20000
    s_and_b32 s27, s46, 7
    s_lshl_b32 s27, s27, 2
    s_add_u32 s27, s27, s4
    s_mul_i32 s27, s27, 2304
    s_and_b32 s31, s30, 0xffffff80
    s_add_u32 s27, s27, s31
    s_add_u32 s27, s27, 589824
    v_min_u32 v246, 5, v1
    v_mul_u32_u24 v247, 21846, v246
    v_lshrrev_b32 v247, 16, v247
    v_mul_u32_u24 v247, 768, v247
    v_lshl_add_u32 v246, v246, 7, v247
    s_mov_b64 exec, 0
    s_cmp_lt_u32 s4, 2
    s_cbranch_scc1 Li26
    s_cmp_eq_u32 s4, 2
    s_cbranch_scc1 Li27
    s_call_b64 s[70:71], Lpad29908_3
    s_branch Li29
Li27:
    s_call_b64 s[70:71], Lpad29908_2
    s_branch Li29
Li26:
    s_cmp_eq_u32 s4, 0
    s_cbranch_scc1 Li28
    s_call_b64 s[70:71], Lpad29908_1
    s_branch Li29
Li28:
    s_call_b64 s[70:71], Lpad29908_0
Li29:
    s_mov_b64 exec, -1
    s_mov_b64 exec, 0
    s_cmp_lt_u32 s4, 2
    s_cbranch_scc1 Li30
    s_cmp_eq_u32 s4, 2
    s_cbranch_scc1 Li31
    s_call_b64 s[70:71], Lpad53076_3
    s_branch Li33
Li31:
    s_call_b64 s[70:71], Lpad53076_2
    s_branch Li33
Li30:
    s_cmp_eq_u32 s4, 0
    s_cbranch_scc1 Li32
    s_call_b64 s[70:71], Lpad53076_1
    s_branch Li33
Li32:
    s_call_b64 s[70:71], Lpad53076_0
Li33:
    s_mov_b64 exec, -1
    s_add_u32 s29, s29, 128
    s_add_u32 m0, s3, 83968
    s_nop 0
    buffer_load_dwordx4 v0, s[8:11], s29 offen lds
    buffer_load_dwordx4 v254, s[8:11], s29 offen offset:1024 lds
    s_lshl_b32 s29, s101, 8
    s_add_u32 s29, s29, s44
    s_add_u32 m0, s3, 86016
    s_nop 0
    buffer_load_dwordx4 v0, s[8:11], s29 offen lds
    buffer_load_dwordx4 v254, s[8:11], s29 offen offset:1024 lds
    s_add_u32 s29, s29, 128
    s_add_u32 m0, s3, 88064
    s_nop 0
    buffer_load_dwordx4 v0, s[8:11], s29 offen lds
    buffer_load_dwordx4 v254, s[8:11], s29 offen offset:1024 lds
    s_add_u32 s29, s44, 1024
    s_add_u32 m0, s3, 90112
    s_nop 0
    buffer_load_dwordx4 v0, s[8:11], s29 offen lds
    buffer_load_dwordx4 v254, s[8:11], s29 offen offset:1024 lds
    buffer_load_dword a255, v246, s[12:15], s27 offen
    buffer_load_dword a255, v246, s[20:23], s27 offen
    v_mov_b32 v246, 0
    v_mov_b32 v247, 0
    v_mov_b32 v248, 0
    v_mov_b32 v249, 0
    s_lshl_b32 s25, s98, 2
    s_add_u32 s25, s25, s4
    s_mul_i32 s25, s25, 36864
    s_add_u32 m0, s24, 0
    s_nop 0
    buffer_load_dwordx4 v4, s[12:15], s25 offen offset:0 lds
    buffer_load_dwordx4 v5, s[12:15], s25 offen offset:1024 lds
    buffer_load_dwordx4 v6, s[12:15], s25 offen offset:2048 lds
    buffer_load_dwordx4 v7, s[12:15], s25 offen offset:3072 lds
    s_waitcnt vmcnt(23)
    ds_read_b128 v[16:19], v14 offset:0
    ds_read_b128 v[20:23], v15 offset:0
    s_waitcnt vmcnt(21)
    ds_read_b128 v[24:27], v14 offset:2048
    ds_read_b128 v[28:31], v15 offset:2048
    s_waitcnt lgkmcnt(2)
    v_lshlrev_b32 v88, 16, v16
    v_and_b32 v89, s41, v16
    v_lshlrev_b32 v90, 16, v17
    v_and_b32 v91, s41, v17
    v_lshlrev_b32 v92, 16, v18
    v_and_b32 v93, s41, v18
    v_lshlrev_b32 v94, 16, v19
    v_and_b32 v95, s41, v19
    v_pk_add_f32 v[246:247], v[246:247], v[88:89]
    v_pk_fma_f32 v[248:249], v[88:89], v[88:89], v[248:249]
    v_pk_add_f32 v[246:247], v[246:247], v[90:91]
    v_pk_fma_f32 v[248:249], v[90:91], v[90:91], v[248:249]
    v_pk_add_f32 v[246:247], v[246:247], v[92:93]
    v_pk_fma_f32 v[248:249], v[92:93], v[92:93], v[248:249]
    v_pk_add_f32 v[246:247], v[246:247], v[94:95]
    v_pk_fma_f32 v[248:249], v[94:95], v[94:95], v[248:249]
    v_lshlrev_b32 v96, 16, v20
    v_and_b32 v97, s41, v20
    v_lshlrev_b32 v98, 16, v21
    v_and_b32 v99, s41, v21
    v_lshlrev_b32 v100, 16, v22
    v_and_b32 v101, s41, v22
    v_lshlrev_b32 v102, 16, v23
    v_and_b32 v103, s41, v23
    v_pk_add_f32 v[246:247], v[246:247], v[96:97]
    v_pk_fma_f32 v[248:249], v[96:97], v[96:97], v[248:249]
    v_pk_add_f32 v[246:247], v[246:247], v[98:99]
    v_pk_fma_f32 v[248:249], v[98:99], v[98:99], v[248:249]
    v_pk_add_f32 v[246:247], v[246:247], v[100:101]
    v_pk_fma_f32 v[248:249], v[100:101], v[100:101], v[248:249]
    v_pk_add_f32 v[246:247], v[246:247], v[102:103]
    v_pk_fma_f32 v[248:249], v[102:103], v[102:103], v[248:249]
    s_waitcnt vmcnt(19)
    ds_read_b128 v[32:35], v14 offset:4096
    ds_read_b128 v[36:39], v15 offset:4096
    s_waitcnt lgkmcnt(2)
    v_lshlrev_b32 v104, 16, v24
    v_and_b32 v105, s41, v24
    v_lshlrev_b32 v106, 16, v25
    v_and_b32 v107, s41, v25
    v_lshlrev_b32 v108, 16, v26
    v_and_b32 v109, s41, v26
    v_lshlrev_b32 v110, 16, v27
    v_and_b32 v111, s41, v27
    v_pk_add_f32 v[246:247], v[246:247], v[104:105]
    v_pk_fma_f32 v[248:249], v[104:105], v[104:105], v[248:249]
    v_pk_add_f32 v[246:247], v[246:247], v[106:107]
    v_pk_fma_f32 v[248:249], v[106:107], v[106:107], v[248:249]
    v_pk_add_f32 v[246:247], v[246:247], v[108:109]
    v_pk_fma_f32 v[248:249], v[108:109], v[108:109], v[248:249]
    v_pk_add_f32 v[246:247], v[246:247], v[110:111]
    v_pk_fma_f32 v[248:249], v[110:111], v[110:111], v[248:249]
    v_lshlrev_b32 v112, 16, v28
    v_and_b32 v113, s41, v28
    v_lshlrev_b32 v114, 16, v29
    v_and_b32 v115, s41, v29
    v_lshlrev_b32 v116, 16, v30
    v_and_b32 v117, s41, v30
    v_lshlrev_b32 v118, 16, v31
    v_and_b32 v119, s41, v31
    v_pk_add_f32 v[246:247], v[246:247], v[112:113]
    v_pk_fma_f32 v[248:249], v[112:113], v[112:113], v[248:249]
    v_pk_add_f32 v[246:247], v[246:247], v[114:115]
    v_pk_fma_f32 v[248:249], v[114:115], v[114:115], v[248:249]
    v_pk_add_f32 v[246:247], v[246:247], v[116:117]
    v_pk_fma_f32 v[248:249], v[116:117], v[116:117], v[248:249]
    v_pk_add_f32 v[246:247], v[246:247], v[118:119]
    v_pk_fma_f32 v[248:249], v[118:119], v[118:119], v[248:249]
    s_waitcnt vmcnt(17)
    ds_read_b128 v[40:43], v14 offset:6144
    ds_read_b128 v[44:47], v15 offset:6144
    s_waitcnt lgkmcnt(2)
    v_lshlrev_b32 v120, 16, v32
    v_and_b32 v121, s41, v32
    v_lshlrev_b32 v122, 16, v33
    v_and_b32 v123, s41, v33
    v_lshlrev_b32 v124, 16, v34
    v_and_b32 v125, s41, v34
    v_lshlrev_b32 v126, 16, v35
    v_and_b32 v127, s41, v35
    v_pk_add_f32 v[246:247], v[246:247], v[120:121]
    v_pk_fma_f32 v[248:249], v[120:121], v[120:121], v[248:249]
    v_pk_add_f32 v[246:247], v[246:247], v[122:123]
    v_pk_fma_f32 v[248:249], v[122:123], v[122:123], v[248:249]
    v_pk_add_f32 v[246:247], v[246:247], v[124:125]
    v_pk_fma_f32 v[248:249], v[124:125], v[124:125], v[248:249]
    v_pk_add_f32 v[246:247], v[246:247], v[126:127]
    v_pk_fma_f32 v[248:249], v[126:127], v[126:127], v[248:249]
    v_lshlrev_b32 v128, 16, v36
    v_and_b32 v129, s41, v36
    v_lshlrev_b32 v130, 16, v37
    v_and_b32 v131, s41, v37
    v_lshlrev_b32 v132, 16, v38
    v_and_b32 v133, s41, v38
    v_lshlrev_b32 v134, 16, v39
    v_and_b32 v135, s41, v39
    v_pk_add_f32 v[246:247], v[246:247], v[128:129]
    v_pk_fma_f32 v[248:249], v[128:129], v[128:129], v[248:249]
    v_pk_add_f32 v[246:247], v[246:247], v[130:131]
    v_pk_fma_f32 v[248:249], v[130:131], v[130:131], v[248:249]
    v_pk_add_f32 v[246:247], v[246:247], v[132:133]
    v_pk_fma_f32 v[248:249], v[132:133], v[132:133], v[248:249]
    v_pk_add_f32 v[246:247], v[246:247], v[134:135]
    v_pk_fma_f32 v[248:249], v[134:135], v[134:135], v[248:249]
    s_add_u32 m0, s24, 4096
    s_nop 0
    buffer_load_dwordx4 v8, s[12:15], s25 offen offset:0 lds
    buffer_load_dwordx4 v9, s[12:15], s25 offen offset:1024 lds
    buffer_load_dwordx4 v10, s[12:15], s25 offen offset:2048 lds
    s_waitcnt vmcnt(18)
    ds_read_b128 v[48:51], v14 offset:8192
    ds_read_b128 v[52:55], v15 offset:8192
    s_waitcnt lgkmcnt(2)
    v_lshlrev_b32 v136, 16, v40
    v_and_b32 v137, s41, v40
    v_lshlrev_b32 v138, 16, v41
    v_and_b32 v139, s41, v41
    v_lshlrev_b32 v140, 16, v42
    v_and_b32 v141, s41, v42
    v_lshlrev_b32 v142, 16, v43
    v_and_b32_e64 v143, s41, v43
    v_pk_add_f32 v[246:247], v[246:247], v[136:137]
    v_pk_fma_f32 v[248:249], v[136:137], v[136:137], v[248:249]
    v_pk_add_f32 v[246:247], v[246:247], v[138:139]
    v_pk_fma_f32 v[248:249], v[138:139], v[138:139], v[248:249]
    v_pk_add_f32 v[246:247], v[246:247], v[140:141]
    v_pk_fma_f32 v[248:249], v[140:141], v[140:141], v[248:249]
    v_pk_add_f32 v[246:247], v[246:247], v[142:143]
    v_pk_fma_f32 v[248:249], v[142:143], v[142:143], v[248:249]
    v_lshlrev_b32 v144, 16, v44
    v_and_b32 v145, s41, v44
    v_lshlrev_b32 v146, 16, v45
    v_and_b32 v147, s41, v45
    v_lshlrev_b32 v148, 16, v46
    v_and_b32 v149, s41, v46
    v_lshlrev_b32 v150, 16, v47
    v_and_b32 v151, s41, v47
    v_pk_add_f32 v[246:247], v[246:247], v[144:145]
    v_pk_fma_f32 v[248:249], v[144:145], v[144:145], v[248:249]
    v_pk_add_f32 v[246:247], v[246:247], v[146:147]
    v_pk_fma_f32 v[248:249], v[146:147], v[146:147], v[248:249]
    v_pk_add_f32 v[246:247], v[246:247], v[148:149]
    v_pk_fma_f32 v[248:249], v[148:149], v[148:149], v[248:249]
    v_pk_add_f32 v[246:247], v[246:247], v[150:151]
    v_pk_fma_f32 v[248:249], v[150:151], v[150:151], v[248:249]
    s_waitcnt vmcnt(15)
    ds_read_b128 v[56:59], v14 offset:10240
    ds_read_b128 v[60:63], v15 offset:10240
    s_waitcnt lgkmcnt(2)
    v_lshlrev_b32 v152, 16, v48
    v_and_b32 v153, s41, v48
    v_lshlrev_b32 v154, 16, v49
    v_and_b32 v155, s41, v49
    v_lshlrev_b32 v156, 16, v50
    v_and_b32 v157, s41, v50
    v_lshlrev_b32 v158, 16, v51
    v_and_b32 v159, s41, v51
    v_pk_add_f32 v[246:247], v[246:247], v[152:153]
    v_pk_fma_f32 v[248:249], v[152:153], v[152:153], v[248:249]
    v_pk_add_f32 v[246:247], v[246:247], v[154:155]
    v_pk_fma_f32 v[248:249], v[154:155], v[154:155], v[248:249]
    v_pk_add_f32 v[246:247], v[246:247], v[156:157]
    v_pk_fma_f32 v[248:249], v[156:157], v[156:157], v[248:249]
    v_pk_add_f32 v[246:247], v[246:247], v[158:159]
    v_pk_fma_f32 v[248:249], v[158:159], v[158:159], v[248:249]
    v_lshlrev_b32 v160, 16, v52
    v_and_b32 v161, s41, v52
    v_lshlrev_b32 v162, 16, v53
    v_and_b32 v163, s41, v53
    v_lshlrev_b32 v164, 16, v54
    v_and_b32 v165, s41, v54
    v_lshlrev_b32 v166, 16, v55
    v_and_b32 v167, s41, v55
    v_pk_add_f32 v[246:247], v[246:247], v[160:161]
    v_pk_fma_f32 v[248:249], v[160:161], v[160:161], v[248:249]
    v_pk_add_f32 v[246:247], v[246:247], v[162:163]
    v_pk_fma_f32 v[248:249], v[162:163], v[162:163], v[248:249]
    v_pk_add_f32 v[246:247], v[246:247], v[164:165]
    v_pk_fma_f32 v[248:249], v[164:165], v[164:165], v[248:249]
    v_pk_add_f32 v[246:247], v[246:247], v[166:167]
    v_pk_fma_f32 v[248:249], v[166:167], v[166:167], v[248:249]
    s_waitcnt vmcnt(13)
    ds_read_b128 v[64:67], v14 offset:12288
    ds_read_b128 v[68:71], v15 offset:12288
    s_waitcnt lgkmcnt(2)
    v_lshlrev_b32 v168, 16, v56
    v_and_b32 v169, s41, v56
    v_lshlrev_b32 v170, 16, v57
    v_and_b32 v171, s41, v57
    v_lshlrev_b32 v172, 16, v58
    v_and_b32 v173, s41, v58
    v_lshlrev_b32 v174, 16, v59
    v_and_b32 v175, s41, v59
    v_pk_add_f32 v[246:247], v[246:247], v[168:169]
    v_pk_fma_f32 v[248:249], v[168:169], v[168:169], v[248:249]
    v_pk_add_f32 v[246:247], v[246:247], v[170:171]
    v_pk_fma_f32 v[248:249], v[170:171], v[170:171], v[248:249]
    v_pk_add_f32 v[246:247], v[246:247], v[172:173]
    v_pk_fma_f32 v[248:249], v[172:173], v[172:173], v[248:249]
    v_pk_add_f32 v[246:247], v[246:247], v[174:175]
    v_pk_fma_f32 v[248:249], v[174:175], v[174:175], v[248:249]
    v_lshlrev_b32 v176, 16, v60
    v_and_b32 v177, s41, v60
    v_lshlrev_b32 v178, 16, v61
    v_and_b32 v179, s41, v61
    v_lshlrev_b32 v180, 16, v62
    v_and_b32 v181, s41, v62
    v_lshlrev_b32 v182, 16, v63
    v_and_b32 v183, s41, v63
    v_pk_add_f32 v[246:247], v[246:247], v[176:177]
    v_pk_fma_f32 v[248:249], v[176:177], v[176:177], v[248:249]
    v_pk_add_f32 v[246:247], v[246:247], v[178:179]
    v_pk_fma_f32 v[248:249], v[178:179], v[178:179], v[248:249]
    v_pk_add_f32 v[246:247], v[246:247], v[180:181]
    v_pk_fma_f32 v[248:249], v[180:181], v[180:181], v[248:249]
    v_pk_add_f32 v[246:247], v[246:247], v[182:183]
    v_pk_fma_f32 v[248:249], v[182:183], v[182:183], v[248:249]
Lpad29908_0:
    s_cbranch_execz Lpad29908_4
    buffer_load_dwordx4 v11, s[12:15], s25 offen offset:3072 lds
    s_add_u32 m0, s24, 8192
    s_nop 0
    buffer_load_dwordx4 v12, s[12:15], s25 offen offset:0 lds
    s_waitcnt vmcnt(13)
    ds_read_b128 v[72:75], v14 offset:14336
    ds_read_b128 v[76:79], v15 offset:14336
    s_waitcnt lgkmcnt(2)
    v_lshlrev_b32 v184, 16, v64
    v_and_b32 v185, s41, v64
    v_lshlrev_b32 v186, 16, v65
    v_and_b32 v187, s41, v65
    v_lshlrev_b32 v188, 16, v66
    v_and_b32 v189, s41, v66
    v_lshlrev_b32 v190, 16, v67
    v_and_b32 v191, s41, v67
    v_pk_add_f32 v[246:247], v[246:247], v[184:185]
    v_pk_fma_f32 v[248:249], v[184:185], v[184:185], v[248:249]
    v_pk_add_f32 v[246:247], v[246:247], v[186:187]
    v_pk_fma_f32 v[248:249], v[186:187], v[186:187], v[248:249]
    v_pk_add_f32 v[246:247], v[246:247], v[188:189]
    v_pk_fma_f32 v[248:249], v[188:189], v[188:189], v[248:249]
    v_pk_add_f32 v[246:247], v[246:247], v[190:191]
    v_pk_fma_f32 v[248:249], v[190:191], v[190:191], v[248:249]
    v_lshlrev_b32 v192, 16, v68
    v_and_b32 v193, s41, v68
    v_lshlrev_b32 v194, 16, v69
    v_and_b32 v195, s41, v69
    v_lshlrev_b32 v196, 16, v70
    v_and_b32 v197, s41, v70
    v_lshlrev_b32 v198, 16, v71
    v_and_b32 v199, s41, v71
    v_pk_add_f32 v[246:247], v[246:247], v[192:193]
    v_pk_fma_f32 v[248:249], v[192:193], v[192:193], v[248:249]
    v_pk_add_f32 v[246:247], v[246:247], v[194:195]
    v_pk_fma_f32 v[248:249], v[194:195], v[194:195], v[248:249]
    v_pk_add_f32 v[246:247], v[246:247], v[196:197]
    v_pk_fma_f32 v[248:249], v[196:197], v[196:197], v[248:249]
    v_pk_add_f32 v[246:247], v[246:247], v[198:199]
    v_pk_fma_f32 v[248:249], v[198:199], v[198:199], v[248:249]
    s_waitcnt vmcnt(11)
    ds_read_b128 v[80:83], v14 offset:16384
    ds_read_b128 v[84:87], v15 offset:16384
    s_waitcnt lgkmcnt(2)
    v_lshlrev_b32 v200, 16, v72
    v_and_b32 v201, s41, v72
    v_lshlrev_b32 v202, 16, v73
    v_and_b32 v203, s41, v73
    v_lshlrev_b32 v204, 16, v74
    v_and_b32 v205, s41, v74
    v_lshlrev_b32 v206, 16, v75
    v_and_b32 v207, s41, v75
    v_pk_add_f32 v[246:247], v[246:247], v[200:201]
    v_pk_fma_f32 v[248:249], v[200:201], v[200:201], v[248:249]
    v_pk_add_f32 v[246:247], v[246:247], v[202:203]
    v_pk_fma_f32 v[248:249], v[202:203], v[202:203], v[248:249]
    v_pk_add_f32 v[246:247], v[246:247], v[204:205]
    v_pk_fma_f32 v[248:249], v[204:205], v[204:205], v[248:249]
    v_pk_add_f32 v[246:247], v[246:247], v[206:207]
    v_pk_fma_f32 v[248:249], v[206:207], v[206:207], v[248:249]
    v_lshlrev_b32 v208, 16, v76
    v_and_b32 v209, s41, v76
    v_lshlrev_b32 v210, 16, v77
    v_and_b32 v211, s41, v77
    v_lshlrev_b32 v212, 16, v78
    v_and_b32 v213, s41, v78
    v_lshlrev_b32 v214, 16, v79
    v_and_b32 v215, s41, v79
    v_pk_add_f32 v[246:247], v[246:247], v[208:209]
    v_pk_fma_f32 v[248:249], v[208:209], v[208:209], v[248:249]
    v_pk_add_f32 v[246:247], v[246:247], v[210:211]
    v_pk_fma_f32 v[248:249], v[210:211], v[210:211], v[248:249]
    v_pk_add_f32 v[246:247], v[246:247], v[212:213]
    v_pk_fma_f32 v[248:249], v[212:213], v[212:213], v[248:249]
    v_pk_add_f32 v[246:247], v[246:247], v[214:215]
    v_pk_fma_f32 v[248:249], v[214:215], v[214:215], v[248:249]
    s_waitcnt lgkmcnt(0)
    v_lshlrev_b32 v216, 16, v80
    v_and_b32 v217, s41, v80
    v_lshlrev_b32 v218, 16, v81
    v_and_b32 v219, s41, v81
    v_lshlrev_b32 v220, 16, v82
    v_and_b32 v221, s41, v82
    v_lshlrev_b32 v222, 16, v83
    v_and_b32_e64 v223, s41, v83
    v_pk_add_f32 v[246:247], v[246:247], v[216:217]
    v_pk_fma_f32 v[248:249], v[216:217], v[216:217], v[248:249]
    v_pk_add_f32 v[246:247], v[246:247], v[218:219]
    v_pk_fma_f32 v[248:249], v[218:219], v[218:219], v[248:249]
    v_pk_add_f32 v[246:247], v[246:247], v[220:221]
    v_pk_fma_f32 v[248:249], v[220:221], v[220:221], v[248:249]
    v_pk_add_f32 v[246:247], v[246:247], v[222:223]
    v_pk_fma_f32 v[248:249], v[222:223], v[222:223], v[248:249]
    v_lshlrev_b32 v224, 16, v84
    v_and_b32 v225, s41, v84
    v_lshlrev_b32 v226, 16, v85
    v_and_b32 v227, s41, v85
    v_lshlrev_b32 v228, 16, v86
    v_and_b32 v229, s41, v86
    v_lshlrev_b32 v230, 16, v87
    v_and_b32 v231, s41, v87
    v_pk_add_f32 v[246:247], v[246:247], v[224:225]
    v_pk_fma_f32 v[248:249], v[224:225], v[224:225], v[248:249]
    v_pk_add_f32 v[246:247], v[246:247], v[226:227]
    v_pk_fma_f32 v[248:249], v[226:227], v[226:227], v[248:249]
    v_pk_add_f32 v[246:247], v[246:247], v[228:229]
    v_pk_fma_f32 v[248:249], v[228:229], v[228:229], v[248:249]
    v_pk_add_f32 v[246:247], v[246:247], v[230:231]
    v_pk_fma_f32 v[248:249], v[230:231], v[230:231], v[248:249]
    v_add_f32 v246, v246, v247
    v_add_f32 v248, v248, v249
    s_barrier
    s_lshl_b32 s25, s99, 2
    s_add_u32 s25, s25, s4
    s_mul_i32 s25, s25, 36864
    s_add_u32 m0, s24, 36864
    s_nop 0
    buffer_load_dwordx4 v4, s[12:15], s25 offen offset:0 lds
    buffer_load_dwordx4 v5, s[12:15], s25 offen offset:1024 lds
    buffer_load_dwordx4 v6, s[12:15], s25 offen offset:2048 lds
    v_mov_b32 v250, v246
    v_mov_b32 v251, v248
    s_nop 0
    v_permlane16_swap_b32 v250, v246
    v_permlane16_swap_b32 v251, v248
    v_add_f32 v246, v250, v246
    v_add_f32 v248, v251, v248
    v_mov_b32 v250, v246
    v_mov_b32 v251, v248
    s_nop 0
    v_permlane32_swap_b32 v250, v246
    v_permlane32_swap_b32 v251, v248
    v_add_f32 v246, v250, v246
    v_add_f32 v248, v251, v248
    v_mul_f32 v246, 0x3ae38e39, v246
    v_mul_f32 v248, 0x3ae38e39, v248
    v_fma_f32 v248, -v246, v246, v248
    v_max_f32 v248, 0, v248
    v_add_f32 v250, 0x3727c5ac, v248
    v_rsq_f32_e64 v232, v250
    s_nop 0
    v_mul_f32 v233, -v246, v232
    v_mul_f32 v250, v232, v232
    v_mul_f32 v250, v250, v248
    v_add_f32 v250, 0x3727c5ac, v250
    v_rsq_f32 v234, v250
    v_lshrrev_b32 v246, 1, v3
    v_lshlrev_b32 v246, 2, v246
    v_and_b32 v247, 1, v3
    v_add_u32_e64 v246, v246, v247
    v_bfe_u32 v247, v1, 2, 2
    v_lshl_add_u32 v246, v246, 2, v247
    v_mul_u32_u24 v246, 288, v246
    v_and_b32_e64 v247, 3, v1
    v_lshl_add_u32 v13, v247, 3, v246
    v_add_u32 v14, 55296, v13
    v_add_u32 v15, 110592, v13
    buffer_load_dwordx4 v7, s[12:15], s25 offen offset:3072 lds
    s_add_u32 m0, s24, 40960
    s_nop 0
    buffer_load_dwordx4 v8, s[12:15], s25 offen offset:0 lds
    buffer_load_dwordx4 v9, s[12:15], s25 offen offset:1024 lds
    v_pk_fma_f32 v[88:89], v[88:89], v[232:233], v[232:233] op_sel:[0,0,1] op_sel_hi:[1,0,1]
    v_pk_fma_f32 v[90:91], v[90:91], v[232:233], v[232:233] op_sel:[0,0,1] op_sel_hi:[1,0,1]
    v_pk_fma_f32 v[92:93], v[92:93], v[232:233], v[232:233] op_sel:[0,0,1] op_sel_hi:[1,0,1]
    v_pk_fma_f32 v[94:95], v[94:95], v[232:233], v[232:233] op_sel:[0,0,1] op_sel_hi:[1,0,1]
    v_cvt_pk_bf16_f32 v16, v88, v89
    v_cvt_pk_bf16_f32 v17, v90, v91
    v_cvt_pk_bf16_f32 v18, v92, v93
    v_cvt_pk_bf16_f32 v19, v94, v95
    v_pk_fma_f32 v[96:97], v[96:97], v[232:233], v[232:233] op_sel:[0,0,1] op_sel_hi:[1,0,1]
    v_pk_fma_f32 v[98:99], v[98:99], v[232:233], v[232:233] op_sel:[0,0,1] op_sel_hi:[1,0,1]
    v_pk_fma_f32 v[100:101], v[100:101], v[232:233], v[232:233] op_sel:[0,0,1] op_sel_hi:[1,0,1]
    v_pk_fma_f32 v[102:103], v[102:103], v[232:233], v[232:233] op_sel:[0,0,1] op_sel_hi:[1,0,1]
    v_cvt_pk_bf16_f32 v20, v96, v97
    v_cvt_pk_bf16_f32 v21, v98, v99
    v_cvt_pk_bf16_f32 v22, v100, v101
    v_cvt_pk_bf16_f32 v23, v102, v103
    v_pk_fma_f32 v[104:105], v[104:105], v[232:233], v[232:233] op_sel:[0,0,1] op_sel_hi:[1,0,1]
    v_pk_fma_f32 v[106:107], v[106:107], v[232:233], v[232:233] op_sel:[0,0,1] op_sel_hi:[1,0,1]
    v_pk_fma_f32 v[108:109], v[108:109], v[232:233], v[232:233] op_sel:[0,0,1] op_sel_hi:[1,0,1]
    v_pk_fma_f32 v[110:111], v[110:111], v[232:233], v[232:233] op_sel:[0,0,1] op_sel_hi:[1,0,1]
    v_cvt_pk_bf16_f32 v24, v104, v105
    v_cvt_pk_bf16_f32 v25, v106, v107
    v_cvt_pk_bf16_f32 v26, v108, v109
    v_cvt_pk_bf16_f32 v27, v110, v111
    v_pk_fma_f32 v[112:113], v[112:113], v[232:233], v[232:233] op_sel:[0,0,1] op_sel_hi:[1,0,1]
    v_pk_fma_f32 v[114:115], v[114:115], v[232:233], v[232:233] op_sel:[0,0,1] op_sel_hi:[1,0,1]
    v_pk_fma_f32 v[116:117], v[116:117], v[232:233], v[232:233] op_sel:[0,0,1] op_sel_hi:[1,0,1]
    v_pk_fma_f32 v[118:119], v[118:119], v[232:233], v[232:233] op_sel:[0,0,1] op_sel_hi:[1,0,1]
    v_cvt_pk_bf16_f32 v28, v112, v113
    v_cvt_pk_bf16_f32 v29, v114, v115
    v_cvt_pk_bf16_f32 v30, v116, v117
    v_cvt_pk_bf16_f32 v31, v118, v119
    v_pk_fma_f32 v[120:121], v[120:121], v[232:233], v[232:233] op_sel:[0,0,1] op_sel_hi:[1,0,1]
    v_pk_fma_f32 v[122:123], v[122:123], v[232:233], v[232:233] op_sel:[0,0,1] op_sel_hi:[1,0,1]
    v_pk_fma_f32 v[124:125], v[124:125], v[232:233], v[232:233] op_sel:[0,0,1] op_sel_hi:[1,0,1]
    v_pk_fma_f32 v[126:127], v[126:127], v[232:233], v[232:233] op_sel:[0,0,1] op_sel_hi:[1,0,1]
    v_cvt_pk_bf16_f32 v32, v120, v121
    v_cvt_pk_bf16_f32 v33, v122, v123
    v_cvt_pk_bf16_f32 v34, v124, v125
    v_cvt_pk_bf16_f32 v35, v126, v127
    buffer_load_dwordx4 v10, s[12:15], s25 offen offset:2048 lds
    buffer_load_dwordx4 v11, s[12:15], s25 offen offset:3072 lds
    s_add_u32 m0, s24, 45056
    s_nop 0
    buffer_load_dwordx4 v12, s[12:15], s25 offen offset:0 lds
    v_pk_fma_f32 v[128:129], v[128:129], v[232:233], v[232:233] op_sel:[0,0,1] op_sel_hi:[1,0,1]
    v_pk_fma_f32 v[130:131], v[130:131], v[232:233], v[232:233] op_sel:[0,0,1] op_sel_hi:[1,0,1]
    v_pk_fma_f32 v[132:133], v[132:133], v[232:233], v[232:233] op_sel:[0,0,1] op_sel_hi:[1,0,1]
    v_pk_fma_f32 v[134:135], v[134:135], v[232:233], v[232:233] op_sel:[0,0,1] op_sel_hi:[1,0,1]
    v_cvt_pk_bf16_f32 v36, v128, v129
    v_cvt_pk_bf16_f32 v37, v130, v131
    v_cvt_pk_bf16_f32 v38, v132, v133
    v_cvt_pk_bf16_f32 v39, v134, v135
    v_pk_fma_f32 v[136:137], v[136:137], v[232:233], v[232:233] op_sel:[0,0,1] op_sel_hi:[1,0,1]
    v_pk_fma_f32 v[138:139], v[138:139], v[232:233], v[232:233] op_sel:[0,0,1] op_sel_hi:[1,0,1]
    v_pk_fma_f32 v[140:141], v[140:141], v[232:233], v[232:233] op_sel:[0,0,1] op_sel_hi:[1,0,1]
    v_pk_fma_f32 v[142:143], v[142:143], v[232:233], v[232:233] op_sel:[0,0,1] op_sel_hi:[1,0,1]
    v_cvt_pk_bf16_f32 v40, v136, v137
    v_cvt_pk_bf16_f32 v41, v138, v139
    v_cvt_pk_bf16_f32 v42, v140, v141
    v_cvt_pk_bf16_f32 v43, v142, v143
    v_pk_fma_f32 v[144:145], v[144:145], v[232:233], v[232:233] op_sel:[0,0,1] op_sel_hi:[1,0,1]
    v_pk_fma_f32 v[146:147], v[146:147], v[232:233], v[232:233] op_sel:[0,0,1] op_sel_hi:[1,0,1]
    v_pk_fma_f32 v[148:149], v[148:149], v[232:233], v[232:233] op_sel:[0,0,1] op_sel_hi:[1,0,1]
    v_pk_fma_f32 v[150:151], v[150:151], v[232:233], v[232:233] op_sel:[0,0,1] op_sel_hi:[1,0,1]
    v_cvt_pk_bf16_f32 v44, v144, v145
    v_cvt_pk_bf16_f32 v45, v146, v147
    v_cvt_pk_bf16_f32 v46, v148, v149
    v_cvt_pk_bf16_f32 v47, v150, v151
    v_pk_fma_f32 v[152:153], v[152:153], v[232:233], v[232:233] op_sel:[0,0,1] op_sel_hi:[1,0,1]
    v_pk_fma_f32 v[154:155], v[154:155], v[232:233], v[232:233] op_sel:[0,0,1] op_sel_hi:[1,0,1]
    v_pk_fma_f32 v[156:157], v[156:157], v[232:233], v[232:233] op_sel:[0,0,1] op_sel_hi:[1,0,1]
    v_pk_fma_f32 v[158:159], v[158:159], v[232:233], v[232:233] op_sel:[0,0,1] op_sel_hi:[1,0,1]
    v_cvt_pk_bf16_f32 v48, v152, v153
    v_cvt_pk_bf16_f32 v49, v154, v155
    v_cvt_pk_bf16_f32 v50, v156, v157
    v_cvt_pk_bf16_f32 v51, v158, v159
    v_pk_fma_f32 v[160:161], v[160:161], v[232:233], v[232:233] op_sel:[0,0,1] op_sel_hi:[1,0,1]
    v_pk_fma_f32 v[162:163], v[162:163], v[232:233], v[232:233] op_sel:[0,0,1] op_sel_hi:[1,0,1]
    v_pk_fma_f32 v[164:165], v[164:165], v[232:233], v[232:233] op_sel:[0,0,1] op_sel_hi:[1,0,1]
    v_pk_fma_f32 v[166:167], v[166:167], v[232:233], v[232:233] op_sel:[0,0,1] op_sel_hi:[1,0,1]
    v_cvt_pk_bf16_f32 v52, v160, v161
    v_cvt_pk_bf16_f32 v53, v162, v163
    v_cvt_pk_bf16_f32 v54, v164, v165
    v_cvt_pk_bf16_f32 v55, v166, v167
    s_lshl_b32 s25, s100, 2
    s_add_u32 s25, s25, s4
    s_mul_i32 s25, s25, 36864
    s_add_u32 m0, s24, 73728
    s_nop 0
    buffer_load_dwordx4 v4, s[12:15], s25 offen offset:0 lds
    buffer_load_dwordx4 v5, s[12:15], s25 offen offset:1024 lds
    buffer_load_dwordx4 v6, s[12:15], s25 offen offset:2048 lds
    v_pk_fma_f32 v[168:169], v[168:169], v[232:233], v[232:233] op_sel:[0,0,1] op_sel_hi:[1,0,1]
    v_pk_fma_f32 v[170:171], v[170:171], v[232:233], v[232:233] op_sel:[0,0,1] op_sel_hi:[1,0,1]
    v_pk_fma_f32 v[172:173], v[172:173], v[232:233], v[232:233] op_sel:[0,0,1] op_sel_hi:[1,0,1]
    v_pk_fma_f32 v[174:175], v[174:175], v[232:233], v[232:233] op_sel:[0,0,1] op_sel_hi:[1,0,1]
    v_cvt_pk_bf16_f32 v56, v168, v169
    v_cvt_pk_bf16_f32 v57, v170, v171
    v_cvt_pk_bf16_f32 v58, v172, v173
    v_cvt_pk_bf16_f32 v59, v174, v175
    v_pk_fma_f32 v[176:177], v[176:177], v[232:233], v[232:233] op_sel:[0,0,1] op_sel_hi:[1,0,1]
    v_pk_fma_f32 v[178:179], v[178:179], v[232:233], v[232:233] op_sel:[0,0,1] op_sel_hi:[1,0,1]
    v_pk_fma_f32 v[180:181], v[180:181], v[232:233], v[232:233] op_sel:[0,0,1] op_sel_hi:[1,0,1]
    v_pk_fma_f32 v[182:183], v[182:183], v[232:233], v[232:233] op_sel:[0,0,1] op_sel_hi:[1,0,1]
    v_cvt_pk_bf16_f32 v60, v176, v177
    v_cvt_pk_bf16_f32 v61, v178, v179
    v_cvt_pk_bf16_f32 v62, v180, v181
    v_cvt_pk_bf16_f32 v63, v182, v183
    v_pk_fma_f32 v[184:185], v[184:185], v[232:233], v[232:233] op_sel:[0,0,1] op_sel_hi:[1,0,1]
    v_pk_fma_f32 v[186:187], v[186:187], v[232:233], v[232:233] op_sel:[0,0,1] op_sel_hi:[1,0,1]
    v_pk_fma_f32 v[188:189], v[188:189], v[232:233], v[232:233] op_sel:[0,0,1] op_sel_hi:[1,0,1]
    v_pk_fma_f32 v[190:191], v[190:191], v[232:233], v[232:233] op_sel:[0,0,1] op_sel_hi:[1,0,1]
    v_cvt_pk_bf16_f32 v64, v184, v185
    v_cvt_pk_bf16_f32 v65, v186, v187
    v_cvt_pk_bf16_f32 v66, v188, v189
    v_cvt_pk_bf16_f32 v67, v190, v191
    v_pk_fma_f32 v[192:193], v[192:193], v[232:233], v[232:233] op_sel:[0,0,1] op_sel_hi:[1,0,1]
    v_pk_fma_f32 v[194:195], v[194:195], v[232:233], v[232:233] op_sel:[0,0,1] op_sel_hi:[1,0,1]
    v_pk_fma_f32 v[196:197], v[196:197], v[232:233], v[232:233] op_sel:[0,0,1] op_sel_hi:[1,0,1]
    v_pk_fma_f32 v[198:199], v[198:199], v[232:233], v[232:233] op_sel:[0,0,1] op_sel_hi:[1,0,1]
    v_cvt_pk_bf16_f32 v68, v192, v193
    v_cvt_pk_bf16_f32 v69, v194, v195
    v_cvt_pk_bf16_f32 v70, v196, v197
    v_cvt_pk_bf16_f32 v71, v198, v199
    v_pk_fma_f32 v[200:201], v[200:201], v[232:233], v[232:233] op_sel:[0,0,1] op_sel_hi:[1,0,1]
    v_pk_fma_f32 v[202:203], v[202:203], v[232:233], v[232:233] op_sel:[0,0,1] op_sel_hi:[1,0,1]
    v_pk_fma_f32 v[204:205], v[204:205], v[232:233], v[232:233] op_sel:[0,0,1] op_sel_hi:[1,0,1]
    v_pk_fma_f32 v[206:207], v[206:207], v[232:233], v[232:233] op_sel:[0,0,1] op_sel_hi:[1,0,1]
    v_cvt_pk_bf16_f32 v72, v200, v201
    v_cvt_pk_bf16_f32 v73, v202, v203
    v_cvt_pk_bf16_f32 v74, v204, v205
    v_cvt_pk_bf16_f32 v75, v206, v207
    buffer_load_dwordx4 v7, s[12:15], s25 offen offset:3072 lds
    s_add_u32 m0, s24, 77824
    s_nop 0
    buffer_load_dwordx4 v8, s[12:15], s25 offen offset:0 lds
    buffer_load_dwordx4 v9, s[12:15], s25 offen offset:1024 lds
    v_pk_fma_f32 v[208:209], v[208:209], v[232:233], v[232:233] op_sel:[0,0,1] op_sel_hi:[1,0,1]
    v_pk_fma_f32 v[210:211], v[210:211], v[232:233], v[232:233] op_sel:[0,0,1] op_sel_hi:[1,0,1]
    v_pk_fma_f32 v[212:213], v[212:213], v[232:233], v[232:233] op_sel:[0,0,1] op_sel_hi:[1,0,1]
    v_pk_fma_f32 v[214:215], v[214:215], v[232:233], v[232:233] op_sel:[0,0,1] op_sel_hi:[1,0,1]
    v_cvt_pk_bf16_f32 v76, v208, v209
    v_cvt_pk_bf16_f32 v77, v210, v211
    v_cvt_pk_bf16_f32 v78, v212, v213
    v_cvt_pk_bf16_f32 v79, v214, v215
    v_pk_fma_f32 v[216:217], v[216:217], v[232:233], v[232:233] op_sel:[0,0,1] op_sel_hi:[1,0,1]
    v_pk_fma_f32 v[218:219], v[218:219], v[232:233], v[232:233] op_sel:[0,0,1] op_sel_hi:[1,0,1]
    v_pk_fma_f32 v[220:221], v[220:221], v[232:233], v[232:233] op_sel:[0,0,1] op_sel_hi:[1,0,1]
    v_pk_fma_f32 v[222:223], v[222:223], v[232:233], v[232:233] op_sel:[0,0,1] op_sel_hi:[1,0,1]
    v_cvt_pk_bf16_f32 v80, v216, v217
    v_cvt_pk_bf16_f32 v81, v218, v219
    v_cvt_pk_bf16_f32 v82, v220, v221
    v_cvt_pk_bf16_f32 v83, v222, v223
    v_pk_fma_f32 v[224:225], v[224:225], v[232:233], v[232:233] op_sel:[0,0,1] op_sel_hi:[1,0,1]
    v_pk_fma_f32 v[226:227], v[226:227], v[232:233], v[232:233] op_sel:[0,0,1] op_sel_hi:[1,0,1]
    v_pk_fma_f32 v[228:229], v[228:229], v[232:233], v[232:233] op_sel:[0,0,1] op_sel_hi:[1,0,1]
    v_pk_fma_f32 v[230:231], v[230:231], v[232:233], v[232:233] op_sel:[0,0,1] op_sel_hi:[1,0,1]
    v_cvt_pk_bf16_f32 v84, v224, v225
    v_cvt_pk_bf16_f32 v85, v226, v227
    v_cvt_pk_bf16_f32 v86, v228, v229
    v_cvt_pk_bf16_f32 v87, v230, v231
    s_waitcnt vmcnt(15)
    s_barrier
    ds_read_b64_tr_b16 a[64:65], v13 offset:0
    ds_read_b64_tr_b16 a[66:67], v13 offset:2304
    ds_read_b64_tr_b16 a[68:69], v13 offset:9216
    ds_read_b64_tr_b16 a[70:71], v13 offset:11520
    ds_read_b64_tr_b16 a[72:73], v13 offset:32
    ds_read_b64_tr_b16 a[74:75], v13 offset:2336
    ds_read_b64_tr_b16 a[76:77], v13 offset:9248
    ds_read_b64_tr_b16 a[78:79], v13 offset:11552
    ds_read_b64_tr_b16 a[80:81], v13 offset:64
    ds_read_b64_tr_b16 a[82:83], v13 offset:2368
    ds_read_b64_tr_b16 a[84:85], v13 offset:9280
    ds_read_b64_tr_b16 a[86:87], v13 offset:11584
    s_waitcnt lgkmcnt(10)
    v_mfma_f32_16x16x32_bf16 v[160:163], a[64:67], v[16:19], 0
    s_waitcnt lgkmcnt(8)
    ds_read_b64_tr_b16 a[88:89], v13 offset:96
    ds_read_b64_tr_b16 a[90:91], v13 offset:2400
    v_mfma_f32_16x16x32_bf16 v[160:163], a[68:71], v[20:23], v[160:163]
    s_waitcnt lgkmcnt(8)
    s_cmp_lg_u32 s4, 0
    s_cbranch_scc1 Lg34
    s_and_b32 s70, s37, 63
    s_lshl_b32 s70, s70, 2
    s_mov_b32 s71, 1
    s_atomic_add s71, s[66:67], s70
Lg34:
    ds_read_b64_tr_b16 a[92:93], v13 offset:9312
    ds_read_b64_tr_b16 a[94:95], v13 offset:11616
    v_mfma_f32_16x16x32_bf16 v[164:167], a[72:75], v[16:19], 0
    s_waitcnt lgkmcnt(8)
    ds_read_b64_tr_b16 a[64:65], v13 offset:128
    ds_read_b64_tr_b16 a[66:67], v13 offset:2432
    v_mfma_f32_16x16x32_bf16 v[164:167], a[76:79], v[20:23], v[164:167]
    s_waitcnt lgkmcnt(8)
    ds_read_b64_tr_b16 a[68:69], v13 offset:9344
    ds_read_b64_tr_b16 a[70:71], v13 offset:11648
    v_mfma_f32_16x16x32_bf16 v[168:171], a[80:83], v[16:19], 0
    s_waitcnt lgkmcnt(8)
    ds_read_b64_tr_b16 a[72:73], v13 offset:160
    ds_read_b64_tr_b16 a[74:75], v13 offset:2464
    v_mfma_f32_16x16x32_bf16 v[168:171], a[84:87], v[20:23], v[168:171]
    s_waitcnt lgkmcnt(8)
    ds_read_b64_tr_b16 a[76:77], v13 offset:9376
    ds_read_b64_tr_b16 a[78:79], v13 offset:11680
    buffer_load_dwordx4 v10, s[12:15], s25 offen offset:2048 lds
    v_mfma_f32_16x16x32_bf16 v[172:175], a[88:91], v[16:19], 0
    s_waitcnt lgkmcnt(8)
    ds_read_b64_tr_b16 a[80:81], v13 offset:192
    ds_read_b64_tr_b16 a[82:83], v13 offset:2496
    v_mfma_f32_16x16x32_bf16 v[172:175], a[92:95], v[20:23], v[172:175]
    s_waitcnt lgkmcnt(8)
    ds_read_b64_tr_b16 a[84:85], v13 offset:9408
    ds_read_b64_tr_b16 a[86:87], v13 offset:11712
    buffer_load_dwordx4 v11, s[12:15], s25 offen offset:3072 lds
    v_mfma_f32_16x16x32_bf16 v[176:179], a[64:67], v[16:19], 0
    s_waitcnt lgkmcnt(8)
    ds_read_b64_tr_b16 a[88:89], v13 offset:224
    ds_read_b64_tr_b16 a[90:91], v13 offset:2528
    v_mfma_f32_16x16x32_bf16 v[176:179], a[68:71], v[20:23], v[176:179]
    s_waitcnt lgkmcnt(8)
    s_add_u32 m0, s24, 81920
    ds_read_b64_tr_b16 a[92:93], v13 offset:9440
    ds_read_b64_tr_b16 a[94:95], v13 offset:11744
    v_mfma_f32_16x16x32_bf16 v[180:183], a[72:75], v[16:19], 0
    s_waitcnt lgkmcnt(8)
    ds_read_b64_tr_b16 a[64:65], v13 offset:256
    ds_read_b64_tr_b16 a[66:67], v13 offset:2560
    v_mfma_f32_16x16x32_bf16 v[180:183], a[76:79], v[20:23], v[180:183]
    s_waitcnt lgkmcnt(8)
    ds_read_b64_tr_b16 a[68:69], v13 offset:9472
    ds_read_b64_tr_b16 a[70:71], v13 offset:11776
    buffer_load_dwordx4 v12, s[12:15], s25 offen offset:0 lds
    v_mfma_f32_16x16x32_bf16 v[184:187], a[80:83], v[16:19], 0
    s_waitcnt lgkmcnt(8)
    ds_read_b64_tr_b16 a[72:73], v13 offset:18432
    ds_read_b64_tr_b16 a[74:75], v13 offset:20736
    v_mfma_f32_16x16x32_bf16 v[184:187], a[84:87], v[20:23], v[184:187]
    s_waitcnt lgkmcnt(8)
    s_lshl_b32 s25, s101, 2
    s_add_u32 s25, s25, s4
    s_mul_i32 s25, s25, 36864
    ds_read_b64_tr_b16 a[76:77], v13 offset:27648
    ds_read_b64_tr_b16 a[78:79], v13 offset:29952
    v_mfma_f32_16x16x32_bf16 v[188:191], a[88:91], v[16:19], 0
    s_waitcnt lgkmcnt(8)
    ds_read_b64_tr_b16 a[80:81], v13 offset:18464
    ds_read_b64_tr_b16 a[82:83], v13 offset:20768
    v_mfma_f32_16x16x32_bf16 v[188:191], a[92:95], v[20:23], v[188:191]
    s_waitcnt lgkmcnt(8)
    s_add_u32 m0, s24, 110592
    ds_read_b64_tr_b16 a[84:85], v13 offset:27680
    ds_read_b64_tr_b16 a[86:87], v13 offset:29984
    v_mfma_f32_16x16x32_bf16 v[192:195], a[64:67], v[16:19], 0
    s_waitcnt lgkmcnt(8)
    ds_read_b64_tr_b16 a[88:89], v13 offset:18496
    ds_read_b64_tr_b16 a[90:91], v13 offset:20800
    v_mfma_f32_16x16x32_bf16 v[192:195], a[68:71], v[20:23], v[192:195]
    s_waitcnt lgkmcnt(8)
    ds_read_b64_tr_b16 a[92:93], v13 offset:27712
    ds_read_b64_tr_b16 a[94:95], v13 offset:30016
    buffer_load_dwordx4 v4, s[12:15], s25 offen offset:0 lds
    v_mfma_f32_16x16x32_bf16 v[160:163], a[72:75], v[24:27], v[160:163]
    s_waitcnt lgkmcnt(8)
    ds_read_b64_tr_b16 a[64:65], v13 offset:18528
    ds_read_b64_tr_b16 a[66:67], v13 offset:20832
    v_mfma_f32_16x16x32_bf16 v[160:163], a[76:79], v[28:31], v[160:163]
    s_waitcnt lgkmcnt(8)
    ds_read_b64_tr_b16 a[68:69], v13 offset:27744
    ds_read_b64_tr_b16 a[70:71], v13 offset:30048
    buffer_load_dwordx4 v5, s[12:15], s25 offen offset:1024 lds
    v_mfma_f32_16x16x32_bf16 v[164:167], a[80:83], v[24:27], v[164:167]
    s_waitcnt lgkmcnt(8)
    ds_read_b64_tr_b16 a[72:73], v13 offset:18560
    ds_read_b64_tr_b16 a[74:75], v13 offset:20864
    v_mfma_f32_16x16x32_bf16 v[164:167], a[84:87], v[28:31], v[164:167]
    s_waitcnt lgkmcnt(8)
    ds_read_b64_tr_b16 a[76:77], v13 offset:27776
    ds_read_b64_tr_b16 a[78:79], v13 offset:30080
    buffer_load_dwordx4 v6, s[12:15], s25 offen offset:2048 lds
    v_mfma_f32_16x16x32_bf16 v[168:171], a[88:91], v[24:27], v[168:171]
    s_waitcnt lgkmcnt(8)
    ds_read_b64_tr_b16 a[80:81], v13 offset:18592
    ds_read_b64_tr_b16 a[82:83], v13 offset:20896
    v_mfma_f32_16x16x32_bf16 v[168:171], a[92:95], v[28:31], v[168:171]
    s_waitcnt lgkmcnt(8)
    ds_read_b64_tr_b16 a[84:85], v13 offset:27808
    ds_read_b64_tr_b16 a[86:87], v13 offset:30112
    v_mfma_f32_16x16x32_bf16 v[172:175], a[64:67], v[24:27], v[172:175]
    s_waitcnt lgkmcnt(8)
    ds_read_b64_tr_b16 a[88:89], v13 offset:18624
    ds_read_b64_tr_b16 a[90:91], v13 offset:20928
    v_mfma_f32_16x16x32_bf16 v[172:175], a[68:71], v[28:31], v[172:175]
    s_waitcnt lgkmcnt(8)
    ds_read_b64_tr_b16 a[92:93], v13 offset:27840
    ds_read_b64_tr_b16 a[94:95], v13 offset:30144
    buffer_load_dwordx4 v7, s[12:15], s25 offen offset:3072 lds
    v_mfma_f32_16x16x32_bf16 v[176:179], a[72:75], v[24:27], v[176:179]
    s_waitcnt lgkmcnt(8)
    ds_read_b64_tr_b16 a[64:65], v13 offset:18656
    ds_read_b64_tr_b16 a[66:67], v13 offset:20960
    v_mfma_f32_16x16x32_bf16 v[176:179], a[76:79], v[28:31], v[176:179]
    s_waitcnt lgkmcnt(8)
    s_add_u32 m0, s24, 114688
    ds_read_b64_tr_b16 a[68:69], v13 offset:27872
    ds_read_b64_tr_b16 a[70:71], v13 offset:30176
    v_mfma_f32_16x16x32_bf16 v[180:183], a[80:83], v[24:27], v[180:183]
    s_waitcnt lgkmcnt(8)
    ds_read_b64_tr_b16 a[72:73], v13 offset:18688
    ds_read_b64_tr_b16 a[74:75], v13 offset:20992
    v_mfma_f32_16x16x32_bf16 v[180:183], a[84:87], v[28:31], v[180:183]
    s_waitcnt lgkmcnt(8)
    ds_read_b64_tr_b16 a[76:77], v13 offset:27904
    ds_read_b64_tr_b16 a[78:79], v13 offset:30208
    buffer_load_dwordx4 v8, s[12:15], s25 offen offset:0 lds
    buffer_load_dwordx4 v9, s[12:15], s25 offen offset:1024 lds
    v_mfma_f32_16x16x32_bf16 v[184:187], a[88:91], v[24:27], v[184:187]
    s_waitcnt lgkmcnt(8)
    s_waitcnt vmcnt(15)
    s_barrier
    ds_read_b64_tr_b16 a[80:81], v13 offset:36864
    ds_read_b64_tr_b16 a[82:83], v13 offset:39168
    v_mfma_f32_16x16x32_bf16 v[184:187], a[92:95], v[28:31], v[184:187]
    s_waitcnt lgkmcnt(8)
    ds_read_b64_tr_b16 a[84:85], v13 offset:46080
    ds_read_b64_tr_b16 a[86:87], v13 offset:48384
    v_mfma_f32_16x16x32_bf16 v[188:191], a[64:67], v[24:27], v[188:191]
    s_waitcnt lgkmcnt(8)
    ds_read_b64_tr_b16 a[88:89], v13 offset:36896
    ds_read_b64_tr_b16 a[90:91], v13 offset:39200
    v_mfma_f32_16x16x32_bf16 v[188:191], a[68:71], v[28:31], v[188:191]
    s_waitcnt lgkmcnt(8)
    ds_read_b64_tr_b16 a[92:93], v13 offset:46112
    ds_read_b64_tr_b16 a[94:95], v13 offset:48416
    buffer_load_dwordx4 v10, s[12:15], s25 offen offset:2048 lds
    v_mfma_f32_16x16x32_bf16 v[192:195], a[72:75], v[24:27], v[192:195]
    s_waitcnt lgkmcnt(8)
    ds_read_b64_tr_b16 a[64:65], v13 offset:36928
    ds_read_b64_tr_b16 a[66:67], v13 offset:39232
    v_mfma_f32_16x16x32_bf16 v[192:195], a[76:79], v[28:31], v[192:195]
    s_waitcnt lgkmcnt(8)
    ds_read_b64_tr_b16 a[68:69], v13 offset:46144
    ds_read_b64_tr_b16 a[70:71], v13 offset:48448
    buffer_load_dwordx4 v11, s[12:15], s25 offen offset:3072 lds
    v_mfma_f32_16x16x32_bf16 v[160:163], a[80:83], v[32:35], v[160:163]
    s_waitcnt lgkmcnt(8)
    ds_read_b64_tr_b16 a[72:73], v13 offset:36960
    ds_read_b64_tr_b16 a[74:75], v13 offset:39264
    v_mfma_f32_16x16x32_bf16 v[160:163], a[84:87], v[36:39], v[160:163]
    s_waitcnt lgkmcnt(8)
    s_add_u32 m0, s24, 118784
    ds_read_b64_tr_b16 a[76:77], v13 offset:46176
    ds_read_b64_tr_b16 a[78:79], v13 offset:48480
    buffer_load_dwordx4 v12, s[12:15], s25 offen offset:0 lds
    v_mfma_f32_16x16x32_bf16 v[164:167], a[88:91], v[32:35], v[164:167]
    s_waitcnt lgkmcnt(8)
    s_barrier
    ds_read_b64_tr_b16 a[80:81], v13 offset:36992
    ds_read_b64_tr_b16 a[82:83], v13 offset:39296
    v_mfma_f32_16x16x32_bf16 v[164:167], a[92:95], v[36:39], v[164:167]
    s_waitcnt lgkmcnt(8)
    ds_read_b64_tr_b16 a[84:85], v13 offset:46208
    ds_read_b64_tr_b16 a[86:87], v13 offset:48512
    v_mfma_f32_16x16x32_bf16 v[168:171], a[64:67], v[32:35], v[168:171]
    s_waitcnt lgkmcnt(8)
    ds_read_b64_tr_b16 a[88:89], v13 offset:37024
    ds_read_b64_tr_b16 a[90:91], v13 offset:39328
    v_mfma_f32_16x16x32_bf16 v[168:171], a[68:71], v[36:39], v[168:171]
    s_waitcnt lgkmcnt(8)
    ds_read_b64_tr_b16 a[92:93], v13 offset:46240
    ds_read_b64_tr_b16 a[94:95], v13 offset:48544
    v_mfma_f32_16x16x32_bf16 v[172:175], a[72:75], v[32:35], v[172:175]
    s_waitcnt lgkmcnt(8)
    ds_read_b64_tr_b16 a[64:65], v13 offset:37056
    ds_read_b64_tr_b16 a[66:67], v13 offset:39360
    v_mfma_f32_16x16x32_bf16 v[172:175], a[76:79], v[36:39], v[172:175]
    s_waitcnt lgkmcnt(8)
    ds_read_b64_tr_b16 a[68:69], v13 offset:46272
    ds_read_b64_tr_b16 a[70:71], v13 offset:48576
    v_mfma_f32_16x16x32_bf16 v[176:179], a[80:83], v[32:35], v[176:179]
    s_waitcnt lgkmcnt(8)
    ds_read_b64_tr_b16 a[72:73], v13 offset:37088
    ds_read_b64_tr_b16 a[74:75], v13 offset:39392
    v_mfma_f32_16x16x32_bf16 v[176:179], a[84:87], v[36:39], v[176:179]
    s_waitcnt lgkmcnt(8)
    ds_read_b64_tr_b16 a[76:77], v13 offset:46304
    ds_read_b64_tr_b16 a[78:79], v13 offset:48608
    v_mfma_f32_16x16x32_bf16 v[180:183], a[88:91], v[32:35], v[180:183]
    s_waitcnt lgkmcnt(8)
    ds_read_b64_tr_b16 a[80:81], v13 offset:37120
    ds_read_b64_tr_b16 a[82:83], v13 offset:39424
    v_mfma_f32_16x16x32_bf16 v[180:183], a[92:95], v[36:39], v[180:183]
    s_waitcnt lgkmcnt(8)
    ds_read_b64_tr_b16 a[84:85], v13 offset:46336
    ds_read_b64_tr_b16 a[86:87], v13 offset:48640
    v_mfma_f32_16x16x32_bf16 v[184:187], a[64:67], v[32:35], v[184:187]
    s_waitcnt lgkmcnt(8)
    ds_read_b64_tr_b16 a[88:89], v14 offset:0
    ds_read_b64_tr_b16 a[90:91], v14 offset:2304
    v_mfma_f32_16x16x32_bf16 v[184:187], a[68:71], v[36:39], v[184:187]
    s_waitcnt lgkmcnt(8)
    s_cmp_ge_u32 s4, 2
    s_cselect_b32 s12, s58, s56
    s_cselect_b32 s13, s59, s57
    s_and_b32 s13, s13, 0xffff
    s_and_b32 s25, s4, 1
    s_add_u32 s25, s25, 16
    s_mul_i32 s25, s25, 36864
    ds_read_b64_tr_b16 a[92:93], v14 offset:9216
    ds_read_b64_tr_b16 a[94:95], v14 offset:11520
    v_mfma_f32_16x16x32_bf16 v[188:191], a[72:75], v[32:35], v[188:191]
    s_waitcnt lgkmcnt(8)
    ds_read_b64_tr_b16 a[64:65], v14 offset:32
    ds_read_b64_tr_b16 a[66:67], v14 offset:2336
    v_mfma_f32_16x16x32_bf16 v[188:191], a[76:79], v[36:39], v[188:191]
    s_waitcnt lgkmcnt(8)
    s_add_u32 m0, s24, 0
    ds_read_b64_tr_b16 a[68:69], v14 offset:9248
    ds_read_b64_tr_b16 a[70:71], v14 offset:11552
    v_mfma_f32_16x16x32_bf16 v[192:195], a[80:83], v[32:35], v[192:195]
    s_waitcnt lgkmcnt(8)
    ds_read_b64_tr_b16 a[72:73], v14 offset:64
    ds_read_b64_tr_b16 a[74:75], v14 offset:2368
    v_mfma_f32_16x16x32_bf16 v[192:195], a[84:87], v[36:39], v[192:195]
    s_waitcnt lgkmcnt(8)
    ds_read_b64_tr_b16 a[76:77], v14 offset:9280
    ds_read_b64_tr_b16 a[78:79], v14 offset:11584
    buffer_load_dwordx4 v4, s[12:15], s25 offen offset:0 lds
    buffer_load_dwordx4 v5, s[12:15], s25 offen offset:1024 lds
    v_mfma_f32_16x16x32_bf16 v[160:163], a[88:91], v[40:43], v[160:163]
Lpad29908_1:
    s_cbranch_execz Lpadret
    s_waitcnt lgkmcnt(8)
    ds_read_b64_tr_b16 a[80:81], v14 offset:96
    ds_read_b64_tr_b16 a[82:83], v14 offset:2400
    v_mfma_f32_16x16x32_bf16 v[160:163], a[92:95], v[44:47], v[160:163]
    s_waitcnt lgkmcnt(8)
    ds_read_b64_tr_b16 a[84:85], v14 offset:9312
    ds_read_b64_tr_b16 a[86:87], v14 offset:11616
    buffer_load_dwordx4 v6, s[12:15], s25 offen offset:2048 lds
    v_mfma_f32_16x16x32_bf16 v[164:167], a[64:67], v[40:43], v[164:167]
    s_waitcnt lgkmcnt(8)
    ds_read_b64_tr_b16 a[88:89], v14 offset:128
    ds_read_b64_tr_b16 a[90:91], v14 offset:2432
    v_mfma_f32_16x16x32_bf16 v[164:167], a[68:71], v[44:47], v[164:167]
    s_waitcnt lgkmcnt(8)
    ds_read_b64_tr_b16 a[92:93], v14 offset:9344
    ds_read_b64_tr_b16 a[94:95], v14 offset:11648
    buffer_load_dwordx4 v7, s[12:15], s25 offen offset:3072 lds
    v_mfma_f32_16x16x32_bf16 v[168:171], a[72:75], v[40:43], v[168:171]
    s_waitcnt lgkmcnt(8)
    ds_read_b64_tr_b16 a[64:65], v14 offset:160
    ds_read_b64_tr_b16 a[66:67], v14 offset:2464
    v_mfma_f32_16x16x32_bf16 v[168:171], a[76:79], v[44:47], v[168:171]
    s_waitcnt lgkmcnt(8)
    s_add_u32 m0, s24, 4096
    ds_read_b64_tr_b16 a[68:69], v14 offset:9376
    ds_read_b64_tr_b16 a[70:71], v14 offset:11680
    v_mfma_f32_16x16x32_bf16 v[172:175], a[80:83], v[40:43], v[172:175]
    s_waitcnt lgkmcnt(8)
    ds_read_b64_tr_b16 a[72:73], v14 offset:192
    ds_read_b64_tr_b16 a[74:75], v14 offset:2496
    v_mfma_f32_16x16x32_bf16 v[172:175], a[84:87], v[44:47], v[172:175]
    s_waitcnt lgkmcnt(8)
    ds_read_b64_tr_b16 a[76:77], v14 offset:9408
    ds_read_b64_tr_b16 a[78:79], v14 offset:11712
    buffer_load_dwordx4 v8, s[12:15], s25 offen offset:0 lds
    buffer_load_dwordx4 v9, s[12:15], s25 offen offset:1024 lds
    v_mfma_f32_16x16x32_bf16 v[176:179], a[88:91], v[40:43], v[176:179]
    s_waitcnt lgkmcnt(8)
    ds_read_b64_tr_b16 a[80:81], v14 offset:224
    ds_read_b64_tr_b16 a[82:83], v14 offset:2528
    v_mfma_f32_16x16x32_bf16 v[176:179], a[92:95], v[44:47], v[176:179]
    s_waitcnt lgkmcnt(8)
    ds_read_b64_tr_b16 a[84:85], v14 offset:9440
    ds_read_b64_tr_b16 a[86:87], v14 offset:11744
    buffer_load_dwordx4 v10, s[12:15], s25 offen offset:2048 lds
    v_mfma_f32_16x16x32_bf16 v[180:183], a[64:67], v[40:43], v[180:183]
    s_waitcnt lgkmcnt(8)
    ds_read_b64_tr_b16 a[88:89], v14 offset:256
    ds_read_b64_tr_b16 a[90:91], v14 offset:2560
    v_mfma_f32_16x16x32_bf16 v[180:183], a[68:71], v[44:47], v[180:183]
    s_waitcnt lgkmcnt(8)
    ds_read_b64_tr_b16 a[92:93], v14 offset:9472
    ds_read_b64_tr_b16 a[94:95], v14 offset:11776
    buffer_load_dwordx4 v11, s[12:15], s25 offen offset:3072 lds
    v_mfma_f32_16x16x32_bf16 v[184:187], a[72:75], v[40:43], v[184:187]
    s_waitcnt lgkmcnt(8)
    s_waitcnt vmcnt(17)
    s_barrier
    ds_read_b64_tr_b16 a[64:65], v14 offset:18432
    ds_read_b64_tr_b16 a[66:67], v14 offset:20736
    v_mfma_f32_16x16x32_bf16 v[184:187], a[76:79], v[44:47], v[184:187]
    s_waitcnt lgkmcnt(8)
    s_add_u32 m0, s24, 8192
    ds_read_b64_tr_b16 a[68:69], v14 offset:27648
    ds_read_b64_tr_b16 a[70:71], v14 offset:29952
    buffer_load_dwordx4 v12, s[12:15], s25 offen offset:0 lds
    v_mfma_f32_16x16x32_bf16 v[188:191], a[80:83], v[40:43], v[188:191]
    s_waitcnt lgkmcnt(8)
    ds_read_b64_tr_b16 a[72:73], v14 offset:18464
    ds_read_b64_tr_b16 a[74:75], v14 offset:20768
    v_mfma_f32_16x16x32_bf16 v[188:191], a[84:87], v[44:47], v[188:191]
    s_waitcnt lgkmcnt(8)
    ds_read_b64_tr_b16 a[76:77], v14 offset:27680
    ds_read_b64_tr_b16 a[78:79], v14 offset:29984
    v_mfma_f32_16x16x32_bf16 v[192:195], a[88:91], v[40:43], v[192:195]
    s_waitcnt lgkmcnt(8)
    ds_read_b64_tr_b16 a[80:81], v14 offset:18496
    ds_read_b64_tr_b16 a[82:83], v14 offset:20800
    v_mfma_f32_16x16x32_bf16 v[192:195], a[92:95], v[44:47], v[192:195]
    s_waitcnt lgkmcnt(8)
    ds_read_b64_tr_b16 a[84:85], v14 offset:27712
    ds_read_b64_tr_b16 a[86:87], v14 offset:30016
    v_mfma_f32_16x16x32_bf16 v[160:163], a[64:67], v[48:51], v[160:163]
    s_waitcnt lgkmcnt(8)
    ds_read_b64_tr_b16 a[88:89], v14 offset:18528
    ds_read_b64_tr_b16 a[90:91], v14 offset:20832
    v_mfma_f32_16x16x32_bf16 v[160:163], a[68:71], v[52:55], v[160:163]
    s_waitcnt lgkmcnt(8)
    ds_read_b64_tr_b16 a[92:93], v14 offset:27744
    ds_read_b64_tr_b16 a[94:95], v14 offset:30048
    v_mfma_f32_16x16x32_bf16 v[164:167], a[72:75], v[48:51], v[164:167]
    s_waitcnt lgkmcnt(8)
    ds_read_b64_tr_b16 a[64:65], v14 offset:18560
    ds_read_b64_tr_b16 a[66:67], v14 offset:20864
    v_mfma_f32_16x16x32_bf16 v[164:167], a[76:79], v[52:55], v[164:167]
    s_waitcnt lgkmcnt(8)
    s_lshl_b32 s27, s7, 4
    s_lshr_b32 s28, s43, 1
    s_add_u32 s28, s28, 1
    s_sub_u32 s31, 0, s28
    s_bitcmp1_b32 s43, 0
    s_cselect_b32 s28, s31, s28
    s_add_u32 s27, s27, s28
    ds_read_b64_tr_b16 a[68:69], v14 offset:27776
    ds_read_b64_tr_b16 a[70:71], v14 offset:30080
    v_mfma_f32_16x16x32_bf16 v[168:171], a[80:83], v[48:51], v[168:171]
    s_waitcnt lgkmcnt(8)
    ds_read_b64_tr_b16 a[72:73], v14 offset:18592
    ds_read_b64_tr_b16 a[74:75], v14 offset:20896
    v_mfma_f32_16x16x32_bf16 v[168:171], a[84:87], v[52:55], v[168:171]
    s_waitcnt lgkmcnt(8)
    ds_read_b64_tr_b16 a[76:77], v14 offset:27808
    ds_read_b64_tr_b16 a[78:79], v14 offset:30112
    v_add_u32 v249, s27, v2
    v_mfma_f32_16x16x32_bf16 v[172:175], a[88:91], v[48:51], v[172:175]
    s_waitcnt lgkmcnt(8)
    ds_read_b64_tr_b16 a[80:81], v14 offset:18624
    ds_read_b64_tr_b16 a[82:83], v14 offset:20928
    v_mfma_f32_16x16x32_bf16 v[172:175], a[92:95], v[52:55], v[172:175]
    s_waitcnt lgkmcnt(8)
    ds_read_b64_tr_b16 a[84:85], v14 offset:27840
    ds_read_b64_tr_b16 a[86:87], v14 offset:30144
    v_bfe_u32 v247, v249, 6, 5
    v_mul_u32_u24 v247, 73728, v247
    v_mfma_f32_16x16x32_bf16 v[176:179], a[64:67], v[48:51], v[176:179]
    s_waitcnt lgkmcnt(8)
    ds_read_b64_tr_b16 a[88:89], v14 offset:18656
    ds_read_b64_tr_b16 a[90:91], v14 offset:20960
    v_mfma_f32_16x16x32_bf16 v[176:179], a[68:71], v[52:55], v[176:179]
    s_waitcnt lgkmcnt(8)
    ds_read_b64_tr_b16 a[92:93], v14 offset:27872
    ds_read_b64_tr_b16 a[94:95], v14 offset:30176
    v_and_b32 v246, 63, v249
    v_lshl_add_u32 v236, v246, 4, v247
    v_mfma_f32_16x16x32_bf16 v[180:183], a[72:75], v[48:51], v[180:183]
    s_waitcnt lgkmcnt(8)
    ds_read_b64_tr_b16 a[64:65], v14 offset:18688
    ds_read_b64_tr_b16 a[66:67], v14 offset:20992
    v_mfma_f32_16x16x32_bf16 v[180:183], a[76:79], v[52:55], v[180:183]
    s_waitcnt lgkmcnt(8)
    ds_read_b64_tr_b16 a[68:69], v14 offset:27904
    ds_read_b64_tr_b16 a[70:71], v14 offset:30208
    v_and_b32 v246, 1, v3
    v_lshrrev_b32 v247, 1, v3
    v_mfma_f32_16x16x32_bf16 v[184:187], a[80:83], v[48:51], v[184:187]
    s_waitcnt lgkmcnt(8)
    ds_read_b64_tr_b16 a[72:73], v14 offset:36864
    ds_read_b64_tr_b16 a[74:75], v14 offset:39168
    v_mfma_f32_16x16x32_bf16 v[184:187], a[84:87], v[52:55], v[184:187]
    s_waitcnt lgkmcnt(8)
    ds_read_b64_tr_b16 a[76:77], v14 offset:46080
    ds_read_b64_tr_b16 a[78:79], v14 offset:48384
    v_lshl_add_u32 v247, v246, 1, v247
    v_lshl_add_u32 v236, v247, 10, v236
    v_mfma_f32_16x16x32_bf16 v[188:191], a[88:91], v[48:51], v[188:191]
    s_waitcnt lgkmcnt(8)
    ds_read_b64_tr_b16 a[80:81], v14 offset:36896
    ds_read_b64_tr_b16 a[82:83], v14 offset:39200
    v_mfma_f32_16x16x32_bf16 v[188:191], a[92:95], v[52:55], v[188:191]
    s_waitcnt lgkmcnt(8)
    ds_read_b64_tr_b16 a[84:85], v14 offset:46112
    ds_read_b64_tr_b16 a[86:87], v14 offset:48416
    v_lshl_add_u32 v240, v3, 10, v238
    v_mfma_f32_16x16x32_bf16 v[192:195], a[64:67], v[48:51], v[192:195]
    s_waitcnt lgkmcnt(8)
    ds_read_b64_tr_b16 a[88:89], v14 offset:36928
    ds_read_b64_tr_b16 a[90:91], v14 offset:39232
    v_mfma_f32_16x16x32_bf16 v[192:195], a[68:71], v[52:55], v[192:195]
    s_waitcnt lgkmcnt(8)
    ds_read_b64_tr_b16 a[92:93], v14 offset:46144
    ds_read_b64_tr_b16 a[94:95], v14 offset:48448
    v_lshl_add_u32 v238, v247, 10, v238
    v_lshl_add_u32 v237, v246, 30, v236
    v_mfma_f32_16x16x32_bf16 v[160:163], a[72:75], v[56:59], v[160:163]
    s_waitcnt lgkmcnt(8)
    ds_read_b64_tr_b16 a[64:65], v14 offset:36960
    ds_read_b64_tr_b16 a[66:67], v14 offset:39264
    v_mfma_f32_16x16x32_bf16 v[160:163], a[76:79], v[60:63], v[160:163]
    s_waitcnt lgkmcnt(8)
    ds_read_b64_tr_b16 a[68:69], v14 offset:46176
    ds_read_b64_tr_b16 a[70:71], v14 offset:48480
    v_lshl_add_u32 v239, v246, 30, v238
    v_cmp_gt_u32 vcc, 0x800, v249
    v_mfma_f32_16x16x32_bf16 v[164:167], a[80:83], v[56:59], v[164:167]
    s_waitcnt lgkmcnt(8)
    ds_read_b64_tr_b16 a[72:73], v14 offset:36992
    ds_read_b64_tr_b16 a[74:75], v14 offset:39296
    v_mfma_f32_16x16x32_bf16 v[164:167], a[84:87], v[60:63], v[164:167]
    s_waitcnt lgkmcnt(8)
    ds_read_b64_tr_b16 a[76:77], v14 offset:46208
    ds_read_b64_tr_b16 a[78:79], v14 offset:48512
    v_mul_f32 v234, s34, v234
    v_cndmask_b32 v234, 0, v234, vcc
    v_mfma_f32_16x16x32_bf16 v[168:171], a[88:91], v[56:59], v[168:171]
    s_waitcnt lgkmcnt(8)
    ds_read_b64_tr_b16 a[80:81], v14 offset:37024
    ds_read_b64_tr_b16 a[82:83], v14 offset:39328
    v_mfma_f32_16x16x32_bf16 v[168:171], a[92:95], v[60:63], v[168:171]
    s_waitcnt lgkmcnt(8)
    s_mul_i32 s27, s43, 18432
    s_and_b32 s28, s43, 1
    s_lshl_b32 s28, s28, 7
    ds_read_b64_tr_b16 a[84:85], v14 offset:46240
    ds_read_b64_tr_b16 a[86:87], v14 offset:48544
    v_mfma_f32_16x16x32_bf16 v[172:175], a[64:67], v[56:59], v[172:175]
    s_waitcnt lgkmcnt(8)
    ds_read_b64_tr_b16 a[88:89], v14 offset:37056
    ds_read_b64_tr_b16 a[90:91], v14 offset:39360
    v_mfma_f32_16x16x32_bf16 v[172:175], a[68:71], v[60:63], v[172:175]
    s_waitcnt lgkmcnt(8)
    s_add_u32 s27, s27, s28
    s_lshl_b32 s28, s4, 8
    s_add_u32 s27, s27, s28
    s_add_u32 s27, s27, s44
    ds_read_b64_tr_b16 a[92:93], v14 offset:46272
    ds_read_b64_tr_b16 a[94:95], v14 offset:48576
    v_mfma_f32_16x16x32_bf16 v[176:179], a[72:75], v[56:59], v[176:179]
    s_waitcnt lgkmcnt(8)
    ds_read_b64_tr_b16 a[64:65], v14 offset:37088
    ds_read_b64_tr_b16 a[66:67], v14 offset:39392
    v_mfma_f32_16x16x32_bf16 v[176:179], a[76:79], v[60:63], v[176:179]
    s_waitcnt lgkmcnt(8)
    s_add_u32 s27, s27, 262144
    ds_read_b64_tr_b16 a[68:69], v14 offset:46304
    ds_read_b64_tr_b16 a[70:71], v14 offset:48608
    v_min_u32 v246, 17, v1
    v_mfma_f32_16x16x32_bf16 v[180:183], a[80:83], v[56:59], v[180:183]
    s_waitcnt lgkmcnt(8)
    ds_read_b64_tr_b16 a[72:73], v14 offset:37120
    ds_read_b64_tr_b16 a[74:75], v14 offset:39424
    v_mfma_f32_16x16x32_bf16 v[180:183], a[84:87], v[60:63], v[180:183]
    s_waitcnt lgkmcnt(8)
    ds_read_b64_tr_b16 a[76:77], v14 offset:46336
    ds_read_b64_tr_b16 a[78:79], v14 offset:48640
    v_lshlrev_b32 v246, 10, v246
    v_mfma_f32_16x16x32_bf16 v[184:187], a[88:91], v[56:59], v[184:187]
    s_waitcnt lgkmcnt(8)
    s_waitcnt vmcnt(9)
    s_barrier
    ds_read_b64_tr_b16 a[80:81], v15 offset:0
    ds_read_b64_tr_b16 a[82:83], v15 offset:2304
    v_mfma_f32_16x16x32_bf16 v[184:187], a[92:95], v[60:63], v[184:187]
    s_waitcnt lgkmcnt(8)
    ds_read_b64_tr_b16 a[84:85], v15 offset:9216
    ds_read_b64_tr_b16 a[86:87], v15 offset:11520
    buffer_load_dword a255, v246, s[16:19], s27 offen sc1
    v_lshlrev_b32 v242, 2, v1
    global_load_dword v241, v242, s[66:67] sc1
    v_mfma_f32_16x16x32_bf16 v[188:191], a[64:67], v[56:59], v[188:191]
    s_waitcnt lgkmcnt(8)
    ds_read_b64_tr_b16 a[88:89], v15 offset:32
    ds_read_b64_tr_b16 a[90:91], v15 offset:2336
    v_mfma_f32_16x16x32_bf16 v[188:191], a[68:71], v[60:63], v[188:191]
    s_waitcnt lgkmcnt(8)
    ds_read_b64_tr_b16 a[92:93], v15 offset:9248
    ds_read_b64_tr_b16 a[94:95], v15 offset:11552
    v_mfma_f32_16x16x32_bf16 v[192:195], a[72:75], v[56:59], v[192:195]
    s_waitcnt lgkmcnt(8)
    ds_read_b64_tr_b16 a[64:65], v15 offset:64
    ds_read_b64_tr_b16 a[66:67], v15 offset:2368
    v_mfma_f32_16x16x32_bf16 v[192:195], a[76:79], v[60:63], v[192:195]
    s_waitcnt lgkmcnt(8)
    s_mov_b32 s12, s58
    ds_read_b64_tr_b16 a[68:69], v15 offset:9280
    ds_read_b64_tr_b16 a[70:71], v15 offset:11584
    v_mfma_f32_16x16x32_bf16 v[160:163], a[80:83], v[64:67], v[160:163]
    s_waitcnt lgkmcnt(8)
    ds_read_b64_tr_b16 a[72:73], v15 offset:96
    ds_read_b64_tr_b16 a[74:75], v15 offset:2400
    v_mfma_f32_16x16x32_bf16 v[160:163], a[84:87], v[68:71], v[160:163]
    s_waitcnt lgkmcnt(8)
    s_and_b32 s13, s59, 0xffff
    ds_read_b64_tr_b16 a[76:77], v15 offset:9312
    ds_read_b64_tr_b16 a[78:79], v15 offset:11616
    v_mfma_f32_16x16x32_bf16 v[164:167], a[88:91], v[64:67], v[164:167]
    s_waitcnt lgkmcnt(8)
    ds_read_b64_tr_b16 a[80:81], v15 offset:128
    ds_read_b64_tr_b16 a[82:83], v15 offset:2432
    v_mfma_f32_16x16x32_bf16 v[164:167], a[92:95], v[68:71], v[164:167]
    s_waitcnt lgkmcnt(8)
    s_lshl_b32 s25, s98, 2
    ds_read_b64_tr_b16 a[84:85], v15 offset:9344
    ds_read_b64_tr_b16 a[86:87], v15 offset:11648
    v_mfma_f32_16x16x32_bf16 v[168:171], a[64:67], v[64:67], v[168:171]
    s_waitcnt lgkmcnt(8)
    ds_read_b64_tr_b16 a[88:89], v15 offset:160
    ds_read_b64_tr_b16 a[90:91], v15 offset:2464
    v_mfma_f32_16x16x32_bf16 v[168:171], a[68:71], v[68:71], v[168:171]
    s_waitcnt lgkmcnt(8)
    s_add_u32 s25, s25, s4
    ds_read_b64_tr_b16 a[92:93], v15 offset:9376
    ds_read_b64_tr_b16 a[94:95], v15 offset:11680
    v_mfma_f32_16x16x32_bf16 v[172:175], a[72:75], v[64:67], v[172:175]
    s_waitcnt lgkmcnt(8)
    ds_read_b64_tr_b16 a[64:65], v15 offset:192
    ds_read_b64_tr_b16 a[66:67], v15 offset:2496
    v_mfma_f32_16x16x32_bf16 v[172:175], a[76:79], v[68:71], v[172:175]
    s_waitcnt lgkmcnt(8)
    s_mul_i32 s25, s25, 36864
    ds_read_b64_tr_b16 a[68:69], v15 offset:9408
    ds_read_b64_tr_b16 a[70:71], v15 offset:11712
    v_mfma_f32_16x16x32_bf16 v[176:179], a[80:83], v[64:67], v[176:179]
    s_waitcnt lgkmcnt(8)
    ds_read_b64_tr_b16 a[72:73], v15 offset:224
    ds_read_b64_tr_b16 a[74:75], v15 offset:2528
    v_mfma_f32_16x16x32_bf16 v[176:179], a[84:87], v[68:71], v[176:179]
    s_waitcnt lgkmcnt(8)
    s_add_u32 m0, s24, 36864
    ds_read_b64_tr_b16 a[76:77], v15 offset:9440
    ds_read_b64_tr_b16 a[78:79], v15 offset:11744
    v_mfma_f32_16x16x32_bf16 v[180:183], a[88:91], v[64:67], v[180:183]
    s_waitcnt lgkmcnt(8)
    ds_read_b64_tr_b16 a[80:81], v15 offset:256
    ds_read_b64_tr_b16 a[82:83], v15 offset:2560
    v_mfma_f32_16x16x32_bf16 v[180:183], a[92:95], v[68:71], v[180:183]
    s_waitcnt lgkmcnt(8)
    ds_read_b64_tr_b16 a[84:85], v15 offset:9472
    ds_read_b64_tr_b16 a[86:87], v15 offset:11776
    v_mfma_f32_16x16x32_bf16 v[184:187], a[64:67], v[64:67], v[184:187]
    s_waitcnt lgkmcnt(8)
    ds_read_b64_tr_b16 a[88:89], v15 offset:18432
    ds_read_b64_tr_b16 a[90:91], v15 offset:20736
    v_mfma_f32_16x16x32_bf16 v[184:187], a[68:71], v[68:71], v[184:187]
    s_waitcnt lgkmcnt(8)
    ds_read_b64_tr_b16 a[92:93], v15 offset:27648
    ds_read_b64_tr_b16 a[94:95], v15 offset:29952
    buffer_load_dwordx4 v4, s[12:15], s25 offen offset:0 lds
    v_mfma_f32_16x16x32_bf16 v[188:191], a[72:75], v[64:67], v[188:191]
    s_waitcnt lgkmcnt(8)
    ds_read_b64_tr_b16 a[64:65], v15 offset:18464
    ds_read_b64_tr_b16 a[66:67], v15 offset:20768
    v_mfma_f32_16x16x32_bf16 v[188:191], a[76:79], v[68:71], v[188:191]
    s_waitcnt lgkmcnt(8)
    ds_read_b64_tr_b16 a[68:69], v15 offset:27680
    ds_read_b64_tr_b16 a[70:71], v15 offset:29984
    v_mfma_f32_16x16x32_bf16 v[192:195], a[80:83], v[64:67], v[192:195]
    s_waitcnt lgkmcnt(8)
    ds_read_b64_tr_b16 a[72:73], v15 offset:18496
    ds_read_b64_tr_b16 a[74:75], v15 offset:20800
    v_mfma_f32_16x16x32_bf16 v[192:195], a[84:87], v[68:71], v[192:195]
    s_waitcnt lgkmcnt(8)
    ds_read_b64_tr_b16 a[76:77], v15 offset:27712
    ds_read_b64_tr_b16 a[78:79], v15 offset:30016
    buffer_load_dwordx4 v5, s[12:15], s25 offen offset:1024 lds
    v_mfma_f32_16x16x32_bf16 v[160:163], a[88:91], v[72:75], v[160:163]
    s_waitcnt lgkmcnt(8)
    ds_read_b64_tr_b16 a[80:81], v15 offset:18528
    ds_read_b64_tr_b16 a[82:83], v15 offset:20832
    v_mfma_f32_16x16x32_bf16 v[160:163], a[92:95], v[76:79], v[160:163]
    s_waitcnt lgkmcnt(8)
    ds_read_b64_tr_b16 a[84:85], v15 offset:27744
    ds_read_b64_tr_b16 a[86:87], v15 offset:30048
    v_mfma_f32_16x16x32_bf16 v[164:167], a[64:67], v[72:75], v[164:167]
    s_waitcnt lgkmcnt(8)
    ds_read_b64_tr_b16 a[88:89], v15 offset:18560
    ds_read_b64_tr_b16 a[90:91], v15 offset:20864
    v_mfma_f32_16x16x32_bf16 v[164:167], a[68:71], v[76:79], v[164:167]
    s_waitcnt lgkmcnt(8)
    ds_read_b64_tr_b16 a[92:93], v15 offset:27776
    ds_read_b64_tr_b16 a[94:95], v15 offset:30080
    buffer_load_dwordx4 v6, s[12:15], s25 offen offset:2048 lds
    v_mfma_f32_16x16x32_bf16 v[168:171], a[72:75], v[72:75], v[168:171]
    s_waitcnt lgkmcnt(8)
    ds_read_b64_tr_b16 a[64:65], v15 offset:18592
    ds_read_b64_tr_b16 a[66:67], v15 offset:20896
    v_mfma_f32_16x16x32_bf16 v[168:171], a[76:79], v[76:79], v[168:171]
    s_waitcnt lgkmcnt(8)
    ds_read_b64_tr_b16 a[68:69], v15 offset:27808
    ds_read_b64_tr_b16 a[70:71], v15 offset:30112
    v_mfma_f32_16x16x32_bf16 v[172:175], a[80:83], v[72:75], v[172:175]
    s_waitcnt lgkmcnt(8)
    ds_read_b64_tr_b16 a[72:73], v15 offset:18624
    ds_read_b64_tr_b16 a[74:75], v15 offset:20928
    v_mfma_f32_16x16x32_bf16 v[172:175], a[84:87], v[76:79], v[172:175]
    s_waitcnt lgkmcnt(8)
    ds_read_b64_tr_b16 a[76:77], v15 offset:27840
    ds_read_b64_tr_b16 a[78:79], v15 offset:30144
    v_mfma_f32_16x16x32_bf16 v[176:179], a[88:91], v[72:75], v[176:179]
    s_waitcnt lgkmcnt(8)
    ds_read_b64_tr_b16 a[80:81], v15 offset:18656
    ds_read_b64_tr_b16 a[82:83], v15 offset:20960
    v_mfma_f32_16x16x32_bf16 v[176:179], a[92:95], v[76:79], v[176:179]
    s_waitcnt lgkmcnt(8)
    ds_read_b64_tr_b16 a[84:85], v15 offset:27872
    ds_read_b64_tr_b16 a[86:87], v15 offset:30176
    buffer_load_dwordx4 v7, s[12:15], s25 offen offset:3072 lds
    v_mfma_f32_16x16x32_bf16 v[180:183], a[64:67], v[72:75], v[180:183]
    s_waitcnt lgkmcnt(8)
    ds_read_b64_tr_b16 a[88:89], v15 offset:18688
    ds_read_b64_tr_b16 a[90:91], v15 offset:20992
    v_mfma_f32_16x16x32_bf16 v[180:183], a[68:71], v[76:79], v[180:183]
    s_waitcnt lgkmcnt(8)
    s_add_u32 m0, s24, 40960
    ds_read_b64_tr_b16 a[92:93], v15 offset:27904
    ds_read_b64_tr_b16 a[94:95], v15 offset:30208
    v_mfma_f32_16x16x32_bf16 v[184:187], a[72:75], v[72:75], v[184:187]
    s_waitcnt lgkmcnt(8)
    s_waitcnt vmcnt(6)
    s_barrier
    ds_read_b64_tr_b16 a[64:65], v13 offset:0
    ds_read_b64_tr_b16 a[66:67], v13 offset:2304
    v_mfma_f32_16x16x32_bf16 v[184:187], a[76:79], v[76:79], v[184:187]
    s_waitcnt lgkmcnt(8)
    ds_read_b64_tr_b16 a[68:69], v13 offset:9216
    ds_read_b64_tr_b16 a[70:71], v13 offset:11520
    v_mfma_f32_16x16x32_bf16 v[188:191], a[80:83], v[72:75], v[188:191]
    s_waitcnt lgkmcnt(8)
    ds_read_b64_tr_b16 a[72:73], v13 offset:32
    ds_read_b64_tr_b16 a[74:75], v13 offset:2336
    v_mfma_f32_16x16x32_bf16 v[188:191], a[84:87], v[76:79], v[188:191]
    s_waitcnt lgkmcnt(8)
    ds_read_b64_tr_b16 a[76:77], v13 offset:9248
    ds_read_b64_tr_b16 a[78:79], v13 offset:11552
    buffer_load_dwordx4 v8, s[12:15], s25 offen offset:0 lds
    v_mfma_f32_16x16x32_bf16 v[192:195], a[88:91], v[72:75], v[192:195]
    s_waitcnt lgkmcnt(8)
    ds_read_b64_tr_b16 a[80:81], v13 offset:64
    ds_read_b64_tr_b16 a[82:83], v13 offset:2368
    v_mfma_f32_16x16x32_bf16 v[192:195], a[92:95], v[76:79], v[192:195]
    s_waitcnt lgkmcnt(8)
    ds_read_b64_tr_b16 a[84:85], v13 offset:9280
    ds_read_b64_tr_b16 a[86:87], v13 offset:11584
    v_mfma_f32_16x16x32_bf16 v[160:163], a[64:67], v[80:83], v[160:163]
    s_waitcnt lgkmcnt(8)
    ds_read_b64_tr_b16 a[88:89], v13 offset:96
    ds_read_b64_tr_b16 a[90:91], v13 offset:2400
    v_mfma_f32_16x16x32_bf16 v[160:163], a[68:71], v[84:87], v[160:163]
    s_waitcnt lgkmcnt(8)
    ds_read_b64_tr_b16 a[92:93], v13 offset:9312
    ds_read_b64_tr_b16 a[94:95], v13 offset:11616
    buffer_load_dwordx4 v9, s[12:15], s25 offen offset:1024 lds
    v_mfma_f32_16x16x32_bf16 v[164:167], a[72:75], v[80:83], v[164:167]
    s_waitcnt lgkmcnt(8)
    ds_read_b64_tr_b16 a[64:65], v13 offset:128
    ds_read_b64_tr_b16 a[66:67], v13 offset:2432
    v_mfma_f32_16x16x32_bf16 v[164:167], a[76:79], v[84:87], v[164:167]
    s_waitcnt lgkmcnt(8)
    ds_read_b64_tr_b16 a[68:69], v13 offset:9344
    ds_read_b64_tr_b16 a[70:71], v13 offset:11648
    v_mfma_f32_16x16x32_bf16 v[168:171], a[80:83], v[80:83], v[168:171]
    s_waitcnt lgkmcnt(8)
    ds_read_b64_tr_b16 a[72:73], v13 offset:160
    ds_read_b64_tr_b16 a[74:75], v13 offset:2464
    v_mfma_f32_16x16x32_bf16 v[168:171], a[84:87], v[84:87], v[168:171]
    s_waitcnt lgkmcnt(8)
    ds_read_b64_tr_b16 a[76:77], v13 offset:9376
    ds_read_b64_tr_b16 a[78:79], v13 offset:11680
    buffer_load_dwordx4 v10, s[12:15], s25 offen offset:2048 lds
    v_mfma_f32_16x16x32_bf16 v[172:175], a[88:91], v[80:83], v[172:175]
    s_waitcnt lgkmcnt(8)
    ds_read_b64_tr_b16 a[80:81], v13 offset:192
    ds_read_b64_tr_b16 a[82:83], v13 offset:2496
    v_mfma_f32_16x16x32_bf16 v[172:175], a[92:95], v[84:87], v[172:175]
    s_waitcnt lgkmcnt(8)
    ds_read_b64_tr_b16 a[84:85], v13 offset:9408
    ds_read_b64_tr_b16 a[86:87], v13 offset:11712
    v_mfma_f32_16x16x32_bf16 v[176:179], a[64:67], v[80:83], v[176:179]
    s_waitcnt lgkmcnt(8)
    ds_read_b64_tr_b16 a[88:89], v13 offset:224
    ds_read_b64_tr_b16 a[90:91], v13 offset:2528
    v_mfma_f32_16x16x32_bf16 v[176:179], a[68:71], v[84:87], v[176:179]
    s_waitcnt lgkmcnt(8)
    ds_read_b64_tr_b16 a[92:93], v13 offset:9440
    ds_read_b64_tr_b16 a[94:95], v13 offset:11744
    buffer_load_dwordx4 v11, s[12:15], s25 offen offset:3072 lds
    v_mfma_f32_16x16x32_bf16 v[180:183], a[72:75], v[80:83], v[180:183]
    s_waitcnt lgkmcnt(8)
    ds_read_b64_tr_b16 a[64:65], v13 offset:256
    ds_read_b64_tr_b16 a[66:67], v13 offset:2560
    v_mfma_f32_16x16x32_bf16 v[180:183], a[76:79], v[84:87], v[180:183]
    s_waitcnt lgkmcnt(8)
    s_add_u32 m0, s24, 45056
    ds_read_b64_tr_b16 a[68:69], v13 offset:9472
    ds_read_b64_tr_b16 a[70:71], v13 offset:11776
    v_mfma_f32_16x16x32_bf16 v[184:187], a[80:83], v[80:83], v[184:187]
    s_waitcnt lgkmcnt(8)
    v_mfma_f32_16x16x32_bf16 v[184:187], a[84:87], v[84:87], v[184:187]
    s_waitcnt lgkmcnt(6)
    buffer_load_dwordx4 v12, s[12:15], s25 offen offset:0 lds
    v_mfma_f32_16x16x32_bf16 v[188:191], a[88:91], v[80:83], v[188:191]
    s_waitcnt lgkmcnt(4)
    v_mfma_f32_16x16x32_bf16 v[188:191], a[92:95], v[84:87], v[188:191]
    s_waitcnt lgkmcnt(2)
    v_mfma_f32_16x16x32_bf16 v[192:195], a[64:67], v[80:83], v[192:195]
    s_waitcnt lgkmcnt(0)
    v_mfma_f32_16x16x32_bf16 v[192:195], a[68:71], v[84:87], v[192:195]
    s_mul_i32 s30, s43, 18432
    s_add_u32 s30, s30, 262144
    v_pk_mul_f32 v[160:161], v[160:161], v[234:235] op_sel_hi:[1,0]
    v_pk_mul_f32 v[162:163], v[162:163], v[234:235] op_sel_hi:[1,0]
    v_pk_mul_f32 v[164:165], v[164:165], v[234:235] op_sel_hi:[1,0]
    v_pk_mul_f32 v[166:167], v[166:167], v[234:235] op_sel_hi:[1,0]
    v_pk_fma_f32 v[204:205], v[160:161], v[160:161], s[32:33] neg_lo:[1,0,0] neg_hi:[1,0,0]
    v_pk_fma_f32 v[206:207], v[162:163], v[162:163], s[32:33] neg_lo:[1,0,0] neg_hi:[1,0,0]
    v_pk_fma_f32 v[208:209], v[164:165], v[164:165], s[32:33] neg_lo:[1,0,0] neg_hi:[1,0,0]
    v_pk_fma_f32 v[210:211], v[166:167], v[166:167], s[32:33] neg_lo:[1,0,0] neg_hi:[1,0,0]
    v_pk_mul_f32 v[204:205], v[204:205], v[160:161]
    v_pk_mul_f32 v[206:207], v[206:207], v[162:163]
    v_pk_mul_f32 v[208:209], v[208:209], v[164:165]
    v_pk_mul_f32 v[210:211], v[210:211], v[166:167]
    v_exp_f32 v204, v204
    v_exp_f32 v205, v205
    v_exp_f32 v206, v206
    v_exp_f32 v207, v207
    v_exp_f32 v208, v208
    v_exp_f32 v209, v209
    v_exp_f32 v210, v210
    v_exp_f32 v211, v211
    v_pk_fma_f32 v[204:205], v[204:205], s[34:35], s[34:35]
    v_pk_fma_f32 v[206:207], v[206:207], s[34:35], s[34:35]
    v_pk_fma_f32 v[208:209], v[208:209], s[34:35], s[34:35]
    v_pk_fma_f32 v[210:211], v[210:211], s[34:35], s[34:35]
    v_rcp_f32 v204, v204
    v_rcp_f32 v205, v205
    v_rcp_f32 v206, v206
    v_rcp_f32 v207, v207
    v_rcp_f32 v208, v208
    v_rcp_f32 v209, v209
    v_rcp_f32 v210, v210
    v_rcp_f32 v211, v211
    v_pk_mul_f32 v[160:161], v[160:161], v[204:205]
    v_pk_mul_f32 v[162:163], v[162:163], v[206:207]
    v_pk_mul_f32 v[164:165], v[164:165], v[208:209]
    v_pk_mul_f32 v[166:167], v[166:167], v[210:211]
    v_cvt_pk_bf16_f32 v196, v160, v161
    v_cvt_pk_bf16_f32 v197, v162, v163
    v_cvt_pk_bf16_f32 v198, v164, v165
    v_cvt_pk_bf16_f32 v199, v166, v167
    s_add_u32 s27, s30, 0
    v_permlane16_swap_b32 v196, v198
    v_permlane16_swap_b32 v197, v199
    buffer_store_dwordx4 v[196:199], v236, s[16:19], s27 offen sc1
    s_lshl_b32 s25, s99, 2
    s_add_u32 s25, s25, s4
    s_mul_i32 s25, s25, 36864
    s_add_u32 m0, s24, 73728
    s_nop 0
    buffer_load_dwordx4 v4, s[12:15], s25 offen offset:0 lds
    buffer_load_dwordx4 v5, s[12:15], s25 offen offset:1024 lds
    v_pk_mul_f32 v[168:169], v[168:169], v[234:235] op_sel_hi:[1,0]
    v_pk_mul_f32 v[170:171], v[170:171], v[234:235] op_sel_hi:[1,0]
    v_pk_mul_f32 v[172:173], v[172:173], v[234:235] op_sel_hi:[1,0]
    v_pk_mul_f32 v[174:175], v[174:175], v[234:235] op_sel_hi:[1,0]
    v_pk_fma_f32 v[204:205], v[168:169], v[168:169], s[32:33] neg_lo:[1,0,0] neg_hi:[1,0,0]
    v_pk_fma_f32 v[206:207], v[170:171], v[170:171], s[32:33] neg_lo:[1,0,0] neg_hi:[1,0,0]
    v_pk_fma_f32 v[208:209], v[172:173], v[172:173], s[32:33] neg_lo:[1,0,0] neg_hi:[1,0,0]
    v_pk_fma_f32 v[210:211], v[174:175], v[174:175], s[32:33] neg_lo:[1,0,0] neg_hi:[1,0,0]
    v_pk_mul_f32 v[204:205], v[204:205], v[168:169]
    v_pk_mul_f32 v[206:207], v[206:207], v[170:171]
    v_pk_mul_f32 v[208:209], v[208:209], v[172:173]
    v_pk_mul_f32 v[210:211], v[210:211], v[174:175]
    v_exp_f32 v204, v204
    v_exp_f32 v205, v205
    v_exp_f32 v206, v206
    v_exp_f32 v207, v207
    v_exp_f32 v208, v208
    v_exp_f32 v209, v209
    v_exp_f32 v210, v210
    v_exp_f32 v211, v211
    v_pk_fma_f32 v[204:205], v[204:205], s[34:35], s[34:35]
    v_pk_fma_f32 v[206:207], v[206:207], s[34:35], s[34:35]
    v_pk_fma_f32 v[208:209], v[208:209], s[34:35], s[34:35]
    v_pk_fma_f32 v[210:211], v[210:211], s[34:35], s[34:35]
    v_rcp_f32 v204, v204
    v_rcp_f32 v205, v205
    v_rcp_f32 v206, v206
    v_rcp_f32 v207, v207
    v_rcp_f32 v208, v208
    v_rcp_f32 v209, v209
    v_rcp_f32 v210, v210
    v_rcp_f32 v211, v211
    v_pk_mul_f32 v[168:169], v[168:169], v[204:205]
    v_pk_mul_f32 v[170:171], v[170:171], v[206:207]
    v_pk_mul_f32 v[172:173], v[172:173], v[208:209]
    v_pk_mul_f32 v[174:175], v[174:175], v[210:211]
    v_cvt_pk_bf16_f32 v200, v168, v169
    v_cvt_pk_bf16_f32 v201, v170, v171
    v_cvt_pk_bf16_f32 v202, v172, v173
    v_cvt_pk_bf16_f32 v203, v174, v175
    s_add_u32 s27, s30, 4096
    v_permlane16_swap_b32 v200, v202
    v_permlane16_swap_b32 v201, v203
    buffer_store_dwordx4 v[200:203], v236, s[16:19], s27 offen sc1
    buffer_load_dwordx4 v6, s[12:15], s25 offen offset:2048 lds
    buffer_load_dwordx4 v7, s[12:15], s25 offen offset:3072 lds
    v_pk_mul_f32 v[176:177], v[176:177], v[234:235] op_sel_hi:[1,0]
    v_pk_mul_f32 v[178:179], v[178:179], v[234:235] op_sel_hi:[1,0]
    v_pk_mul_f32 v[180:181], v[180:181], v[234:235] op_sel_hi:[1,0]
    v_pk_mul_f32 v[182:183], v[182:183], v[234:235] op_sel_hi:[1,0]
    v_pk_fma_f32 v[204:205], v[176:177], v[176:177], s[32:33] neg_lo:[1,0,0] neg_hi:[1,0,0]
    v_pk_fma_f32 v[206:207], v[178:179], v[178:179], s[32:33] neg_lo:[1,0,0] neg_hi:[1,0,0]
    v_pk_fma_f32 v[208:209], v[180:181], v[180:181], s[32:33] neg_lo:[1,0,0] neg_hi:[1,0,0]
    v_pk_fma_f32 v[210:211], v[182:183], v[182:183], s[32:33] neg_lo:[1,0,0] neg_hi:[1,0,0]
    v_pk_mul_f32 v[204:205], v[204:205], v[176:177]
    v_pk_mul_f32 v[206:207], v[206:207], v[178:179]
    v_pk_mul_f32 v[208:209], v[208:209], v[180:181]
    v_pk_mul_f32 v[210:211], v[210:211], v[182:183]
    v_exp_f32 v204, v204
    v_exp_f32 v205, v205
Lpad29908_2:
    s_cbranch_execz Lpadret
    v_exp_f32 v206, v206
    v_exp_f32 v207, v207
    v_exp_f32 v208, v208
    v_exp_f32 v209, v209
    v_exp_f32 v210, v210
    v_exp_f32_e64 v211, v211
    v_pk_fma_f32 v[204:205], v[204:205], s[34:35], s[34:35]
    v_pk_fma_f32 v[206:207], v[206:207], s[34:35], s[34:35]
    v_pk_fma_f32 v[208:209], v[208:209], s[34:35], s[34:35]
    v_pk_fma_f32 v[210:211], v[210:211], s[34:35], s[34:35]
    v_rcp_f32 v204, v204
    v_rcp_f32 v205, v205
    v_rcp_f32 v206, v206
    v_rcp_f32 v207, v207
    v_rcp_f32 v208, v208
    v_rcp_f32 v209, v209
    v_rcp_f32 v210, v210
    v_rcp_f32 v211, v211
    v_pk_mul_f32 v[176:177], v[176:177], v[204:205]
    v_pk_mul_f32 v[178:179], v[178:179], v[206:207]
    v_pk_mul_f32 v[180:181], v[180:181], v[208:209]
    v_pk_mul_f32 v[182:183], v[182:183], v[210:211]
    v_cvt_pk_bf16_f32 v196, v176, v177
    v_cvt_pk_bf16_f32 v197, v178, v179
    v_cvt_pk_bf16_f32 v198, v180, v181
    v_cvt_pk_bf16_f32 v199, v182, v183
    s_add_u32 s27, s30, 8192
    v_permlane16_swap_b32 v196, v198
    v_permlane16_swap_b32 v197, v199
    buffer_store_dwordx4 v[196:199], v236, s[16:19], s27 offen sc1
    v_pk_mul_f32 v[184:185], v[184:185], v[234:235] op_sel_hi:[1,0]
    v_pk_mul_f32 v[186:187], v[186:187], v[234:235] op_sel_hi:[1,0]
    v_pk_mul_f32 v[188:189], v[188:189], v[234:235] op_sel_hi:[1,0]
    v_pk_mul_f32 v[190:191], v[190:191], v[234:235] op_sel_hi:[1,0]
    v_pk_fma_f32 v[204:205], v[184:185], v[184:185], s[32:33] neg_lo:[1,0,0] neg_hi:[1,0,0]
    v_pk_fma_f32 v[206:207], v[186:187], v[186:187], s[32:33] neg_lo:[1,0,0] neg_hi:[1,0,0]
    v_pk_fma_f32 v[208:209], v[188:189], v[188:189], s[32:33] neg_lo:[1,0,0] neg_hi:[1,0,0]
    v_pk_fma_f32 v[210:211], v[190:191], v[190:191], s[32:33] neg_lo:[1,0,0] neg_hi:[1,0,0]
    v_pk_mul_f32 v[204:205], v[204:205], v[184:185]
    v_pk_mul_f32 v[206:207], v[206:207], v[186:187]
    v_pk_mul_f32 v[208:209], v[208:209], v[188:189]
    v_pk_mul_f32 v[210:211], v[210:211], v[190:191]
    v_exp_f32 v204, v204
    v_exp_f32 v205, v205
    v_exp_f32 v206, v206
    v_exp_f32 v207, v207
    v_exp_f32 v208, v208
    v_exp_f32 v209, v209
    v_exp_f32 v210, v210
    v_exp_f32 v211, v211
    v_pk_fma_f32 v[204:205], v[204:205], s[34:35], s[34:35]
    v_pk_fma_f32 v[206:207], v[206:207], s[34:35], s[34:35]
    v_pk_fma_f32 v[208:209], v[208:209], s[34:35], s[34:35]
    v_pk_fma_f32 v[210:211], v[210:211], s[34:35], s[34:35]
    v_rcp_f32 v204, v204
    v_rcp_f32 v205, v205
    v_rcp_f32 v206, v206
    v_rcp_f32 v207, v207
    v_rcp_f32 v208, v208
    v_rcp_f32 v209, v209
    v_rcp_f32 v210, v210
    v_rcp_f32 v211, v211
    v_pk_mul_f32 v[184:185], v[184:185], v[204:205]
    v_pk_mul_f32 v[186:187], v[186:187], v[206:207]
    v_pk_mul_f32 v[188:189], v[188:189], v[208:209]
    v_pk_mul_f32 v[190:191], v[190:191], v[210:211]
    v_cvt_pk_bf16_f32 v200, v184, v185
    v_cvt_pk_bf16_f32 v201, v186, v187
    v_cvt_pk_bf16_f32 v202, v188, v189
    v_cvt_pk_bf16_f32 v203, v190, v191
    s_add_u32 s27, s30, 12288
    v_permlane16_swap_b32 v200, v202
    v_permlane16_swap_b32 v201, v203
    buffer_store_dwordx4 v[200:203], v236, s[16:19], s27 offen sc1
    v_pk_mul_f32 v[192:193], v[192:193], v[234:235] op_sel_hi:[1,0]
    v_pk_mul_f32 v[194:195], v[194:195], v[234:235] op_sel_hi:[1,0]
    v_pk_fma_f32 v[204:205], v[192:193], v[192:193], s[32:33] neg_lo:[1,0,0] neg_hi:[1,0,0]
    v_pk_fma_f32 v[206:207], v[194:195], v[194:195], s[32:33] neg_lo:[1,0,0] neg_hi:[1,0,0]
    v_pk_mul_f32 v[204:205], v[204:205], v[192:193]
    v_pk_mul_f32 v[206:207], v[206:207], v[194:195]
    v_exp_f32 v204, v204
    v_exp_f32 v205, v205
    v_exp_f32 v206, v206
    v_exp_f32 v207, v207
    v_pk_fma_f32 v[204:205], v[204:205], s[34:35], s[34:35]
    v_pk_fma_f32 v[206:207], v[206:207], s[34:35], s[34:35]
    v_rcp_f32 v204, v204
    v_rcp_f32 v205, v205
    v_rcp_f32 v206, v206
    v_rcp_f32 v207, v207
    v_pk_mul_f32 v[192:193], v[192:193], v[204:205]
    v_pk_mul_f32 v[194:195], v[194:195], v[206:207]
    v_cvt_pk_bf16_f32 v196, v192, v193
    v_cvt_pk_bf16_f32 v197, v194, v195
    s_add_u32 s27, s30, 16384
    v_permlane16_swap_b32 v196, v198
    v_permlane16_swap_b32 v197, v199
    buffer_store_dwordx4 v[196:199], v237, s[16:19], s27 offen sc1
    s_barrier
    s_add_u32 m0, s24, 77824
    s_nop 0
    buffer_load_dwordx4 v8, s[12:15], s25 offen offset:0 lds
    buffer_load_dwordx4 v9, s[12:15], s25 offen offset:1024 lds
    buffer_load_dwordx4 v10, s[12:15], s25 offen offset:2048 lds
    buffer_load_dwordx4 v11, s[12:15], s25 offen offset:3072 lds
    s_add_u32 m0, s24, 81920
    s_nop 0
    buffer_load_dwordx4 v12, s[12:15], s25 offen offset:0 lds
    s_mov_b32 s56, s62
    s_and_b32 s57, s63, 0xffff
    s_mov_b32 s58, 5308416
    s_mov_b32 s59, 0x20000
    v_and_b32 v254, 16, v1
    v_and_b32 v255, 7, v1
    v_lshlrev_b32 v255, 3, v255
    v_xor_b32 v254, v254, v255
    v_lshrrev_b32 v255, 3, v1
    v_lshrrev_b32 v252, 2, v255
    v_and_b32_e64 v253, 3, v255
    v_lshl_add_u32 v252, v252, 4, v253
    s_mov_b32 s55, 4608
    s_lshl_b32 s28, s46, 2
    s_add_u32 s28, s28, s4
    s_mul_i32 s27, s28, 86
    s_lshr_b32 s27, s27, 8
    s_mul_i32 s31, s27, 3
    s_sub_u32 s28, s28, s31
    s_mul_i32 s54, s5, 18
    s_add_u32 s54, s54, s27
    s_mul_i32 s54, s54, 36864
    s_lshr_b32 s65, s27, 2
    s_and_b32 s31, s27, 3
    s_lshl_b32 s31, s31, 2
    s_add_u32 s65, s65, s31
    s_add_u32 s31, s27, 3
    s_cmp_ge_u32 s27, 16
    s_cselect_b32 s65, s31, s65
    s_cmp_lt_u32 s27, 18
    s_cbranch_scc1 Lc35
    s_mov_b32 s56, s52
    s_and_b32 s57, s53, 0xffff
    s_mov_b32 s58, 663552
    s_mul_i32 s54, s5, 82944
    s_mov_b32 s55, 20736
    s_sub_u32 s65, s27, 2
    s_sub_u32 s31, s27, 18
    s_lshl_b32 s31, s31, 3
    v_add_u32 v252, s31, v255
    s_cmp_lt_u32 s27, 20
    s_cbranch_scc1 Lc35
    s_mov_b32 s55, 0
    v_lshrrev_b32 v252, 1, v255
    v_lshl_add_u32 v252, v252, 4, v255
    v_add_u32 v252, 16, v252
Lc35:
    v_mul_u32_u24 v252, 1152, v252
    v_lshl_add_u32 v252, v254, 1, v252
    v_xor_b32 v253, 64, v252
    s_mul_i32 s31, s28, 384
    s_add_u32 s54, s54, s31
    s_mul_i32 s31, s5, 3
    s_add_u32 s31, s31, s28
    s_mul_i32 s31, s31, 252
    s_add_u32 s65, s65, s31
    s_lshl_b32 s65, s65, 10
    s_add_u32 s65, s65, 33357824
    s_cmp_ge_u32 s27, 21
    s_cselect_b32 s65, 1073741824, s65
    v_bfe_u32 v254, v1, 3, 2
    v_lshlrev_b32 v254, 5, v254
    v_and_b32 v248, 3, v1
    v_lshl_add_u32 v254, v248, 3, v254
    v_bfe_u32 v248, v1, 2, 2
    v_lshl_add_u32 v254, v248, 7, v254
    v_lshl_add_u32 v254, v3, 10, v254
    v_lshl_add_u32 v248, s4, 12, v254
    v_xor_b32 v249, 32, v248
    v_xor_b32 v250, 64, v248
    v_xor_b32 v251, 96, v248
    s_waitcnt vmcnt(23)
    v_cmp_gt_u32 vcc, 2, v241
    s_cbranch_vccnz Ls36
Lb37:
    s_and_b32 s28, s43, 1
    s_lshl_b32 s28, s28, 1
    s_sub_u32 s28, s7, s28
    s_add_u32 s28, s28, 1
    s_and_b32 s28, s28, 127
    s_lshl_b32 s28, s28, 7
    s_add_u32 s28, s28, 32768
    s_lshl_b32 s30, s7, 7
    s_add_u32 s30, s30, 32768
    s_waitcnt vmcnt(5)
    s_atomic_add s36, s[68:69], s28
    s_atomic_add s36, s[68:69], s30
    s_lshl_b32 s25, s100, 2
    s_add_u32 s25, s25, s4
    s_mul_i32 s25, s25, 36864
    s_add_u32 m0, s24, 110592
    s_nop 0
    buffer_load_dwordx4 v4, s[12:15], s25 offen offset:0 lds
    buffer_load_dwordx4 v5, s[12:15], s25 offen offset:1024 lds
    buffer_load_dwordx4 v6, s[12:15], s25 offen offset:2048 lds
    buffer_load_dwordx4 v7, s[12:15], s25 offen offset:3072 lds
    s_add_u32 m0, s24, 114688
    s_nop 0
    buffer_load_dwordx4 v8, s[12:15], s25 offen offset:0 lds
    buffer_load_dwordx4 v9, s[12:15], s25 offen offset:1024 lds
    buffer_load_dwordx4 v10, s[12:15], s25 offen offset:2048 lds
    buffer_load_dwordx4 v11, s[12:15], s25 offen offset:3072 lds
    s_add_u32 m0, s24, 118784
    s_nop 0
    buffer_load_dwordx4 v12, s[12:15], s25 offen offset:0 lds
    s_mov_b32 s29, 0
    s_atomic_add s29, s[68:69], s30 glc
    s_waitcnt lgkmcnt(0)
    s_add_u32 s29, s29, 1
    s_andn2_b32 s29, 8, s29
    s_cbranch_scc0 Lb39
Ls38:
    s_sub_u32 s26, s26, 1
    s_cselect_b32 s26, 0, s26
    s_cbranch_scc1 Lb39
    s_mov_b32 s29, 0
    s_atomic_add s29, s[68:69], s30 glc
    s_waitcnt lgkmcnt(0)
    s_add_u32 s29, s29, 1
    s_andn2_b32 s29, 8, s29
    s_cbranch_scc1 Ls38
Lb39:
    s_mov_b32 s29, 327680
    buffer_load_dwordx4 v[88:91], v240, s[16:19], s29 offen sc1
    s_add_u32 s29, s29, 4096
    buffer_load_dwordx4 v[92:95], v240, s[16:19], s29 offen sc1
    s_lshl_b32 s29, s98, 14
    s_add_u32 s29, s29, 262144
    buffer_load_dwordx4 v[96:99], v240, s[16:19], s29 offen sc1
    s_add_u32 s29, s29, 4096
    buffer_load_dwordx4 v[100:103], v240, s[16:19], s29 offen sc1
    s_add_u32 s29, s29, 4096
    buffer_load_dwordx4 v[104:107], v240, s[16:19], s29 offen sc1
    s_add_u32 s29, s29, 4096
    buffer_load_dwordx4 v[108:111], v240, s[16:19], s29 offen sc1
    s_lshl_b32 s29, s99, 14
    s_add_u32 s29, s29, 262144
    buffer_load_dwordx4 v[112:115], v240, s[16:19], s29 offen sc1
    s_add_u32 s29, s29, 4096
    buffer_load_dwordx4 v[116:119], v240, s[16:19], s29 offen sc1
    s_add_u32 s29, s29, 4096
    buffer_load_dwordx4 v[120:123], v240, s[16:19], s29 offen sc1
    s_add_u32 s29, s29, 4096
    buffer_load_dwordx4 v[124:127], v240, s[16:19], s29 offen sc1
    ds_read_b64_tr_b16 a[64:65], v13 offset:18432
    ds_read_b64_tr_b16 a[66:67], v13 offset:20736
    ds_read_b64_tr_b16 a[68:69], v13 offset:27648
    ds_read_b64_tr_b16 a[70:71], v13 offset:29952
    ds_read_b64_tr_b16 a[72:73], v13 offset:18464
    ds_read_b64_tr_b16 a[74:75], v13 offset:20768
    ds_read_b64_tr_b16 a[76:77], v13 offset:27680
    ds_read_b64_tr_b16 a[78:79], v13 offset:29984
    ds_read_b64_tr_b16 a[80:81], v13 offset:18496
    ds_read_b64_tr_b16 a[82:83], v13 offset:20800
    ds_read_b64_tr_b16 a[84:85], v13 offset:27712
    ds_read_b64_tr_b16 a[86:87], v13 offset:30016
    s_waitcnt vmcnt(9) lgkmcnt(10)
    v_mfma_f32_16x16x32_bf16 v[160:163], a[64:67], v[88:91], 0
    s_waitcnt vmcnt(8) lgkmcnt(8)
    ds_read_b64_tr_b16 a[88:89], v13 offset:18528
    ds_read_b64_tr_b16 a[90:91], v13 offset:20832
    v_mfma_f32_16x16x32_bf16 v[160:163], a[68:71], v[92:95], v[160:163]
    s_waitcnt lgkmcnt(8)
    s_lshl_b32 s29, s100, 14
    ds_read_b64_tr_b16 a[92:93], v13 offset:27744
    ds_read_b64_tr_b16 a[94:95], v13 offset:30048
    v_mfma_f32_16x16x32_bf16 v[164:167], a[72:75], v[88:91], 0
    s_waitcnt lgkmcnt(8)
    ds_read_b64_tr_b16 a[64:65], v13 offset:18560
    ds_read_b64_tr_b16 a[66:67], v13 offset:20864
    v_mfma_f32_16x16x32_bf16 v[164:167], a[76:79], v[92:95], v[164:167]
    s_waitcnt lgkmcnt(8)
    s_add_u32 s29, s29, 262144
    ds_read_b64_tr_b16 a[68:69], v13 offset:27776
    ds_read_b64_tr_b16 a[70:71], v13 offset:30080
    v_mfma_f32_16x16x32_bf16 v[168:171], a[80:83], v[88:91], 0
    s_waitcnt lgkmcnt(8)
    ds_read_b64_tr_b16 a[72:73], v13 offset:18592
    ds_read_b64_tr_b16 a[74:75], v13 offset:20896
    v_mfma_f32_16x16x32_bf16 v[168:171], a[84:87], v[92:95], v[168:171]
    s_waitcnt lgkmcnt(8)
    ds_read_b64_tr_b16 a[76:77], v13 offset:27808
    ds_read_b64_tr_b16 a[78:79], v13 offset:30112
    buffer_load_dwordx4 v[128:131], v240, s[16:19], s29 offen sc1
    v_mfma_f32_16x16x32_bf16 v[172:175], a[88:91], v[88:91], 0
    s_waitcnt lgkmcnt(8)
    ds_read_b64_tr_b16 a[80:81], v13 offset:18624
    ds_read_b64_tr_b16 a[82:83], v13 offset:20928
    v_mfma_f32_16x16x32_bf16 v[172:175], a[92:95], v[92:95], v[172:175]
    s_waitcnt lgkmcnt(8)
    s_add_u32 s29, s29, 4096
    ds_read_b64_tr_b16 a[84:85], v13 offset:27840
    ds_read_b64_tr_b16 a[86:87], v13 offset:30144
    v_mfma_f32_16x16x32_bf16 v[176:179], a[64:67], v[88:91], 0
    s_waitcnt lgkmcnt(8)
    ds_read_b64_tr_b16 a[88:89], v13 offset:18656
    ds_read_b64_tr_b16 a[90:91], v13 offset:20960
    v_mfma_f32_16x16x32_bf16 v[176:179], a[68:71], v[92:95], v[176:179]
    s_waitcnt lgkmcnt(8)
    ds_read_b64_tr_b16 a[92:93], v13 offset:27872
    ds_read_b64_tr_b16 a[94:95], v13 offset:30176
    buffer_load_dwordx4 v[132:135], v240, s[16:19], s29 offen sc1
    v_mfma_f32_16x16x32_bf16 v[180:183], a[72:75], v[88:91], 0
    s_waitcnt lgkmcnt(8)
    ds_read_b64_tr_b16 a[64:65], v13 offset:18688
    ds_read_b64_tr_b16 a[66:67], v13 offset:20992
    v_mfma_f32_16x16x32_bf16 v[180:183], a[76:79], v[92:95], v[180:183]
    s_waitcnt lgkmcnt(8)
    s_add_u32 s29, s29, 4096
    ds_read_b64_tr_b16 a[68:69], v13 offset:27904
    ds_read_b64_tr_b16 a[70:71], v13 offset:30208
    v_mfma_f32_16x16x32_bf16 v[184:187], a[80:83], v[88:91], 0
    s_waitcnt lgkmcnt(8)
    s_barrier
    ds_read_b64_tr_b16 a[72:73], v13 offset:36864
    ds_read_b64_tr_b16 a[74:75], v13 offset:39168
    v_mfma_f32_16x16x32_bf16 v[184:187], a[84:87], v[92:95], v[184:187]
    s_waitcnt lgkmcnt(8)
    ds_read_b64_tr_b16 a[76:77], v13 offset:46080
    ds_read_b64_tr_b16 a[78:79], v13 offset:48384
    buffer_load_dwordx4 v[136:139], v240, s[16:19], s29 offen sc1
    v_mfma_f32_16x16x32_bf16 v[188:191], a[88:91], v[88:91], 0
    s_waitcnt lgkmcnt(8)
    ds_read_b64_tr_b16 a[80:81], v13 offset:36896
    ds_read_b64_tr_b16 a[82:83], v13 offset:39200
    v_mfma_f32_16x16x32_bf16 v[188:191], a[92:95], v[92:95], v[188:191]
    s_waitcnt lgkmcnt(8)
    s_add_u32 s29, s29, 4096
    ds_read_b64_tr_b16 a[84:85], v13 offset:46112
    ds_read_b64_tr_b16 a[86:87], v13 offset:48416
    v_mfma_f32_16x16x32_bf16 v[192:195], a[64:67], v[88:91], 0
    s_waitcnt lgkmcnt(8)
    ds_read_b64_tr_b16 a[88:89], v13 offset:36928
    ds_read_b64_tr_b16 a[90:91], v13 offset:39232
    v_mfma_f32_16x16x32_bf16 v[192:195], a[68:71], v[92:95], v[192:195]
    s_waitcnt vmcnt(10) lgkmcnt(8)
    ds_read_b64_tr_b16 a[92:93], v13 offset:46144
    ds_read_b64_tr_b16 a[94:95], v13 offset:48448
    buffer_load_dwordx4 v[140:143], v240, s[16:19], s29 offen sc1
    v_mfma_f32_16x16x32_bf16 v[160:163], a[72:75], v[96:99], v[160:163]
    s_waitcnt vmcnt(10) lgkmcnt(8)
    ds_read_b64_tr_b16 a[64:65], v13 offset:36960
    ds_read_b64_tr_b16 a[66:67], v13 offset:39264
    v_mfma_f32_16x16x32_bf16 v[160:163], a[76:79], v[100:103], v[160:163]
    s_waitcnt lgkmcnt(8)
    s_lshl_b32 s29, s101, 14
    ds_read_b64_tr_b16 a[68:69], v13 offset:46176
    ds_read_b64_tr_b16 a[70:71], v13 offset:48480
    v_mfma_f32_16x16x32_bf16 v[164:167], a[80:83], v[96:99], v[164:167]
    s_waitcnt lgkmcnt(8)
    ds_read_b64_tr_b16 a[72:73], v13 offset:36992
    ds_read_b64_tr_b16 a[74:75], v13 offset:39296
    v_mfma_f32_16x16x32_bf16 v[164:167], a[84:87], v[100:103], v[164:167]
    s_waitcnt lgkmcnt(8)
    s_add_u32 s29, s29, 262144
    ds_read_b64_tr_b16 a[76:77], v13 offset:46208
    ds_read_b64_tr_b16 a[78:79], v13 offset:48512
    v_mfma_f32_16x16x32_bf16 v[168:171], a[88:91], v[96:99], v[168:171]
    s_waitcnt lgkmcnt(8)
    ds_read_b64_tr_b16 a[80:81], v13 offset:37024
    ds_read_b64_tr_b16 a[82:83], v13 offset:39328
    v_mfma_f32_16x16x32_bf16 v[168:171], a[92:95], v[100:103], v[168:171]
    s_waitcnt lgkmcnt(8)
    ds_read_b64_tr_b16 a[84:85], v13 offset:46240
    ds_read_b64_tr_b16 a[86:87], v13 offset:48544
    buffer_load_dwordx4 v[144:147], v240, s[16:19], s29 offen sc1
    v_mfma_f32_16x16x32_bf16 v[172:175], a[64:67], v[96:99], v[172:175]
    s_waitcnt lgkmcnt(8)
    ds_read_b64_tr_b16 a[88:89], v13 offset:37056
    ds_read_b64_tr_b16 a[90:91], v13 offset:39360
    v_mfma_f32_16x16x32_bf16 v[172:175], a[68:71], v[100:103], v[172:175]
    s_waitcnt lgkmcnt(8)
    s_add_u32 s29, s29, 4096
    ds_read_b64_tr_b16 a[92:93], v13 offset:46272
    ds_read_b64_tr_b16 a[94:95], v13 offset:48576
    v_mfma_f32_16x16x32_bf16 v[176:179], a[72:75], v[96:99], v[176:179]
    s_waitcnt lgkmcnt(8)
    ds_read_b64_tr_b16 a[64:65], v13 offset:37088
    ds_read_b64_tr_b16 a[66:67], v13 offset:39392
    v_mfma_f32_16x16x32_bf16 v[176:179], a[76:79], v[100:103], v[176:179]
    s_waitcnt lgkmcnt(8)
    s_barrier
    ds_read_b64_tr_b16 a[68:69], v13 offset:46304
    ds_read_b64_tr_b16 a[70:71], v13 offset:48608
    buffer_load_dwordx4 v[148:151], v240, s[16:19], s29 offen sc1
    v_mfma_f32_16x16x32_bf16 v[180:183], a[80:83], v[96:99], v[180:183]
    s_waitcnt lgkmcnt(8)
    ds_read_b64_tr_b16 a[72:73], v13 offset:37120
    ds_read_b64_tr_b16 a[74:75], v13 offset:39424
    v_mfma_f32_16x16x32_bf16 v[180:183], a[84:87], v[100:103], v[180:183]
    s_waitcnt lgkmcnt(8)
    s_add_u32 s29, s29, 4096
    ds_read_b64_tr_b16 a[76:77], v13 offset:46336
    ds_read_b64_tr_b16 a[78:79], v13 offset:48640
    v_mfma_f32_16x16x32_bf16 v[184:187], a[88:91], v[96:99], v[184:187]
    s_waitcnt lgkmcnt(8)
    ds_read_b64_tr_b16 a[80:81], v14 offset:0
    ds_read_b64_tr_b16 a[82:83], v14 offset:2304
    v_mfma_f32_16x16x32_bf16 v[184:187], a[92:95], v[100:103], v[184:187]
    s_waitcnt lgkmcnt(8)
    ds_read_b64_tr_b16 a[84:85], v14 offset:9216
    ds_read_b64_tr_b16 a[86:87], v14 offset:11520
    buffer_load_dwordx4 v[152:155], v240, s[16:19], s29 offen sc1
    v_mfma_f32_16x16x32_bf16 v[188:191], a[64:67], v[96:99], v[188:191]
    s_waitcnt lgkmcnt(8)
    ds_read_b64_tr_b16 a[88:89], v14 offset:32
    ds_read_b64_tr_b16 a[90:91], v14 offset:2336
    v_mfma_f32_16x16x32_bf16 v[188:191], a[68:71], v[100:103], v[188:191]
    s_waitcnt lgkmcnt(8)
    s_add_u32 s29, s29, 4096
    ds_read_b64_tr_b16 a[92:93], v14 offset:9248
    ds_read_b64_tr_b16 a[94:95], v14 offset:11552
    v_mfma_f32_16x16x32_bf16 v[192:195], a[72:75], v[96:99], v[192:195]
    s_waitcnt lgkmcnt(8)
    ds_read_b64_tr_b16 a[64:65], v14 offset:64
    ds_read_b64_tr_b16 a[66:67], v14 offset:2368
    v_mfma_f32_16x16x32_bf16 v[192:195], a[76:79], v[100:103], v[192:195]
    s_waitcnt vmcnt(12) lgkmcnt(8)
    ds_read_b64_tr_b16 a[68:69], v14 offset:9280
    ds_read_b64_tr_b16 a[70:71], v14 offset:11584
    buffer_load_dwordx4 v[156:159], v240, s[16:19], s29 offen sc1
    v_mfma_f32_16x16x32_bf16 v[160:163], a[80:83], v[104:107], v[160:163]
    s_waitcnt vmcnt(12) lgkmcnt(8)
    ds_read_b64_tr_b16 a[72:73], v14 offset:96
    ds_read_b64_tr_b16 a[74:75], v14 offset:2400
    v_mfma_f32_16x16x32_bf16 v[160:163], a[84:87], v[108:111], v[160:163]
    s_waitcnt lgkmcnt(8)
    s_lshl_b32 s25, s101, 2
    ds_read_b64_tr_b16 a[76:77], v14 offset:9312
    ds_read_b64_tr_b16 a[78:79], v14 offset:11616
    v_mfma_f32_16x16x32_bf16 v[164:167], a[88:91], v[104:107], v[164:167]
    s_waitcnt lgkmcnt(8)
    ds_read_b64_tr_b16 a[80:81], v14 offset:128
    ds_read_b64_tr_b16 a[82:83], v14 offset:2432
    v_mfma_f32_16x16x32_bf16 v[164:167], a[92:95], v[108:111], v[164:167]
    s_waitcnt lgkmcnt(8)
    s_add_u32 s25, s25, s4
    s_mul_i32 s25, s25, 36864
    ds_read_b64_tr_b16 a[84:85], v14 offset:9344
    ds_read_b64_tr_b16 a[86:87], v14 offset:11648
    v_mfma_f32_16x16x32_bf16 v[168:171], a[64:67], v[104:107], v[168:171]
    s_waitcnt lgkmcnt(8)
    ds_read_b64_tr_b16 a[88:89], v14 offset:160
    ds_read_b64_tr_b16 a[90:91], v14 offset:2464
    v_mfma_f32_16x16x32_bf16 v[168:171], a[68:71], v[108:111], v[168:171]
    s_waitcnt lgkmcnt(8)
    s_add_u32 m0, s24, 0
    ds_read_b64_tr_b16 a[92:93], v14 offset:9376
    ds_read_b64_tr_b16 a[94:95], v14 offset:11680
    v_mfma_f32_16x16x32_bf16 v[172:175], a[72:75], v[104:107], v[172:175]
    s_waitcnt lgkmcnt(8)
    ds_read_b64_tr_b16 a[64:65], v14 offset:192
    ds_read_b64_tr_b16 a[66:67], v14 offset:2496
    v_mfma_f32_16x16x32_bf16 v[172:175], a[76:79], v[108:111], v[172:175]
    s_waitcnt lgkmcnt(8)
    ds_read_b64_tr_b16 a[68:69], v14 offset:9408
    ds_read_b64_tr_b16 a[70:71], v14 offset:11712
    buffer_load_dwordx4 v4, s[12:15], s25 offen offset:0 lds
    v_mfma_f32_16x16x32_bf16 v[176:179], a[80:83], v[104:107], v[176:179]
    s_waitcnt lgkmcnt(8)
    ds_read_b64_tr_b16 a[72:73], v14 offset:224
    ds_read_b64_tr_b16 a[74:75], v14 offset:2528
    v_mfma_f32_16x16x32_bf16 v[176:179], a[84:87], v[108:111], v[176:179]
    s_waitcnt lgkmcnt(8)
    ds_read_b64_tr_b16 a[76:77], v14 offset:9440
    ds_read_b64_tr_b16 a[78:79], v14 offset:11744
    buffer_load_dwordx4 v5, s[12:15], s25 offen offset:1024 lds
    v_mfma_f32_16x16x32_bf16 v[180:183], a[88:91], v[104:107], v[180:183]
    s_waitcnt lgkmcnt(8)
    ds_read_b64_tr_b16 a[80:81], v14 offset:256
    ds_read_b64_tr_b16 a[82:83], v14 offset:2560
    v_mfma_f32_16x16x32_bf16 v[180:183], a[92:95], v[108:111], v[180:183]
    s_waitcnt lgkmcnt(8)
    ds_read_b64_tr_b16 a[84:85], v14 offset:9472
    ds_read_b64_tr_b16 a[86:87], v14 offset:11776
    buffer_load_dwordx4 v6, s[12:15], s25 offen offset:2048 lds
    v_mfma_f32_16x16x32_bf16 v[184:187], a[64:67], v[104:107], v[184:187]
    s_waitcnt lgkmcnt(8)
    ds_read_b64_tr_b16 a[88:89], v14 offset:18432
    ds_read_b64_tr_b16 a[90:91], v14 offset:20736
    v_mfma_f32_16x16x32_bf16 v[184:187], a[68:71], v[108:111], v[184:187]
    s_waitcnt lgkmcnt(8)
    ds_read_b64_tr_b16 a[92:93], v14 offset:27648
    ds_read_b64_tr_b16 a[94:95], v14 offset:29952
    buffer_load_dwordx4 v7, s[12:15], s25 offen offset:3072 lds
    v_mfma_f32_16x16x32_bf16 v[188:191], a[72:75], v[104:107], v[188:191]
    s_waitcnt lgkmcnt(8)
    ds_read_b64_tr_b16 a[64:65], v14 offset:18464
    ds_read_b64_tr_b16 a[66:67], v14 offset:20768
    v_mfma_f32_16x16x32_bf16 v[188:191], a[76:79], v[108:111], v[188:191]
    s_waitcnt lgkmcnt(8)
    s_add_u32 m0, s24, 4096
    ds_read_b64_tr_b16 a[68:69], v14 offset:27680
    ds_read_b64_tr_b16 a[70:71], v14 offset:29984
    v_mfma_f32_16x16x32_bf16 v[192:195], a[80:83], v[104:107], v[192:195]
    s_waitcnt lgkmcnt(8)
    ds_read_b64_tr_b16 a[72:73], v14 offset:18496
    ds_read_b64_tr_b16 a[74:75], v14 offset:20800
    v_mfma_f32_16x16x32_bf16 v[192:195], a[84:87], v[108:111], v[192:195]
    s_waitcnt vmcnt(15) lgkmcnt(8)
    ds_read_b64_tr_b16 a[76:77], v14 offset:27712
    ds_read_b64_tr_b16 a[78:79], v14 offset:30016
    buffer_load_dwordx4 v8, s[12:15], s25 offen offset:0 lds
    v_mfma_f32_16x16x32_bf16 v[160:163], a[88:91], v[112:115], v[160:163]
    s_waitcnt vmcnt(15) lgkmcnt(8)
    ds_read_b64_tr_b16 a[80:81], v14 offset:18528
    ds_read_b64_tr_b16 a[82:83], v14 offset:20832
    v_mfma_f32_16x16x32_bf16 v[160:163], a[92:95], v[116:119], v[160:163]
    s_waitcnt lgkmcnt(8)
    ds_read_b64_tr_b16 a[84:85], v14 offset:27744
    ds_read_b64_tr_b16 a[86:87], v14 offset:30048
    buffer_load_dwordx4 v9, s[12:15], s25 offen offset:1024 lds
    v_mfma_f32_16x16x32_bf16 v[164:167], a[64:67], v[112:115], v[164:167]
    s_waitcnt lgkmcnt(8)
    ds_read_b64_tr_b16 a[88:89], v14 offset:18560
    ds_read_b64_tr_b16 a[90:91], v14 offset:20864
    v_mfma_f32_16x16x32_bf16 v[164:167], a[68:71], v[116:119], v[164:167]
    s_waitcnt lgkmcnt(8)
    ds_read_b64_tr_b16 a[92:93], v14 offset:27776
    ds_read_b64_tr_b16 a[94:95], v14 offset:30080
    buffer_load_dwordx4 v10, s[12:15], s25 offen offset:2048 lds
    v_mfma_f32_16x16x32_bf16 v[168:171], a[72:75], v[112:115], v[168:171]
    s_waitcnt lgkmcnt(8)
    ds_read_b64_tr_b16 a[64:65], v14 offset:18592
    ds_read_b64_tr_b16 a[66:67], v14 offset:20896
    v_mfma_f32_16x16x32_bf16 v[168:171], a[76:79], v[116:119], v[168:171]
    s_waitcnt lgkmcnt(8)
    ds_read_b64_tr_b16 a[68:69], v14 offset:27808
    ds_read_b64_tr_b16 a[70:71], v14 offset:30112
    buffer_load_dwordx4 v11, s[12:15], s25 offen offset:3072 lds
    v_mfma_f32_16x16x32_bf16 v[172:175], a[80:83], v[112:115], v[172:175]
    s_waitcnt lgkmcnt(8)
    ds_read_b64_tr_b16 a[72:73], v14 offset:18624
    ds_read_b64_tr_b16 a[74:75], v14 offset:20928
    v_mfma_f32_16x16x32_bf16 v[172:175], a[84:87], v[116:119], v[172:175]
    s_waitcnt lgkmcnt(8)
    s_add_u32 m0, s24, 8192
    ds_read_b64_tr_b16 a[76:77], v14 offset:27840
    ds_read_b64_tr_b16 a[78:79], v14 offset:30144
    buffer_load_dwordx4 v12, s[12:15], s25 offen offset:0 lds
    v_mfma_f32_16x16x32_bf16 v[176:179], a[88:91], v[112:115], v[176:179]
    s_waitcnt lgkmcnt(8)
    s_barrier
    ds_read_b64_tr_b16 a[80:81], v14 offset:18656
    ds_read_b64_tr_b16 a[82:83], v14 offset:20960
    v_mfma_f32_16x16x32_bf16 v[176:179], a[92:95], v[116:119], v[176:179]
    s_waitcnt lgkmcnt(8)
    ds_read_b64_tr_b16 a[84:85], v14 offset:27872
    ds_read_b64_tr_b16 a[86:87], v14 offset:30176
    v_mfma_f32_16x16x32_bf16 v[180:183], a[64:67], v[112:115], v[180:183]
    s_waitcnt lgkmcnt(8)
    ds_read_b64_tr_b16 a[88:89], v14 offset:18688
    ds_read_b64_tr_b16 a[90:91], v14 offset:20992
    v_mfma_f32_16x16x32_bf16 v[180:183], a[68:71], v[116:119], v[180:183]
    s_waitcnt lgkmcnt(8)
    s_lshl_b32 s70, s4, 12
    s_add_u32 m0, s70, 36864
    ds_read_b64_tr_b16 a[92:93], v14 offset:27904
    ds_read_b64_tr_b16 a[94:95], v14 offset:30208
    v_mfma_f32_16x16x32_bf16 v[184:187], a[72:75], v[112:115], v[184:187]
    s_waitcnt lgkmcnt(8)
    ds_read_b64_tr_b16 a[64:65], v14 offset:36864
    ds_read_b64_tr_b16 a[66:67], v14 offset:39168
    v_mfma_f32_16x16x32_bf16 v[184:187], a[76:79], v[116:119], v[184:187]
    s_waitcnt lgkmcnt(8)
    ds_read_b64_tr_b16 a[68:69], v14 offset:46080
    ds_read_b64_tr_b16 a[70:71], v14 offset:48384
    buffer_load_dwordx4 v252, s[56:59], s54 offen offset:0 lds
    v_mfma_f32_16x16x32_bf16 v[188:191], a[80:83], v[112:115], v[188:191]
    s_waitcnt lgkmcnt(8)
    ds_read_b64_tr_b16 a[72:73], v14 offset:36896
    ds_read_b64_tr_b16 a[74:75], v14 offset:39200
    v_mfma_f32_16x16x32_bf16 v[188:191], a[84:87], v[116:119], v[188:191]
    s_waitcnt lgkmcnt(8)
    s_add_u32 m0, s70, 53120
    ds_read_b64_tr_b16 a[76:77], v14 offset:46112
    ds_read_b64_tr_b16 a[78:79], v14 offset:48416
    v_mfma_f32_16x16x32_bf16 v[192:195], a[88:91], v[112:115], v[192:195]
    s_waitcnt lgkmcnt(8)
    ds_read_b64_tr_b16 a[80:81], v14 offset:36928
    ds_read_b64_tr_b16 a[82:83], v14 offset:39232
    v_mfma_f32_16x16x32_bf16 v[192:195], a[92:95], v[116:119], v[192:195]
    s_waitcnt vmcnt(19) lgkmcnt(8)
    ds_read_b64_tr_b16 a[84:85], v14 offset:46144
    ds_read_b64_tr_b16 a[86:87], v14 offset:48448
    buffer_load_dwordx4 v252, s[56:59], s54 offen offset:128 lds
    v_mfma_f32_16x16x32_bf16 v[160:163], a[64:67], v[120:123], v[160:163]
    s_waitcnt vmcnt(19) lgkmcnt(8)
    ds_read_b64_tr_b16 a[88:89], v14 offset:36960
    ds_read_b64_tr_b16 a[90:91], v14 offset:39264
    v_mfma_f32_16x16x32_bf16 v[160:163], a[68:71], v[124:127], v[160:163]
    s_waitcnt lgkmcnt(8)
    s_add_u32 m0, s70, 147200
    ds_read_b64_tr_b16 a[92:93], v14 offset:46176
    ds_read_b64_tr_b16 a[94:95], v14 offset:48480
    v_mfma_f32_16x16x32_bf16 v[164:167], a[72:75], v[120:123], v[164:167]
    s_waitcnt lgkmcnt(8)
    ds_read_b64_tr_b16 a[64:65], v14 offset:36992
    ds_read_b64_tr_b16 a[66:67], v14 offset:39296
    v_mfma_f32_16x16x32_bf16 v[164:167], a[76:79], v[124:127], v[164:167]
    s_waitcnt lgkmcnt(8)
    ds_read_b64_tr_b16 a[68:69], v14 offset:46208
    ds_read_b64_tr_b16 a[70:71], v14 offset:48512
    buffer_load_dwordx4 v252, s[56:59], s54 offen offset:256 lds
    v_mfma_f32_16x16x32_bf16 v[168:171], a[80:83], v[120:123], v[168:171]
    s_waitcnt lgkmcnt(8)
    ds_read_b64_tr_b16 a[72:73], v14 offset:37024
    ds_read_b64_tr_b16 a[74:75], v14 offset:39328
    v_mfma_f32_16x16x32_bf16 v[168:171], a[84:87], v[124:127], v[168:171]
    s_waitcnt lgkmcnt(8)
    s_add_u32 s54, s54, s55
    s_add_u32 m0, s70, 37888
    ds_read_b64_tr_b16 a[76:77], v14 offset:46240
    ds_read_b64_tr_b16 a[78:79], v14 offset:48544
    v_mfma_f32_16x16x32_bf16 v[172:175], a[88:91], v[120:123], v[172:175]
Lpad29908_3:
    s_cbranch_execz Lpadret
    s_waitcnt lgkmcnt(8)
    ds_read_b64_tr_b16 a[80:81], v14 offset:37056
    ds_read_b64_tr_b16 a[82:83], v14 offset:39360
    v_mfma_f32_16x16x32_bf16 v[172:175], a[92:95], v[124:127], v[172:175]
    s_waitcnt lgkmcnt(8)
    ds_read_b64_tr_b16 a[84:85], v14 offset:46272
    ds_read_b64_tr_b16 a[86:87], v14 offset:48576
    buffer_load_dwordx4 v253, s[56:59], s54 offen offset:0 lds
    v_mfma_f32_16x16x32_bf16 v[176:179], a[64:67], v[120:123], v[176:179]
    s_waitcnt lgkmcnt(8)
    ds_read_b64_tr_b16 a[88:89], v14 offset:37088
    ds_read_b64_tr_b16 a[90:91], v14 offset:39392
    v_mfma_f32_16x16x32_bf16 v[176:179], a[68:71], v[124:127], v[176:179]
    s_waitcnt lgkmcnt(8)
    s_add_u32 m0, s70, 54144
    ds_read_b64_tr_b16 a[92:93], v14 offset:46304
    ds_read_b64_tr_b16 a[94:95], v14 offset:48608
    v_mfma_f32_16x16x32_bf16 v[180:183], a[72:75], v[120:123], v[180:183]
    s_waitcnt lgkmcnt(8)
    ds_read_b64_tr_b16 a[64:65], v14 offset:37120
    ds_read_b64_tr_b16 a[66:67], v14 offset:39424
    v_mfma_f32_16x16x32_bf16 v[180:183], a[76:79], v[124:127], v[180:183]
    s_waitcnt lgkmcnt(8)
    ds_read_b64_tr_b16 a[68:69], v14 offset:46336
    ds_read_b64_tr_b16 a[70:71], v14 offset:48640
    buffer_load_dwordx4 v253, s[56:59], s54 offen offset:128 lds
    v_mfma_f32_16x16x32_bf16 v[184:187], a[80:83], v[120:123], v[184:187]
    s_waitcnt lgkmcnt(8)
    ds_read_b64_tr_b16 a[72:73], v15 offset:0
    ds_read_b64_tr_b16 a[74:75], v15 offset:2304
    v_mfma_f32_16x16x32_bf16 v[184:187], a[84:87], v[124:127], v[184:187]
    s_waitcnt lgkmcnt(8)
    s_add_u32 m0, s70, 148224
    ds_read_b64_tr_b16 a[76:77], v15 offset:9216
    ds_read_b64_tr_b16 a[78:79], v15 offset:11520
    v_mfma_f32_16x16x32_bf16 v[188:191], a[88:91], v[120:123], v[188:191]
    s_waitcnt lgkmcnt(8)
    ds_read_b64_tr_b16 a[80:81], v15 offset:32
    ds_read_b64_tr_b16 a[82:83], v15 offset:2336
    v_mfma_f32_16x16x32_bf16 v[188:191], a[92:95], v[124:127], v[188:191]
    s_waitcnt lgkmcnt(8)
    ds_read_b64_tr_b16 a[84:85], v15 offset:9248
    ds_read_b64_tr_b16 a[86:87], v15 offset:11552
    buffer_load_dwordx4 v253, s[56:59], s54 offen offset:256 lds
    v_mfma_f32_16x16x32_bf16 v[192:195], a[64:67], v[120:123], v[192:195]
    s_waitcnt lgkmcnt(8)
    ds_read_b64_tr_b16 a[88:89], v15 offset:64
    ds_read_b64_tr_b16 a[90:91], v15 offset:2368
    v_mfma_f32_16x16x32_bf16 v[192:195], a[68:71], v[124:127], v[192:195]
    s_waitcnt vmcnt(22) lgkmcnt(8)
    s_add_u32 s54, s54, s55
    s_add_u32 m0, s70, 38912
    ds_read_b64_tr_b16 a[92:93], v15 offset:9280
    ds_read_b64_tr_b16 a[94:95], v15 offset:11584
    v_mfma_f32_16x16x32_bf16 v[160:163], a[72:75], v[128:131], v[160:163]
    s_waitcnt vmcnt(21) lgkmcnt(8)
    ds_read_b64_tr_b16 a[64:65], v15 offset:96
    ds_read_b64_tr_b16 a[66:67], v15 offset:2400
    v_mfma_f32_16x16x32_bf16 v[160:163], a[76:79], v[132:135], v[160:163]
    s_waitcnt lgkmcnt(8)
    ds_read_b64_tr_b16 a[68:69], v15 offset:9312
    ds_read_b64_tr_b16 a[70:71], v15 offset:11616
    buffer_load_dwordx4 v252, s[56:59], s54 offen offset:0 lds
    v_mfma_f32_16x16x32_bf16 v[164:167], a[80:83], v[128:131], v[164:167]
    s_waitcnt lgkmcnt(8)
    ds_read_b64_tr_b16 a[72:73], v15 offset:128
    ds_read_b64_tr_b16 a[74:75], v15 offset:2432
    v_mfma_f32_16x16x32_bf16 v[164:167], a[84:87], v[132:135], v[164:167]
    s_waitcnt lgkmcnt(8)
    s_add_u32 m0, s70, 55168
    ds_read_b64_tr_b16 a[76:77], v15 offset:9344
    ds_read_b64_tr_b16 a[78:79], v15 offset:11648
    v_mfma_f32_16x16x32_bf16 v[168:171], a[88:91], v[128:131], v[168:171]
    s_waitcnt lgkmcnt(8)
    ds_read_b64_tr_b16 a[80:81], v15 offset:160
    ds_read_b64_tr_b16 a[82:83], v15 offset:2464
    v_mfma_f32_16x16x32_bf16 v[168:171], a[92:95], v[132:135], v[168:171]
    s_waitcnt lgkmcnt(8)
    ds_read_b64_tr_b16 a[84:85], v15 offset:9376
    ds_read_b64_tr_b16 a[86:87], v15 offset:11680
    buffer_load_dwordx4 v252, s[56:59], s54 offen offset:128 lds
    v_mfma_f32_16x16x32_bf16 v[172:175], a[64:67], v[128:131], v[172:175]
    s_waitcnt lgkmcnt(8)
    ds_read_b64_tr_b16 a[88:89], v15 offset:192
    ds_read_b64_tr_b16 a[90:91], v15 offset:2496
    v_mfma_f32_16x16x32_bf16 v[172:175], a[68:71], v[132:135], v[172:175]
    s_waitcnt lgkmcnt(8)
    s_add_u32 m0, s70, 149248
    ds_read_b64_tr_b16 a[92:93], v15 offset:9408
    ds_read_b64_tr_b16 a[94:95], v15 offset:11712
    v_mfma_f32_16x16x32_bf16 v[176:179], a[72:75], v[128:131], v[176:179]
    s_waitcnt lgkmcnt(8)
    ds_read_b64_tr_b16 a[64:65], v15 offset:224
    ds_read_b64_tr_b16 a[66:67], v15 offset:2528
    v_mfma_f32_16x16x32_bf16 v[176:179], a[76:79], v[132:135], v[176:179]
    s_waitcnt lgkmcnt(8)
    ds_read_b64_tr_b16 a[68:69], v15 offset:9440
    ds_read_b64_tr_b16 a[70:71], v15 offset:11744
    buffer_load_dwordx4 v252, s[56:59], s54 offen offset:256 lds
    v_mfma_f32_16x16x32_bf16 v[180:183], a[80:83], v[128:131], v[180:183]
    s_waitcnt lgkmcnt(8)
    ds_read_b64_tr_b16 a[72:73], v15 offset:256
    ds_read_b64_tr_b16 a[74:75], v15 offset:2560
    v_mfma_f32_16x16x32_bf16 v[180:183], a[84:87], v[132:135], v[180:183]
    s_waitcnt lgkmcnt(8)
    s_add_u32 s54, s54, s55
    s_add_u32 m0, s70, 39936
    ds_read_b64_tr_b16 a[76:77], v15 offset:9472
    ds_read_b64_tr_b16 a[78:79], v15 offset:11776
    v_mfma_f32_16x16x32_bf16 v[184:187], a[88:91], v[128:131], v[184:187]
    s_waitcnt lgkmcnt(8)
    ds_read_b64_tr_b16 a[80:81], v15 offset:18432
    ds_read_b64_tr_b16 a[82:83], v15 offset:20736
    v_mfma_f32_16x16x32_bf16 v[184:187], a[92:95], v[132:135], v[184:187]
    s_waitcnt lgkmcnt(8)
    ds_read_b64_tr_b16 a[84:85], v15 offset:27648
    ds_read_b64_tr_b16 a[86:87], v15 offset:29952
    buffer_load_dwordx4 v253, s[56:59], s54 offen offset:0 lds
    v_mfma_f32_16x16x32_bf16 v[188:191], a[64:67], v[128:131], v[188:191]
    s_waitcnt lgkmcnt(8)
    ds_read_b64_tr_b16 a[88:89], v15 offset:18464
    ds_read_b64_tr_b16 a[90:91], v15 offset:20768
    v_mfma_f32_16x16x32_bf16 v[188:191], a[68:71], v[132:135], v[188:191]
    s_waitcnt lgkmcnt(8)
    s_add_u32 m0, s70, 56192
    ds_read_b64_tr_b16 a[92:93], v15 offset:27680
    ds_read_b64_tr_b16 a[94:95], v15 offset:29984
    v_mfma_f32_16x16x32_bf16 v[192:195], a[72:75], v[128:131], v[192:195]
    s_waitcnt lgkmcnt(8)
    ds_read_b64_tr_b16 a[64:65], v15 offset:18496
    ds_read_b64_tr_b16 a[66:67], v15 offset:20800
    v_mfma_f32_16x16x32_bf16 v[192:195], a[76:79], v[132:135], v[192:195]
    s_waitcnt vmcnt(24) lgkmcnt(8)
    ds_read_b64_tr_b16 a[68:69], v15 offset:27712
    ds_read_b64_tr_b16 a[70:71], v15 offset:30016
    buffer_load_dwordx4 v253, s[56:59], s54 offen offset:128 lds
    v_mfma_f32_16x16x32_bf16 v[160:163], a[80:83], v[136:139], v[160:163]
    s_waitcnt vmcnt(24) lgkmcnt(8)
    ds_read_b64_tr_b16 a[72:73], v15 offset:18528
    ds_read_b64_tr_b16 a[74:75], v15 offset:20832
    v_mfma_f32_16x16x32_bf16 v[160:163], a[84:87], v[140:143], v[160:163]
    s_waitcnt lgkmcnt(8)
    s_add_u32 m0, s70, 150272
    ds_read_b64_tr_b16 a[76:77], v15 offset:27744
    ds_read_b64_tr_b16 a[78:79], v15 offset:30048
    buffer_load_dwordx4 v253, s[56:59], s54 offen offset:256 lds
    v_mfma_f32_16x16x32_bf16 v[164:167], a[88:91], v[136:139], v[164:167]
    s_waitcnt lgkmcnt(8)
    ds_read_b64_tr_b16 a[80:81], v15 offset:18560
    ds_read_b64_tr_b16 a[82:83], v15 offset:20864
    v_mfma_f32_16x16x32_bf16 v[164:167], a[92:95], v[140:143], v[164:167]
    s_waitcnt lgkmcnt(8)
    ds_read_b64_tr_b16 a[84:85], v15 offset:27776
    ds_read_b64_tr_b16 a[86:87], v15 offset:30080
    v_mfma_f32_16x16x32_bf16 v[168:171], a[64:67], v[136:139], v[168:171]
    s_waitcnt lgkmcnt(8)
    ds_read_b64_tr_b16 a[88:89], v15 offset:18592
    ds_read_b64_tr_b16 a[90:91], v15 offset:20896
    v_mfma_f32_16x16x32_bf16 v[168:171], a[68:71], v[140:143], v[168:171]
    s_waitcnt lgkmcnt(8)
    ds_read_b64_tr_b16 a[92:93], v15 offset:27808
    ds_read_b64_tr_b16 a[94:95], v15 offset:30112
    v_mfma_f32_16x16x32_bf16 v[172:175], a[72:75], v[136:139], v[172:175]
    s_waitcnt lgkmcnt(8)
    ds_read_b64_tr_b16 a[64:65], v15 offset:18624
    ds_read_b64_tr_b16 a[66:67], v15 offset:20928
    v_mfma_f32_16x16x32_bf16 v[172:175], a[76:79], v[140:143], v[172:175]
    s_waitcnt lgkmcnt(8)
    ds_read_b64_tr_b16 a[68:69], v15 offset:27840
    ds_read_b64_tr_b16 a[70:71], v15 offset:30144
    v_mfma_f32_16x16x32_bf16 v[176:179], a[80:83], v[136:139], v[176:179]
    s_waitcnt lgkmcnt(8)
    ds_read_b64_tr_b16 a[72:73], v15 offset:18656
    ds_read_b64_tr_b16 a[74:75], v15 offset:20960
    v_mfma_f32_16x16x32_bf16 v[176:179], a[84:87], v[140:143], v[176:179]
    s_waitcnt lgkmcnt(8)
    ds_read_b64_tr_b16 a[76:77], v15 offset:27872
    ds_read_b64_tr_b16 a[78:79], v15 offset:30176
    v_mfma_f32_16x16x32_bf16 v[180:183], a[88:91], v[136:139], v[180:183]
    s_waitcnt lgkmcnt(8)
    ds_read_b64_tr_b16 a[80:81], v15 offset:18688
    ds_read_b64_tr_b16 a[82:83], v15 offset:20992
    v_mfma_f32_16x16x32_bf16 v[180:183], a[92:95], v[140:143], v[180:183]
    s_waitcnt lgkmcnt(8)
    ds_read_b64_tr_b16 a[84:85], v15 offset:27904
    ds_read_b64_tr_b16 a[86:87], v15 offset:30208
    v_mfma_f32_16x16x32_bf16 v[184:187], a[64:67], v[136:139], v[184:187]
    s_waitcnt lgkmcnt(8)
    s_waitcnt vmcnt(12)
    s_barrier
    ds_read_b64_tr_b16 a[88:89], v13 offset:0
    ds_read_b64_tr_b16 a[90:91], v13 offset:2304
    v_mfma_f32_16x16x32_bf16 v[184:187], a[68:71], v[140:143], v[184:187]
    s_waitcnt lgkmcnt(8)
    ds_read_b64_tr_b16 a[92:93], v13 offset:9216
    ds_read_b64_tr_b16 a[94:95], v13 offset:11520
    v_mfma_f32_16x16x32_bf16 v[188:191], a[72:75], v[136:139], v[188:191]
    s_waitcnt lgkmcnt(8)
    ds_read_b64_tr_b16 a[64:65], v13 offset:32
    ds_read_b64_tr_b16 a[66:67], v13 offset:2336
    v_mfma_f32_16x16x32_bf16 v[188:191], a[76:79], v[140:143], v[188:191]
    s_waitcnt lgkmcnt(8)
    ds_read_b64_tr_b16 a[68:69], v13 offset:9248
    ds_read_b64_tr_b16 a[70:71], v13 offset:11552
    v_mfma_f32_16x16x32_bf16 v[192:195], a[80:83], v[136:139], v[192:195]
    s_waitcnt lgkmcnt(8)
    ds_read_b64_tr_b16 a[72:73], v13 offset:64
    ds_read_b64_tr_b16 a[74:75], v13 offset:2368
    v_mfma_f32_16x16x32_bf16 v[192:195], a[84:87], v[140:143], v[192:195]
    s_waitcnt lgkmcnt(8)
    ds_read_b64_tr_b16 a[76:77], v13 offset:9280
    ds_read_b64_tr_b16 a[78:79], v13 offset:11584
    v_mfma_f32_16x16x32_bf16 v[160:163], a[88:91], v[144:147], v[160:163]
    s_waitcnt lgkmcnt(8)
    ds_read_b64_tr_b16 a[80:81], v13 offset:96
    ds_read_b64_tr_b16 a[82:83], v13 offset:2400
    v_mfma_f32_16x16x32_bf16 v[160:163], a[92:95], v[148:151], v[160:163]
    s_waitcnt lgkmcnt(8)
    ds_read_b64_tr_b16 a[84:85], v13 offset:9312
    ds_read_b64_tr_b16 a[86:87], v13 offset:11616
    v_mfma_f32_16x16x32_bf16 v[164:167], a[64:67], v[144:147], v[164:167]
    s_waitcnt lgkmcnt(8)
    ds_read_b64_tr_b16 a[88:89], v13 offset:128
    ds_read_b64_tr_b16 a[90:91], v13 offset:2432
    v_mfma_f32_16x16x32_bf16 v[164:167], a[68:71], v[148:151], v[164:167]
    s_waitcnt lgkmcnt(8)
    ds_read_b64_tr_b16 a[92:93], v13 offset:9344
    ds_read_b64_tr_b16 a[94:95], v13 offset:11648
    v_mfma_f32_16x16x32_bf16 v[168:171], a[72:75], v[144:147], v[168:171]
    s_waitcnt lgkmcnt(8)
    ds_read_b64_tr_b16 a[64:65], v13 offset:160
    ds_read_b64_tr_b16 a[66:67], v13 offset:2464
    v_mfma_f32_16x16x32_bf16 v[168:171], a[76:79], v[148:151], v[168:171]
    s_waitcnt lgkmcnt(8)
    ds_read_b64_tr_b16 a[68:69], v13 offset:9376
    ds_read_b64_tr_b16 a[70:71], v13 offset:11680
    v_mfma_f32_16x16x32_bf16 v[172:175], a[80:83], v[144:147], v[172:175]
    s_waitcnt lgkmcnt(8)
    ds_read_b64_tr_b16 a[72:73], v13 offset:192
    ds_read_b64_tr_b16 a[74:75], v13 offset:2496
    v_mfma_f32_16x16x32_bf16 v[172:175], a[84:87], v[148:151], v[172:175]
    s_waitcnt lgkmcnt(8)
    ds_read_b64_tr_b16 a[76:77], v13 offset:9408
    ds_read_b64_tr_b16 a[78:79], v13 offset:11712
    v_mfma_f32_16x16x32_bf16 v[176:179], a[88:91], v[144:147], v[176:179]
    s_waitcnt lgkmcnt(8)
    ds_read_b64_tr_b16 a[80:81], v13 offset:224
    ds_read_b64_tr_b16 a[82:83], v13 offset:2528
    v_mfma_f32_16x16x32_bf16 v[176:179], a[92:95], v[148:151], v[176:179]
    s_waitcnt lgkmcnt(8)
    ds_read_b64_tr_b16 a[84:85], v13 offset:9440
    ds_read_b64_tr_b16 a[86:87], v13 offset:11744
    v_mfma_f32_16x16x32_bf16 v[180:183], a[64:67], v[144:147], v[180:183]
    s_waitcnt lgkmcnt(8)
    ds_read_b64_tr_b16 a[88:89], v13 offset:256
    ds_read_b64_tr_b16 a[90:91], v13 offset:2560
    v_mfma_f32_16x16x32_bf16 v[180:183], a[68:71], v[148:151], v[180:183]
    s_waitcnt lgkmcnt(8)
    ds_read_b64_tr_b16 a[92:93], v13 offset:9472
    ds_read_b64_tr_b16 a[94:95], v13 offset:11776
    v_mfma_f32_16x16x32_bf16 v[184:187], a[72:75], v[144:147], v[184:187]
    s_waitcnt lgkmcnt(8)
    ds_read_b64_tr_b16 a[64:65], v13 offset:18432
    ds_read_b64_tr_b16 a[66:67], v13 offset:20736
    v_mfma_f32_16x16x32_bf16 v[184:187], a[76:79], v[148:151], v[184:187]
    s_waitcnt lgkmcnt(8)
    ds_read_b64_tr_b16 a[68:69], v13 offset:27648
    ds_read_b64_tr_b16 a[70:71], v13 offset:29952
    v_mfma_f32_16x16x32_bf16 v[188:191], a[80:83], v[144:147], v[188:191]
    s_waitcnt lgkmcnt(8)
    ds_read_b64_tr_b16 a[72:73], v13 offset:18464
    ds_read_b64_tr_b16 a[74:75], v13 offset:20768
    v_mfma_f32_16x16x32_bf16 v[188:191], a[84:87], v[148:151], v[188:191]
    s_waitcnt lgkmcnt(8)
    ds_read_b64_tr_b16 a[76:77], v13 offset:27680
    ds_read_b64_tr_b16 a[78:79], v13 offset:29984
    v_mfma_f32_16x16x32_bf16 v[192:195], a[88:91], v[144:147], v[192:195]
    s_waitcnt lgkmcnt(8)
    ds_read_b64_tr_b16 a[80:81], v13 offset:18496
    ds_read_b64_tr_b16 a[82:83], v13 offset:20800
    v_mfma_f32_16x16x32_bf16 v[192:195], a[92:95], v[148:151], v[192:195]
    s_waitcnt lgkmcnt(8)
    ds_read_b64_tr_b16 a[84:85], v13 offset:27712
    ds_read_b64_tr_b16 a[86:87], v13 offset:30016
    v_mfma_f32_16x16x32_bf16 v[160:163], a[64:67], v[152:155], v[160:163]
    s_waitcnt lgkmcnt(8)
    ds_read_b64_tr_b16 a[88:89], v13 offset:18528
    ds_read_b64_tr_b16 a[90:91], v13 offset:20832
    v_mfma_f32_16x16x32_bf16 v[160:163], a[68:71], v[156:159], v[160:163]
    s_waitcnt lgkmcnt(8)
    ds_read_b64_tr_b16 a[92:93], v13 offset:27744
    ds_read_b64_tr_b16 a[94:95], v13 offset:30048
    v_mfma_f32_16x16x32_bf16 v[164:167], a[72:75], v[152:155], v[164:167]
    s_waitcnt lgkmcnt(8)
    ds_read_b64_tr_b16 a[64:65], v13 offset:18560
    ds_read_b64_tr_b16 a[66:67], v13 offset:20864
    v_mfma_f32_16x16x32_bf16 v[164:167], a[76:79], v[156:159], v[164:167]
    s_waitcnt lgkmcnt(8)
    ds_read_b64_tr_b16 a[68:69], v13 offset:27776
    ds_read_b64_tr_b16 a[70:71], v13 offset:30080
    v_mfma_f32_16x16x32_bf16 v[168:171], a[80:83], v[152:155], v[168:171]
    s_waitcnt lgkmcnt(8)
    ds_read_b64_tr_b16 a[72:73], v13 offset:18592
    ds_read_b64_tr_b16 a[74:75], v13 offset:20896
    v_mfma_f32_16x16x32_bf16 v[168:171], a[84:87], v[156:159], v[168:171]
    s_waitcnt lgkmcnt(8)
    ds_read_b64_tr_b16 a[76:77], v13 offset:27808
    ds_read_b64_tr_b16 a[78:79], v13 offset:30112
    v_mfma_f32_16x16x32_bf16 v[172:175], a[88:91], v[152:155], v[172:175]
    s_waitcnt lgkmcnt(8)
    ds_read_b64_tr_b16 a[80:81], v13 offset:18624
    ds_read_b64_tr_b16 a[82:83], v13 offset:20928
    v_mfma_f32_16x16x32_bf16 v[172:175], a[92:95], v[156:159], v[172:175]
    s_waitcnt lgkmcnt(8)
    ds_read_b64_tr_b16 a[84:85], v13 offset:27840
    ds_read_b64_tr_b16 a[86:87], v13 offset:30144
    v_mfma_f32_16x16x32_bf16 v[176:179], a[64:67], v[152:155], v[176:179]
    s_waitcnt lgkmcnt(8)
    ds_read_b64_tr_b16 a[88:89], v13 offset:18656
    ds_read_b64_tr_b16 a[90:91], v13 offset:20960
    v_mfma_f32_16x16x32_bf16 v[176:179], a[68:71], v[156:159], v[176:179]
    s_waitcnt lgkmcnt(8)
    ds_read_b64_tr_b16 a[92:93], v13 offset:27872
    ds_read_b64_tr_b16 a[94:95], v13 offset:30176
    v_mfma_f32_16x16x32_bf16 v[180:183], a[72:75], v[152:155], v[180:183]
    s_waitcnt lgkmcnt(8)
    ds_read_b64_tr_b16 a[64:65], v13 offset:18688
    ds_read_b64_tr_b16 a[66:67], v13 offset:20992
    v_mfma_f32_16x16x32_bf16 v[180:183], a[76:79], v[156:159], v[180:183]
    s_waitcnt lgkmcnt(8)
    ds_read_b64_tr_b16 a[68:69], v13 offset:27904
    ds_read_b64_tr_b16 a[70:71], v13 offset:30208
    v_mfma_f32_16x16x32_bf16 v[184:187], a[80:83], v[152:155], v[184:187]
    s_waitcnt lgkmcnt(8)
    v_mfma_f32_16x16x32_bf16 v[184:187], a[84:87], v[156:159], v[184:187]
    s_waitcnt lgkmcnt(6)
    v_mfma_f32_16x16x32_bf16 v[188:191], a[88:91], v[152:155], v[188:191]
    s_waitcnt lgkmcnt(4)
    v_mfma_f32_16x16x32_bf16 v[188:191], a[92:95], v[156:159], v[188:191]
    s_waitcnt lgkmcnt(2)
    v_mfma_f32_16x16x32_bf16 v[192:195], a[64:67], v[152:155], v[192:195]
    s_waitcnt lgkmcnt(0)
    v_mfma_f32_16x16x32_bf16 v[192:195], a[68:71], v[156:159], v[192:195]
    s_mul_i32 s30, s43, 18432
    s_add_u32 s30, s30, 2621440
    v_cvt_pk_bf16_f32 v196, v160, v161
    v_cvt_pk_bf16_f32 v197, v162, v163
    v_cvt_pk_bf16_f32 v198, v164, v165
    v_cvt_pk_bf16_f32 v199, v166, v167
    s_add_u32 s27, s30, 0
    v_permlane16_swap_b32 v196, v198
    v_permlane16_swap_b32 v197, v199
    buffer_store_dwordx4 v[196:199], v238, s[16:19], s27 offen sc1
    v_cvt_pk_bf16_f32 v200, v168, v169
    v_cvt_pk_bf16_f32 v201, v170, v171
    v_cvt_pk_bf16_f32 v202, v172, v173
    v_cvt_pk_bf16_f32 v203, v174, v175
    s_add_u32 s27, s30, 4096
    v_permlane16_swap_b32 v200, v202
    v_permlane16_swap_b32 v201, v203
    buffer_store_dwordx4 v[200:203], v238, s[16:19], s27 offen sc1
    v_cvt_pk_bf16_f32 v196, v176, v177
    v_cvt_pk_bf16_f32 v197, v178, v179
    v_cvt_pk_bf16_f32 v198, v180, v181
    v_cvt_pk_bf16_f32 v199, v182, v183
    s_add_u32 s27, s30, 8192
    v_permlane16_swap_b32 v196, v198
    v_permlane16_swap_b32 v197, v199
    buffer_store_dwordx4 v[196:199], v238, s[16:19], s27 offen sc1
    v_cvt_pk_bf16_f32 v200, v184, v185
    v_cvt_pk_bf16_f32 v201, v186, v187
    v_cvt_pk_bf16_f32 v202, v188, v189
    v_cvt_pk_bf16_f32 v203, v190, v191
    s_add_u32 s27, s30, 12288
    v_permlane16_swap_b32 v200, v202
    v_permlane16_swap_b32 v201, v203
    buffer_store_dwordx4 v[200:203], v238, s[16:19], s27 offen sc1
    v_cvt_pk_bf16_f32 v196, v192, v193
    v_cvt_pk_bf16_f32 v197, v194, v195
    s_add_u32 s27, s30, 16384
    v_permlane16_swap_b32 v196, v198
    v_permlane16_swap_b32 v197, v199
    buffer_store_dwordx4 v[196:199], v239, s[16:19], s27 offen sc1
    v_mov_b32 v14, v232
    v_mov_b32 v15, v233
    v_lshlrev_b32 v228, 16, v84
    v_and_b32 v229, s41, v84
    v_lshlrev_b32 v230, 16, v85
    v_and_b32 v231, s41, v85
    v_lshlrev_b32 v224, 16, v80
    v_and_b32 v225, s41, v80
    v_lshlrev_b32 v226, 16, v81
    v_and_b32 v227, s41, v81
    v_lshlrev_b32 v220, 16, v76
    v_and_b32 v221, s41, v76
    v_lshlrev_b32 v222, 16, v77
    v_and_b32 v223, s41, v77
    v_lshlrev_b32 v216, 16, v72
    v_and_b32 v217, s41, v72
    v_lshlrev_b32 v218, 16, v73
    v_and_b32 v219, s41, v73
    v_lshlrev_b32 v212, 16, v68
    v_and_b32 v213, s41, v68
    v_lshlrev_b32 v214, 16, v69
    v_and_b32 v215, s41, v69
    v_lshlrev_b32 v208, 16, v64
    v_and_b32 v209, s41, v64
    v_lshlrev_b32 v210, 16, v65
    v_and_b32 v211, s41, v65
    v_lshlrev_b32 v204, 16, v60
    v_and_b32 v205, s41, v60
    v_lshlrev_b32 v206, 16, v61
    v_and_b32 v207, s41, v61
    v_lshlrev_b32 v200, 16, v56
    v_and_b32 v201, s41, v56
    v_lshlrev_b32 v202, 16, v57
    v_and_b32 v203, s41, v57
    v_lshlrev_b32 v196, 16, v52
    v_and_b32 v197, s41, v52
    v_lshlrev_b32 v198, 16, v53
    v_and_b32 v199, s41, v53
    v_lshlrev_b32 v192, 16, v48
    v_and_b32 v193, s41, v48
    v_lshlrev_b32 v194, 16, v49
    v_and_b32 v195, s41, v49
    v_lshlrev_b32 v188, 16, v44
    v_and_b32 v189, s41, v44
    v_lshlrev_b32 v190, 16, v45
    v_and_b32 v191, s41, v45
    v_lshlrev_b32 v184, 16, v40
    v_and_b32 v185, s41, v40
    v_lshlrev_b32 v186, 16, v41
    v_and_b32 v187, s41, v41
    v_lshlrev_b32 v180, 16, v36
    v_and_b32 v181, s41, v36
    v_lshlrev_b32 v182, 16, v37
    v_and_b32 v183, s41, v37
    v_lshlrev_b32 v176, 16, v32
    v_and_b32 v177, s41, v32
    v_lshlrev_b32 v178, 16, v33
    v_and_b32 v179, s41, v33
    v_lshlrev_b32 v172, 16, v28
    v_and_b32 v173, s41, v28
    v_lshlrev_b32 v174, 16, v29
    v_and_b32 v175, s41, v29
    v_lshlrev_b32 v168, 16, v24
    v_and_b32 v169, s41, v24
    v_lshlrev_b32 v170, 16, v25
    v_and_b32 v171, s41, v25
    v_lshlrev_b32 v164, 16, v20
    v_and_b32 v165, s41, v20
    v_lshlrev_b32 v166, 16, v21
    v_and_b32 v167, s41, v21
    v_lshlrev_b32 v160, 16, v16
    v_and_b32 v161, s41, v16
    v_lshlrev_b32 v162, 16, v17
    v_and_b32 v163, s41, v17
    s_lshl_b32 s30, s4, 8
    s_add_u32 s30, s30, s44
    v_lshl_add_u32 v11, v2, 4, s30
    v_lshl_add_u32 v11, v3, 10, v11
    s_lshl_b32 s30, s7, 7
    s_add_u32 s30, s30, 49152
    s_mov_b64 exec, 0
    s_cmp_lt_u32 s4, 2
    s_cbranch_scc1 Li40
    s_cmp_eq_u32 s4, 2
    s_cbranch_scc1 Li41
    s_call_b64 s[70:71], Lpad53076_3
    s_branch Li43
Li41:
    s_call_b64 s[70:71], Lpad53076_2
    s_branch Li43
Li40:
    s_cmp_eq_u32 s4, 0
    s_cbranch_scc1 Li42
    s_call_b64 s[70:71], Lpad53076_1
    s_branch Li43
Li42:
    s_call_b64 s[70:71], Lpad53076_0
Li43:
    s_mov_b64 exec, -1
    s_waitcnt vmcnt(0)
    s_atomic_add s36, s[68:69], s30
    ds_read_b64_tr_b16 a[208:209], v248 offset:36864
    ds_read_b64_tr_b16 a[210:211], v248 offset:37376
    ds_read_b64_tr_b16 a[212:213], v249 offset:36864
    ds_read_b64_tr_b16 a[214:215], v249 offset:37376
    ds_read_b64_tr_b16 a[216:217], v250 offset:36864
    ds_read_b64_tr_b16 a[218:219], v250 offset:37376
    ds_read_b64_tr_b16 a[220:221], v251 offset:36864
    ds_read_b64_tr_b16 a[222:223], v251 offset:37376
    ds_read_b64_tr_b16 a[224:225], v248 offset:53248
    ds_read_b64_tr_b16 a[226:227], v248 offset:53760
    ds_read_b64_tr_b16 a[228:229], v249 offset:53248
    ds_read_b64_tr_b16 a[230:231], v249 offset:53760
    ds_read_b64_tr_b16 a[232:233], v250 offset:53248
    ds_read_b64_tr_b16 a[234:235], v250 offset:53760
    ds_read_b64_tr_b16 a[236:237], v251 offset:53248
    ds_read_b64_tr_b16 a[238:239], v251 offset:53760
    v_add_u32 v248, 147456, v248
    v_add_u32 v249, 147456, v249
    v_add_u32 v250, 147456, v250
    v_add_u32 v251, 147456, v251
    ds_read_b64_tr_b16 a[240:241], v248 offset:0
    ds_read_b64_tr_b16 a[242:243], v248 offset:512
    ds_read_b64_tr_b16 a[244:245], v249 offset:0
    ds_read_b64_tr_b16 a[246:247], v249 offset:512
    ds_read_b64_tr_b16 a[248:249], v250 offset:0
    ds_read_b64_tr_b16 a[250:251], v250 offset:512
    ds_read_b64_tr_b16 a[252:253], v251 offset:0
    ds_read_b64_tr_b16 a[254:255], v251 offset:512
    s_mov_b32 s31, 0
    s_atomic_add s31, s[68:69], s30 glc
    s_waitcnt lgkmcnt(0)
    s_add_u32 s31, s31, 1
    s_andn2_b32 s31, 4, s31
    s_cbranch_scc0 Lb45
Ls44:
    s_sub_u32 s26, s26, 1
    s_cselect_b32 s26, 0, s26
    s_cbranch_scc1 Lb45
    s_mov_b32 s31, 0
    s_atomic_add s31, s[68:69], s30 glc
    s_waitcnt lgkmcnt(0)
    s_add_u32 s31, s31, 1
    s_andn2_b32 s31, 4, s31
    s_cbranch_scc1 Ls44
Lb45:
    s_lshl_b32 s25, s98, 14
    s_add_u32 s25, s25, 2621440
    buffer_load_dwordx4 v[88:91], v11, s[16:19], s25 offen sc1
    s_add_u32 s25, s25, 4096
    buffer_load_dwordx4 v[92:95], v11, s[16:19], s25 offen sc1
    s_add_u32 s25, s25, 4096
    buffer_load_dwordx4 v[96:99], v11, s[16:19], s25 offen sc1
    s_add_u32 s25, s25, 4096
    buffer_load_dwordx4 v[100:103], v11, s[16:19], s25 offen sc1
    s_lshl_b32 s25, s99, 14
    s_add_u32 s25, s25, 2621440
    buffer_load_dwordx4 v[104:107], v11, s[16:19], s25 offen sc1
    s_add_u32 s25, s25, 4096
    buffer_load_dwordx4 v[108:111], v11, s[16:19], s25 offen sc1
    s_add_u32 s25, s25, 4096
    buffer_load_dwordx4 v[112:115], v11, s[16:19], s25 offen sc1
    s_add_u32 s25, s25, 4096
    buffer_load_dwordx4 v[116:119], v11, s[16:19], s25 offen sc1
    s_lshl_b32 s25, s100, 14
    s_add_u32 s25, s25, 2621440
    buffer_load_dwordx4 v[120:123], v11, s[16:19], s25 offen sc1
    s_add_u32 s25, s25, 4096
    buffer_load_dwordx4 v[124:127], v11, s[16:19], s25 offen sc1
    v_lshlrev_b32 v4, 4, v1
    v_mov_b32 v232, 0
    v_mov_b32 v233, 0
    v_mov_b32 v234, 0
    v_mov_b32 v235, 0
    s_mov_b32 s22, 2359296
    s_mov_b32 s23, 0x20000
    s_load_dwordx2 s[20:21], s[0:1], 64
    s_mov_b32 s27, 0
    s_mov_b32 s28, 0x17654321
    s_mov_b32 s29, 0x765432
    s_lshr_b64 s[28:29], s[28:29], s27
    s_mov_b32 s2, s28
    s_barrier
    s_lshl_b32 s27, s4, 7
    s_add_u32 s27, s27, 159744
    v_lshl_add_u32 v9, v2, 3, s27
    ds_write_b64 v9, v[14:15]
    s_lshl_b32 s31, s5, 3
    s_add_u32 s31, s31, s4
    s_lshl_b32 s31, s31, 7
    s_add_u32 s31, s31, 81920
    s_waitcnt vmcnt(9)
    v_dot2c_f32_bf16 v160, s38, v88
    v_dot2c_f32_bf16 v161, s39, v88
    v_dot2c_f32_bf16 v162, s38, v89
    v_dot2c_f32_bf16 v163, s39, v89
    v_lshlrev_b32 v16, 16, v18
    v_and_b32 v17, s41, v18
    v_dot2c_f32_bf16 v16, s38, v90
    v_dot2c_f32_bf16 v17, s39, v90
    v_lshlrev_b32 v88, 16, v19
    v_and_b32_e64 v89, s41, v19
    v_dot2c_f32_bf16 v88, s38, v91
    v_dot2c_f32_bf16 v89, s39, v91
    v_pk_add_f32 v[232:233], v[232:233], v[160:161]
    v_pk_fma_f32 v[234:235], v[160:161], v[160:161], v[234:235]
    v_pk_add_f32 v[232:233], v[232:233], v[162:163]
    v_pk_fma_f32 v[234:235], v[162:163], v[162:163], v[234:235]
    v_pk_add_f32 v[232:233], v[232:233], v[16:17]
    v_pk_fma_f32 v[234:235], v[16:17], v[16:17], v[234:235]
    v_pk_add_f32 v[232:233], v[232:233], v[88:89]
    v_pk_fma_f32 v[234:235], v[88:89], v[88:89], v[234:235]
    s_add_u32 s25, s25, 4096
    buffer_load_dwordx4 v[128:131], v11, s[16:19], s25 offen sc1
    s_waitcnt vmcnt(9)
    v_dot2c_f32_bf16 v164, s38, v92
    v_dot2c_f32_bf16 v165, s39, v92
    v_dot2c_f32_bf16 v166, s38, v93
    v_dot2c_f32_bf16 v167, s39, v93
    v_lshlrev_b32 v20, 16, v22
    v_and_b32 v21, s41, v22
    v_dot2c_f32_bf16 v20, s38, v94
    v_dot2c_f32_bf16 v21, s39, v94
    v_lshlrev_b32 v92, 16, v23
    v_and_b32 v93, s41, v23
    v_dot2c_f32_bf16 v92, s38, v95
    v_dot2c_f32_bf16 v93, s39, v95
    v_pk_add_f32 v[232:233], v[232:233], v[164:165]
    v_pk_fma_f32 v[234:235], v[164:165], v[164:165], v[234:235]
    v_pk_add_f32 v[232:233], v[232:233], v[166:167]
    v_pk_fma_f32 v[234:235], v[166:167], v[166:167], v[234:235]
    v_pk_add_f32 v[232:233], v[232:233], v[20:21]
    v_pk_fma_f32 v[234:235], v[20:21], v[20:21], v[234:235]
    v_pk_add_f32 v[232:233], v[232:233], v[92:93]
    v_pk_fma_f32 v[234:235], v[92:93], v[92:93], v[234:235]
    s_add_u32 s25, s25, 4096
    buffer_load_dwordx4 v[132:135], v11, s[16:19], s25 offen sc1
    s_waitcnt vmcnt(9)
    v_dot2c_f32_bf16 v168, s38, v96
    v_dot2c_f32_bf16 v169, s39, v96
    v_dot2c_f32_bf16 v170, s38, v97
    v_dot2c_f32_bf16 v171, s39, v97
    v_lshlrev_b32 v24, 16, v26
    v_and_b32 v25, s41, v26
    v_dot2c_f32_bf16 v24, s38, v98
    v_dot2c_f32_bf16 v25, s39, v98
    v_lshlrev_b32 v96, 16, v27
    v_and_b32 v97, s41, v27
    v_dot2c_f32_bf16 v96, s38, v99
    v_dot2c_f32_bf16 v97, s39, v99
    v_pk_add_f32 v[232:233], v[232:233], v[168:169]
    v_pk_fma_f32 v[234:235], v[168:169], v[168:169], v[234:235]
    v_pk_add_f32 v[232:233], v[232:233], v[170:171]
    v_pk_fma_f32 v[234:235], v[170:171], v[170:171], v[234:235]
    v_pk_add_f32 v[232:233], v[232:233], v[24:25]
    v_pk_fma_f32 v[234:235], v[24:25], v[24:25], v[234:235]
    v_pk_add_f32 v[232:233], v[232:233], v[96:97]
    v_pk_fma_f32 v[234:235], v[96:97], v[96:97], v[234:235]
    s_lshl_b32 s25, s101, 14
    s_add_u32 s25, s25, 2621440
    buffer_load_dwordx4 v[136:139], v11, s[16:19], s25 offen sc1
    s_waitcnt vmcnt(9)
Lpad29908_4:
    s_cbranch_execz Lpadret
    v_dot2c_f32_bf16 v172, s38, v100
    v_dot2c_f32_bf16 v173, s39, v100
    v_dot2c_f32_bf16 v174, s38, v101
    v_dot2c_f32_bf16 v175, s39, v101
    v_lshlrev_b32 v28, 16, v30
    v_and_b32 v29, s41, v30
    v_dot2c_f32_bf16 v28, s38, v102
    v_dot2c_f32_bf16 v29, s39, v102
    v_lshlrev_b32 v100, 16, v31
    v_and_b32_e64 v101, s41, v31
    v_dot2c_f32_bf16 v100, s38, v103
    v_dot2c_f32_bf16 v101, s39, v103
    v_pk_add_f32 v[232:233], v[232:233], v[172:173]
    v_pk_fma_f32 v[234:235], v[172:173], v[172:173], v[234:235]
    v_pk_add_f32 v[232:233], v[232:233], v[174:175]
    v_pk_fma_f32 v[234:235], v[174:175], v[174:175], v[234:235]
    v_pk_add_f32 v[232:233], v[232:233], v[28:29]
    v_pk_fma_f32 v[234:235], v[28:29], v[28:29], v[234:235]
    v_pk_add_f32 v[232:233], v[232:233], v[100:101]
    v_pk_fma_f32 v[234:235], v[100:101], v[100:101], v[234:235]
    s_add_u32 s25, s25, 4096
    buffer_load_dwordx4 v[140:143], v11, s[16:19], s25 offen sc1
    s_waitcnt vmcnt(9)
    v_dot2c_f32_bf16 v176, s38, v104
    v_dot2c_f32_bf16 v177, s39, v104
    v_dot2c_f32_bf16 v178, s38, v105
    v_dot2c_f32_bf16 v179, s39, v105
    v_lshlrev_b32 v32, 16, v34
    v_and_b32 v33, s41, v34
    v_dot2c_f32_bf16 v32, s38, v106
    v_dot2c_f32_bf16 v33, s39, v106
    v_lshlrev_b32 v104, 16, v35
    v_and_b32_e64 v105, s41, v35
    v_dot2c_f32_bf16 v104, s38, v107
    v_dot2c_f32_bf16 v105, s39, v107
    v_pk_add_f32 v[232:233], v[232:233], v[176:177]
    v_pk_fma_f32 v[234:235], v[176:177], v[176:177], v[234:235]
    v_pk_add_f32 v[232:233], v[232:233], v[178:179]
    v_pk_fma_f32 v[234:235], v[178:179], v[178:179], v[234:235]
    v_pk_add_f32 v[232:233], v[232:233], v[32:33]
    v_pk_fma_f32 v[234:235], v[32:33], v[32:33], v[234:235]
    v_pk_add_f32 v[232:233], v[232:233], v[104:105]
    v_pk_fma_f32 v[234:235], v[104:105], v[104:105], v[234:235]
    s_add_u32 s25, s25, 4096
    buffer_load_dwordx4 v[144:147], v11, s[16:19], s25 offen sc1
    s_waitcnt vmcnt(9)
    v_dot2c_f32_bf16 v180, s38, v108
    v_dot2c_f32_bf16 v181, s39, v108
    v_dot2c_f32_bf16 v182, s38, v109
    v_dot2c_f32_bf16 v183, s39, v109
    v_lshlrev_b32 v36, 16, v38
    v_and_b32 v37, s41, v38
    v_dot2c_f32_bf16 v36, s38, v110
    v_dot2c_f32_bf16 v37, s39, v110
    v_lshlrev_b32 v108, 16, v39
    v_and_b32 v109, s41, v39
    v_dot2c_f32_bf16 v108, s38, v111
    v_dot2c_f32_bf16 v109, s39, v111
    v_pk_add_f32 v[232:233], v[232:233], v[180:181]
    v_pk_fma_f32 v[234:235], v[180:181], v[180:181], v[234:235]
    v_pk_add_f32 v[232:233], v[232:233], v[182:183]
    v_pk_fma_f32 v[234:235], v[182:183], v[182:183], v[234:235]
    v_pk_add_f32 v[232:233], v[232:233], v[36:37]
    v_pk_fma_f32 v[234:235], v[36:37], v[36:37], v[234:235]
    v_pk_add_f32 v[232:233], v[232:233], v[108:109]
    v_pk_fma_f32 v[234:235], v[108:109], v[108:109], v[234:235]
    s_add_u32 s25, s25, 4096
    buffer_load_dwordx4 v[148:151], v11, s[16:19], s25 offen sc1
    s_waitcnt vmcnt(9)
    v_dot2c_f32_bf16 v184, s38, v112
    v_dot2c_f32_bf16 v185, s39, v112
    v_dot2c_f32_bf16 v186, s38, v113
    v_dot2c_f32_bf16 v187, s39, v113
    v_lshlrev_b32 v40, 16, v42
    v_and_b32 v41, s41, v42
    v_dot2c_f32_bf16 v40, s38, v114
    v_dot2c_f32_bf16 v41, s39, v114
    v_lshlrev_b32 v112, 16, v43
    v_and_b32 v113, s41, v43
    v_dot2c_f32_bf16 v112, s38, v115
    v_dot2c_f32_bf16 v113, s39, v115
    v_pk_add_f32 v[232:233], v[232:233], v[184:185]
    v_pk_fma_f32 v[234:235], v[184:185], v[184:185], v[234:235]
    v_pk_add_f32 v[232:233], v[232:233], v[186:187]
    v_pk_fma_f32 v[234:235], v[186:187], v[186:187], v[234:235]
    v_pk_add_f32 v[232:233], v[232:233], v[40:41]
    v_pk_fma_f32 v[234:235], v[40:41], v[40:41], v[234:235]
    v_pk_add_f32 v[232:233], v[232:233], v[112:113]
    v_pk_fma_f32 v[234:235], v[112:113], v[112:113], v[234:235]
    s_mov_b32 s25, 2686976
    buffer_load_dwordx4 v[152:155], v11, s[16:19], s25 offen sc1
    s_waitcnt vmcnt(9)
    v_dot2c_f32_bf16 v188, s38, v116
    v_dot2c_f32_bf16 v189, s39, v116
    v_dot2c_f32_bf16 v190, s38, v117
    v_dot2c_f32_bf16 v191, s39, v117
    v_lshlrev_b32 v44, 16, v46
    v_and_b32 v45, s41, v46
    v_dot2c_f32_bf16 v44, s38, v118
    v_dot2c_f32_bf16 v45, s39, v118
    v_lshlrev_b32 v116, 16, v47
    v_and_b32_e64 v117, s41, v47
    v_dot2c_f32_bf16 v116, s38, v119
    v_dot2c_f32_bf16 v117, s39, v119
    v_pk_add_f32 v[232:233], v[232:233], v[188:189]
    v_pk_fma_f32 v[234:235], v[188:189], v[188:189], v[234:235]
    v_pk_add_f32 v[232:233], v[232:233], v[190:191]
    v_pk_fma_f32 v[234:235], v[190:191], v[190:191], v[234:235]
    v_pk_add_f32 v[232:233], v[232:233], v[44:45]
    v_pk_fma_f32 v[234:235], v[44:45], v[44:45], v[234:235]
    v_pk_add_f32 v[232:233], v[232:233], v[116:117]
    v_pk_fma_f32 v[234:235], v[116:117], v[116:117], v[234:235]
    s_add_u32 s25, s25, 4096
    buffer_load_dwordx4 v[156:159], v11, s[16:19], s25 offen sc1
    s_waitcnt vmcnt(9)
    v_dot2c_f32_bf16 v192, s38, v120
    v_dot2c_f32_bf16 v193, s39, v120
    v_dot2c_f32_bf16 v194, s38, v121
    v_dot2c_f32_bf16 v195, s39, v121
    v_lshlrev_b32 v48, 16, v50
    v_and_b32 v49, s41, v50
    v_dot2c_f32_bf16 v48, s38, v122
    v_dot2c_f32_bf16 v49, s39, v122
    v_lshlrev_b32 v120, 16, v51
    v_and_b32_e64 v121, s41, v51
    v_dot2c_f32_bf16 v120, s38, v123
    v_dot2c_f32_bf16 v121, s39, v123
    v_pk_add_f32 v[232:233], v[232:233], v[192:193]
    v_pk_fma_f32 v[234:235], v[192:193], v[192:193], v[234:235]
    v_pk_add_f32 v[232:233], v[232:233], v[194:195]
    v_pk_fma_f32 v[234:235], v[194:195], v[194:195], v[234:235]
    v_pk_add_f32 v[232:233], v[232:233], v[48:49]
    v_pk_fma_f32 v[234:235], v[48:49], v[48:49], v[234:235]
    v_pk_add_f32 v[232:233], v[232:233], v[120:121]
    v_pk_fma_f32 v[234:235], v[120:121], v[120:121], v[234:235]
    s_waitcnt vmcnt(8)
    v_dot2c_f32_bf16 v196, s38, v124
    v_dot2c_f32_bf16 v197, s39, v124
    v_dot2c_f32_bf16 v198, s38, v125
    v_dot2c_f32_bf16 v199, s39, v125
    v_lshlrev_b32 v52, 16, v54
    v_and_b32 v53, s41, v54
    v_dot2c_f32_bf16 v52, s38, v126
    v_dot2c_f32_bf16 v53, s39, v126
    v_lshlrev_b32 v124, 16, v55
    v_and_b32_e64 v125, s41, v55
    v_dot2c_f32_bf16 v124, s38, v127
    v_dot2c_f32_bf16 v125, s39, v127
    v_pk_add_f32 v[232:233], v[232:233], v[196:197]
    v_pk_fma_f32 v[234:235], v[196:197], v[196:197], v[234:235]
    v_pk_add_f32 v[232:233], v[232:233], v[198:199]
    v_pk_fma_f32 v[234:235], v[198:199], v[198:199], v[234:235]
    v_pk_add_f32 v[232:233], v[232:233], v[52:53]
    v_pk_fma_f32 v[234:235], v[52:53], v[52:53], v[234:235]
    v_pk_add_f32 v[232:233], v[232:233], v[124:125]
    v_pk_fma_f32 v[234:235], v[124:125], v[124:125], v[234:235]
    buffer_store_dwordx4 a[208:211], v4, s[16:19], s65 offen sc1
    s_waitcnt vmcnt(8)
    v_dot2c_f32_bf16 v200, s38, v128
    v_dot2c_f32_bf16 v201, s39, v128
    v_dot2c_f32_bf16 v202, s38, v129
    v_dot2c_f32_bf16 v203, s39, v129
    v_lshlrev_b32 v56, 16, v58
    v_and_b32 v57, s41, v58
    v_dot2c_f32_bf16 v56, s38, v130
    v_dot2c_f32_bf16 v57, s39, v130
    v_lshlrev_b32 v128, 16, v59
    v_and_b32_e64 v129, s41, v59
    v_dot2c_f32_bf16 v128, s38, v131
    v_dot2c_f32_bf16 v129, s39, v131
    v_pk_add_f32 v[232:233], v[232:233], v[200:201]
    v_pk_fma_f32 v[234:235], v[200:201], v[200:201], v[234:235]
    v_pk_add_f32 v[232:233], v[232:233], v[202:203]
    v_pk_fma_f32 v[234:235], v[202:203], v[202:203], v[234:235]
    v_pk_add_f32 v[232:233], v[232:233], v[56:57]
    v_pk_fma_f32 v[234:235], v[56:57], v[56:57], v[234:235]
    v_pk_add_f32 v[232:233], v[232:233], v[128:129]
    v_pk_fma_f32 v[234:235], v[128:129], v[128:129], v[234:235]
    s_waitcnt vmcnt(7)
    v_dot2c_f32_bf16 v204, s38, v132
    v_dot2c_f32_bf16 v205, s39, v132
    v_dot2c_f32_bf16 v206, s38, v133
    v_dot2c_f32_bf16 v207, s39, v133
    v_lshlrev_b32 v60, 16, v62
    v_and_b32 v61, s41, v62
    v_dot2c_f32_bf16 v60, s38, v134
    v_dot2c_f32_bf16 v61, s39, v134
    v_lshlrev_b32 v132, 16, v63
    v_and_b32 v133, s41, v63
    v_dot2c_f32_bf16 v132, s38, v135
    v_dot2c_f32_bf16 v133, s39, v135
    v_pk_add_f32 v[232:233], v[232:233], v[204:205]
    v_pk_fma_f32 v[234:235], v[204:205], v[204:205], v[234:235]
    v_pk_add_f32 v[232:233], v[232:233], v[206:207]
    v_pk_fma_f32 v[234:235], v[206:207], v[206:207], v[234:235]
    v_pk_add_f32 v[232:233], v[232:233], v[60:61]
    v_pk_fma_f32 v[234:235], v[60:61], v[60:61], v[234:235]
    v_pk_add_f32 v[232:233], v[232:233], v[132:133]
    v_pk_fma_f32 v[234:235], v[132:133], v[132:133], v[234:235]
    s_add_u32 s65, s65, 21504
    buffer_store_dwordx4 a[212:215], v4, s[16:19], s65 offen sc1
    s_waitcnt vmcnt(7)
    v_dot2c_f32_bf16 v208, s38, v136
    v_dot2c_f32_bf16 v209, s39, v136
    v_dot2c_f32_bf16 v210, s38, v137
    v_dot2c_f32_bf16 v211, s39, v137
    v_lshlrev_b32 v64, 16, v66
    v_and_b32 v65, s41, v66
    v_dot2c_f32_bf16 v64, s38, v138
    v_dot2c_f32_bf16 v65, s39, v138
    v_lshlrev_b32 v136, 16, v67
    v_and_b32 v137, s41, v67
    v_dot2c_f32_bf16 v136, s38, v139
    v_dot2c_f32_bf16 v137, s39, v139
    v_pk_add_f32 v[232:233], v[232:233], v[208:209]
    v_pk_fma_f32 v[234:235], v[208:209], v[208:209], v[234:235]
    v_pk_add_f32 v[232:233], v[232:233], v[210:211]
    v_pk_fma_f32 v[234:235], v[210:211], v[210:211], v[234:235]
    v_pk_add_f32 v[232:233], v[232:233], v[64:65]
    v_pk_fma_f32 v[234:235], v[64:65], v[64:65], v[234:235]
    v_pk_add_f32 v[232:233], v[232:233], v[136:137]
    v_pk_fma_f32 v[234:235], v[136:137], v[136:137], v[234:235]
    s_waitcnt vmcnt(6)
    v_dot2c_f32_bf16 v212, s38, v140
    v_dot2c_f32_bf16 v213, s39, v140
    v_dot2c_f32_bf16 v214, s38, v141
    v_dot2c_f32_bf16 v215, s39, v141
    v_lshlrev_b32 v68, 16, v70
    v_and_b32 v69, s41, v70
    v_dot2c_f32_bf16 v68, s38, v142
    v_dot2c_f32_bf16 v69, s39, v142
    v_lshlrev_b32 v140, 16, v71
    v_and_b32_e64 v141, s41, v71
    v_dot2c_f32_bf16 v140, s38, v143
    v_dot2c_f32_bf16 v141, s39, v143
    v_pk_add_f32 v[232:233], v[232:233], v[212:213]
    v_pk_fma_f32 v[234:235], v[212:213], v[212:213], v[234:235]
    v_pk_add_f32 v[232:233], v[232:233], v[214:215]
    v_pk_fma_f32 v[234:235], v[214:215], v[214:215], v[234:235]
    v_pk_add_f32 v[232:233], v[232:233], v[68:69]
    v_pk_fma_f32 v[234:235], v[68:69], v[68:69], v[234:235]
    v_pk_add_f32 v[232:233], v[232:233], v[140:141]
    v_pk_fma_f32 v[234:235], v[140:141], v[140:141], v[234:235]
    s_add_u32 s65, s65, 21504
    buffer_store_dwordx4 a[216:219], v4, s[16:19], s65 offen sc1
    s_waitcnt vmcnt(6)
    v_dot2c_f32_bf16 v216, s38, v144
    v_dot2c_f32_bf16 v217, s39, v144
    v_dot2c_f32_bf16 v218, s38, v145
    v_dot2c_f32_bf16 v219, s39, v145
    v_lshlrev_b32 v72, 16, v74
    v_and_b32 v73, s41, v74
    v_dot2c_f32_bf16 v72, s38, v146
    v_dot2c_f32_bf16 v73, s39, v146
    v_lshlrev_b32 v144, 16, v75
    v_and_b32 v145, s41, v75
    v_dot2c_f32_bf16 v144, s38, v147
    v_dot2c_f32_bf16 v145, s39, v147
    v_pk_add_f32 v[232:233], v[232:233], v[216:217]
    v_pk_fma_f32 v[234:235], v[216:217], v[216:217], v[234:235]
    v_pk_add_f32 v[232:233], v[232:233], v[218:219]
    v_pk_fma_f32 v[234:235], v[218:219], v[218:219], v[234:235]
    v_pk_add_f32 v[232:233], v[232:233], v[72:73]
    v_pk_fma_f32 v[234:235], v[72:73], v[72:73], v[234:235]
    v_pk_add_f32 v[232:233], v[232:233], v[144:145]
    v_pk_fma_f32 v[234:235], v[144:145], v[144:145], v[234:235]
    s_waitcnt vmcnt(5)
    v_dot2c_f32_bf16 v220, s38, v148
    v_dot2c_f32_bf16 v221, s39, v148
    v_dot2c_f32_bf16 v222, s38, v149
    v_dot2c_f32_bf16 v223, s39, v149
    v_lshlrev_b32 v76, 16, v78
    v_and_b32 v77, s41, v78
    v_dot2c_f32_bf16 v76, s38, v150
    v_dot2c_f32_bf16 v77, s39, v150
    v_lshlrev_b32 v148, 16, v79
    v_and_b32 v149, s41, v79
    v_dot2c_f32_bf16 v148, s38, v151
    v_dot2c_f32_bf16 v149, s39, v151
    v_pk_add_f32 v[232:233], v[232:233], v[220:221]
    v_pk_fma_f32 v[234:235], v[220:221], v[220:221], v[234:235]
    v_pk_add_f32 v[232:233], v[232:233], v[222:223]
    v_pk_fma_f32 v[234:235], v[222:223], v[222:223], v[234:235]
    v_pk_add_f32 v[232:233], v[232:233], v[76:77]
    v_pk_fma_f32 v[234:235], v[76:77], v[76:77], v[234:235]
    v_pk_add_f32 v[232:233], v[232:233], v[148:149]
    v_pk_fma_f32 v[234:235], v[148:149], v[148:149], v[234:235]
    s_add_u32 s65, s65, 21504
    buffer_store_dwordx4 a[220:223], v4, s[16:19], s65 offen sc1
    s_waitcnt vmcnt(5)
    v_dot2c_f32_bf16 v224, s38, v152
    v_dot2c_f32_bf16 v225, s39, v152
    v_dot2c_f32_bf16 v226, s38, v153
    v_dot2c_f32_bf16 v227, s39, v153
    v_lshlrev_b32 v80, 16, v82
    v_and_b32 v81, s41, v82
    v_dot2c_f32_bf16 v80, s38, v154
    v_dot2c_f32_bf16 v81, s39, v154
    v_lshlrev_b32 v152, 16, v83
    v_and_b32_e64 v153, s41, v83
    v_dot2c_f32_bf16 v152, s38, v155
    v_dot2c_f32_bf16 v153, s39, v155
    v_pk_add_f32 v[232:233], v[232:233], v[224:225]
    v_pk_fma_f32 v[234:235], v[224:225], v[224:225], v[234:235]
    v_pk_add_f32 v[232:233], v[232:233], v[226:227]
    v_pk_fma_f32 v[234:235], v[226:227], v[226:227], v[234:235]
    v_pk_add_f32 v[232:233], v[232:233], v[80:81]
    v_pk_fma_f32 v[234:235], v[80:81], v[80:81], v[234:235]
    v_pk_add_f32 v[232:233], v[232:233], v[152:153]
    v_pk_fma_f32 v[234:235], v[152:153], v[152:153], v[234:235]
    s_waitcnt vmcnt(4)
    v_dot2c_f32_bf16 v228, s38, v156
    v_dot2c_f32_bf16 v229, s39, v156
    v_dot2c_f32_bf16 v230, s38, v157
    v_dot2c_f32_bf16 v231, s39, v157
    v_lshlrev_b32 v84, 16, v86
    v_and_b32 v85, s41, v86
    v_dot2c_f32_bf16 v84, s38, v158
    v_dot2c_f32_bf16 v85, s39, v158
    v_lshlrev_b32 v156, 16, v87
    v_and_b32_e64 v157, s41, v87
    v_dot2c_f32_bf16 v156, s38, v159
    v_dot2c_f32_bf16 v157, s39, v159
    v_pk_add_f32 v[232:233], v[232:233], v[228:229]
    v_pk_fma_f32 v[234:235], v[228:229], v[228:229], v[234:235]
    v_pk_add_f32 v[232:233], v[232:233], v[230:231]
    v_pk_fma_f32 v[234:235], v[230:231], v[230:231], v[234:235]
    v_pk_add_f32 v[232:233], v[232:233], v[84:85]
    v_pk_fma_f32 v[234:235], v[84:85], v[84:85], v[234:235]
    v_pk_add_f32 v[232:233], v[232:233], v[156:157]
    v_pk_fma_f32 v[234:235], v[156:157], v[156:157], v[234:235]
    v_add_f32 v232, v232, v233
    v_add_f32 v234, v234, v235
    s_add_u32 s65, s65, 21504
    buffer_store_dwordx4 a[224:227], v4, s[16:19], s65 offen sc1
    v_mov_b32 v12, v232
    v_mov_b32 v13, v234
    s_nop 0
    v_permlane16_swap_b32 v12, v232
    v_permlane16_swap_b32 v13, v234
    v_add_f32 v232, v12, v232
    v_add_f32 v234, v13, v234
    v_mov_b32 v12, v232
    v_mov_b32 v13, v234
    s_nop 0
    v_permlane32_swap_b32 v12, v232
    v_permlane32_swap_b32 v13, v234
    v_add_f32 v232, v12, v232
    v_add_f32 v234, v13, v234
    v_mul_f32 v232, 0x3ae38e39, v232
    v_mul_f32 v234, 0x3ae38e39, v234
    v_fma_f32 v234, -v232, v232, v234
    v_max_f32 v234, 0, v234
    v_add_f32 v12, 0x3727c5ac, v234
    v_rsq_f32 v236, v12
    s_nop 0
    v_mul_f32 v237, -v232, v236
    v_mul_f32 v236, s34, v236
    v_mul_f32 v237, s34, v237
    s_lshl_b32 s27, s4, 10
    v_add_u32_e64 v9, s27, v4
    s_add_u32 s65, s65, 21504
    buffer_store_dwordx4 a[228:231], v4, s[16:19], s65 offen sc1
    v_lshl_add_u32 v10, s98, 14, v9
    v_pk_fma_f32 v[160:161], v[160:161], v[236:237], v[236:237] op_sel:[0,0,1] op_sel_hi:[1,0,1]
    v_pk_fma_f32 v[162:163], v[162:163], v[236:237], v[236:237] op_sel:[0,0,1] op_sel_hi:[1,0,1]
    v_pk_fma_f32 v[16:17], v[16:17], v[236:237], v[236:237] op_sel:[0,0,1] op_sel_hi:[1,0,1]
    v_pk_fma_f32 v[88:89], v[88:89], v[236:237], v[236:237] op_sel:[0,0,1] op_sel_hi:[1,0,1]
    v_cvt_pk_bf16_f32 v240, v160, v161
    v_cvt_pk_bf16_f32 v241, v162, v163
    v_cvt_pk_bf16_f32 v242, v16, v17
    v_cvt_pk_bf16_f32 v243, v88, v89
    ds_write_b128 v10, v[240:243] offset:0
    v_pk_fma_f32 v[164:165], v[164:165], v[236:237], v[236:237] op_sel:[0,0,1] op_sel_hi:[1,0,1]
    v_pk_fma_f32 v[166:167], v[166:167], v[236:237], v[236:237] op_sel:[0,0,1] op_sel_hi:[1,0,1]
    v_pk_fma_f32 v[20:21], v[20:21], v[236:237], v[236:237] op_sel:[0,0,1] op_sel_hi:[1,0,1]
    v_pk_fma_f32 v[92:93], v[92:93], v[236:237], v[236:237] op_sel:[0,0,1] op_sel_hi:[1,0,1]
    v_cvt_pk_bf16_f32 v244, v164, v165
    v_cvt_pk_bf16_f32 v245, v166, v167
    v_cvt_pk_bf16_f32 v246, v20, v21
    v_cvt_pk_bf16_f32 v247, v92, v93
    ds_write_b128 v10, v[244:247] offset:4096
    s_mov_b32 s53, 0
    s_atomic_add s53, s[68:69], s31 glc
    s_add_u32 s65, s65, 21504
    buffer_store_dwordx4 a[232:235], v4, s[16:19], s65 offen sc1
    v_pk_fma_f32 v[168:169], v[168:169], v[236:237], v[236:237] op_sel:[0,0,1] op_sel_hi:[1,0,1]
    v_pk_fma_f32 v[170:171], v[170:171], v[236:237], v[236:237] op_sel:[0,0,1] op_sel_hi:[1,0,1]
    v_pk_fma_f32 v[24:25], v[24:25], v[236:237], v[236:237] op_sel:[0,0,1] op_sel_hi:[1,0,1]
    v_pk_fma_f32 v[96:97], v[96:97], v[236:237], v[236:237] op_sel:[0,0,1] op_sel_hi:[1,0,1]
    v_cvt_pk_bf16_f32 v240, v168, v169
    v_cvt_pk_bf16_f32 v241, v170, v171
    v_cvt_pk_bf16_f32 v242, v24, v25
    v_cvt_pk_bf16_f32 v243, v96, v97
    ds_write_b128 v10, v[240:243] offset:8192
    v_pk_fma_f32 v[172:173], v[172:173], v[236:237], v[236:237] op_sel:[0,0,1] op_sel_hi:[1,0,1]
    v_pk_fma_f32 v[174:175], v[174:175], v[236:237], v[236:237] op_sel:[0,0,1] op_sel_hi:[1,0,1]
    v_pk_fma_f32 v[28:29], v[28:29], v[236:237], v[236:237] op_sel:[0,0,1] op_sel_hi:[1,0,1]
    v_pk_fma_f32 v[100:101], v[100:101], v[236:237], v[236:237] op_sel:[0,0,1] op_sel_hi:[1,0,1]
    v_cvt_pk_bf16_f32 v244, v172, v173
    v_cvt_pk_bf16_f32 v245, v174, v175
    v_cvt_pk_bf16_f32 v246, v28, v29
    v_cvt_pk_bf16_f32 v247, v100, v101
    ds_write_b128 v10, v[244:247] offset:12288
    s_add_u32 s65, s65, 21504
    buffer_store_dwordx4 a[236:239], v4, s[16:19], s65 offen sc1
    v_lshl_add_u32 v11, s99, 14, v9
    v_pk_fma_f32 v[176:177], v[176:177], v[236:237], v[236:237] op_sel:[0,0,1] op_sel_hi:[1,0,1]
    v_pk_fma_f32 v[178:179], v[178:179], v[236:237], v[236:237] op_sel:[0,0,1] op_sel_hi:[1,0,1]
    v_pk_fma_f32 v[32:33], v[32:33], v[236:237], v[236:237] op_sel:[0,0,1] op_sel_hi:[1,0,1]
    v_pk_fma_f32 v[104:105], v[104:105], v[236:237], v[236:237] op_sel:[0,0,1] op_sel_hi:[1,0,1]
    v_cvt_pk_bf16_f32 v240, v176, v177
    v_cvt_pk_bf16_f32 v241, v178, v179
    v_cvt_pk_bf16_f32 v242, v32, v33
    v_cvt_pk_bf16_f32 v243, v104, v105
    ds_write_b128 v11, v[240:243] offset:0
    v_pk_fma_f32 v[180:181], v[180:181], v[236:237], v[236:237] op_sel:[0,0,1] op_sel_hi:[1,0,1]
    v_pk_fma_f32 v[182:183], v[182:183], v[236:237], v[236:237] op_sel:[0,0,1] op_sel_hi:[1,0,1]
    v_pk_fma_f32 v[36:37], v[36:37], v[236:237], v[236:237] op_sel:[0,0,1] op_sel_hi:[1,0,1]
    v_pk_fma_f32 v[108:109], v[108:109], v[236:237], v[236:237] op_sel:[0,0,1] op_sel_hi:[1,0,1]
    v_cvt_pk_bf16_f32 v244, v180, v181
    v_cvt_pk_bf16_f32 v245, v182, v183
    v_cvt_pk_bf16_f32 v246, v36, v37
    v_cvt_pk_bf16_f32 v247, v108, v109
    ds_write_b128 v11, v[244:247] offset:4096
    s_add_u32 s65, s65, 21504
    buffer_store_dwordx4 a[240:243], v4, s[16:19], s65 offen sc1
    v_pk_fma_f32 v[184:185], v[184:185], v[236:237], v[236:237] op_sel:[0,0,1] op_sel_hi:[1,0,1]
    v_pk_fma_f32 v[186:187], v[186:187], v[236:237], v[236:237] op_sel:[0,0,1] op_sel_hi:[1,0,1]
    v_pk_fma_f32 v[40:41], v[40:41], v[236:237], v[236:237] op_sel:[0,0,1] op_sel_hi:[1,0,1]
    v_pk_fma_f32 v[112:113], v[112:113], v[236:237], v[236:237] op_sel:[0,0,1] op_sel_hi:[1,0,1]
    v_cvt_pk_bf16_f32 v240, v184, v185
    v_cvt_pk_bf16_f32 v241, v186, v187
    v_cvt_pk_bf16_f32 v242, v40, v41
    v_cvt_pk_bf16_f32 v243, v112, v113
    ds_write_b128 v11, v[240:243] offset:8192
    v_pk_fma_f32 v[188:189], v[188:189], v[236:237], v[236:237] op_sel:[0,0,1] op_sel_hi:[1,0,1]
    v_pk_fma_f32 v[190:191], v[190:191], v[236:237], v[236:237] op_sel:[0,0,1] op_sel_hi:[1,0,1]
    v_pk_fma_f32 v[44:45], v[44:45], v[236:237], v[236:237] op_sel:[0,0,1] op_sel_hi:[1,0,1]
    v_pk_fma_f32 v[116:117], v[116:117], v[236:237], v[236:237] op_sel:[0,0,1] op_sel_hi:[1,0,1]
    v_cvt_pk_bf16_f32 v244, v188, v189
    v_cvt_pk_bf16_f32 v245, v190, v191
    v_cvt_pk_bf16_f32 v246, v44, v45
    v_cvt_pk_bf16_f32 v247, v116, v117
    ds_write_b128 v11, v[244:247] offset:12288
    s_add_u32 s65, s65, 21504
    buffer_store_dwordx4 a[244:247], v4, s[16:19], s65 offen sc1
    v_lshl_add_u32 v10, s100, 14, v9
    v_pk_fma_f32 v[192:193], v[192:193], v[236:237], v[236:237] op_sel:[0,0,1] op_sel_hi:[1,0,1]
    v_pk_fma_f32 v[194:195], v[194:195], v[236:237], v[236:237] op_sel:[0,0,1] op_sel_hi:[1,0,1]
    v_pk_fma_f32 v[48:49], v[48:49], v[236:237], v[236:237] op_sel:[0,0,1] op_sel_hi:[1,0,1]
    v_pk_fma_f32 v[120:121], v[120:121], v[236:237], v[236:237] op_sel:[0,0,1] op_sel_hi:[1,0,1]
    v_cvt_pk_bf16_f32 v240, v192, v193
    v_cvt_pk_bf16_f32 v241, v194, v195
    v_cvt_pk_bf16_f32 v242, v48, v49
    v_cvt_pk_bf16_f32 v243, v120, v121
    ds_write_b128 v10, v[240:243] offset:0
    v_pk_fma_f32 v[196:197], v[196:197], v[236:237], v[236:237] op_sel:[0,0,1] op_sel_hi:[1,0,1]
    v_pk_fma_f32 v[198:199], v[198:199], v[236:237], v[236:237] op_sel:[0,0,1] op_sel_hi:[1,0,1]
    v_pk_fma_f32 v[52:53], v[52:53], v[236:237], v[236:237] op_sel:[0,0,1] op_sel_hi:[1,0,1]
    v_pk_fma_f32 v[124:125], v[124:125], v[236:237], v[236:237] op_sel:[0,0,1] op_sel_hi:[1,0,1]
    v_cvt_pk_bf16_f32 v244, v196, v197
    v_cvt_pk_bf16_f32 v245, v198, v199
    v_cvt_pk_bf16_f32 v246, v52, v53
    v_cvt_pk_bf16_f32 v247, v124, v125
    ds_write_b128 v10, v[244:247] offset:4096
    s_waitcnt lgkmcnt(0)
    s_add_u32 s53, s53, 1
    s_andn2_b32 s53, 64, s53
    s_cbranch_scc0 Lb47
Ls46:
    s_sub_u32 s26, s26, 1
    s_cselect_b32 s26, 0, s26
    s_cbranch_scc1 Lb47
    s_sleep 8
    s_mov_b32 s53, 0
    s_atomic_add s53, s[68:69], s31 glc
    s_waitcnt lgkmcnt(0)
    s_add_u32 s53, s53, 1
    s_andn2_b32 s53, 64, s53
    s_cbranch_scc1 Ls46
Lb47:
    s_add_u32 s65, s65, 21504
    buffer_store_dwordx4 a[248:251], v4, s[16:19], s65 offen sc1
    s_add_u32 s65, s65, 21504
    buffer_store_dwordx4 a[252:255], v4, s[16:19], s65 offen sc1
    s_lshl_b32 s55, s5, 2
    s_add_u32 s55, s55, s4
    s_mul_i32 s55, s55, 165888
    s_add_u32 s55, s55, 28049408
    s_mul_i32 s42, s98, 0
    s_add_u32 s42, s42, s55
    buffer_load_dwordx4 a[0:3], v4, s[16:19], s42 offen offset:0 sc1
    buffer_load_dwordx4 a[4:7], v4, s[16:19], s42 offen offset:1024 sc1
    v_pk_fma_f32 v[200:201], v[200:201], v[236:237], v[236:237] op_sel:[0,0,1] op_sel_hi:[1,0,1]
    v_pk_fma_f32 v[202:203], v[202:203], v[236:237], v[236:237] op_sel:[0,0,1] op_sel_hi:[1,0,1]
    v_pk_fma_f32 v[56:57], v[56:57], v[236:237], v[236:237] op_sel:[0,0,1] op_sel_hi:[1,0,1]
    v_pk_fma_f32 v[128:129], v[128:129], v[236:237], v[236:237] op_sel:[0,0,1] op_sel_hi:[1,0,1]
    v_cvt_pk_bf16_f32 v240, v200, v201
    v_cvt_pk_bf16_f32 v241, v202, v203
    v_cvt_pk_bf16_f32 v242, v56, v57
    v_cvt_pk_bf16_f32 v243, v128, v129
    ds_write_b128 v10, v[240:243] offset:8192
    buffer_load_dwordx4 a[8:11], v4, s[16:19], s42 offen offset:2048 sc1
    buffer_load_dwordx4 a[12:15], v4, s[16:19], s42 offen offset:3072 sc1
    v_pk_fma_f32 v[204:205], v[204:205], v[236:237], v[236:237] op_sel:[0,0,1] op_sel_hi:[1,0,1]
    v_pk_fma_f32 v[206:207], v[206:207], v[236:237], v[236:237] op_sel:[0,0,1] op_sel_hi:[1,0,1]
    v_pk_fma_f32 v[60:61], v[60:61], v[236:237], v[236:237] op_sel:[0,0,1] op_sel_hi:[1,0,1]
    v_pk_fma_f32 v[132:133], v[132:133], v[236:237], v[236:237] op_sel:[0,0,1] op_sel_hi:[1,0,1]
    v_cvt_pk_bf16_f32 v244, v204, v205
    v_cvt_pk_bf16_f32 v245, v206, v207
    v_cvt_pk_bf16_f32 v246, v60, v61
    v_cvt_pk_bf16_f32 v247, v132, v133
    ds_write_b128 v10, v[244:247] offset:12288
    s_add_u32 s42, s42, 4096
    buffer_load_dwordx4 a[16:19], v4, s[16:19], s42 offen offset:0 sc1
    buffer_load_dwordx4 a[20:23], v4, s[16:19], s42 offen offset:1024 sc1
    v_lshl_add_u32 v11, s101, 14, v9
    v_pk_fma_f32 v[208:209], v[208:209], v[236:237], v[236:237] op_sel:[0,0,1] op_sel_hi:[1,0,1]
    v_pk_fma_f32 v[210:211], v[210:211], v[236:237], v[236:237] op_sel:[0,0,1] op_sel_hi:[1,0,1]
    v_pk_fma_f32 v[64:65], v[64:65], v[236:237], v[236:237] op_sel:[0,0,1] op_sel_hi:[1,0,1]
    v_pk_fma_f32 v[136:137], v[136:137], v[236:237], v[236:237] op_sel:[0,0,1] op_sel_hi:[1,0,1]
    v_cvt_pk_bf16_f32 v240, v208, v209
    v_cvt_pk_bf16_f32 v241, v210, v211
    v_cvt_pk_bf16_f32 v242, v64, v65
    v_cvt_pk_bf16_f32 v243, v136, v137
    ds_write_b128 v11, v[240:243] offset:0
    buffer_load_dwordx4 a[24:27], v4, s[16:19], s42 offen offset:2048 sc1
    buffer_load_dwordx4 a[28:31], v4, s[16:19], s42 offen offset:3072 sc1
    v_pk_fma_f32 v[212:213], v[212:213], v[236:237], v[236:237] op_sel:[0,0,1] op_sel_hi:[1,0,1]
    v_pk_fma_f32 v[214:215], v[214:215], v[236:237], v[236:237] op_sel:[0,0,1] op_sel_hi:[1,0,1]
    v_pk_fma_f32 v[68:69], v[68:69], v[236:237], v[236:237] op_sel:[0,0,1] op_sel_hi:[1,0,1]
    v_pk_fma_f32 v[140:141], v[140:141], v[236:237], v[236:237] op_sel:[0,0,1] op_sel_hi:[1,0,1]
    v_cvt_pk_bf16_f32 v244, v212, v213
    v_cvt_pk_bf16_f32 v245, v214, v215
    v_cvt_pk_bf16_f32 v246, v68, v69
    v_cvt_pk_bf16_f32 v247, v140, v141
    ds_write_b128 v11, v[244:247] offset:4096
    s_add_u32 s42, s42, 4096
    buffer_load_dwordx4 a[32:35], v4, s[16:19], s42 offen offset:0 sc1
    buffer_load_dwordx4 a[36:39], v4, s[16:19], s42 offen offset:1024 sc1
    v_pk_fma_f32 v[216:217], v[216:217], v[236:237], v[236:237] op_sel:[0,0,1] op_sel_hi:[1,0,1]
    v_pk_fma_f32 v[218:219], v[218:219], v[236:237], v[236:237] op_sel:[0,0,1] op_sel_hi:[1,0,1]
    v_pk_fma_f32 v[72:73], v[72:73], v[236:237], v[236:237] op_sel:[0,0,1] op_sel_hi:[1,0,1]
    v_pk_fma_f32 v[144:145], v[144:145], v[236:237], v[236:237] op_sel:[0,0,1] op_sel_hi:[1,0,1]
    v_cvt_pk_bf16_f32 v240, v216, v217
    v_cvt_pk_bf16_f32 v241, v218, v219
    v_cvt_pk_bf16_f32 v242, v72, v73
    v_cvt_pk_bf16_f32 v243, v144, v145
    ds_write_b128 v11, v[240:243] offset:8192
    buffer_load_dwordx4 a[40:43], v4, s[16:19], s42 offen offset:2048 sc1
    buffer_load_dwordx4 a[44:47], v4, s[16:19], s42 offen offset:3072 sc1
    v_pk_fma_f32 v[220:221], v[220:221], v[236:237], v[236:237] op_sel:[0,0,1] op_sel_hi:[1,0,1]
    v_pk_fma_f32 v[222:223], v[222:223], v[236:237], v[236:237] op_sel:[0,0,1] op_sel_hi:[1,0,1]
    v_pk_fma_f32 v[76:77], v[76:77], v[236:237], v[236:237] op_sel:[0,0,1] op_sel_hi:[1,0,1]
    v_pk_fma_f32 v[148:149], v[148:149], v[236:237], v[236:237] op_sel:[0,0,1] op_sel_hi:[1,0,1]
    v_cvt_pk_bf16_f32 v244, v220, v221
    v_cvt_pk_bf16_f32 v245, v222, v223
    v_cvt_pk_bf16_f32 v246, v76, v77
    v_cvt_pk_bf16_f32 v247, v148, v149
    ds_write_b128 v11, v[244:247] offset:12288
    s_add_u32 s65, s65, 21504
    s_mul_i32 s28, s6, 9
    s_add_u32 s28, s28, s5
    s_lshl_b32 s28, s28, 5
    s_add_u32 s28, s28, s4
    s_lshl_b32 s28, s28, 11
    s_add_u32 s28, s28, 9175040
    v_mov_b32 v248, -1
    v_mov_b32 v249, -1
    v_mov_b32 v250, -1
    v_mov_b32 v251, -1
    s_bfe_u32 s29, s2, 196628
    s_sub_u32 s29, s5, s29
    s_and_b32 s29, s29, 7
    s_lshl_b32 s29, s29, 13
    s_add_u32 s29, s29, s28
    buffer_store_dwordx4 v[248:251], v4, s[16:19], s29 offen offset:0 sc1
    buffer_store_dwordx4 v[248:251], v4, s[16:19], s29 offen offset:1024 sc1
    v_add_u32 v10, 0x10000, v9
    v_pk_fma_f32 v[224:225], v[224:225], v[236:237], v[236:237] op_sel:[0,0,1] op_sel_hi:[1,0,1]
    v_pk_fma_f32 v[226:227], v[226:227], v[236:237], v[236:237] op_sel:[0,0,1] op_sel_hi:[1,0,1]
    v_pk_fma_f32 v[80:81], v[80:81], v[236:237], v[236:237] op_sel:[0,0,1] op_sel_hi:[1,0,1]
    v_pk_fma_f32 v[152:153], v[152:153], v[236:237], v[236:237] op_sel:[0,0,1] op_sel_hi:[1,0,1]
    v_cvt_pk_bf16_f32 v240, v224, v225
    v_cvt_pk_bf16_f32 v241, v226, v227
    v_cvt_pk_bf16_f32 v242, v80, v81
    v_cvt_pk_bf16_f32 v243, v152, v153
    ds_write_b128 v10, v[240:243] offset:0
    s_bfe_u32 s29, s2, 196632
    s_sub_u32 s29, s5, s29
    s_and_b32 s29, s29, 7
    s_lshl_b32 s29, s29, 13
    s_add_u32 s29, s29, s28
    buffer_store_dwordx4 v[248:251], v4, s[16:19], s29 offen offset:0 sc1
    buffer_store_dwordx4 v[248:251], v4, s[16:19], s29 offen offset:1024 sc1
    v_pk_fma_f32 v[228:229], v[228:229], v[236:237], v[236:237] op_sel:[0,0,1] op_sel_hi:[1,0,1]
    v_pk_fma_f32 v[230:231], v[230:231], v[236:237], v[236:237] op_sel:[0,0,1] op_sel_hi:[1,0,1]
    v_pk_fma_f32 v[84:85], v[84:85], v[236:237], v[236:237] op_sel:[0,0,1] op_sel_hi:[1,0,1]
    v_pk_fma_f32 v[156:157], v[156:157], v[236:237], v[236:237] op_sel:[0,0,1] op_sel_hi:[1,0,1]
    v_cvt_pk_bf16_f32 v244, v228, v229
    v_cvt_pk_bf16_f32 v245, v230, v231
    v_cvt_pk_bf16_f32 v246, v84, v85
    v_cvt_pk_bf16_f32 v247, v156, v157
    ds_write_b128 v10, v[244:247] offset:4096
    v_add_u32 v5, 73728, v4
    v_add_u32 v6, 147456, v4
    v_add_u32 v7, 0x10000, v4
    v_add_u32 v8, 0x10000, v5
    s_waitcnt lgkmcnt(0)
    s_barrier
    s_and_b32 s21, s21, 0xffff
    s_mov_b32 s98, 0
    s_mov_b32 s99, 1
    s_mov_b32 s100, 2
    s_mov_b32 s101, 3
    .p2align 5
Lcommon:
Lpad53076_0:
    s_cbranch_execz Lpad53076_4
    ds_read_b128 v[112:115], v4 offset:0
    ds_read_b128 v[116:119], v4 offset:1024
    ds_read_b128 v[120:123], v4 offset:2048
    ds_read_b128 v[124:127], v4 offset:3072
    ds_read_b128 v[128:131], v4 offset:4096
    ds_read_b128 v[132:135], v4 offset:5120
    ds_read_b128 v[136:139], v4 offset:6144
    ds_read_b128 v[140:143], v4 offset:7168
    ds_read_b128 v[144:147], v4 offset:8192
    ds_read_b128 v[148:151], v4 offset:9216
    ds_read_b128 v[152:155], v4 offset:10240
    ds_read_b128 v[156:159], v4 offset:11264
    ds_read_b128 v[160:163], v4 offset:12288
    ds_read_b128 v[164:167], v4 offset:13312
    ds_read_b128 v[168:171], v4 offset:14336
    ds_read_b128 v[172:175], v4 offset:15360
    s_waitcnt vmcnt(14) lgkmcnt(8)
    v_mfma_f32_16x16x32_bf16 v[16:19], a[0:3], v[112:115], 0
    ds_read_b128 v[176:179], v4 offset:16384
    v_mfma_f32_16x16x32_bf16 v[16:19], a[4:7], v[128:131], v[16:19]
Lpad53076_1:
    s_cbranch_execz Lpad53076_5
    ds_read_b128 v[180:183], v4 offset:17408
    v_mfma_f32_16x16x32_bf16 v[20:23], a[0:3], v[116:119], 0
    s_add_u32 s42, s42, 4096
    s_lshl_b32 s27, s4, 14
    ds_read_b128 v[184:187], v4 offset:18432
    v_mfma_f32_16x16x32_bf16 v[20:23], a[4:7], v[132:135], v[20:23]
    buffer_load_dwordx4 a[48:51], v4, s[16:19], s42 offen offset:0 sc1
    ds_read_b128 v[188:191], v4 offset:19456
    v_mfma_f32_16x16x32_bf16 v[24:27], a[0:3], v[120:123], 0
    ds_read_b128 v[192:195], v4 offset:20480
    v_add_u32 v9, s27, v5
    v_mfma_f32_16x16x32_bf16 v[24:27], a[4:7], v[136:139], v[24:27]
    s_lshr_b32 s27, s4, 1
    s_lshl_b32 s27, s27, 12
    buffer_load_dwordx4 a[52:55], v4, s[16:19], s42 offen offset:1024 sc1
    ds_read_b128 v[196:199], v4 offset:21504
    v_mfma_f32_16x16x32_bf16 v[28:31], a[0:3], v[124:127], 0
    s_and_b32 s28, s4, 1
    s_lshl_b32 s28, s28, 3
    ds_read_b128 v[200:203], v4 offset:22528
    v_mfma_f32_16x16x32_bf16 v[28:31], a[4:7], v[140:143], v[28:31]
    s_waitcnt vmcnt(14) lgkmcnt(7)
    s_add_u32 s27, s27, s28
    ds_read_b128 v[204:207], v4 offset:23552
    v_mfma_f32_16x16x32_bf16 v[16:19], a[8:11], v[144:147], v[16:19]
    ds_read_b128 v[208:211], v4 offset:24576
    v_add_u32 v10, s27, v8
    v_mfma_f32_16x16x32_bf16 v[16:19], a[12:15], v[160:163], v[16:19]
    ds_read_b128 v[212:215], v4 offset:25600
    v_bfe_u32 v12, v2, 1, 1
    v_mfma_f32_16x16x32_bf16 v[20:23], a[8:11], v[148:151], v[20:23]
    ds_read_b128 v[216:219], v4 offset:26624
    v_lshlrev_b32_e64 v12, 9, v12
    v_mfma_f32_16x16x32_bf16 v[20:23], a[12:15], v[164:167], v[20:23]
    buffer_load_dwordx4 a[56:59], v4, s[16:19], s42 offen offset:2048 sc1
    ds_read_b128 v[220:223], v4 offset:27648
    v_mfma_f32_16x16x32_bf16 v[24:27], a[8:11], v[152:155], v[24:27]
    ds_read_b128 v[224:227], v4 offset:28672
    v_lshl_add_u32 v12, v3, 10, v12
    v_mfma_f32_16x16x32_bf16 v[24:27], a[12:15], v[168:171], v[24:27]
    buffer_load_dwordx4 a[60:63], v4, s[16:19], s42 offen offset:3072 sc1
    ds_read_b128 v[228:231], v4 offset:29696
    v_mfma_f32_16x16x32_bf16 v[28:31], a[8:11], v[156:159], v[28:31]
    ds_read_b128 v[232:235], v4 offset:30720
    v_lshrrev_b32 v13, 2, v2
    v_mfma_f32_16x16x32_bf16 v[28:31], a[12:15], v[172:175], v[28:31]
    s_waitcnt vmcnt(14) lgkmcnt(7)
    ds_read_b128 v[236:239], v4 offset:31744
    v_lshl_add_u32 v12, v13, 5, v12
    v_mfma_f32_16x16x32_bf16 v[16:19], a[16:19], v[176:179], v[16:19]
    ds_read_b128 v[240:243], v4 offset:32768
    v_and_b32_e64 v13, 1, v2
    v_mfma_f32_16x16x32_bf16 v[16:19], a[20:23], v[192:195], v[16:19]
    ds_read_b128 v[244:247], v4 offset:33792
    v_lshl_add_u32 v12, v13, 4, v12
    v_mfma_f32_16x16x32_bf16 v[20:23], a[16:19], v[180:183], v[20:23]
    s_add_u32 s42, s42, 4096
    ds_read_b128 v[248:251], v4 offset:34816
    v_lshl_add_u32 v11, s4, 7, v12
    v_mfma_f32_16x16x32_bf16 v[20:23], a[20:23], v[196:199], v[20:23]
    s_mul_i32 s27, s6, 288
    buffer_load_dwordx4 a[0:3], v4, s[16:19], s42 offen offset:0 sc1
    ds_read_b128 v[252:255], v4 offset:35840
    v_mfma_f32_16x16x32_bf16 v[24:27], a[16:19], v[184:187], v[24:27]
    s_lshl_b32 s28, s5, 2
    s_add_u32 s28, s28, s4
    ds_read_b128 a[64:67], v4 offset:36864
    v_mfma_f32_16x16x32_bf16 v[24:27], a[20:23], v[200:203], v[24:27]
    s_add_u32 s57, s27, s28
    buffer_load_dwordx4 a[4:7], v4, s[16:19], s42 offen offset:1024 sc1
    ds_read_b128 a[68:71], v4 offset:37888
    v_mfma_f32_16x16x32_bf16 v[28:31], a[16:19], v[188:191], v[28:31]
    s_lshl_b32 s57, s57, 11
    s_add_u32 s57, s57, 9175040
    ds_read_b128 a[72:75], v4 offset:38912
    v_mfma_f32_16x16x32_bf16 v[28:31], a[20:23], v[204:207], v[28:31]
    s_waitcnt vmcnt(14) lgkmcnt(7)
    s_lshl_b32 s58, s6, 5
    ds_read_b128 a[76:79], v4 offset:39936
    v_mfma_f32_16x16x32_bf16 v[16:19], a[24:27], v[208:211], v[16:19]
    s_add_u32 s63, s58, s28
    s_lshl_b32 s63, s63, 7
    ds_read_b128 a[80:83], v4 offset:40960
    v_mfma_f32_16x16x32_bf16 v[16:19], a[28:31], v[224:227], v[16:19]
    s_add_u32 s63, s63, 131072
    s_add_u32 s58, s58, s4
    ds_read_b128 a[84:87], v4 offset:41984
    v_mfma_f32_16x16x32_bf16 v[20:23], a[24:27], v[212:215], v[20:23]
    s_lshl_b32 s58, s58, 7
    s_add_u32 s58, s58, 131072
    ds_read_b128 a[88:91], v4 offset:43008
    v_mfma_f32_16x16x32_bf16 v[20:23], a[28:31], v[228:231], v[20:23]
    s_mul_i32 s59, s5, 774144
    buffer_load_dwordx4 a[8:11], v4, s[16:19], s42 offen offset:2048 sc1
    ds_read_b128 a[92:95], v4 offset:44032
    v_mfma_f32_16x16x32_bf16 v[24:27], a[24:27], v[216:219], v[24:27]
    s_mul_i32 s27, s4, 21504
    s_add_u32 s59, s59, s27
    ds_read_b128 a[96:99], v4 offset:45056
    v_mfma_f32_16x16x32_bf16 v[24:27], a[28:31], v[232:235], v[24:27]
    s_add_u32 s59, s59, 33357824
    buffer_load_dwordx4 a[12:15], v4, s[16:19], s42 offen offset:3072 sc1
    ds_read_b128 a[100:103], v4 offset:46080
    v_mfma_f32_16x16x32_bf16 v[28:31], a[24:27], v[220:223], v[28:31]
    s_add_u32 s56, s59, 688128
    s_bfe_u32 s48, s2, 196608
    ds_read_b128 a[104:107], v4 offset:47104
    v_mfma_f32_16x16x32_bf16 v[28:31], a[28:31], v[236:239], v[28:31]
    s_waitcnt vmcnt(14) lgkmcnt(7)
    s_add_u32 s48, s5, s48
    ds_read_b128 a[108:111], v4 offset:48128
    v_mfma_f32_16x16x32_bf16 v[16:19], a[32:35], v[240:243], v[16:19]
    s_and_b32 s48, s48, 7
    s_mul_i32 s48, s48, 86016
    ds_read_b128 a[112:115], v4 offset:49152
    v_mfma_f32_16x16x32_bf16 v[16:19], a[36:39], a[64:67], v[16:19]
    s_add_u32 s48, s48, s59
    s_lshr_b32 s25, s47, 3
    ds_read_b128 a[116:119], v4 offset:50176
    v_mfma_f32_16x16x32_bf16 v[20:23], a[32:35], v[244:247], v[20:23]
    s_add_u32 s42, s42, 4096
    s_and_b32 s25, s25, 7
    ds_read_b128 a[120:123], v4 offset:51200
    v_mfma_f32_16x16x32_bf16 v[20:23], a[36:39], a[68:71], v[20:23]
    s_lshl_b32 s25, 1, s25
    buffer_load_dwordx4 a[16:19], v4, s[16:19], s42 offen offset:0 sc1
    ds_read_b128 a[124:127], v4 offset:52224
    v_mfma_f32_16x16x32_bf16 v[24:27], a[32:35], v[248:251], v[24:27]
    s_lshl_b32 s12, s98, 12
    s_lshl_b32 s13, s99, 12
    ds_read_b128 a[128:131], v4 offset:53248
    v_mfma_f32_16x16x32_bf16 v[24:27], a[36:39], a[72:75], v[24:27]
    s_lshl_b32 s14, s100, 12
    buffer_load_dwordx4 a[20:23], v4, s[16:19], s42 offen offset:1024 sc1
    ds_read_b128 a[132:135], v4 offset:54272
    v_mfma_f32_16x16x32_bf16 v[28:31], a[32:35], v[252:255], v[28:31]
    s_lshl_b32 s15, s101, 12
    s_mul_i32 s3, s4, 0
    ds_read_b128 a[136:139], v4 offset:55296
    v_mfma_f32_16x16x32_bf16 v[28:31], a[36:39], a[76:79], v[28:31]
    s_waitcnt vmcnt(14) lgkmcnt(7)
    ds_read_b128 a[140:143], v4 offset:56320
    v_add_u32_e64 v0, s3, v4
    v_mfma_f32_16x16x32_bf16 v[16:19], a[40:43], a[80:83], v[16:19]
    s_mul_i32 s62, s6, 9
    s_add_u32 s62, s62, s5
    ds_read_b128 a[144:147], v4 offset:57344
    v_mfma_f32_16x16x32_bf16 v[16:19], a[44:47], a[96:99], v[16:19]
    s_lshl_b32 s62, s62, 5
    s_add_u32 s62, s62, s4
    ds_read_b128 a[148:151], v4 offset:58368
    v_mfma_f32_16x16x32_bf16 v[20:23], a[40:43], a[84:87], v[20:23]
    s_lshl_b32 s62, s62, 11
    s_add_u32 s62, s62, 9175040
    ds_read_b128 a[152:155], v4 offset:59392
    v_mfma_f32_16x16x32_bf16 v[20:23], a[44:47], a[100:103], v[20:23]
    buffer_load_dwordx4 a[24:27], v4, s[16:19], s42 offen offset:2048 sc1
    ds_read_b128 a[156:159], v4 offset:60416
    v_mfma_f32_16x16x32_bf16 v[24:27], a[40:43], a[88:91], v[24:27]
    ds_read_b128 a[160:163], v4 offset:61440
    v_lshrrev_b32 v12, 3, v1
    v_mfma_f32_16x16x32_bf16 v[24:27], a[44:47], a[104:107], v[24:27]
    buffer_load_dwordx4 a[28:31], v4, s[16:19], s42 offen offset:3072 sc1
    ds_read_b128 a[164:167], v4 offset:62464
    v_mfma_f32_16x16x32_bf16 v[28:31], a[40:43], a[92:95], v[28:31]
    ds_read_b128 a[168:171], v4 offset:63488
    v_and_b32 v13, 7, v1
    v_mfma_f32_16x16x32_bf16 v[28:31], a[44:47], a[108:111], v[28:31]
    s_waitcnt vmcnt(10) lgkmcnt(7)
    ds_read_b128 a[172:175], v4 offset:64512
    v_xor_b32_e64 v13, v13, v12
    v_mfma_f32_16x16x32_bf16 v[16:19], a[48:51], a[112:115], v[16:19]
    ds_read_b128 a[176:179], v7 offset:0
    v_mul_u32_u24 v12, 1152, v12
    v_mfma_f32_16x16x32_bf16 v[16:19], a[52:55], a[128:131], v[16:19]
    ds_read_b128 a[180:183], v7 offset:1024
    v_lshl_add_u32 v62, v13, 4, v12
    v_mfma_f32_16x16x32_bf16 v[20:23], a[48:51], a[116:119], v[20:23]
    s_add_u32 s42, s42, 4096
    ds_read_b128 a[184:187], v7 offset:2048
    v_and_b32_e64 v12, 3, v1
    v_mfma_f32_16x16x32_bf16 v[20:23], a[52:55], a[132:135], v[20:23]
    buffer_load_dwordx4 a[32:35], v4, s[16:19], s42 offen offset:0 sc1
    ds_read_b128 a[188:191], v7 offset:3072
    v_mfma_f32_16x16x32_bf16 v[24:27], a[48:51], a[120:123], v[24:27]
    ds_read_b128 a[192:195], v7 offset:4096
    v_lshlrev_b32_e64 v12, 8, v12
    v_mfma_f32_16x16x32_bf16 v[24:27], a[52:55], a[136:139], v[24:27]
    buffer_load_dwordx4 a[36:39], v4, s[16:19], s42 offen offset:1024 sc1
    ds_read_b128 a[196:199], v7 offset:5120
    v_mfma_f32_16x16x32_bf16 v[28:31], a[48:51], a[124:127], v[28:31]
    ds_read_b128 a[200:203], v7 offset:6144
    v_lshl_add_u32 v12, v3, 4, v12
    v_mfma_f32_16x16x32_bf16 v[28:31], a[52:55], a[140:143], v[28:31]
    s_waitcnt vmcnt(10) lgkmcnt(7)
    ds_read_b128 a[204:207], v7 offset:7168
    v_bfe_u32 v13, v1, 2, 1
    v_mfma_f32_16x16x32_bf16 v[16:19], a[56:59], a[144:147], v[16:19]
    v_lshl_add_u32 v12, v13, 3, v12
    v_bfe_u32 v13, v1, 3, 1
    v_mfma_f32_16x16x32_bf16 v[16:19], a[60:63], a[160:163], v[16:19]
    v_lshl_add_u32 v12, v13, 2, v12
    v_lshl_add_u32 v15, s4, 6, v12
    v_mfma_f32_16x16x32_bf16 v[20:23], a[56:59], a[148:151], v[20:23]
    v_lshlrev_b32 v14, 4, v2
    v_lshl_add_u32 v56, v3, 26, v14
    v_mfma_f32_16x16x32_bf16 v[20:23], a[60:63], a[164:167], v[20:23]
    buffer_load_dwordx4 a[40:43], v4, s[16:19], s42 offen offset:2048 sc1
    v_add_u32 v14, 155648, v14
    v_mfma_f32_16x16x32_bf16 v[24:27], a[56:59], a[152:155], v[24:27]
    v_mfma_f32_16x16x32_bf16 v[24:27], a[60:63], a[168:171], v[24:27]
    buffer_load_dwordx4 a[44:47], v4, s[16:19], s42 offen offset:3072 sc1
    v_mfma_f32_16x16x32_bf16 v[28:31], a[56:59], a[156:159], v[28:31]
    v_mfma_f32_16x16x32_bf16 v[28:31], a[60:63], a[172:175], v[28:31]
    s_waitcnt vmcnt(10) lgkmcnt(0)
    v_mfma_f32_16x16x32_bf16 v[16:19], a[0:3], a[176:179], v[16:19]
    v_mfma_f32_16x16x32_bf16 v[16:19], a[4:7], a[192:195], v[16:19]
    v_mfma_f32_16x16x32_bf16 v[20:23], a[0:3], a[180:183], v[20:23]
    s_add_u32 s42, s42, 4096
    v_mfma_f32_16x16x32_bf16 v[20:23], a[4:7], a[196:199], v[20:23]
    buffer_load_dwordx4 a[48:51], v4, s[16:19], s42 offen offset:0 sc1
    v_mfma_f32_16x16x32_bf16 v[24:27], a[0:3], a[184:187], v[24:27]
    v_mfma_f32_16x16x32_bf16 v[24:27], a[4:7], a[200:203], v[24:27]
    buffer_load_dwordx4 a[52:55], v4, s[16:19], s42 offen offset:1024 sc1
    v_mfma_f32_16x16x32_bf16 v[28:31], a[0:3], a[188:191], v[28:31]
    v_mfma_f32_16x16x32_bf16 v[28:31], a[4:7], a[204:207], v[28:31]
    s_waitcnt vmcnt(10)
    s_add_u32 s31, s31, 512
    s_lshl_b32 s30, s37, 7
    s_add_u32 s30, s30, 0
    s_cmp_eq_u32 s45, 1
    s_cbranch_scc1 Lw48
    s_lshl_b32 s70, s5, 10
    s_add_u32 s70, s70, 82432
    v_lshrrev_b32 v12, 2, v1
    v_lshlrev_b32 v12, 26, v12
    v_lshl_add_u32 v12, v1, 7, v12
    v_mov_b32 v13, 1
    buffer_atomic_add v13, v12, s[16:19], s70 offen sc1
    s_branch Lw49
Lw48:
    s_atomic_add s36, s[68:69], s30
Lw49:
    v_mfma_f32_16x16x32_bf16 v[32:35], a[8:11], v[112:115], 0
    v_fma_f32 v48, -v16, v16, s32
    v_fma_f32 v49, -v17, v17, s32
    v_mfma_f32_16x16x32_bf16 v[32:35], a[12:15], v[128:131], v[32:35]
    v_fma_f32 v50, -v18, v18, s32
    v_fma_f32 v51, -v19, v19, s32
    v_mfma_f32_16x16x32_bf16 v[36:39], a[8:11], v[116:119], 0
    v_mul_f32 v48, v48, v16
    v_mul_f32 v49, v49, v17
    v_mfma_f32_16x16x32_bf16 v[36:39], a[12:15], v[132:135], v[36:39]
    buffer_load_dwordx4 a[56:59], v4, s[16:19], s42 offen offset:2048 sc1
    v_mul_f32 v50, v50, v18
    v_mul_f32 v51, v51, v19
    v_mfma_f32_16x16x32_bf16 v[40:43], a[8:11], v[120:123], 0
    v_exp_f32 v48, v48
    v_mfma_f32_16x16x32_bf16 v[40:43], a[12:15], v[136:139], v[40:43]
    buffer_load_dwordx4 a[60:63], v4, s[16:19], s42 offen offset:3072 sc1
    v_exp_f32 v49, v49
    v_mfma_f32_16x16x32_bf16 v[44:47], a[8:11], v[124:127], 0
    v_exp_f32 v50, v50
    v_mfma_f32_16x16x32_bf16 v[44:47], a[12:15], v[140:143], v[44:47]
    s_waitcnt vmcnt(10)
    v_exp_f32 v51, v51
    v_mfma_f32_16x16x32_bf16 v[32:35], a[16:19], v[144:147], v[32:35]
    v_fma_f32 v48, v48, s34, s34
    v_fma_f32 v49, v49, s34, s34
    v_mfma_f32_16x16x32_bf16 v[32:35], a[20:23], v[160:163], v[32:35]
    v_fma_f32 v50, v50, s34, s34
    v_fma_f32 v51, v51, s34, s34
    v_mfma_f32_16x16x32_bf16 v[36:39], a[16:19], v[148:151], v[36:39]
    s_add_u32 s42, s42, 4096
    v_rcp_f32 v48, v48
    v_mfma_f32_16x16x32_bf16 v[36:39], a[20:23], v[164:167], v[36:39]
    buffer_load_dwordx4 a[0:3], v4, s[16:19], s42 offen offset:0 sc1
    v_rcp_f32 v49, v49
    v_mfma_f32_16x16x32_bf16 v[40:43], a[16:19], v[152:155], v[40:43]
    v_rcp_f32 v50, v50
    v_mfma_f32_16x16x32_bf16 v[40:43], a[20:23], v[168:171], v[40:43]
    buffer_load_dwordx4 a[4:7], v4, s[16:19], s42 offen offset:1024 sc1
    v_rcp_f32 v51, v51
    v_mfma_f32_16x16x32_bf16 v[44:47], a[16:19], v[156:159], v[44:47]
    v_mul_f32 v48, v48, v16
    v_mul_f32 v49, v49, v17
    v_mfma_f32_16x16x32_bf16 v[44:47], a[20:23], v[172:175], v[44:47]
    s_waitcnt vmcnt(10)
    v_mul_f32 v50, v50, v18
    v_mul_f32_e64 v51, v51, v19
    v_mfma_f32_16x16x32_bf16 v[32:35], a[24:27], v[176:179], v[32:35]
    v_cvt_pk_bf16_f32 v58, v48, v49
    v_cvt_pk_bf16_f32 v59, v50, v51
    v_mfma_f32_16x16x32_bf16 v[32:35], a[28:31], v[192:195], v[32:35]
    ds_write_b64 v9, v[58:59] offset:0
    v_mfma_f32_16x16x32_bf16 v[36:39], a[24:27], v[180:183], v[36:39]
    v_fma_f32 v52, -v20, v20, s32
    v_fma_f32 v53, -v21, v21, s32
    v_mfma_f32_16x16x32_bf16 v[36:39], a[28:31], v[196:199], v[36:39]
    buffer_load_dwordx4 a[8:11], v4, s[16:19], s42 offen offset:2048 sc1
    v_fma_f32 v54, -v22, v22, s32
    v_fma_f32 v55, -v23, v23, s32
    v_mfma_f32_16x16x32_bf16 v[40:43], a[24:27], v[184:187], v[40:43]
    v_mul_f32 v52, v52, v20
    v_mul_f32 v53, v53, v21
    v_mfma_f32_16x16x32_bf16 v[40:43], a[28:31], v[200:203], v[40:43]
    buffer_load_dwordx4 a[12:15], v4, s[16:19], s42 offen offset:3072 sc1
    v_mul_f32 v54, v54, v22
    v_mul_f32 v55, v55, v23
    v_mfma_f32_16x16x32_bf16 v[44:47], a[24:27], v[188:191], v[44:47]
    v_exp_f32 v52, v52
    v_mfma_f32_16x16x32_bf16 v[44:47], a[28:31], v[204:207], v[44:47]
    s_waitcnt vmcnt(10)
    v_exp_f32 v53, v53
    v_mfma_f32_16x16x32_bf16 v[32:35], a[32:35], v[208:211], v[32:35]
    v_exp_f32 v54, v54
    v_mfma_f32_16x16x32_bf16 v[32:35], a[36:39], v[224:227], v[32:35]
    s_mul_i32 s42, s99, 36864
    v_exp_f32 v55, v55
    v_mfma_f32_16x16x32_bf16 v[36:39], a[32:35], v[212:215], v[36:39]
    s_add_u32 s42, s42, s55
    v_fma_f32 v52, v52, s34, s34
    v_fma_f32 v53, v53, s34, s34
    v_mfma_f32_16x16x32_bf16 v[36:39], a[36:39], v[228:231], v[36:39]
    buffer_load_dwordx4 a[16:19], v4, s[16:19], s42 offen offset:0 sc1
    v_fma_f32 v54, v54, s34, s34
    v_fma_f32 v55, v55, s34, s34
    v_mfma_f32_16x16x32_bf16 v[40:43], a[32:35], v[216:219], v[40:43]
    v_rcp_f32 v52, v52
    v_mfma_f32_16x16x32_bf16 v[40:43], a[36:39], v[232:235], v[40:43]
    buffer_load_dwordx4 a[20:23], v4, s[16:19], s42 offen offset:1024 sc1
    v_rcp_f32 v53, v53
    v_mfma_f32_16x16x32_bf16 v[44:47], a[32:35], v[220:223], v[44:47]
    v_rcp_f32 v54, v54
    v_mfma_f32_16x16x32_bf16 v[44:47], a[36:39], v[236:239], v[44:47]
    s_waitcnt vmcnt(10)
    v_rcp_f32_e64 v55, v55
    v_mfma_f32_16x16x32_bf16 v[32:35], a[40:43], v[240:243], v[32:35]
    v_mul_f32 v52, v52, v20
    v_mul_f32 v53, v53, v21
    v_mfma_f32_16x16x32_bf16 v[32:35], a[44:47], a[64:67], v[32:35]
    v_mul_f32 v54, v54, v22
    v_mul_f32 v55, v55, v23
    v_mfma_f32_16x16x32_bf16 v[36:39], a[40:43], v[244:247], v[36:39]
    v_cvt_pk_bf16_f32 v60, v52, v53
    v_cvt_pk_bf16_f32 v61, v54, v55
    v_mfma_f32_16x16x32_bf16 v[36:39], a[44:47], a[68:71], v[36:39]
    buffer_load_dwordx4 a[24:27], v4, s[16:19], s42 offen offset:2048 sc1
    ds_write_b64 v9, v[60:61] offset:1024
    v_mfma_f32_16x16x32_bf16 v[40:43], a[40:43], v[248:251], v[40:43]
    v_fma_f32 v48, -v24, v24, s32
    v_fma_f32 v49, -v25, v25, s32
    v_mfma_f32_16x16x32_bf16 v[40:43], a[44:47], a[72:75], v[40:43]
    buffer_load_dwordx4 a[28:31], v4, s[16:19], s42 offen offset:3072 sc1
    v_fma_f32 v50, -v26, v26, s32
    v_fma_f32 v51, -v27, v27, s32
    v_mfma_f32_16x16x32_bf16 v[44:47], a[40:43], v[252:255], v[44:47]
    v_mul_f32 v48, v48, v24
    v_mul_f32 v49, v49, v25
    v_mfma_f32_16x16x32_bf16 v[44:47], a[44:47], a[76:79], v[44:47]
    s_waitcnt vmcnt(10)
    v_mul_f32 v50, v50, v26
    v_mul_f32 v51, v51, v27
    v_mfma_f32_16x16x32_bf16 v[32:35], a[48:51], a[80:83], v[32:35]
    v_exp_f32 v48, v48
    v_mfma_f32_16x16x32_bf16 v[32:35], a[52:55], a[96:99], v[32:35]
    v_exp_f32 v49, v49
    v_mfma_f32_16x16x32_bf16 v[36:39], a[48:51], a[84:87], v[36:39]
    s_add_u32 s42, s42, 4096
    v_exp_f32 v50, v50
    v_mfma_f32_16x16x32_bf16 v[36:39], a[52:55], a[100:103], v[36:39]
    buffer_load_dwordx4 a[32:35], v4, s[16:19], s42 offen offset:0 sc1
    v_exp_f32_e64 v51, v51
    v_mfma_f32_16x16x32_bf16 v[40:43], a[48:51], a[88:91], v[40:43]
    v_fma_f32 v48, v48, s34, s34
    v_fma_f32 v49, v49, s34, s34
    v_mfma_f32_16x16x32_bf16 v[40:43], a[52:55], a[104:107], v[40:43]
    buffer_load_dwordx4 a[36:39], v4, s[16:19], s42 offen offset:1024 sc1
    v_fma_f32 v50, v50, s34, s34
    v_fma_f32 v51, v51, s34, s34
    v_mfma_f32_16x16x32_bf16 v[44:47], a[48:51], a[92:95], v[44:47]
    v_rcp_f32 v48, v48
    v_mfma_f32_16x16x32_bf16 v[44:47], a[52:55], a[108:111], v[44:47]
    s_waitcnt vmcnt(10)
    v_rcp_f32 v49, v49
    v_mfma_f32_16x16x32_bf16 v[32:35], a[56:59], a[112:115], v[32:35]
    v_rcp_f32 v50, v50
    v_mfma_f32_16x16x32_bf16 v[32:35], a[60:63], a[128:131], v[32:35]
    v_rcp_f32_e64 v51, v51
    v_mfma_f32_16x16x32_bf16 v[36:39], a[56:59], a[116:119], v[36:39]
    v_mul_f32 v48, v48, v24
    v_mul_f32 v49, v49, v25
    v_mfma_f32_16x16x32_bf16 v[36:39], a[60:63], a[132:135], v[36:39]
    buffer_load_dwordx4 a[40:43], v4, s[16:19], s42 offen offset:2048 sc1
    v_mul_f32 v50, v50, v26
    v_mul_f32 v51, v51, v27
    v_mfma_f32_16x16x32_bf16 v[40:43], a[56:59], a[120:123], v[40:43]
    v_cvt_pk_bf16_f32 v58, v48, v49
    v_cvt_pk_bf16_f32 v59, v50, v51
    v_mfma_f32_16x16x32_bf16 v[40:43], a[60:63], a[136:139], v[40:43]
    buffer_load_dwordx4 a[44:47], v4, s[16:19], s42 offen offset:3072 sc1
    ds_write_b64 v9, v[58:59] offset:2048
    v_mfma_f32_16x16x32_bf16 v[44:47], a[56:59], a[124:127], v[44:47]
    v_fma_f32 v52, -v28, v28, s32
    v_fma_f32 v53, -v29, v29, s32
    v_mfma_f32_16x16x32_bf16 v[44:47], a[60:63], a[140:143], v[44:47]
    s_waitcnt vmcnt(10)
    v_fma_f32 v54, -v30, v30, s32
    v_fma_f32 v55, -v31, v31, s32
    v_mfma_f32_16x16x32_bf16 v[32:35], a[0:3], a[144:147], v[32:35]
    v_mul_f32 v52, v52, v28
    v_mul_f32_e64 v53, v53, v29
    v_mfma_f32_16x16x32_bf16 v[32:35], a[4:7], a[160:163], v[32:35]
    v_mul_f32 v54, v54, v30
    v_mul_f32 v55, v55, v31
    v_mfma_f32_16x16x32_bf16 v[36:39], a[0:3], a[148:151], v[36:39]
    s_add_u32 s42, s42, 4096
    v_exp_f32 v52, v52
    v_mfma_f32_16x16x32_bf16 v[36:39], a[4:7], a[164:167], v[36:39]
    buffer_load_dwordx4 a[48:51], v4, s[16:19], s42 offen offset:0 sc1
    v_exp_f32 v53, v53
    v_mfma_f32_16x16x32_bf16 v[40:43], a[0:3], a[152:155], v[40:43]
    v_exp_f32 v54, v54
    v_mfma_f32_16x16x32_bf16 v[40:43], a[4:7], a[168:171], v[40:43]
    buffer_load_dwordx4 a[52:55], v4, s[16:19], s42 offen offset:1024 sc1
    v_exp_f32 v55, v55
    v_mfma_f32_16x16x32_bf16 v[44:47], a[0:3], a[156:159], v[44:47]
    v_fma_f32 v52, v52, s34, s34
    v_fma_f32 v53, v53, s34, s34
    v_mfma_f32_16x16x32_bf16 v[44:47], a[4:7], a[172:175], v[44:47]
    s_waitcnt vmcnt(10)
    v_fma_f32 v54, v54, s34, s34
    v_fma_f32 v55, v55, s34, s34
    v_mfma_f32_16x16x32_bf16 v[32:35], a[8:11], a[176:179], v[32:35]
    v_rcp_f32 v52, v52
    v_mfma_f32_16x16x32_bf16 v[32:35], a[12:15], a[192:195], v[32:35]
    v_rcp_f32 v53, v53
    v_mfma_f32_16x16x32_bf16 v[36:39], a[8:11], a[180:183], v[36:39]
    v_rcp_f32 v54, v54
    v_mfma_f32_16x16x32_bf16 v[36:39], a[12:15], a[196:199], v[36:39]
    buffer_load_dwordx4 a[56:59], v4, s[16:19], s42 offen offset:2048 sc1
    v_rcp_f32 v55, v55
    v_mfma_f32_16x16x32_bf16 v[40:43], a[8:11], a[184:187], v[40:43]
    v_mul_f32 v52, v52, v28
    v_mul_f32_e64 v53, v53, v29
    v_mfma_f32_16x16x32_bf16 v[40:43], a[12:15], a[200:203], v[40:43]
    buffer_load_dwordx4 a[60:63], v4, s[16:19], s42 offen offset:3072 sc1
    v_mul_f32 v54, v54, v30
    v_mul_f32 v55, v55, v31
    v_mfma_f32_16x16x32_bf16 v[44:47], a[8:11], a[188:191], v[44:47]
    v_cvt_pk_bf16_f32 v60, v52, v53
    v_cvt_pk_bf16_f32 v61, v54, v55
    v_mfma_f32_16x16x32_bf16 v[44:47], a[12:15], a[204:207], v[44:47]
    s_waitcnt vmcnt(10)
    ds_write_b64 v9, v[60:61] offset:3072
    v_mfma_f32_16x16x32_bf16 v[16:19], a[16:19], v[112:115], 0
    v_fma_f32 v48, -v32, v32, s32
    v_fma_f32 v49, -v33, v33, s32
    v_mfma_f32_16x16x32_bf16 v[16:19], a[20:23], v[128:131], v[16:19]
    s_barrier
    v_fma_f32 v50, -v34, v34, s32
    v_fma_f32 v51, -v35, v35, s32
    v_mfma_f32_16x16x32_bf16 v[20:23], a[16:19], v[116:119], 0
    s_add_u32 s42, s42, 4096
    s_lshl_b32 s27, s5, 7
    v_mul_f32 v48, v48, v32
    v_mfma_f32_16x16x32_bf16 v[20:23], a[20:23], v[132:135], v[20:23]
    buffer_load_dwordx4 a[0:3], v4, s[16:19], s42 offen offset:0 sc1
    v_mul_f32 v49, v49, v33
    v_mul_f32 v50, v50, v34
    v_mul_f32 v51, v51, v35
    v_mfma_f32_16x16x32_bf16 v[24:27], a[16:19], v[120:123], 0
    v_exp_f32_e64 v48, v48
    v_mfma_f32_16x16x32_bf16 v[24:27], a[20:23], v[136:139], v[24:27]
    s_add_u32 s27, s27, s44
    buffer_load_dwordx4 a[4:7], v4, s[16:19], s42 offen offset:1024 sc1
    v_exp_f32 v49, v49
    v_mfma_f32_16x16x32_bf16 v[28:31], a[16:19], v[124:127], 0
    v_exp_f32 v50, v50
    v_mfma_f32_16x16x32_bf16 v[28:31], a[20:23], v[140:143], v[28:31]
    s_waitcnt vmcnt(10)
    v_exp_f32 v51, v51
    v_mfma_f32_16x16x32_bf16 v[16:19], a[24:27], v[144:147], v[16:19]
    s_mul_i32 s28, s4, 18432
    v_fma_f32 v48, v48, s34, s34
    v_fma_f32 v49, v49, s34, s34
    v_mfma_f32_16x16x32_bf16 v[16:19], a[28:31], v[160:163], v[16:19]
    v_fma_f32 v50, v50, s34, s34
    v_fma_f32 v51, v51, s34, s34
    v_mfma_f32_16x16x32_bf16 v[20:23], a[24:27], v[148:151], v[20:23]
    v_rcp_f32 v48, v48
    v_mfma_f32_16x16x32_bf16 v[20:23], a[28:31], v[164:167], v[20:23]
    s_add_u32 s70, s27, s28
    buffer_load_dwordx4 a[8:11], v4, s[16:19], s42 offen offset:2048 sc1
    v_rcp_f32 v49, v49
    v_mfma_f32_16x16x32_bf16 v[24:27], a[24:27], v[152:155], v[24:27]
    v_rcp_f32 v50, v50
    v_mfma_f32_16x16x32_bf16 v[24:27], a[28:31], v[168:171], v[24:27]
    buffer_load_dwordx4 a[12:15], v4, s[16:19], s42 offen offset:3072 sc1
    v_rcp_f32 v51, v51
    v_mfma_f32_16x16x32_bf16 v[28:31], a[24:27], v[156:159], v[28:31]
    s_lshl_b32 s28, s4, 11
    v_mul_f32 v48, v48, v32
    v_mul_f32 v49, v49, v33
    v_mfma_f32_16x16x32_bf16 v[28:31], a[28:31], v[172:175], v[28:31]
    s_waitcnt vmcnt(10)
    v_mul_f32 v50, v50, v34
    v_mul_f32_e64 v51, v51, v35
    v_mfma_f32_16x16x32_bf16 v[16:19], a[32:35], v[176:179], v[16:19]
    v_cvt_pk_bf16_f32 v58, v48, v49
    v_cvt_pk_bf16_f32 v59, v50, v51
    v_mfma_f32_16x16x32_bf16 v[16:19], a[36:39], v[192:195], v[16:19]
    s_add_u32 m0, s28, 0
    ds_write_b64 v9, v[58:59] offset:8
    v_mfma_f32_16x16x32_bf16 v[20:23], a[32:35], v[180:183], v[20:23]
    s_add_u32 s42, s42, 4096
    v_fma_f32 v52, -v36, v36, s32
    v_fma_f32 v53, -v37, v37, s32
    v_mfma_f32_16x16x32_bf16 v[20:23], a[36:39], v[196:199], v[20:23]
    buffer_load_dwordx4 a[16:19], v4, s[16:19], s42 offen offset:0 sc1
    v_fma_f32 v54, -v38, v38, s32
    v_fma_f32 v55, -v39, v39, s32
    v_mfma_f32_16x16x32_bf16 v[24:27], a[32:35], v[184:187], v[24:27]
    v_mul_f32 v52, v52, v36
    v_mul_f32_e64 v53, v53, v37
    v_mfma_f32_16x16x32_bf16 v[24:27], a[36:39], v[200:203], v[24:27]
    buffer_load_dwordx4 a[20:23], v4, s[16:19], s42 offen offset:1024 sc1
    buffer_load_dwordx4 v62, s[8:11], s70 offen lds
    v_mul_f32 v54, v54, v38
    v_mul_f32 v55, v55, v39
    v_mfma_f32_16x16x32_bf16 v[28:31], a[32:35], v[188:191], v[28:31]
    v_exp_f32_e64 v52, v52
    v_mfma_f32_16x16x32_bf16 v[28:31], a[36:39], v[204:207], v[28:31]
    s_waitcnt vmcnt(11)
    v_exp_f32 v53, v53
    v_mfma_f32_16x16x32_bf16 v[16:19], a[40:43], v[208:211], v[16:19]
    v_exp_f32_e64 v54, v54
    v_mfma_f32_16x16x32_bf16 v[16:19], a[44:47], v[224:227], v[16:19]
    v_exp_f32_e64 v55, v55
    v_mfma_f32_16x16x32_bf16 v[20:23], a[40:43], v[212:215], v[20:23]
    s_add_u32 s27, s70, 8192
    v_fma_f32 v52, v52, s34, s34
    v_fma_f32 v53, v53, s34, s34
    v_mfma_f32_16x16x32_bf16 v[20:23], a[44:47], v[228:231], v[20:23]
    buffer_load_dwordx4 a[24:27], v4, s[16:19], s42 offen offset:2048 sc1
    v_fma_f32 v54, v54, s34, s34
    v_fma_f32 v55, v55, s34, s34
    v_mfma_f32_16x16x32_bf16 v[24:27], a[40:43], v[216:219], v[24:27]
    v_rcp_f32_e64 v52, v52
    v_mfma_f32_16x16x32_bf16 v[24:27], a[44:47], v[232:235], v[24:27]
    buffer_load_dwordx4 a[28:31], v4, s[16:19], s42 offen offset:3072 sc1
    buffer_load_dwordx4 v62, s[8:11], s27 offen offset:1024 lds
    v_rcp_f32_e64 v53, v53
    v_mfma_f32_16x16x32_bf16 v[28:31], a[40:43], v[220:223], v[28:31]
    v_rcp_f32 v54, v54
    v_mfma_f32_16x16x32_bf16 v[28:31], a[44:47], v[236:239], v[28:31]
    s_waitcnt vmcnt(12)
    v_rcp_f32_e64 v55, v55
    v_mfma_f32_16x16x32_bf16 v[16:19], a[48:51], v[240:243], v[16:19]
    v_mul_f32 v52, v52, v36
    v_mul_f32 v53, v53, v37
    v_mfma_f32_16x16x32_bf16 v[16:19], a[52:55], a[64:67], v[16:19]
    v_mul_f32 v54, v54, v38
    v_mul_f32 v55, v55, v39
    v_mfma_f32_16x16x32_bf16 v[20:23], a[48:51], v[244:247], v[20:23]
    s_add_u32 s42, s42, 4096
    v_cvt_pk_bf16_f32 v60, v52, v53
    v_cvt_pk_bf16_f32 v61, v54, v55
    v_mfma_f32_16x16x32_bf16 v[20:23], a[52:55], a[68:71], v[20:23]
    s_mul_i32 s71, s5, 9216
    buffer_load_dwordx4 a[32:35], v4, s[16:19], s42 offen offset:0 sc1
    ds_write_b64 v9, v[60:61] offset:1032
    v_mfma_f32_16x16x32_bf16 v[24:27], a[48:51], v[248:251], v[24:27]
    v_fma_f32 v48, -v40, v40, s32
    v_fma_f32 v49, -v41, v41, s32
    v_mfma_f32_16x16x32_bf16 v[24:27], a[52:55], a[72:75], v[24:27]
    buffer_load_dwordx4 a[36:39], v4, s[16:19], s42 offen offset:1024 sc1
    v_fma_f32 v50, -v42, v42, s32
    v_fma_f32 v51, -v43, v43, s32
    v_mfma_f32_16x16x32_bf16 v[28:31], a[48:51], v[252:255], v[28:31]
    s_add_u32 s71, s71, s44
    v_mul_f32 v48, v48, v40
    v_mul_f32 v49, v49, v41
    v_mfma_f32_16x16x32_bf16 v[28:31], a[52:55], a[76:79], v[28:31]
    s_waitcnt vmcnt(12)
    v_mul_f32 v50, v50, v42
    v_mul_f32 v51, v51, v43
    v_mfma_f32_16x16x32_bf16 v[16:19], a[56:59], a[80:83], v[16:19]
    v_exp_f32 v48, v48
    v_mfma_f32_16x16x32_bf16 v[16:19], a[60:63], a[96:99], v[16:19]
    s_add_u32 s71, s71, 1024
    v_exp_f32 v49, v49
    v_mfma_f32_16x16x32_bf16 v[20:23], a[56:59], a[84:87], v[20:23]
    v_exp_f32 v50, v50
    v_mfma_f32_16x16x32_bf16 v[20:23], a[60:63], a[100:103], v[20:23]
    buffer_load_dwordx4 a[40:43], v4, s[16:19], s42 offen offset:2048 sc1
    v_exp_f32 v51, v51
    v_mfma_f32_16x16x32_bf16 v[24:27], a[56:59], a[88:91], v[24:27]
Lpad53076_2:
    s_cbranch_execz Lpad53076_6
    s_mov_b32 m0, 8192
    v_fma_f32 v48, v48, s34, s34
    v_fma_f32 v49, v49, s34, s34
    v_mfma_f32_16x16x32_bf16 v[24:27], a[60:63], a[104:107], v[24:27]
    buffer_load_dwordx4 a[44:47], v4, s[16:19], s42 offen offset:3072 sc1
    v_fma_f32 v50, v50, s34, s34
    v_fma_f32 v51, v51, s34, s34
    v_mfma_f32_16x16x32_bf16 v[28:31], a[56:59], a[92:95], v[28:31]
    v_rcp_f32 v48, v48
    v_mfma_f32_16x16x32_bf16 v[28:31], a[60:63], a[108:111], v[28:31]
    s_waitcnt vmcnt(12)
    v_rcp_f32 v49, v49
    v_mfma_f32_16x16x32_bf16 v[16:19], a[0:3], a[112:115], v[16:19]
    v_rcp_f32 v50, v50
    v_mfma_f32_16x16x32_bf16 v[16:19], a[4:7], a[128:131], v[16:19]
    s_cmp_lg_u32 s4, 0
    s_cselect_b32 s71, 1073741824, s71
    s_cbranch_scc1 Lx50
    buffer_load_dwordx4 v62, s[8:11], s71 offen lds
Lx50:
    v_rcp_f32 v51, v51
    v_mfma_f32_16x16x32_bf16 v[20:23], a[0:3], a[116:119], v[20:23]
    s_add_u32 s42, s42, 4096
    v_mul_f32 v48, v48, v40
    v_mul_f32 v49, v49, v41
    v_mfma_f32_16x16x32_bf16 v[20:23], a[4:7], a[132:135], v[20:23]
    buffer_load_dwordx4 a[48:51], v4, s[16:19], s42 offen offset:0 sc1
    v_mul_f32 v50, v50, v42
    v_mul_f32_e64 v51, v51, v43
    v_mfma_f32_16x16x32_bf16 v[24:27], a[0:3], a[120:123], v[24:27]
    v_cvt_pk_bf16_f32 v58, v48, v49
    v_cvt_pk_bf16_f32 v59, v50, v51
    v_mfma_f32_16x16x32_bf16 v[24:27], a[4:7], a[136:139], v[24:27]
    buffer_load_dwordx4 a[52:55], v4, s[16:19], s42 offen offset:1024 sc1
    ds_write_b64 v9, v[58:59] offset:2056
    v_mfma_f32_16x16x32_bf16 v[28:31], a[0:3], a[124:127], v[28:31]
    v_fma_f32 v52, -v44, v44, s32
    v_fma_f32 v53, -v45, v45, s32
    v_mfma_f32_16x16x32_bf16 v[28:31], a[4:7], a[140:143], v[28:31]
    s_waitcnt vmcnt(12)
    v_fma_f32 v54, -v46, v46, s32
    v_fma_f32 v55, -v47, v47, s32
    v_mfma_f32_16x16x32_bf16 v[16:19], a[8:11], a[144:147], v[16:19]
    v_mul_f32 v52, v52, v44
    v_mul_f32 v53, v53, v45
    v_mfma_f32_16x16x32_bf16 v[16:19], a[12:15], a[160:163], v[16:19]
    v_mul_f32 v54, v54, v46
    v_mul_f32 v55, v55, v47
    v_mfma_f32_16x16x32_bf16 v[20:23], a[8:11], a[148:151], v[20:23]
    v_exp_f32 v52, v52
    v_mfma_f32_16x16x32_bf16 v[20:23], a[12:15], a[164:167], v[20:23]
    buffer_load_dwordx4 a[56:59], v4, s[16:19], s42 offen offset:2048 sc1
    v_exp_f32 v53, v53
    v_mfma_f32_16x16x32_bf16 v[24:27], a[8:11], a[152:155], v[24:27]
    v_exp_f32 v54, v54
    v_mfma_f32_16x16x32_bf16 v[24:27], a[12:15], a[168:171], v[24:27]
    buffer_load_dwordx4 a[60:63], v4, s[16:19], s42 offen offset:3072 sc1
    v_exp_f32_e64 v55, v55
    v_mfma_f32_16x16x32_bf16 v[28:31], a[8:11], a[156:159], v[28:31]
    v_fma_f32 v52, v52, s34, s34
    v_fma_f32 v53, v53, s34, s34
    v_mfma_f32_16x16x32_bf16 v[28:31], a[12:15], a[172:175], v[28:31]
    s_waitcnt vmcnt(12)
    v_fma_f32 v54, v54, s34, s34
    v_fma_f32 v55, v55, s34, s34
    v_mfma_f32_16x16x32_bf16 v[16:19], a[16:19], a[176:179], v[16:19]
    v_rcp_f32 v52, v52
    v_mfma_f32_16x16x32_bf16 v[16:19], a[20:23], a[192:195], v[16:19]
    v_rcp_f32_e64 v53, v53
    v_mfma_f32_16x16x32_bf16 v[20:23], a[16:19], a[180:183], v[20:23]
    s_add_u32 s42, s42, 4096
    v_rcp_f32 v54, v54
    v_mfma_f32_16x16x32_bf16 v[20:23], a[20:23], a[196:199], v[20:23]
    buffer_load_dwordx4 a[0:3], v4, s[16:19], s42 offen offset:0 sc1
    v_rcp_f32 v55, v55
    v_mfma_f32_16x16x32_bf16 v[24:27], a[16:19], a[184:187], v[24:27]
    v_mul_f32 v52, v52, v44
    v_mul_f32 v53, v53, v45
    v_mfma_f32_16x16x32_bf16 v[24:27], a[20:23], a[200:203], v[24:27]
    buffer_load_dwordx4 a[4:7], v4, s[16:19], s42 offen offset:1024 sc1
    v_mul_f32 v54, v54, v46
    v_mul_f32 v55, v55, v47
    v_mfma_f32_16x16x32_bf16 v[28:31], a[16:19], a[188:191], v[28:31]
    v_cvt_pk_bf16_f32 v60, v52, v53
    v_cvt_pk_bf16_f32 v61, v54, v55
    v_mfma_f32_16x16x32_bf16 v[28:31], a[20:23], a[204:207], v[28:31]
    s_waitcnt vmcnt(11)
    ds_write_b64 v9, v[60:61] offset:3080
    v_mfma_f32_16x16x32_bf16 v[32:35], a[24:27], v[112:115], 0
    v_fma_f32 v48, -v16, v16, s32
    v_fma_f32 v49, -v17, v17, s32
    v_mfma_f32_16x16x32_bf16 v[32:35], a[28:31], v[128:131], v[32:35]
    v_fma_f32 v50, -v18, v18, s32
    v_fma_f32 v51, -v19, v19, s32
    v_mfma_f32_16x16x32_bf16 v[36:39], a[24:27], v[116:119], 0
    v_mul_f32 v48, v48, v16
    v_mul_f32_e64 v49, v49, v17
    v_mfma_f32_16x16x32_bf16 v[36:39], a[28:31], v[132:135], v[36:39]
    buffer_load_dwordx4 a[8:11], v4, s[16:19], s42 offen offset:2048 sc1
    v_mul_f32 v50, v50, v18
    v_mul_f32 v51, v51, v19
    v_mfma_f32_16x16x32_bf16 v[40:43], a[24:27], v[120:123], 0
    v_exp_f32_e64 v48, v48
    v_mfma_f32_16x16x32_bf16 v[40:43], a[28:31], v[136:139], v[40:43]
    buffer_load_dwordx4 a[12:15], v4, s[16:19], s42 offen offset:3072 sc1
    v_exp_f32 v49, v49
    v_mfma_f32_16x16x32_bf16 v[44:47], a[24:27], v[124:127], 0
    v_exp_f32 v50, v50
    v_mfma_f32_16x16x32_bf16 v[44:47], a[28:31], v[140:143], v[44:47]
    s_waitcnt vmcnt(10)
    v_exp_f32 v51, v51
    v_mfma_f32_16x16x32_bf16 v[32:35], a[32:35], v[144:147], v[32:35]
    v_fma_f32 v48, v48, s34, s34
    v_fma_f32 v49, v49, s34, s34
    v_mfma_f32_16x16x32_bf16 v[32:35], a[36:39], v[160:163], v[32:35]
    v_fma_f32 v50, v50, s34, s34
    v_fma_f32 v51, v51, s34, s34
    v_mfma_f32_16x16x32_bf16 v[36:39], a[32:35], v[148:151], v[36:39]
    s_add_u32 s42, s42, 4096
    v_rcp_f32_e64 v48, v48
    v_mfma_f32_16x16x32_bf16 v[36:39], a[36:39], v[164:167], v[36:39]
    buffer_load_dwordx4 a[16:19], v4, s[16:19], s42 offen offset:0 sc1
    v_rcp_f32 v49, v49
    v_mfma_f32_16x16x32_bf16 v[40:43], a[32:35], v[152:155], v[40:43]
    v_rcp_f32 v50, v50
    v_mfma_f32_16x16x32_bf16 v[40:43], a[36:39], v[168:171], v[40:43]
    buffer_load_dwordx4 a[20:23], v4, s[16:19], s42 offen offset:1024 sc1
    v_rcp_f32 v51, v51
    v_mfma_f32_16x16x32_bf16 v[44:47], a[32:35], v[156:159], v[44:47]
    v_mul_f32 v48, v48, v16
    v_mul_f32_e64 v49, v49, v17
    v_mfma_f32_16x16x32_bf16 v[44:47], a[36:39], v[172:175], v[44:47]
    s_waitcnt vmcnt(10)
    v_mul_f32 v50, v50, v18
    v_mul_f32_e64 v51, v51, v19
    v_mfma_f32_16x16x32_bf16 v[32:35], a[40:43], v[176:179], v[32:35]
    v_cvt_pk_bf16_f32 v58, v48, v49
    v_cvt_pk_bf16_f32 v59, v50, v51
    v_mfma_f32_16x16x32_bf16 v[32:35], a[44:47], v[192:195], v[32:35]
    ds_write_b64 v9, v[58:59] offset:4096
    v_mfma_f32_16x16x32_bf16 v[36:39], a[40:43], v[180:183], v[36:39]
    v_fma_f32 v52, -v20, v20, s32
    v_fma_f32 v53, -v21, v21, s32
    v_mfma_f32_16x16x32_bf16 v[36:39], a[44:47], v[196:199], v[36:39]
    buffer_load_dwordx4 a[24:27], v4, s[16:19], s42 offen offset:2048 sc1
    v_fma_f32 v54, -v22, v22, s32
    v_fma_f32 v55, -v23, v23, s32
    v_mfma_f32_16x16x32_bf16 v[40:43], a[40:43], v[184:187], v[40:43]
    v_mul_f32 v52, v52, v20
    v_mul_f32 v53, v53, v21
    v_mfma_f32_16x16x32_bf16 v[40:43], a[44:47], v[200:203], v[40:43]
    buffer_load_dwordx4 a[28:31], v4, s[16:19], s42 offen offset:3072 sc1
    v_mul_f32 v54, v54, v22
    v_mul_f32 v55, v55, v23
    v_mfma_f32_16x16x32_bf16 v[44:47], a[40:43], v[188:191], v[44:47]
    v_exp_f32 v52, v52
    v_mfma_f32_16x16x32_bf16 v[44:47], a[44:47], v[204:207], v[44:47]
    s_waitcnt vmcnt(10)
    v_exp_f32_e64 v53, v53
    v_mfma_f32_16x16x32_bf16 v[32:35], a[48:51], v[208:211], v[32:35]
    v_exp_f32 v54, v54
    v_mfma_f32_16x16x32_bf16 v[32:35], a[52:55], v[224:227], v[32:35]
    s_mul_i32 s42, s100, 36864
    v_exp_f32 v55, v55
    v_mfma_f32_16x16x32_bf16 v[36:39], a[48:51], v[212:215], v[36:39]
    s_add_u32 s42, s42, s55
    v_fma_f32 v52, v52, s34, s34
    v_fma_f32 v53, v53, s34, s34
    v_mfma_f32_16x16x32_bf16 v[36:39], a[52:55], v[228:231], v[36:39]
    buffer_load_dwordx4 a[32:35], v4, s[16:19], s42 offen offset:0 sc1
    v_fma_f32 v54, v54, s34, s34
    v_fma_f32 v55, v55, s34, s34
    v_mfma_f32_16x16x32_bf16 v[40:43], a[48:51], v[216:219], v[40:43]
    v_rcp_f32 v52, v52
    v_mfma_f32_16x16x32_bf16 v[40:43], a[52:55], v[232:235], v[40:43]
    buffer_load_dwordx4 a[36:39], v4, s[16:19], s42 offen offset:1024 sc1
    v_rcp_f32_e64 v53, v53
    v_mfma_f32_16x16x32_bf16 v[44:47], a[48:51], v[220:223], v[44:47]
    v_rcp_f32 v54, v54
    v_mfma_f32_16x16x32_bf16 v[44:47], a[52:55], v[236:239], v[44:47]
    s_waitcnt vmcnt(10)
    v_rcp_f32_e64 v55, v55
    v_mfma_f32_16x16x32_bf16 v[32:35], a[56:59], v[240:243], v[32:35]
    v_mul_f32 v52, v52, v20
    v_mul_f32 v53, v53, v21
    v_mfma_f32_16x16x32_bf16 v[32:35], a[60:63], a[64:67], v[32:35]
    v_mul_f32 v54, v54, v22
    v_mul_f32 v55, v55, v23
    v_mfma_f32_16x16x32_bf16 v[36:39], a[56:59], v[244:247], v[36:39]
    v_cvt_pk_bf16_f32 v60, v52, v53
    v_cvt_pk_bf16_f32 v61, v54, v55
    v_mfma_f32_16x16x32_bf16 v[36:39], a[60:63], a[68:71], v[36:39]
    buffer_load_dwordx4 a[40:43], v4, s[16:19], s42 offen offset:2048 sc1
    ds_write_b64 v9, v[60:61] offset:5120
    v_mfma_f32_16x16x32_bf16 v[40:43], a[56:59], v[248:251], v[40:43]
    v_fma_f32 v48, -v24, v24, s32
    v_fma_f32 v49, -v25, v25, s32
    v_mfma_f32_16x16x32_bf16 v[40:43], a[60:63], a[72:75], v[40:43]
    buffer_load_dwordx4 a[44:47], v4, s[16:19], s42 offen offset:3072 sc1
    v_fma_f32 v50, -v26, v26, s32
    v_fma_f32 v51, -v27, v27, s32
    v_mfma_f32_16x16x32_bf16 v[44:47], a[56:59], v[252:255], v[44:47]
    v_mul_f32 v48, v48, v24
    v_mul_f32 v49, v49, v25
    v_mfma_f32_16x16x32_bf16 v[44:47], a[60:63], a[76:79], v[44:47]
    s_waitcnt vmcnt(10)
    v_mul_f32 v50, v50, v26
    v_mul_f32 v51, v51, v27
    v_mfma_f32_16x16x32_bf16 v[32:35], a[0:3], a[80:83], v[32:35]
    v_exp_f32 v48, v48
    v_mfma_f32_16x16x32_bf16 v[32:35], a[4:7], a[96:99], v[32:35]
    v_exp_f32 v49, v49
    v_mfma_f32_16x16x32_bf16 v[36:39], a[0:3], a[84:87], v[36:39]
    s_add_u32 s42, s42, 4096
    v_exp_f32 v50, v50
    v_mfma_f32_16x16x32_bf16 v[36:39], a[4:7], a[100:103], v[36:39]
    buffer_load_dwordx4 a[48:51], v4, s[16:19], s42 offen offset:0 sc1
    v_exp_f32_e64 v51, v51
    v_mfma_f32_16x16x32_bf16 v[40:43], a[0:3], a[88:91], v[40:43]
    v_fma_f32 v48, v48, s34, s34
    v_fma_f32 v49, v49, s34, s34
    v_mfma_f32_16x16x32_bf16 v[40:43], a[4:7], a[104:107], v[40:43]
    buffer_load_dwordx4 a[52:55], v4, s[16:19], s42 offen offset:1024 sc1
    v_fma_f32 v50, v50, s34, s34
    v_fma_f32 v51, v51, s34, s34
    v_mfma_f32_16x16x32_bf16 v[44:47], a[0:3], a[92:95], v[44:47]
    v_rcp_f32 v48, v48
    v_mfma_f32_16x16x32_bf16 v[44:47], a[4:7], a[108:111], v[44:47]
    s_waitcnt vmcnt(10)
    v_rcp_f32 v49, v49
    v_mfma_f32_16x16x32_bf16 v[32:35], a[8:11], a[112:115], v[32:35]
    v_rcp_f32 v50, v50
    v_mfma_f32_16x16x32_bf16 v[32:35], a[12:15], a[128:131], v[32:35]
    v_rcp_f32_e64 v51, v51
    v_mfma_f32_16x16x32_bf16 v[36:39], a[8:11], a[116:119], v[36:39]
    v_mul_f32 v48, v48, v24
    v_mul_f32 v49, v49, v25
    v_mfma_f32_16x16x32_bf16 v[36:39], a[12:15], a[132:135], v[36:39]
    buffer_load_dwordx4 a[56:59], v4, s[16:19], s42 offen offset:2048 sc1
    v_mul_f32 v50, v50, v26
    v_mul_f32 v51, v51, v27
    v_mfma_f32_16x16x32_bf16 v[40:43], a[8:11], a[120:123], v[40:43]
    v_cvt_pk_bf16_f32 v58, v48, v49
    v_cvt_pk_bf16_f32 v59, v50, v51
    v_mfma_f32_16x16x32_bf16 v[40:43], a[12:15], a[136:139], v[40:43]
    buffer_load_dwordx4 a[60:63], v4, s[16:19], s42 offen offset:3072 sc1
    ds_write_b64 v9, v[58:59] offset:6144
    v_mfma_f32_16x16x32_bf16 v[44:47], a[8:11], a[124:127], v[44:47]
    v_fma_f32 v52, -v28, v28, s32
    v_fma_f32 v53, -v29, v29, s32
    v_mfma_f32_16x16x32_bf16 v[44:47], a[12:15], a[140:143], v[44:47]
    s_waitcnt vmcnt(10)
    v_fma_f32 v54, -v30, v30, s32
    v_fma_f32 v55, -v31, v31, s32
    v_mfma_f32_16x16x32_bf16 v[32:35], a[16:19], a[144:147], v[32:35]
    v_mul_f32 v52, v52, v28
    v_mul_f32_e64 v53, v53, v29
    v_mfma_f32_16x16x32_bf16 v[32:35], a[20:23], a[160:163], v[32:35]
    v_mul_f32 v54, v54, v30
    v_mul_f32 v55, v55, v31
    v_mfma_f32_16x16x32_bf16 v[36:39], a[16:19], a[148:151], v[36:39]
    s_add_u32 s42, s42, 4096
    v_exp_f32 v52, v52
    v_mfma_f32_16x16x32_bf16 v[36:39], a[20:23], a[164:167], v[36:39]
    buffer_load_dwordx4 a[0:3], v4, s[16:19], s42 offen offset:0 sc1
    v_exp_f32 v53, v53
    v_mfma_f32_16x16x32_bf16 v[40:43], a[16:19], a[152:155], v[40:43]
    v_exp_f32 v54, v54
    v_mfma_f32_16x16x32_bf16 v[40:43], a[20:23], a[168:171], v[40:43]
    buffer_load_dwordx4 a[4:7], v4, s[16:19], s42 offen offset:1024 sc1
    v_exp_f32 v55, v55
    v_mfma_f32_16x16x32_bf16 v[44:47], a[16:19], a[156:159], v[44:47]
    v_fma_f32 v52, v52, s34, s34
    v_fma_f32 v53, v53, s34, s34
    v_mfma_f32_16x16x32_bf16 v[44:47], a[20:23], a[172:175], v[44:47]
    s_waitcnt vmcnt(10)
    v_fma_f32 v54, v54, s34, s34
    v_fma_f32 v55, v55, s34, s34
    v_mfma_f32_16x16x32_bf16 v[32:35], a[24:27], a[176:179], v[32:35]
    v_rcp_f32 v52, v52
    v_mfma_f32_16x16x32_bf16 v[32:35], a[28:31], a[192:195], v[32:35]
    v_rcp_f32 v53, v53
    v_mfma_f32_16x16x32_bf16 v[36:39], a[24:27], a[180:183], v[36:39]
    v_rcp_f32 v54, v54
    v_mfma_f32_16x16x32_bf16 v[36:39], a[28:31], a[196:199], v[36:39]
    buffer_load_dwordx4 a[8:11], v4, s[16:19], s42 offen offset:2048 sc1
    v_rcp_f32 v55, v55
    v_mfma_f32_16x16x32_bf16 v[40:43], a[24:27], a[184:187], v[40:43]
    v_mul_f32 v52, v52, v28
    v_mul_f32_e64 v53, v53, v29
    v_mfma_f32_16x16x32_bf16 v[40:43], a[28:31], a[200:203], v[40:43]
    buffer_load_dwordx4 a[12:15], v4, s[16:19], s42 offen offset:3072 sc1
    v_mul_f32 v54, v54, v30
    v_mul_f32 v55, v55, v31
    v_mfma_f32_16x16x32_bf16 v[44:47], a[24:27], a[188:191], v[44:47]
    v_cvt_pk_bf16_f32 v60, v52, v53
    v_cvt_pk_bf16_f32 v61, v54, v55
    v_mfma_f32_16x16x32_bf16 v[44:47], a[28:31], a[204:207], v[44:47]
    s_waitcnt vmcnt(10)
    ds_write_b64 v9, v[60:61] offset:7168
    v_mfma_f32_16x16x32_bf16 v[16:19], a[32:35], v[112:115], 0
    v_fma_f32 v48, -v32, v32, s32
    v_fma_f32 v49, -v33, v33, s32
    v_mfma_f32_16x16x32_bf16 v[16:19], a[36:39], v[128:131], v[16:19]
    v_fma_f32 v50, -v34, v34, s32
    v_fma_f32 v51, -v35, v35, s32
    v_mfma_f32_16x16x32_bf16 v[20:23], a[32:35], v[116:119], 0
    s_add_u32 s42, s42, 4096
    v_mul_f32 v48, v48, v32
    v_mul_f32 v49, v49, v33
    v_mfma_f32_16x16x32_bf16 v[20:23], a[36:39], v[132:135], v[20:23]
    buffer_load_dwordx4 a[16:19], v4, s[16:19], s42 offen offset:0 sc1
    v_mul_f32 v50, v50, v34
    v_mul_f32_e64 v51, v51, v35
    v_mfma_f32_16x16x32_bf16 v[24:27], a[32:35], v[120:123], 0
    v_exp_f32 v48, v48
    v_mfma_f32_16x16x32_bf16 v[24:27], a[36:39], v[136:139], v[24:27]
    buffer_load_dwordx4 a[20:23], v4, s[16:19], s42 offen offset:1024 sc1
    v_exp_f32 v49, v49
    v_mfma_f32_16x16x32_bf16 v[28:31], a[32:35], v[124:127], 0
    v_exp_f32 v50, v50
    v_mfma_f32_16x16x32_bf16 v[28:31], a[36:39], v[140:143], v[28:31]
    s_waitcnt vmcnt(10)
    v_exp_f32_e64 v51, v51
    v_mfma_f32_16x16x32_bf16 v[16:19], a[40:43], v[144:147], v[16:19]
    v_fma_f32 v48, v48, s34, s34
    v_fma_f32 v49, v49, s34, s34
    v_mfma_f32_16x16x32_bf16 v[16:19], a[44:47], v[160:163], v[16:19]
    v_fma_f32 v50, v50, s34, s34
    v_fma_f32 v51, v51, s34, s34
    v_mfma_f32_16x16x32_bf16 v[20:23], a[40:43], v[148:151], v[20:23]
    v_rcp_f32_e64 v48, v48
    v_mfma_f32_16x16x32_bf16 v[20:23], a[44:47], v[164:167], v[20:23]
    buffer_load_dwordx4 a[24:27], v4, s[16:19], s42 offen offset:2048 sc1
    v_rcp_f32 v49, v49
    v_mfma_f32_16x16x32_bf16 v[24:27], a[40:43], v[152:155], v[24:27]
    v_rcp_f32 v50, v50
    v_mfma_f32_16x16x32_bf16 v[24:27], a[44:47], v[168:171], v[24:27]
    buffer_load_dwordx4 a[28:31], v4, s[16:19], s42 offen offset:3072 sc1
    v_rcp_f32 v51, v51
    v_mfma_f32_16x16x32_bf16 v[28:31], a[40:43], v[156:159], v[28:31]
    v_mul_f32 v48, v48, v32
    v_mul_f32 v49, v49, v33
    v_mfma_f32_16x16x32_bf16 v[28:31], a[44:47], v[172:175], v[28:31]
    s_waitcnt vmcnt(10)
    v_mul_f32 v50, v50, v34
    v_mul_f32 v51, v51, v35
    v_mfma_f32_16x16x32_bf16 v[16:19], a[48:51], v[176:179], v[16:19]
    v_cvt_pk_bf16_f32 v58, v48, v49
    v_cvt_pk_bf16_f32 v59, v50, v51
    v_mfma_f32_16x16x32_bf16 v[16:19], a[52:55], v[192:195], v[16:19]
    ds_write_b64 v9, v[58:59] offset:4104
    v_mfma_f32_16x16x32_bf16 v[20:23], a[48:51], v[180:183], v[20:23]
    s_add_u32 s42, s42, 4096
    v_fma_f32 v52, -v36, v36, s32
    v_fma_f32 v53, -v37, v37, s32
    v_mfma_f32_16x16x32_bf16 v[20:23], a[52:55], v[196:199], v[20:23]
    buffer_load_dwordx4 a[32:35], v4, s[16:19], s42 offen offset:0 sc1
    v_fma_f32 v54, -v38, v38, s32
    v_fma_f32 v55, -v39, v39, s32
    v_mfma_f32_16x16x32_bf16 v[24:27], a[48:51], v[184:187], v[24:27]
    v_mul_f32 v52, v52, v36
    v_mul_f32 v53, v53, v37
    v_mfma_f32_16x16x32_bf16 v[24:27], a[52:55], v[200:203], v[24:27]
    buffer_load_dwordx4 a[36:39], v4, s[16:19], s42 offen offset:1024 sc1
    v_mul_f32 v54, v54, v38
    v_mul_f32 v55, v55, v39
    v_mfma_f32_16x16x32_bf16 v[28:31], a[48:51], v[188:191], v[28:31]
    v_exp_f32 v52, v52
    v_mfma_f32_16x16x32_bf16 v[28:31], a[52:55], v[204:207], v[28:31]
    s_waitcnt vmcnt(10)
    v_exp_f32 v53, v53
    v_mfma_f32_16x16x32_bf16 v[16:19], a[56:59], v[208:211], v[16:19]
    v_exp_f32 v54, v54
    v_mfma_f32_16x16x32_bf16 v[16:19], a[60:63], v[224:227], v[16:19]
    v_exp_f32_e64 v55, v55
    v_mfma_f32_16x16x32_bf16 v[20:23], a[56:59], v[212:215], v[20:23]
    v_fma_f32 v52, v52, s34, s34
    v_fma_f32 v53, v53, s34, s34
    v_mfma_f32_16x16x32_bf16 v[20:23], a[60:63], v[228:231], v[20:23]
    buffer_load_dwordx4 a[40:43], v4, s[16:19], s42 offen offset:2048 sc1
    v_fma_f32 v54, v54, s34, s34
    v_fma_f32 v55, v55, s34, s34
    v_mfma_f32_16x16x32_bf16 v[24:27], a[56:59], v[216:219], v[24:27]
    v_rcp_f32 v52, v52
    v_mfma_f32_16x16x32_bf16 v[24:27], a[60:63], v[232:235], v[24:27]
    buffer_load_dwordx4 a[44:47], v4, s[16:19], s42 offen offset:3072 sc1
    v_rcp_f32 v53, v53
    v_mfma_f32_16x16x32_bf16 v[28:31], a[56:59], v[220:223], v[28:31]
    v_rcp_f32 v54, v54
    v_mfma_f32_16x16x32_bf16 v[28:31], a[60:63], v[236:239], v[28:31]
    s_waitcnt vmcnt(10)
    v_rcp_f32 v55, v55
    v_mfma_f32_16x16x32_bf16 v[16:19], a[0:3], v[240:243], v[16:19]
    v_mul_f32 v52, v52, v36
    v_mul_f32 v53, v53, v37
    v_mfma_f32_16x16x32_bf16 v[16:19], a[4:7], a[64:67], v[16:19]
    v_mul_f32 v54, v54, v38
    v_mul_f32_e64 v55, v55, v39
    v_mfma_f32_16x16x32_bf16 v[20:23], a[0:3], v[244:247], v[20:23]
    s_add_u32 s42, s42, 4096
    v_cvt_pk_bf16_f32 v60, v52, v53
    v_cvt_pk_bf16_f32 v61, v54, v55
    v_mfma_f32_16x16x32_bf16 v[20:23], a[4:7], a[68:71], v[20:23]
    buffer_load_dwordx4 a[48:51], v4, s[16:19], s42 offen offset:0 sc1
    ds_write_b64 v9, v[60:61] offset:5128
    v_mfma_f32_16x16x32_bf16 v[24:27], a[0:3], v[248:251], v[24:27]
    v_fma_f32 v48, -v40, v40, s32
    v_fma_f32 v49, -v41, v41, s32
    v_mfma_f32_16x16x32_bf16 v[24:27], a[4:7], a[72:75], v[24:27]
    buffer_load_dwordx4 a[52:55], v4, s[16:19], s42 offen offset:1024 sc1
    v_fma_f32 v50, -v42, v42, s32
    v_fma_f32 v51, -v43, v43, s32
    v_mfma_f32_16x16x32_bf16 v[28:31], a[0:3], v[252:255], v[28:31]
    v_mul_f32 v48, v48, v40
    v_mul_f32 v49, v49, v41
    v_mfma_f32_16x16x32_bf16 v[28:31], a[4:7], a[76:79], v[28:31]
    s_waitcnt vmcnt(10)
    v_mul_f32 v50, v50, v42
    v_mul_f32 v51, v51, v43
    v_mfma_f32_16x16x32_bf16 v[16:19], a[8:11], a[80:83], v[16:19]
    v_exp_f32 v48, v48
    v_mfma_f32_16x16x32_bf16 v[16:19], a[12:15], a[96:99], v[16:19]
    v_exp_f32 v49, v49
    v_mfma_f32_16x16x32_bf16 v[20:23], a[8:11], a[84:87], v[20:23]
    v_exp_f32 v50, v50
    v_mfma_f32_16x16x32_bf16 v[20:23], a[12:15], a[100:103], v[20:23]
    buffer_load_dwordx4 a[56:59], v4, s[16:19], s42 offen offset:2048 sc1
    v_exp_f32_e64 v51, v51
    v_mfma_f32_16x16x32_bf16 v[24:27], a[8:11], a[88:91], v[24:27]
    v_fma_f32 v48, v48, s34, s34
    v_fma_f32 v49, v49, s34, s34
    v_mfma_f32_16x16x32_bf16 v[24:27], a[12:15], a[104:107], v[24:27]
    buffer_load_dwordx4 a[60:63], v4, s[16:19], s42 offen offset:3072 sc1
    v_fma_f32 v50, v50, s34, s34
    v_fma_f32 v51, v51, s34, s34
    v_mfma_f32_16x16x32_bf16 v[28:31], a[8:11], a[92:95], v[28:31]
    v_rcp_f32 v48, v48
    v_mfma_f32_16x16x32_bf16 v[28:31], a[12:15], a[108:111], v[28:31]
    s_waitcnt vmcnt(10)
    v_rcp_f32_e64 v49, v49
    v_mfma_f32_16x16x32_bf16 v[16:19], a[16:19], a[112:115], v[16:19]
    v_rcp_f32 v50, v50
    v_mfma_f32_16x16x32_bf16 v[16:19], a[20:23], a[128:131], v[16:19]
    v_rcp_f32 v51, v51
    v_mfma_f32_16x16x32_bf16 v[20:23], a[16:19], a[116:119], v[20:23]
    s_add_u32 s42, s42, 4096
    v_mul_f32 v48, v48, v40
    v_mul_f32 v49, v49, v41
    v_mfma_f32_16x16x32_bf16 v[20:23], a[20:23], a[132:135], v[20:23]
    buffer_load_dwordx4 a[0:3], v4, s[16:19], s42 offen offset:0 sc1
    v_mul_f32 v50, v50, v42
    v_mul_f32 v51, v51, v43
    v_mfma_f32_16x16x32_bf16 v[24:27], a[16:19], a[120:123], v[24:27]
    v_cvt_pk_bf16_f32 v58, v48, v49
    v_cvt_pk_bf16_f32 v59, v50, v51
    v_mfma_f32_16x16x32_bf16 v[24:27], a[20:23], a[136:139], v[24:27]
    buffer_load_dwordx4 a[4:7], v4, s[16:19], s42 offen offset:1024 sc1
    ds_write_b64 v9, v[58:59] offset:6152
    v_mfma_f32_16x16x32_bf16 v[28:31], a[16:19], a[124:127], v[28:31]
    v_fma_f32 v52, -v44, v44, s32
    v_fma_f32 v53, -v45, v45, s32
    v_mfma_f32_16x16x32_bf16 v[28:31], a[20:23], a[140:143], v[28:31]
    s_waitcnt vmcnt(10)
    v_fma_f32 v54, -v46, v46, s32
    v_fma_f32 v55, -v47, v47, s32
    v_mfma_f32_16x16x32_bf16 v[16:19], a[24:27], a[144:147], v[16:19]
    v_mul_f32 v52, v52, v44
    v_mul_f32_e64 v53, v53, v45
    v_mfma_f32_16x16x32_bf16 v[16:19], a[28:31], a[160:163], v[16:19]
    v_mul_f32 v54, v54, v46
    v_mul_f32 v55, v55, v47
    v_mfma_f32_16x16x32_bf16 v[20:23], a[24:27], a[148:151], v[20:23]
    v_exp_f32_e64 v52, v52
    v_mfma_f32_16x16x32_bf16 v[20:23], a[28:31], a[164:167], v[20:23]
    buffer_load_dwordx4 a[8:11], v4, s[16:19], s42 offen offset:2048 sc1
    v_exp_f32 v53, v53
    v_mfma_f32_16x16x32_bf16 v[24:27], a[24:27], a[152:155], v[24:27]
    v_exp_f32 v54, v54
    v_mfma_f32_16x16x32_bf16 v[24:27], a[28:31], a[168:171], v[24:27]
    buffer_load_dwordx4 a[12:15], v4, s[16:19], s42 offen offset:3072 sc1
    v_exp_f32_e64 v55, v55
    v_mfma_f32_16x16x32_bf16 v[28:31], a[24:27], a[156:159], v[28:31]
    v_fma_f32 v52, v52, s34, s34
    v_fma_f32 v53, v53, s34, s34
    v_mfma_f32_16x16x32_bf16 v[28:31], a[28:31], a[172:175], v[28:31]
    s_waitcnt vmcnt(10)
    v_fma_f32 v54, v54, s34, s34
    v_fma_f32 v55, v55, s34, s34
    v_mfma_f32_16x16x32_bf16 v[16:19], a[32:35], a[176:179], v[16:19]
    v_rcp_f32 v52, v52
    v_mfma_f32_16x16x32_bf16 v[16:19], a[36:39], a[192:195], v[16:19]
    v_rcp_f32 v53, v53
    v_mfma_f32_16x16x32_bf16 v[20:23], a[32:35], a[180:183], v[20:23]
    s_add_u32 s42, s42, 4096
    v_rcp_f32 v54, v54
    v_mfma_f32_16x16x32_bf16 v[20:23], a[36:39], a[196:199], v[20:23]
    buffer_load_dwordx4 a[16:19], v4, s[16:19], s42 offen offset:0 sc1
    v_rcp_f32 v55, v55
    v_mfma_f32_16x16x32_bf16 v[24:27], a[32:35], a[184:187], v[24:27]
    v_mul_f32 v52, v52, v44
    v_mul_f32_e64 v53, v53, v45
    v_mfma_f32_16x16x32_bf16 v[24:27], a[36:39], a[200:203], v[24:27]
    buffer_load_dwordx4 a[20:23], v4, s[16:19], s42 offen offset:1024 sc1
    v_mul_f32 v54, v54, v46
    v_mul_f32 v55, v55, v47
    v_mfma_f32_16x16x32_bf16 v[28:31], a[32:35], a[188:191], v[28:31]
    v_cvt_pk_bf16_f32 v60, v52, v53
    v_cvt_pk_bf16_f32 v61, v54, v55
    v_mfma_f32_16x16x32_bf16 v[28:31], a[36:39], a[204:207], v[28:31]
    s_waitcnt vmcnt(10)
    ds_write_b64 v9, v[60:61] offset:7176
    v_mfma_f32_16x16x32_bf16 v[32:35], a[40:43], v[112:115], 0
    v_fma_f32 v48, -v16, v16, s32
    v_fma_f32 v49, -v17, v17, s32
    v_mfma_f32_16x16x32_bf16 v[32:35], a[44:47], v[128:131], v[32:35]
    v_fma_f32 v50, -v18, v18, s32
    v_fma_f32 v51, -v19, v19, s32
    v_mfma_f32_16x16x32_bf16 v[36:39], a[40:43], v[116:119], 0
    v_mul_f32 v48, v48, v16
    v_mul_f32 v49, v49, v17
    v_mfma_f32_16x16x32_bf16 v[36:39], a[44:47], v[132:135], v[36:39]
    buffer_load_dwordx4 a[24:27], v4, s[16:19], s42 offen offset:2048 sc1
    v_mul_f32 v50, v50, v18
    v_mul_f32_e64 v51, v51, v19
    v_mfma_f32_16x16x32_bf16 v[40:43], a[40:43], v[120:123], 0
    v_exp_f32 v48, v48
    v_mfma_f32_16x16x32_bf16 v[40:43], a[44:47], v[136:139], v[40:43]
    buffer_load_dwordx4 a[28:31], v4, s[16:19], s42 offen offset:3072 sc1
    v_exp_f32 v49, v49
    v_mfma_f32_16x16x32_bf16 v[44:47], a[40:43], v[124:127], 0
    v_exp_f32 v50, v50
    v_mfma_f32_16x16x32_bf16 v[44:47], a[44:47], v[140:143], v[44:47]
    s_waitcnt vmcnt(10)
    v_exp_f32_e64 v51, v51
    v_mfma_f32_16x16x32_bf16 v[32:35], a[48:51], v[144:147], v[32:35]
    v_fma_f32 v48, v48, s34, s34
    v_fma_f32 v49, v49, s34, s34
    v_mfma_f32_16x16x32_bf16 v[32:35], a[52:55], v[160:163], v[32:35]
    v_fma_f32 v50, v50, s34, s34
    v_fma_f32 v51, v51, s34, s34
    v_mfma_f32_16x16x32_bf16 v[36:39], a[48:51], v[148:151], v[36:39]
    s_add_u32 s42, s42, 4096
    v_rcp_f32 v48, v48
    v_mfma_f32_16x16x32_bf16 v[36:39], a[52:55], v[164:167], v[36:39]
    buffer_load_dwordx4 a[32:35], v4, s[16:19], s42 offen offset:0 sc1
    v_rcp_f32 v49, v49
    v_mfma_f32_16x16x32_bf16 v[40:43], a[48:51], v[152:155], v[40:43]
    v_rcp_f32 v50, v50
    v_mfma_f32_16x16x32_bf16 v[40:43], a[52:55], v[168:171], v[40:43]
    buffer_load_dwordx4 a[36:39], v4, s[16:19], s42 offen offset:1024 sc1
    v_rcp_f32 v51, v51
    v_mfma_f32_16x16x32_bf16 v[44:47], a[48:51], v[156:159], v[44:47]
    v_mul_f32 v48, v48, v16
    v_mul_f32 v49, v49, v17
    v_mfma_f32_16x16x32_bf16 v[44:47], a[52:55], v[172:175], v[44:47]
    s_waitcnt vmcnt(10)
    v_mul_f32 v50, v50, v18
    v_mul_f32_e64 v51, v51, v19
    v_mfma_f32_16x16x32_bf16 v[32:35], a[56:59], v[176:179], v[32:35]
    v_cvt_pk_bf16_f32 v58, v48, v49
    v_cvt_pk_bf16_f32 v59, v50, v51
    v_mfma_f32_16x16x32_bf16 v[32:35], a[60:63], v[192:195], v[32:35]
    ds_write_b64 v9, v[58:59] offset:8192
    v_mfma_f32_16x16x32_bf16 v[36:39], a[56:59], v[180:183], v[36:39]
    v_fma_f32 v52, -v20, v20, s32
    v_fma_f32 v53, -v21, v21, s32
    v_mfma_f32_16x16x32_bf16 v[36:39], a[60:63], v[196:199], v[36:39]
    buffer_load_dwordx4 a[40:43], v4, s[16:19], s42 offen offset:2048 sc1
    v_fma_f32 v54, -v22, v22, s32
    v_fma_f32 v55, -v23, v23, s32
    v_mfma_f32_16x16x32_bf16 v[40:43], a[56:59], v[184:187], v[40:43]
    v_mul_f32 v52, v52, v20
    v_mul_f32 v53, v53, v21
    v_mfma_f32_16x16x32_bf16 v[40:43], a[60:63], v[200:203], v[40:43]
    buffer_load_dwordx4 a[44:47], v4, s[16:19], s42 offen offset:3072 sc1
    v_mul_f32 v54, v54, v22
    v_mul_f32 v55, v55, v23
    v_mfma_f32_16x16x32_bf16 v[44:47], a[56:59], v[188:191], v[44:47]
    v_exp_f32 v52, v52
    v_mfma_f32_16x16x32_bf16 v[44:47], a[60:63], v[204:207], v[44:47]
    s_waitcnt vmcnt(10)
    v_exp_f32 v53, v53
    v_mfma_f32_16x16x32_bf16 v[32:35], a[0:3], v[208:211], v[32:35]
    v_exp_f32 v54, v54
    v_mfma_f32_16x16x32_bf16 v[32:35], a[4:7], v[224:227], v[32:35]
    s_mul_i32 s42, s101, 36864
    v_exp_f32 v55, v55
    v_mfma_f32_16x16x32_bf16 v[36:39], a[0:3], v[212:215], v[36:39]
    s_add_u32 s42, s42, s55
    v_fma_f32 v52, v52, s34, s34
    v_fma_f32 v53, v53, s34, s34
    v_mfma_f32_16x16x32_bf16 v[36:39], a[4:7], v[228:231], v[36:39]
    buffer_load_dwordx4 a[48:51], v4, s[16:19], s42 offen offset:0 sc1
    v_fma_f32 v54, v54, s34, s34
    v_fma_f32 v55, v55, s34, s34
    v_mfma_f32_16x16x32_bf16 v[40:43], a[0:3], v[216:219], v[40:43]
    v_rcp_f32 v52, v52
    v_mfma_f32_16x16x32_bf16 v[40:43], a[4:7], v[232:235], v[40:43]
    buffer_load_dwordx4 a[52:55], v4, s[16:19], s42 offen offset:1024 sc1
    v_rcp_f32 v53, v53
    v_mfma_f32_16x16x32_bf16 v[44:47], a[0:3], v[220:223], v[44:47]
Lpad53076_3:
    s_cbranch_execz Lpad53076_7
    s_mov_b32 s53, 0
    s_atomic_add s53, s[68:69], s30 glc
    s_mov_b32 s24, 0
    v_mfma_f32_16x16x32_bf16 v[44:47], a[4:7], v[236:239], v[44:47]
    s_waitcnt vmcnt(10)
    s_atomic_add s24, s[68:69], s31 glc
    v_rcp_f32 v54, v54
    v_rcp_f32 v55, v55
    v_mfma_f32_16x16x32_bf16 v[32:35], a[8:11], v[240:243], v[32:35]
    v_mul_f32 v52, v52, v20
    v_mul_f32 v53, v53, v21
    v_mfma_f32_16x16x32_bf16 v[32:35], a[12:15], a[64:67], v[32:35]
    v_mul_f32 v54, v54, v22
    v_mul_f32 v55, v55, v23
    v_mfma_f32_16x16x32_bf16 v[36:39], a[8:11], v[244:247], v[36:39]
    v_cvt_pk_bf16_f32 v60, v52, v53
    v_cvt_pk_bf16_f32 v61, v54, v55
    v_mfma_f32_16x16x32_bf16 v[36:39], a[12:15], a[68:71], v[36:39]
    buffer_load_dwordx4 a[56:59], v4, s[16:19], s42 offen offset:2048 sc1
    ds_write_b64 v9, v[60:61] offset:9216
    v_mfma_f32_16x16x32_bf16 v[40:43], a[8:11], v[248:251], v[40:43]
    v_fma_f32 v48, -v24, v24, s32
    v_fma_f32 v49, -v25, v25, s32
    v_mfma_f32_16x16x32_bf16 v[40:43], a[12:15], a[72:75], v[40:43]
    buffer_load_dwordx4 a[60:63], v4, s[16:19], s42 offen offset:3072 sc1
    v_fma_f32 v50, -v26, v26, s32
    v_fma_f32 v51, -v27, v27, s32
    v_mfma_f32_16x16x32_bf16 v[44:47], a[8:11], v[252:255], v[44:47]
    v_mul_f32 v48, v48, v24
    v_mul_f32 v49, v49, v25
    v_mfma_f32_16x16x32_bf16 v[44:47], a[12:15], a[76:79], v[44:47]
    s_waitcnt vmcnt(10)
    v_mul_f32 v50, v50, v26
    v_mul_f32 v51, v51, v27
    v_mfma_f32_16x16x32_bf16 v[32:35], a[16:19], a[80:83], v[32:35]
    v_exp_f32 v48, v48
    v_mfma_f32_16x16x32_bf16 v[32:35], a[20:23], a[96:99], v[32:35]
    v_exp_f32_e64 v49, v49
    v_mfma_f32_16x16x32_bf16 v[36:39], a[16:19], a[84:87], v[36:39]
    s_add_u32 s42, s42, 4096
    v_exp_f32_e64 v50, v50
    v_mfma_f32_16x16x32_bf16 v[36:39], a[20:23], a[100:103], v[36:39]
    buffer_load_dwordx4 a[0:3], v4, s[16:19], s42 offen offset:0 sc1
    v_exp_f32_e64 v51, v51
    v_mfma_f32_16x16x32_bf16 v[40:43], a[16:19], a[88:91], v[40:43]
    v_fma_f32 v48, v48, s34, s34
    v_fma_f32 v49, v49, s34, s34
    v_mfma_f32_16x16x32_bf16 v[40:43], a[20:23], a[104:107], v[40:43]
    buffer_load_dwordx4 a[4:7], v4, s[16:19], s42 offen offset:1024 sc1
    v_fma_f32 v50, v50, s34, s34
    v_fma_f32 v51, v51, s34, s34
    v_mfma_f32_16x16x32_bf16 v[44:47], a[16:19], a[92:95], v[44:47]
    v_rcp_f32 v48, v48
    v_mfma_f32_16x16x32_bf16 v[44:47], a[20:23], a[108:111], v[44:47]
    s_waitcnt vmcnt(10)
    v_rcp_f32 v49, v49
    v_mfma_f32_16x16x32_bf16 v[32:35], a[24:27], a[112:115], v[32:35]
    v_rcp_f32 v50, v50
    v_mfma_f32_16x16x32_bf16 v[32:35], a[28:31], a[128:131], v[32:35]
    v_rcp_f32_e64 v51, v51
    v_mfma_f32_16x16x32_bf16 v[36:39], a[24:27], a[116:119], v[36:39]
    v_mul_f32 v48, v48, v24
    v_mul_f32 v49, v49, v25
    v_mfma_f32_16x16x32_bf16 v[36:39], a[28:31], a[132:135], v[36:39]
    buffer_load_dwordx4 a[8:11], v4, s[16:19], s42 offen offset:2048 sc1
    v_mul_f32 v50, v50, v26
    v_mul_f32 v51, v51, v27
    v_mfma_f32_16x16x32_bf16 v[40:43], a[24:27], a[120:123], v[40:43]
    v_cvt_pk_bf16_f32 v58, v48, v49
    v_cvt_pk_bf16_f32 v59, v50, v51
    v_mfma_f32_16x16x32_bf16 v[40:43], a[28:31], a[136:139], v[40:43]
    buffer_load_dwordx4 a[12:15], v4, s[16:19], s42 offen offset:3072 sc1
    ds_write_b64 v9, v[58:59] offset:10240
    v_mfma_f32_16x16x32_bf16 v[44:47], a[24:27], a[124:127], v[44:47]
    v_fma_f32 v52, -v28, v28, s32
    v_fma_f32 v53, -v29, v29, s32
    v_mfma_f32_16x16x32_bf16 v[44:47], a[28:31], a[140:143], v[44:47]
    s_waitcnt vmcnt(10)
    v_fma_f32 v54, -v30, v30, s32
    v_fma_f32 v55, -v31, v31, s32
    v_mfma_f32_16x16x32_bf16 v[32:35], a[32:35], a[144:147], v[32:35]
    v_mul_f32 v52, v52, v28
    v_mul_f32_e64 v53, v53, v29
    v_mfma_f32_16x16x32_bf16 v[32:35], a[36:39], a[160:163], v[32:35]
    v_mul_f32 v54, v54, v30
    v_mul_f32 v55, v55, v31
    v_mfma_f32_16x16x32_bf16 v[36:39], a[32:35], a[148:151], v[36:39]
    s_add_u32 s42, s42, 4096
    v_exp_f32 v52, v52
    v_mfma_f32_16x16x32_bf16 v[36:39], a[36:39], a[164:167], v[36:39]
    buffer_load_dwordx4 a[16:19], v4, s[16:19], s42 offen offset:0 sc1
    v_exp_f32 v53, v53
    v_mfma_f32_16x16x32_bf16 v[40:43], a[32:35], a[152:155], v[40:43]
    v_exp_f32 v54, v54
    v_mfma_f32_16x16x32_bf16 v[40:43], a[36:39], a[168:171], v[40:43]
    buffer_load_dwordx4 a[20:23], v4, s[16:19], s42 offen offset:1024 sc1
    v_exp_f32 v55, v55
    v_mfma_f32_16x16x32_bf16 v[44:47], a[32:35], a[156:159], v[44:47]
    v_fma_f32 v52, v52, s34, s34
    v_fma_f32 v53, v53, s34, s34
    v_mfma_f32_16x16x32_bf16 v[44:47], a[36:39], a[172:175], v[44:47]
    s_waitcnt vmcnt(10)
    v_fma_f32 v54, v54, s34, s34
    v_fma_f32 v55, v55, s34, s34
    v_mfma_f32_16x16x32_bf16 v[32:35], a[40:43], a[176:179], v[32:35]
    v_rcp_f32 v52, v52
    v_mfma_f32_16x16x32_bf16 v[32:35], a[44:47], a[192:195], v[32:35]
    v_rcp_f32 v53, v53
    v_mfma_f32_16x16x32_bf16 v[36:39], a[40:43], a[180:183], v[36:39]
    v_rcp_f32 v54, v54
    v_mfma_f32_16x16x32_bf16 v[36:39], a[44:47], a[196:199], v[36:39]
    buffer_load_dwordx4 a[24:27], v4, s[16:19], s42 offen offset:2048 sc1
    v_rcp_f32 v55, v55
    v_mfma_f32_16x16x32_bf16 v[40:43], a[40:43], a[184:187], v[40:43]
    v_mul_f32 v52, v52, v28
    v_mul_f32_e64 v53, v53, v29
    v_mfma_f32_16x16x32_bf16 v[40:43], a[44:47], a[200:203], v[40:43]
    buffer_load_dwordx4 a[28:31], v4, s[16:19], s42 offen offset:3072 sc1
    v_mul_f32 v54, v54, v30
    v_mul_f32 v55, v55, v31
    v_mfma_f32_16x16x32_bf16 v[44:47], a[40:43], a[188:191], v[44:47]
    v_cvt_pk_bf16_f32 v60, v52, v53
    v_cvt_pk_bf16_f32 v61, v54, v55
    v_mfma_f32_16x16x32_bf16 v[44:47], a[44:47], a[204:207], v[44:47]
    s_waitcnt vmcnt(10)
    ds_write_b64 v9, v[60:61] offset:11264
    v_mfma_f32_16x16x32_bf16 v[16:19], a[48:51], v[112:115], 0
    v_fma_f32 v48, -v32, v32, s32
    v_fma_f32 v49, -v33, v33, s32
    v_mfma_f32_16x16x32_bf16 v[16:19], a[52:55], v[128:131], v[16:19]
    s_waitcnt lgkmcnt(0)
    s_add_u32 s53, s53, 1
    s_andn2_b32 s53, 4, s53
    s_cbranch_scc1 Ls51
Lb52:
    v_fma_f32 v50, -v34, v34, s32
    v_fma_f32 v51, -v35, v35, s32
    v_mfma_f32_16x16x32_bf16 v[20:23], a[48:51], v[116:119], 0
    s_add_u32 s42, s42, 4096
    v_mul_f32 v48, v48, v32
    v_mul_f32_e64 v49, v49, v33
    v_mfma_f32_16x16x32_bf16 v[20:23], a[52:55], v[132:135], v[20:23]
    buffer_load_dwordx4 a[32:35], v4, s[16:19], s42 offen offset:0 sc1
    v_mul_f32 v50, v50, v34
    v_mul_f32 v51, v51, v35
    v_mfma_f32_16x16x32_bf16 v[24:27], a[48:51], v[120:123], 0
    v_exp_f32_e64 v48, v48
    v_mfma_f32_16x16x32_bf16 v[24:27], a[52:55], v[136:139], v[24:27]
    buffer_load_dwordx4 a[36:39], v4, s[16:19], s42 offen offset:1024 sc1
    v_exp_f32 v49, v49
    v_mfma_f32_16x16x32_bf16 v[28:31], a[48:51], v[124:127], 0
    v_exp_f32 v50, v50
    v_mfma_f32_16x16x32_bf16 v[28:31], a[52:55], v[140:143], v[28:31]
    s_waitcnt vmcnt(10)
    v_exp_f32 v51, v51
    v_mfma_f32_16x16x32_bf16 v[16:19], a[56:59], v[144:147], v[16:19]
    v_fma_f32 v48, v48, s34, s34
    v_fma_f32 v49, v49, s34, s34
    v_mfma_f32_16x16x32_bf16 v[16:19], a[60:63], v[160:163], v[16:19]
    s_add_u32 s24, s24, 1
    s_andn2_b32 s24, 64, s24
    s_cbranch_scc1 Ls53
Lb54:
    v_fma_f32 v50, v50, s34, s34
    v_fma_f32 v51, v51, s34, s34
    v_mfma_f32_16x16x32_bf16 v[20:23], a[56:59], v[148:151], v[20:23]
    s_lshl_b32 s27, s6, 3
    s_add_u32 s27, s27, s5
    s_mul_i32 s27, s27, 12288
    v_mfma_f32_16x16x32_bf16 v[20:23], a[60:63], v[164:167], v[20:23]
    s_add_u32 s27, s27, 6029312
    s_lshl_b32 s28, s4, 10
    buffer_load_dwordx4 a[40:43], v4, s[16:19], s42 offen offset:2048 sc1
    v_rcp_f32 v48, v48
    v_rcp_f32 v49, v49
    v_mfma_f32_16x16x32_bf16 v[24:27], a[56:59], v[152:155], v[24:27]
    s_add_u32 m0, s28, 147456
    v_rcp_f32_e64 v50, v50
    v_mfma_f32_16x16x32_bf16 v[24:27], a[60:63], v[168:171], v[24:27]
    buffer_load_dwordx4 a[44:47], v4, s[16:19], s42 offen offset:3072 sc1
    buffer_load_dwordx4 v11, s[16:19], s27 offen sc1 lds
    v_rcp_f32_e64 v51, v51
    v_mfma_f32_16x16x32_bf16 v[28:31], a[56:59], v[156:159], v[28:31]
    s_add_u32 s27, s27, 4096
    s_add_u32 m0, s28, 151552
    v_mul_f32_e64 v48, v48, v32
    v_mfma_f32_16x16x32_bf16 v[28:31], a[60:63], v[172:175], v[28:31]
    s_waitcnt vmcnt(11)
    buffer_load_dwordx4 v11, s[16:19], s27 offen sc1 lds
    v_mul_f32 v49, v49, v33
    v_mul_f32 v50, v50, v34
    v_mul_f32 v51, v51, v35
    v_mfma_f32_16x16x32_bf16 v[16:19], a[0:3], v[176:179], v[16:19]
    s_add_u32 s27, s27, 4096
    s_lshr_b32 s28, s28, 2
    s_add_u32 m0, s28, 155648
    v_mfma_f32_16x16x32_bf16 v[16:19], a[4:7], v[192:195], v[16:19]
    buffer_load_dword v15, s[16:19], s27 offen sc1 lds
    v_cvt_pk_bf16_f32 v58, v48, v49
    v_cvt_pk_bf16_f32 v59, v50, v51
    v_mfma_f32_16x16x32_bf16 v[20:23], a[0:3], v[180:183], v[20:23]
    s_add_u32 s42, s42, 4096
    v_mfma_f32_16x16x32_bf16 v[20:23], a[4:7], v[196:199], v[20:23]
    buffer_load_dwordx4 a[48:51], v4, s[16:19], s42 offen offset:0 sc1
    ds_write_b64 v9, v[58:59] offset:8200
    v_fma_f32 v52, -v36, v36, s32
    v_fma_f32 v53, -v37, v37, s32
    v_fma_f32 v54, -v38, v38, s32
    v_fma_f32 v55, -v39, v39, s32
    v_mfma_f32_16x16x32_bf16 v[24:27], a[0:3], v[184:187], v[24:27]
    v_mul_f32 v52, v52, v36
    v_mul_f32_e64 v53, v53, v37
    v_mfma_f32_16x16x32_bf16 v[24:27], a[4:7], v[200:203], v[24:27]
    buffer_load_dwordx4 a[52:55], v4, s[16:19], s42 offen offset:1024 sc1
    v_mul_f32 v54, v54, v38
    v_mul_f32 v55, v55, v39
    v_mfma_f32_16x16x32_bf16 v[28:31], a[0:3], v[188:191], v[28:31]
    v_exp_f32_e64 v52, v52
    v_mfma_f32_16x16x32_bf16 v[28:31], a[4:7], v[204:207], v[28:31]
    s_waitcnt vmcnt(13)
    v_exp_f32 v53, v53
    v_mfma_f32_16x16x32_bf16 v[16:19], a[8:11], v[208:211], v[16:19]
    v_exp_f32_e64 v54, v54
    v_mfma_f32_16x16x32_bf16 v[16:19], a[12:15], v[224:227], v[16:19]
    v_exp_f32_e64 v55, v55
    v_mfma_f32_16x16x32_bf16 v[20:23], a[8:11], v[212:215], v[20:23]
    v_fma_f32 v52, v52, s34, s34
    v_fma_f32 v53, v53, s34, s34
    v_mfma_f32_16x16x32_bf16 v[20:23], a[12:15], v[228:231], v[20:23]
    buffer_load_dwordx4 a[56:59], v4, s[16:19], s42 offen offset:2048 sc1
    v_fma_f32 v54, v54, s34, s34
    v_fma_f32 v55, v55, s34, s34
    v_mfma_f32_16x16x32_bf16 v[24:27], a[8:11], v[216:219], v[24:27]
    v_rcp_f32_e64 v52, v52
    v_mfma_f32_16x16x32_bf16 v[24:27], a[12:15], v[232:235], v[24:27]
    buffer_load_dwordx4 a[60:63], v4, s[16:19], s42 offen offset:3072 sc1
    v_rcp_f32 v53, v53
    v_mfma_f32_16x16x32_bf16 v[28:31], a[8:11], v[220:223], v[28:31]
    v_rcp_f32 v54, v54
    v_mfma_f32_16x16x32_bf16 v[28:31], a[12:15], v[236:239], v[28:31]
    s_waitcnt vmcnt(13)
    v_rcp_f32 v55, v55
    v_mfma_f32_16x16x32_bf16 v[16:19], a[16:19], v[240:243], v[16:19]
    v_mul_f32 v52, v52, v36
    v_mul_f32 v53, v53, v37
    v_mfma_f32_16x16x32_bf16 v[16:19], a[20:23], a[64:67], v[16:19]
    v_mul_f32 v54, v54, v38
    v_mul_f32 v55, v55, v39
    v_mfma_f32_16x16x32_bf16 v[20:23], a[16:19], v[244:247], v[20:23]
    s_add_u32 s42, s42, 4096
    v_cvt_pk_bf16_f32 v60, v52, v53
    v_cvt_pk_bf16_f32 v61, v54, v55
    v_mfma_f32_16x16x32_bf16 v[20:23], a[20:23], a[68:71], v[20:23]
    buffer_load_dwordx4 a[0:3], v4, s[16:19], s42 offen offset:0 sc1
    ds_write_b64 v9, v[60:61] offset:9224
    v_mfma_f32_16x16x32_bf16 v[24:27], a[16:19], v[248:251], v[24:27]
    v_fma_f32 v48, -v40, v40, s32
    v_fma_f32 v49, -v41, v41, s32
    v_mfma_f32_16x16x32_bf16 v[24:27], a[20:23], a[72:75], v[24:27]
    buffer_load_dwordx4 a[4:7], v4, s[16:19], s42 offen offset:1024 sc1
    v_fma_f32 v50, -v42, v42, s32
    v_fma_f32 v51, -v43, v43, s32
    v_mfma_f32_16x16x32_bf16 v[28:31], a[16:19], v[252:255], v[28:31]
    v_mul_f32 v48, v48, v40
    v_mul_f32 v49, v49, v41
    v_mfma_f32_16x16x32_bf16 v[28:31], a[20:23], a[76:79], v[28:31]
    s_waitcnt vmcnt(13)
    v_mul_f32 v50, v50, v42
    v_mul_f32_e64 v51, v51, v43
    v_mfma_f32_16x16x32_bf16 v[16:19], a[24:27], a[80:83], v[16:19]
    v_exp_f32 v48, v48
    v_mfma_f32_16x16x32_bf16 v[16:19], a[28:31], a[96:99], v[16:19]
    v_exp_f32 v49, v49
    v_mfma_f32_16x16x32_bf16 v[20:23], a[24:27], a[84:87], v[20:23]
    v_exp_f32 v50, v50
    v_mfma_f32_16x16x32_bf16 v[20:23], a[28:31], a[100:103], v[20:23]
    buffer_load_dwordx4 a[8:11], v4, s[16:19], s42 offen offset:2048 sc1
    v_exp_f32 v51, v51
    v_mfma_f32_16x16x32_bf16 v[24:27], a[24:27], a[88:91], v[24:27]
    v_fma_f32 v48, v48, s34, s34
    v_fma_f32 v49, v49, s34, s34
    v_mfma_f32_16x16x32_bf16 v[24:27], a[28:31], a[104:107], v[24:27]
    buffer_load_dwordx4 a[12:15], v4, s[16:19], s42 offen offset:3072 sc1
    v_fma_f32 v50, v50, s34, s34
    v_fma_f32 v51, v51, s34, s34
    v_mfma_f32_16x16x32_bf16 v[28:31], a[24:27], a[92:95], v[28:31]
    v_rcp_f32_e64 v48, v48
    v_mfma_f32_16x16x32_bf16 v[28:31], a[28:31], a[108:111], v[28:31]
    s_waitcnt vmcnt(13)
    v_rcp_f32 v49, v49
    v_mfma_f32_16x16x32_bf16 v[16:19], a[32:35], a[112:115], v[16:19]
    v_rcp_f32_e64 v50, v50
    v_mfma_f32_16x16x32_bf16 v[16:19], a[36:39], a[128:131], v[16:19]
    v_rcp_f32 v51, v51
    v_mfma_f32_16x16x32_bf16 v[20:23], a[32:35], a[116:119], v[20:23]
    s_add_u32 s42, s42, 4096
    v_mul_f32 v48, v48, v40
    v_mul_f32 v49, v49, v41
    v_mfma_f32_16x16x32_bf16 v[20:23], a[36:39], a[132:135], v[20:23]
    buffer_load_dwordx4 a[16:19], v4, s[16:19], s42 offen offset:0 sc1
    v_mul_f32 v50, v50, v42
    v_mul_f32_e64 v51, v51, v43
    v_mfma_f32_16x16x32_bf16 v[24:27], a[32:35], a[120:123], v[24:27]
    v_cvt_pk_bf16_f32 v58, v48, v49
    v_cvt_pk_bf16_f32 v59, v50, v51
    v_mfma_f32_16x16x32_bf16 v[24:27], a[36:39], a[136:139], v[24:27]
    buffer_load_dwordx4 a[20:23], v4, s[16:19], s42 offen offset:1024 sc1
    ds_write_b64 v9, v[58:59] offset:10248
    v_mfma_f32_16x16x32_bf16 v[28:31], a[32:35], a[124:127], v[28:31]
    v_fma_f32 v52, -v44, v44, s32
    v_fma_f32 v53, -v45, v45, s32
    v_mfma_f32_16x16x32_bf16 v[28:31], a[36:39], a[140:143], v[28:31]
    s_waitcnt vmcnt(13)
    v_fma_f32 v54, -v46, v46, s32
    v_fma_f32 v55, -v47, v47, s32
    v_mfma_f32_16x16x32_bf16 v[16:19], a[40:43], a[144:147], v[16:19]
    v_mul_f32 v52, v52, v44
    v_mul_f32 v53, v53, v45
    v_mfma_f32_16x16x32_bf16 v[16:19], a[44:47], a[160:163], v[16:19]
    v_mul_f32 v54, v54, v46
    v_mul_f32 v55, v55, v47
    v_mfma_f32_16x16x32_bf16 v[20:23], a[40:43], a[148:151], v[20:23]
    v_exp_f32 v52, v52
    v_mfma_f32_16x16x32_bf16 v[20:23], a[44:47], a[164:167], v[20:23]
    buffer_load_dwordx4 a[24:27], v4, s[16:19], s42 offen offset:2048 sc1
    v_exp_f32 v53, v53
    v_mfma_f32_16x16x32_bf16 v[24:27], a[40:43], a[152:155], v[24:27]
    v_exp_f32 v54, v54
    v_mfma_f32_16x16x32_bf16 v[24:27], a[44:47], a[168:171], v[24:27]
    buffer_load_dwordx4 a[28:31], v4, s[16:19], s42 offen offset:3072 sc1
    v_exp_f32_e64 v55, v55
    v_mfma_f32_16x16x32_bf16 v[28:31], a[40:43], a[156:159], v[28:31]
    v_fma_f32 v52, v52, s34, s34
    v_fma_f32 v53, v53, s34, s34
    v_mfma_f32_16x16x32_bf16 v[28:31], a[44:47], a[172:175], v[28:31]
    s_waitcnt vmcnt(10)
    v_fma_f32 v54, v54, s34, s34
    v_fma_f32 v55, v55, s34, s34
    v_mfma_f32_16x16x32_bf16 v[16:19], a[48:51], a[176:179], v[16:19]
    v_rcp_f32 v52, v52
    v_mfma_f32_16x16x32_bf16 v[16:19], a[52:55], a[192:195], v[16:19]
    v_rcp_f32_e64 v53, v53
    v_mfma_f32_16x16x32_bf16 v[20:23], a[48:51], a[180:183], v[20:23]
    s_add_u32 s42, s42, 4096
    v_rcp_f32 v54, v54
    v_mfma_f32_16x16x32_bf16 v[20:23], a[52:55], a[196:199], v[20:23]
    buffer_load_dwordx4 a[32:35], v4, s[16:19], s42 offen offset:0 sc1
    v_rcp_f32 v55, v55
    v_mfma_f32_16x16x32_bf16 v[24:27], a[48:51], a[184:187], v[24:27]
    v_mul_f32 v52, v52, v44
    v_mul_f32 v53, v53, v45
    v_mfma_f32_16x16x32_bf16 v[24:27], a[52:55], a[200:203], v[24:27]
    buffer_load_dwordx4 a[36:39], v4, s[16:19], s42 offen offset:1024 sc1
    v_mul_f32 v54, v54, v46
    v_mul_f32 v55, v55, v47
    v_mfma_f32_16x16x32_bf16 v[28:31], a[48:51], a[188:191], v[28:31]
    v_cvt_pk_bf16_f32 v60, v52, v53
    v_cvt_pk_bf16_f32 v61, v54, v55
    v_mfma_f32_16x16x32_bf16 v[28:31], a[52:55], a[204:207], v[28:31]
    s_waitcnt vmcnt(10)
    ds_write_b64 v9, v[60:61] offset:11272
    v_mfma_f32_16x16x32_bf16 v[32:35], a[56:59], v[112:115], 0
    v_fma_f32 v48, -v16, v16, s32
    v_fma_f32 v49, -v17, v17, s32
    v_mfma_f32_16x16x32_bf16 v[32:35], a[60:63], v[128:131], v[32:35]
    v_fma_f32 v50, -v18, v18, s32
    v_fma_f32 v51, -v19, v19, s32
    v_mfma_f32_16x16x32_bf16 v[36:39], a[56:59], v[116:119], 0
    v_mul_f32 v48, v48, v16
    v_mul_f32_e64 v49, v49, v17
    v_mfma_f32_16x16x32_bf16 v[36:39], a[60:63], v[132:135], v[36:39]
    buffer_load_dwordx4 a[40:43], v4, s[16:19], s42 offen offset:2048 sc1
    v_mul_f32 v50, v50, v18
    v_mul_f32 v51, v51, v19
    v_mfma_f32_16x16x32_bf16 v[40:43], a[56:59], v[120:123], 0
    v_exp_f32_e64 v48, v48
    v_mfma_f32_16x16x32_bf16 v[40:43], a[60:63], v[136:139], v[40:43]
    buffer_load_dwordx4 a[44:47], v4, s[16:19], s42 offen offset:3072 sc1
    v_exp_f32 v49, v49
    v_mfma_f32_16x16x32_bf16 v[44:47], a[56:59], v[124:127], 0
    v_exp_f32 v50, v50
    v_mfma_f32_16x16x32_bf16 v[44:47], a[60:63], v[140:143], v[44:47]
    s_waitcnt vmcnt(10)
    v_exp_f32 v51, v51
    v_mfma_f32_16x16x32_bf16 v[32:35], a[0:3], v[144:147], v[32:35]
    v_fma_f32 v48, v48, s34, s34
    v_fma_f32 v49, v49, s34, s34
    v_mfma_f32_16x16x32_bf16 v[32:35], a[4:7], v[160:163], v[32:35]
    v_fma_f32 v50, v50, s34, s34
    v_fma_f32 v51, v51, s34, s34
    v_mfma_f32_16x16x32_bf16 v[36:39], a[0:3], v[148:151], v[36:39]
    s_add_u32 s42, s42, 4096
    v_rcp_f32_e64 v48, v48
    v_mfma_f32_16x16x32_bf16 v[36:39], a[4:7], v[164:167], v[36:39]
    buffer_load_dwordx4 a[48:51], v4, s[16:19], s42 offen offset:0 sc1
    v_rcp_f32 v49, v49
    v_mfma_f32_16x16x32_bf16 v[40:43], a[0:3], v[152:155], v[40:43]
    v_rcp_f32 v50, v50
    v_mfma_f32_16x16x32_bf16 v[40:43], a[4:7], v[168:171], v[40:43]
    buffer_load_dwordx4 a[52:55], v4, s[16:19], s42 offen offset:1024 sc1
    v_rcp_f32 v51, v51
    v_mfma_f32_16x16x32_bf16 v[44:47], a[0:3], v[156:159], v[44:47]
    v_mul_f32 v48, v48, v16
    v_mul_f32_e64 v49, v49, v17
    v_mfma_f32_16x16x32_bf16 v[44:47], a[4:7], v[172:175], v[44:47]
    s_waitcnt vmcnt(10)
    v_mul_f32 v50, v50, v18
    v_mul_f32_e64 v51, v51, v19
    v_mfma_f32_16x16x32_bf16 v[32:35], a[8:11], v[176:179], v[32:35]
    v_cvt_pk_bf16_f32 v58, v48, v49
    v_cvt_pk_bf16_f32 v59, v50, v51
    v_mfma_f32_16x16x32_bf16 v[32:35], a[12:15], v[192:195], v[32:35]
    ds_write_b64 v9, v[58:59] offset:12288
    v_mfma_f32_16x16x32_bf16 v[36:39], a[8:11], v[180:183], v[36:39]
    v_fma_f32 v52, -v20, v20, s32
    v_fma_f32 v53, -v21, v21, s32
    v_mfma_f32_16x16x32_bf16 v[36:39], a[12:15], v[196:199], v[36:39]
    buffer_load_dwordx4 a[56:59], v4, s[16:19], s42 offen offset:2048 sc1
    v_fma_f32 v54, -v22, v22, s32
    v_fma_f32 v55, -v23, v23, s32
    v_mfma_f32_16x16x32_bf16 v[40:43], a[8:11], v[184:187], v[40:43]
    v_mul_f32 v52, v52, v20
    v_mul_f32 v53, v53, v21
    v_mfma_f32_16x16x32_bf16 v[40:43], a[12:15], v[200:203], v[40:43]
    buffer_load_dwordx4 a[60:63], v4, s[16:19], s42 offen offset:3072 sc1
    v_mul_f32 v54, v54, v22
    v_mul_f32 v55, v55, v23
    v_mfma_f32_16x16x32_bf16 v[44:47], a[8:11], v[188:191], v[44:47]
    v_exp_f32 v52, v52
    v_mfma_f32_16x16x32_bf16 v[44:47], a[12:15], v[204:207], v[44:47]
    s_waitcnt vmcnt(10)
    v_exp_f32_e64 v53, v53
    v_mfma_f32_16x16x32_bf16 v[32:35], a[16:19], v[208:211], v[32:35]
    v_exp_f32 v54, v54
    v_mfma_f32_16x16x32_bf16 v[32:35], a[20:23], v[224:227], v[32:35]
    v_exp_f32 v55, v55
    v_mfma_f32_16x16x32_bf16 v[36:39], a[16:19], v[212:215], v[36:39]
    s_add_u32 s42, s55, 147456
    v_fma_f32 v52, v52, s34, s34
    v_fma_f32 v53, v53, s34, s34
    v_mfma_f32_16x16x32_bf16 v[36:39], a[20:23], v[228:231], v[36:39]
    buffer_load_dwordx4 a[0:3], v4, s[16:19], s42 offen offset:0 sc1
    v_fma_f32 v54, v54, s34, s34
    v_fma_f32 v55, v55, s34, s34
    v_mfma_f32_16x16x32_bf16 v[40:43], a[16:19], v[216:219], v[40:43]
    v_rcp_f32 v52, v52
    v_mfma_f32_16x16x32_bf16 v[40:43], a[20:23], v[232:235], v[40:43]
    buffer_load_dwordx4 a[4:7], v4, s[16:19], s42 offen offset:1024 sc1
    v_rcp_f32 v53, v53
    v_mfma_f32_16x16x32_bf16 v[44:47], a[16:19], v[220:223], v[44:47]
    v_rcp_f32 v54, v54
    v_mfma_f32_16x16x32_bf16 v[44:47], a[20:23], v[236:239], v[44:47]
    s_waitcnt vmcnt(10)
    v_rcp_f32 v55, v55
    v_mfma_f32_16x16x32_bf16 v[32:35], a[24:27], v[240:243], v[32:35]
    v_mul_f32 v52, v52, v20
    v_mul_f32 v53, v53, v21
    v_mfma_f32_16x16x32_bf16 v[32:35], a[28:31], a[64:67], v[32:35]
    v_mul_f32 v54, v54, v22
    v_mul_f32_e64 v55, v55, v23
    v_mfma_f32_16x16x32_bf16 v[36:39], a[24:27], v[244:247], v[36:39]
    v_cvt_pk_bf16_f32 v60, v52, v53
    v_cvt_pk_bf16_f32 v61, v54, v55
    v_mfma_f32_16x16x32_bf16 v[36:39], a[28:31], a[68:71], v[36:39]
    buffer_load_dwordx4 a[8:11], v4, s[16:19], s42 offen offset:2048 sc1
    ds_write_b64 v9, v[60:61] offset:13312
    v_mfma_f32_16x16x32_bf16 v[40:43], a[24:27], v[248:251], v[40:43]
    v_fma_f32 v48, -v24, v24, s32
    v_fma_f32 v49, -v25, v25, s32
    v_mfma_f32_16x16x32_bf16 v[40:43], a[28:31], a[72:75], v[40:43]
    buffer_load_dwordx4 a[12:15], v4, s[16:19], s42 offen offset:3072 sc1
    v_fma_f32 v50, -v26, v26, s32
    v_fma_f32 v51, -v27, v27, s32
    v_mfma_f32_16x16x32_bf16 v[44:47], a[24:27], v[252:255], v[44:47]
    v_mul_f32 v48, v48, v24
    v_mul_f32 v49, v49, v25
    v_mfma_f32_16x16x32_bf16 v[44:47], a[28:31], a[76:79], v[44:47]
    s_waitcnt vmcnt(10)
    v_mul_f32 v50, v50, v26
    v_mul_f32 v51, v51, v27
    v_mfma_f32_16x16x32_bf16 v[32:35], a[32:35], a[80:83], v[32:35]
    v_exp_f32 v48, v48
    v_mfma_f32_16x16x32_bf16 v[32:35], a[36:39], a[96:99], v[32:35]
    v_exp_f32_e64 v49, v49
    v_mfma_f32_16x16x32_bf16 v[36:39], a[32:35], a[84:87], v[36:39]
    s_add_u32 s42, s42, 4096
    v_exp_f32_e64 v50, v50
    v_mfma_f32_16x16x32_bf16 v[36:39], a[36:39], a[100:103], v[36:39]
    buffer_load_dwordx4 a[16:19], v4, s[16:19], s42 offen offset:0 sc1
    v_exp_f32_e64 v51, v51
    v_mfma_f32_16x16x32_bf16 v[40:43], a[32:35], a[88:91], v[40:43]
    v_fma_f32 v48, v48, s34, s34
    v_fma_f32 v49, v49, s34, s34
    v_mfma_f32_16x16x32_bf16 v[40:43], a[36:39], a[104:107], v[40:43]
    buffer_load_dwordx4 a[20:23], v4, s[16:19], s42 offen offset:1024 sc1
    v_fma_f32 v50, v50, s34, s34
    v_fma_f32 v51, v51, s34, s34
    v_mfma_f32_16x16x32_bf16 v[44:47], a[32:35], a[92:95], v[44:47]
    v_rcp_f32 v48, v48
    v_mfma_f32_16x16x32_bf16 v[44:47], a[36:39], a[108:111], v[44:47]
    s_waitcnt vmcnt(10)
    v_rcp_f32 v49, v49
    v_mfma_f32_16x16x32_bf16 v[32:35], a[40:43], a[112:115], v[32:35]
    v_rcp_f32 v50, v50
    v_mfma_f32_16x16x32_bf16 v[32:35], a[44:47], a[128:131], v[32:35]
    v_rcp_f32_e64 v51, v51
    v_mfma_f32_16x16x32_bf16 v[36:39], a[40:43], a[116:119], v[36:39]
    v_mul_f32 v48, v48, v24
    v_mul_f32 v49, v49, v25
    v_mfma_f32_16x16x32_bf16 v[36:39], a[44:47], a[132:135], v[36:39]
    buffer_load_dwordx4 a[24:27], v4, s[16:19], s42 offen offset:2048 sc1
    v_mul_f32 v50, v50, v26
    v_mul_f32 v51, v51, v27
    v_mfma_f32_16x16x32_bf16 v[40:43], a[40:43], a[120:123], v[40:43]
    v_cvt_pk_bf16_f32 v58, v48, v49
    v_cvt_pk_bf16_f32 v59, v50, v51
    v_mfma_f32_16x16x32_bf16 v[40:43], a[44:47], a[136:139], v[40:43]
    buffer_load_dwordx4 a[28:31], v4, s[16:19], s42 offen offset:3072 sc1
    ds_write_b64 v9, v[58:59] offset:14336
    v_mfma_f32_16x16x32_bf16 v[44:47], a[40:43], a[124:127], v[44:47]
    v_fma_f32 v52, -v28, v28, s32
    v_fma_f32 v53, -v29, v29, s32
    v_mfma_f32_16x16x32_bf16 v[44:47], a[44:47], a[140:143], v[44:47]
    s_waitcnt vmcnt(10)
    v_fma_f32 v54, -v30, v30, s32
    v_fma_f32 v55, -v31, v31, s32
    v_mfma_f32_16x16x32_bf16 v[32:35], a[48:51], a[144:147], v[32:35]
    v_mul_f32 v52, v52, v28
    v_mul_f32_e64 v53, v53, v29
    v_mfma_f32_16x16x32_bf16 v[32:35], a[52:55], a[160:163], v[32:35]
    v_mul_f32 v54, v54, v30
    v_mul_f32 v55, v55, v31
    v_mfma_f32_16x16x32_bf16 v[36:39], a[48:51], a[148:151], v[36:39]
    s_add_u32 s42, s42, 4096
    v_exp_f32 v52, v52
    v_mfma_f32_16x16x32_bf16 v[36:39], a[52:55], a[164:167], v[36:39]
    buffer_load_dwordx4 a[32:35], v4, s[16:19], s42 offen offset:0 sc1
    v_exp_f32 v53, v53
    v_mfma_f32_16x16x32_bf16 v[40:43], a[48:51], a[152:155], v[40:43]
    v_exp_f32 v54, v54
    v_mfma_f32_16x16x32_bf16 v[40:43], a[52:55], a[168:171], v[40:43]
    buffer_load_dwordx4 a[36:39], v4, s[16:19], s42 offen offset:1024 sc1
    v_exp_f32 v55, v55
    v_mfma_f32_16x16x32_bf16 v[44:47], a[48:51], a[156:159], v[44:47]
    v_fma_f32 v52, v52, s34, s34
    v_fma_f32 v53, v53, s34, s34
    v_mfma_f32_16x16x32_bf16 v[44:47], a[52:55], a[172:175], v[44:47]
    s_waitcnt vmcnt(10)
    v_fma_f32 v54, v54, s34, s34
    v_fma_f32 v55, v55, s34, s34
    v_mfma_f32_16x16x32_bf16 v[32:35], a[56:59], a[176:179], v[32:35]
    v_rcp_f32 v52, v52
    v_mfma_f32_16x16x32_bf16 v[32:35], a[60:63], a[192:195], v[32:35]
    v_rcp_f32 v53, v53
    v_mfma_f32_16x16x32_bf16 v[36:39], a[56:59], a[180:183], v[36:39]
    v_rcp_f32 v54, v54
    v_mfma_f32_16x16x32_bf16 v[36:39], a[60:63], a[196:199], v[36:39]
    buffer_load_dwordx4 a[40:43], v4, s[16:19], s42 offen offset:2048 sc1
    v_rcp_f32 v55, v55
    v_mfma_f32_16x16x32_bf16 v[40:43], a[56:59], a[184:187], v[40:43]
    v_mul_f32 v52, v52, v28
    v_mul_f32_e64 v53, v53, v29
    v_mfma_f32_16x16x32_bf16 v[40:43], a[60:63], a[200:203], v[40:43]
    buffer_load_dwordx4 a[44:47], v4, s[16:19], s42 offen offset:3072 sc1
    v_mul_f32 v54, v54, v30
    v_mul_f32 v55, v55, v31
    v_mfma_f32_16x16x32_bf16 v[44:47], a[56:59], a[188:191], v[44:47]
    v_cvt_pk_bf16_f32 v60, v52, v53
    v_cvt_pk_bf16_f32 v61, v54, v55
    v_mfma_f32_16x16x32_bf16 v[44:47], a[60:63], a[204:207], v[44:47]
    s_waitcnt vmcnt(10)
    ds_write_b64 v9, v[60:61] offset:15360
    v_mfma_f32_16x16x32_bf16 v[16:19], a[0:3], v[112:115], 0
    v_fma_f32 v48, -v32, v32, s32
    v_fma_f32 v49, -v33, v33, s32
    v_mfma_f32_16x16x32_bf16 v[16:19], a[4:7], v[128:131], v[16:19]
    s_waitcnt lgkmcnt(4)
    s_barrier
    v_fma_f32 v50, -v34, v34, s32
    v_fma_f32 v51, -v35, v35, s32
    v_mfma_f32_16x16x32_bf16 v[20:23], a[0:3], v[116:119], 0
    s_add_u32 s42, s42, 4096
    v_mul_f32 v48, v48, v32
    v_mul_f32 v49, v49, v33
    v_mfma_f32_16x16x32_bf16 v[20:23], a[4:7], v[132:135], v[20:23]
    buffer_load_dwordx4 a[48:51], v4, s[16:19], s42 offen offset:0 sc1
    v_mul_f32 v50, v50, v34
    v_mul_f32 v51, v51, v35
    v_mfma_f32_16x16x32_bf16 v[24:27], a[0:3], v[120:123], 0
    v_exp_f32 v48, v48
    v_mfma_f32_16x16x32_bf16 v[24:27], a[4:7], v[136:139], v[24:27]
    buffer_load_dwordx4 a[52:55], v4, s[16:19], s42 offen offset:1024 sc1
    v_exp_f32 v49, v49
    v_mfma_f32_16x16x32_bf16 v[28:31], a[0:3], v[124:127], 0
    v_exp_f32 v50, v50
    v_mfma_f32_16x16x32_bf16 v[28:31], a[4:7], v[140:143], v[28:31]
    s_waitcnt vmcnt(10)
    v_exp_f32 v51, v51
    v_mfma_f32_16x16x32_bf16 v[16:19], a[8:11], v[144:147], v[16:19]
    ds_read_b128 v[112:115], v5 offset:0
    v_fma_f32 v48, v48, s34, s34
    v_mfma_f32_16x16x32_bf16 v[16:19], a[12:15], v[160:163], v[16:19]
Lpad53076_4:
    s_cbranch_execz Lpad53076_8
    ds_read_b128 v[116:119], v5 offset:1024
    v_fma_f32 v49, v49, s34, s34
    v_fma_f32 v50, v50, s34, s34
    v_fma_f32 v51, v51, s34, s34
    v_mfma_f32_16x16x32_bf16 v[20:23], a[8:11], v[148:151], v[20:23]
    ds_read_b128 v[120:123], v5 offset:2048
    v_mfma_f32_16x16x32_bf16 v[20:23], a[12:15], v[164:167], v[20:23]
    buffer_load_dwordx4 a[56:59], v4, s[16:19], s42 offen offset:2048 sc1
    ds_read_b128 v[124:127], v5 offset:3072
    v_rcp_f32 v48, v48
    v_rcp_f32_e64 v49, v49
    v_mfma_f32_16x16x32_bf16 v[24:27], a[8:11], v[152:155], v[24:27]
    ds_read_b128 v[128:131], v5 offset:16384
    v_mfma_f32_16x16x32_bf16 v[24:27], a[12:15], v[168:171], v[24:27]
    buffer_load_dwordx4 a[60:63], v4, s[16:19], s42 offen offset:3072 sc1
    ds_read_b128 v[132:135], v5 offset:17408
    v_rcp_f32 v50, v50
    v_rcp_f32 v51, v51
    v_mfma_f32_16x16x32_bf16 v[28:31], a[8:11], v[156:159], v[28:31]
    ds_read_b128 v[136:139], v5 offset:18432
    v_mul_f32_e64 v48, v48, v32
    v_mfma_f32_16x16x32_bf16 v[28:31], a[12:15], v[172:175], v[28:31]
    s_waitcnt vmcnt(10)
    ds_read_b128 v[140:143], v5 offset:19456
    v_mul_f32 v49, v49, v33
    v_mul_f32 v50, v50, v34
    v_mul_f32 v51, v51, v35
    v_mfma_f32_16x16x32_bf16 v[16:19], a[16:19], v[176:179], v[16:19]
    ds_read_b128 v[144:147], v5 offset:32768
    v_cvt_pk_bf16_f32 v58, v48, v49
    v_mfma_f32_16x16x32_bf16 v[16:19], a[20:23], v[192:195], v[16:19]
    ds_read_b128 v[148:151], v5 offset:33792
    v_cvt_pk_bf16_f32 v59, v50, v51
    v_mfma_f32_16x16x32_bf16 v[20:23], a[16:19], v[180:183], v[20:23]
    s_add_u32 s42, s42, 4096
    ds_read_b128 v[152:155], v5 offset:34816
    v_mfma_f32_16x16x32_bf16 v[20:23], a[20:23], v[196:199], v[20:23]
    buffer_load_dwordx4 a[0:3], v4, s[16:19], s42 offen offset:0 sc1
    ds_read_b128 v[156:159], v5 offset:35840
    ds_write_b64 v9, v[58:59] offset:12296
    v_fma_f32 v52, -v36, v36, s32
    v_fma_f32 v53, -v37, v37, s32
    v_fma_f32 v54, -v38, v38, s32
    v_fma_f32 v55, -v39, v39, s32
    v_mfma_f32_16x16x32_bf16 v[24:27], a[16:19], v[184:187], v[24:27]
    ds_read_b128 v[160:163], v5 offset:49152
    v_mul_f32_e64 v52, v52, v36
    v_mfma_f32_16x16x32_bf16 v[24:27], a[20:23], v[200:203], v[24:27]
    buffer_load_dwordx4 a[4:7], v4, s[16:19], s42 offen offset:1024 sc1
    ds_read_b128 v[164:167], v5 offset:50176
    v_mul_f32 v53, v53, v37
    v_mul_f32 v54, v54, v38
    v_mul_f32 v55, v55, v39
    v_mfma_f32_16x16x32_bf16 v[28:31], a[16:19], v[188:191], v[28:31]
    ds_read_b128 v[168:171], v5 offset:51200
    v_mfma_f32_16x16x32_bf16 v[28:31], a[20:23], v[204:207], v[28:31]
    s_waitcnt vmcnt(10)
    ds_read_b128 v[172:175], v5 offset:52224
    v_exp_f32 v52, v52
    v_exp_f32 v53, v53
    v_mfma_f32_16x16x32_bf16 v[16:19], a[24:27], v[208:211], v[16:19]
    ds_read_b128 v[176:179], v5 offset:4096
    v_mfma_f32_16x16x32_bf16 v[16:19], a[28:31], v[224:227], v[16:19]
    ds_read_b128 v[180:183], v5 offset:5120
    v_exp_f32 v54, v54
    v_exp_f32 v55, v55
    v_mfma_f32_16x16x32_bf16 v[20:23], a[24:27], v[212:215], v[20:23]
    s_add_u32 s42, s56, s12
    ds_read_b128 v[184:187], v5 offset:6144
    v_fma_f32 v52, v52, s34, s34
    v_mfma_f32_16x16x32_bf16 v[20:23], a[28:31], v[228:231], v[20:23]
    buffer_load_dwordx4 a[8:11], v4, s[16:19], s42 offen offset:0 sc1
    ds_read_b128 v[188:191], v5 offset:7168
    v_fma_f32 v53, v53, s34, s34
    v_fma_f32 v54, v54, s34, s34
    v_fma_f32 v55, v55, s34, s34
    v_mfma_f32_16x16x32_bf16 v[24:27], a[24:27], v[216:219], v[24:27]
    ds_read_b128 v[192:195], v5 offset:20480
    v_mfma_f32_16x16x32_bf16 v[24:27], a[28:31], v[232:235], v[24:27]
    buffer_load_dwordx4 a[12:15], v4, s[16:19], s42 offen offset:1024 sc1
    ds_read_b128 v[196:199], v5 offset:21504
    v_rcp_f32 v52, v52
    v_rcp_f32_e64 v53, v53
    v_mfma_f32_16x16x32_bf16 v[28:31], a[24:27], v[220:223], v[28:31]
    ds_read_b128 v[200:203], v5 offset:22528
    v_mfma_f32_16x16x32_bf16 v[28:31], a[28:31], v[236:239], v[28:31]
    s_waitcnt vmcnt(10)
    ds_read_b128 v[204:207], v5 offset:23552
    v_rcp_f32 v54, v54
    v_rcp_f32 v55, v55
    v_mfma_f32_16x16x32_bf16 v[16:19], a[32:35], v[240:243], v[16:19]
    ds_read_b128 v[208:211], v5 offset:36864
    v_mul_f32 v52, v52, v36
    v_mfma_f32_16x16x32_bf16 v[16:19], a[36:39], a[64:67], v[16:19]
    ds_read_b128 v[212:215], v5 offset:37888
    v_mul_f32 v53, v53, v37
    v_mul_f32 v54, v54, v38
    v_mul_f32_e64 v55, v55, v39
    v_mfma_f32_16x16x32_bf16 v[20:23], a[32:35], v[244:247], v[20:23]
    ds_read_b128 v[216:219], v5 offset:38912
    v_cvt_pk_bf16_f32 v60, v52, v53
    v_mfma_f32_16x16x32_bf16 v[20:23], a[36:39], a[68:71], v[20:23]
    buffer_load_dwordx4 a[16:19], v4, s[16:19], s42 offen offset:2048 sc1
    ds_read_b128 v[220:223], v5 offset:39936
    v_cvt_pk_bf16_f32 v61, v54, v55
    v_mfma_f32_16x16x32_bf16 v[24:27], a[32:35], v[248:251], v[24:27]
    ds_read_b128 v[224:227], v5 offset:53248
    v_mfma_f32_16x16x32_bf16 v[24:27], a[36:39], a[72:75], v[24:27]
    buffer_load_dwordx4 a[20:23], v4, s[16:19], s42 offen offset:3072 sc1
    ds_read_b128 v[228:231], v5 offset:54272
    ds_write_b64 v9, v[60:61] offset:13320
    v_fma_f32 v48, -v40, v40, s32
    v_fma_f32 v49, -v41, v41, s32
    v_fma_f32 v50, -v42, v42, s32
    v_fma_f32 v51, -v43, v43, s32
    v_mfma_f32_16x16x32_bf16 v[28:31], a[32:35], v[252:255], v[28:31]
    ds_read_b128 v[232:235], v5 offset:55296
    v_mul_f32 v48, v48, v40
    v_mfma_f32_16x16x32_bf16 v[28:31], a[36:39], a[76:79], v[28:31]
    s_waitcnt vmcnt(10)
    ds_read_b128 v[236:239], v5 offset:56320
    v_mul_f32 v49, v49, v41
    v_mul_f32 v50, v50, v42
    v_mul_f32_e64 v51, v51, v43
    v_mfma_f32_16x16x32_bf16 v[16:19], a[40:43], a[80:83], v[16:19]
    ds_read_b128 v[240:243], v5 offset:8192
    v_mfma_f32_16x16x32_bf16 v[16:19], a[44:47], a[96:99], v[16:19]
    ds_read_b128 v[244:247], v5 offset:9216
    v_exp_f32 v48, v48
    v_exp_f32 v49, v49
    v_mfma_f32_16x16x32_bf16 v[20:23], a[40:43], a[84:87], v[20:23]
    s_add_u32 s42, s56, s13
    ds_read_b128 v[248:251], v5 offset:10240
    v_mfma_f32_16x16x32_bf16 v[20:23], a[44:47], a[100:103], v[20:23]
    buffer_load_dwordx4 a[24:27], v4, s[16:19], s42 offen offset:0 sc1
    ds_read_b128 v[252:255], v5 offset:11264
    v_exp_f32 v50, v50
    v_exp_f32_e64 v51, v51
    v_mfma_f32_16x16x32_bf16 v[24:27], a[40:43], a[88:91], v[24:27]
    ds_read_b128 a[64:67], v5 offset:24576
    v_fma_f32 v48, v48, s34, s34
    v_mfma_f32_16x16x32_bf16 v[24:27], a[44:47], a[104:107], v[24:27]
    buffer_load_dwordx4 a[28:31], v4, s[16:19], s42 offen offset:1024 sc1
    ds_read_b128 a[68:71], v5 offset:25600
    v_fma_f32 v49, v49, s34, s34
    v_fma_f32 v50, v50, s34, s34
    v_fma_f32 v51, v51, s34, s34
    v_mfma_f32_16x16x32_bf16 v[28:31], a[40:43], a[92:95], v[28:31]
    ds_read_b128 a[72:75], v5 offset:26624
    v_mfma_f32_16x16x32_bf16 v[28:31], a[44:47], a[108:111], v[28:31]
    s_waitcnt vmcnt(10)
    ds_read_b128 a[76:79], v5 offset:27648
    v_rcp_f32 v48, v48
    v_rcp_f32_e64 v49, v49
    v_mfma_f32_16x16x32_bf16 v[16:19], a[48:51], a[112:115], v[16:19]
    ds_read_b128 a[80:83], v5 offset:40960
    v_mfma_f32_16x16x32_bf16 v[16:19], a[52:55], a[128:131], v[16:19]
    ds_read_b128 a[84:87], v5 offset:41984
    v_rcp_f32 v50, v50
    v_rcp_f32 v51, v51
    v_mfma_f32_16x16x32_bf16 v[20:23], a[48:51], a[116:119], v[20:23]
    ds_read_b128 a[88:91], v5 offset:43008
    v_mul_f32_e64 v48, v48, v40
    v_mfma_f32_16x16x32_bf16 v[20:23], a[52:55], a[132:135], v[20:23]
    buffer_load_dwordx4 a[32:35], v4, s[16:19], s42 offen offset:2048 sc1
    ds_read_b128 a[92:95], v5 offset:44032
    v_mul_f32 v49, v49, v41
    v_mul_f32 v50, v50, v42
    v_mul_f32_e64 v51, v51, v43
    v_mfma_f32_16x16x32_bf16 v[24:27], a[48:51], a[120:123], v[24:27]
    ds_read_b128 a[96:99], v5 offset:57344
    v_cvt_pk_bf16_f32 v58, v48, v49
    v_mfma_f32_16x16x32_bf16 v[24:27], a[52:55], a[136:139], v[24:27]
    buffer_load_dwordx4 a[36:39], v4, s[16:19], s42 offen offset:3072 sc1
    ds_read_b128 a[100:103], v5 offset:58368
    v_cvt_pk_bf16_f32 v59, v50, v51
    v_mfma_f32_16x16x32_bf16 v[28:31], a[48:51], a[124:127], v[28:31]
    ds_read_b128 a[104:107], v5 offset:59392
    v_mfma_f32_16x16x32_bf16 v[28:31], a[52:55], a[140:143], v[28:31]
    s_waitcnt vmcnt(10)
    ds_read_b128 a[108:111], v5 offset:60416
    ds_write_b64 v9, v[58:59] offset:14344
    v_fma_f32 v52, -v44, v44, s32
    v_fma_f32 v53, -v45, v45, s32
    v_fma_f32 v54, -v46, v46, s32
    v_fma_f32 v55, -v47, v47, s32
    v_mfma_f32_16x16x32_bf16 v[16:19], a[56:59], a[144:147], v[16:19]
    ds_read_b128 a[208:211], v6 offset:0
    v_mul_f32 v52, v52, v44
    v_mfma_f32_16x16x32_bf16 v[16:19], a[60:63], a[160:163], v[16:19]
    ds_read_b128 a[212:215], v6 offset:1024
    v_mul_f32 v53, v53, v45
    v_mul_f32 v54, v54, v46
    v_mul_f32 v55, v55, v47
    v_mfma_f32_16x16x32_bf16 v[20:23], a[56:59], a[148:151], v[20:23]
    s_add_u32 s42, s56, s14
    ds_read_b128 a[216:219], v6 offset:2048
    v_mfma_f32_16x16x32_bf16 v[20:23], a[60:63], a[164:167], v[20:23]
    buffer_load_dwordx4 a[40:43], v4, s[16:19], s42 offen offset:0 sc1
    ds_read_b128 a[220:223], v6 offset:3072
    v_exp_f32 v52, v52
    v_exp_f32 v53, v53
    v_mfma_f32_16x16x32_bf16 v[24:27], a[56:59], a[152:155], v[24:27]
    ds_read_b128 a[224:227], v6 offset:4096
    v_mfma_f32_16x16x32_bf16 v[24:27], a[60:63], a[168:171], v[24:27]
    buffer_load_dwordx4 a[44:47], v4, s[16:19], s42 offen offset:1024 sc1
    ds_read_b128 a[228:231], v6 offset:5120
    v_exp_f32 v54, v54
    v_exp_f32 v55, v55
    v_mfma_f32_16x16x32_bf16 v[28:31], a[56:59], a[156:159], v[28:31]
    ds_read_b128 a[232:235], v6 offset:6144
    v_fma_f32 v52, v52, s34, s34
    v_mfma_f32_16x16x32_bf16 v[28:31], a[60:63], a[172:175], v[28:31]
    s_waitcnt vmcnt(10)
    ds_read_b128 a[236:239], v6 offset:7168
    v_fma_f32 v53, v53, s34, s34
    v_fma_f32 v54, v54, s34, s34
    v_fma_f32 v55, v55, s34, s34
    v_mfma_f32_16x16x32_bf16 v[16:19], a[0:3], a[176:179], v[16:19]
    ds_read_b128 a[240:243], v14 offset:0
    v_mfma_f32_16x16x32_bf16 v[16:19], a[4:7], a[192:195], v[16:19]
    ds_read_b128 a[244:247], v14 offset:256
    v_rcp_f32 v52, v52
    v_rcp_f32_e64 v53, v53
    v_mfma_f32_16x16x32_bf16 v[20:23], a[0:3], a[180:183], v[20:23]
    ds_read_b128 a[248:251], v14 offset:512
    v_mfma_f32_16x16x32_bf16 v[20:23], a[4:7], a[196:199], v[20:23]
    buffer_load_dwordx4 a[48:51], v4, s[16:19], s42 offen offset:2048 sc1
    ds_read_b128 a[252:255], v14 offset:768
    v_rcp_f32 v54, v54
    v_rcp_f32 v55, v55
    v_mfma_f32_16x16x32_bf16 v[24:27], a[0:3], a[184:187], v[24:27]
    v_mul_f32 v52, v52, v44
    v_mul_f32 v53, v53, v45
    v_mfma_f32_16x16x32_bf16 v[24:27], a[4:7], a[200:203], v[24:27]
    buffer_load_dwordx4 a[52:55], v4, s[16:19], s42 offen offset:3072 sc1
    v_mul_f32 v54, v54, v46
    v_mul_f32 v55, v55, v47
    v_mfma_f32_16x16x32_bf16 v[28:31], a[0:3], a[188:191], v[28:31]
    v_cvt_pk_bf16_f32 v60, v52, v53
    v_cvt_pk_bf16_f32 v61, v54, v55
    v_mfma_f32_16x16x32_bf16 v[28:31], a[4:7], a[204:207], v[28:31]
    s_waitcnt vmcnt(11) lgkmcnt(15)
    ds_write_b64 v9, v[60:61] offset:15368
    v_mfma_f32_16x16x32_bf16 v[32:35], a[8:11], v[112:115], 0
    v_fma_f32 v48, -v16, v16, s32
    v_fma_f32 v49, -v17, v17, s32
    v_mfma_f32_16x16x32_bf16 v[36:39], a[8:11], v[116:119], 0
    s_add_u32 s42, s56, 16384
    v_fma_f32 v50, -v18, v18, s32
    v_fma_f32 v51, -v19, v19, s32
    v_mfma_f32_16x16x32_bf16 v[40:43], a[8:11], v[120:123], 0
    buffer_load_dwordx4 a[56:59], v4, s[16:19], s42 offen offset:0 sc1
    s_waitcnt lgkmcnt(0)
    s_barrier
    v_mul_f32 v48, v48, v16
    v_mul_f32 v49, v49, v17
    v_mul_f32 v50, v50, v18
    v_mfma_f32_16x16x32_bf16 v[44:47], a[8:11], v[124:127], 0
    s_waitcnt vmcnt(10)
    v_mul_f32 v51, v51, v19
    v_exp_f32 v48, v48
    v_mfma_f32_16x16x32_bf16 v[32:35], a[12:15], v[128:131], v[32:35]
    v_exp_f32 v49, v49
    v_mfma_f32_16x16x32_bf16 v[32:35], a[16:19], v[144:147], v[32:35]
    v_exp_f32 v50, v50
    v_mfma_f32_16x16x32_bf16 v[36:39], a[12:15], v[132:135], v[36:39]
    v_exp_f32 v51, v51
    v_mfma_f32_16x16x32_bf16 v[36:39], a[16:19], v[148:151], v[36:39]
    buffer_load_dwordx4 a[60:63], v4, s[16:19], s42 offen offset:1024 sc1
    v_fma_f32 v48, v48, s34, s34
    v_fma_f32 v49, v49, s34, s34
    v_mfma_f32_16x16x32_bf16 v[40:43], a[12:15], v[136:139], v[40:43]
    ds_read_b128 a[112:115], v5 offset:12288
    v_fma_f32 v50, v50, s34, s34
    v_mfma_f32_16x16x32_bf16 v[40:43], a[16:19], v[152:155], v[40:43]
    buffer_load_dwordx4 a[0:3], v56, s[16:19], s42 offen offset:2048 sc1
    ds_read_b128 a[116:119], v5 offset:13312
    v_fma_f32 v51, v51, s34, s34
    v_rcp_f32_e64 v48, v48
    v_mfma_f32_16x16x32_bf16 v[44:47], a[12:15], v[140:143], v[44:47]
    ds_read_b128 a[120:123], v5 offset:14336
    v_mfma_f32_16x16x32_bf16 v[44:47], a[16:19], v[156:159], v[44:47]
    s_waitcnt vmcnt(10)
    ds_read_b128 a[124:127], v5 offset:15360
    v_rcp_f32 v49, v49
    v_rcp_f32 v50, v50
    v_rcp_f32 v51, v51
    v_mfma_f32_16x16x32_bf16 v[32:35], a[20:23], v[160:163], v[32:35]
    v_mul_f32 v48, v48, v16
    v_mul_f32 v49, v49, v17
    v_mfma_f32_16x16x32_bf16 v[32:35], a[24:27], v[176:179], v[32:35]
    v_mul_f32 v50, v50, v18
    v_mul_f32_e64 v51, v51, v19
    v_mfma_f32_16x16x32_bf16 v[36:39], a[20:23], v[164:167], v[36:39]
    s_add_u32 s42, s56, s15
    v_cvt_pk_bf16_f32 v58, v48, v49
    v_cvt_pk_bf16_f32 v59, v50, v51
    v_mfma_f32_16x16x32_bf16 v[36:39], a[24:27], v[180:183], v[36:39]
    buffer_load_dwordx4 a[4:7], v4, s[16:19], s42 offen offset:0 sc1
    ds_write_b64 v10, v[58:59] offset:0
    v_mfma_f32_16x16x32_bf16 v[40:43], a[20:23], v[168:171], v[40:43]
    v_fma_f32 v52, -v20, v20, s32
    v_fma_f32 v53, -v21, v21, s32
    v_mfma_f32_16x16x32_bf16 v[40:43], a[24:27], v[184:187], v[40:43]
    buffer_load_dwordx4 a[8:11], v4, s[16:19], s42 offen offset:1024 sc1
    v_fma_f32 v54, -v22, v22, s32
    v_fma_f32 v55, -v23, v23, s32
    v_mul_f32_e64 v52, v52, v20
    v_mfma_f32_16x16x32_bf16 v[44:47], a[20:23], v[172:175], v[44:47]
    v_mul_f32 v53, v53, v21
    v_mul_f32 v54, v54, v22
    v_mfma_f32_16x16x32_bf16 v[44:47], a[24:27], v[188:191], v[44:47]
    s_waitcnt vmcnt(10)
    v_mul_f32 v55, v55, v23
    v_exp_f32_e64 v52, v52
    v_mfma_f32_16x16x32_bf16 v[32:35], a[28:31], v[192:195], v[32:35]
    ds_read_b128 a[128:131], v5 offset:28672
    v_mfma_f32_16x16x32_bf16 v[32:35], a[32:35], v[208:211], v[32:35]
    ds_read_b128 a[132:135], v5 offset:29696
    v_exp_f32 v53, v53
    v_exp_f32 v54, v54
    v_mfma_f32_16x16x32_bf16 v[36:39], a[28:31], v[196:199], v[36:39]
    ds_read_b128 a[136:139], v5 offset:30720
    v_mfma_f32_16x16x32_bf16 v[36:39], a[32:35], v[212:215], v[36:39]
    buffer_load_dwordx4 a[12:15], v4, s[16:19], s42 offen offset:2048 sc1
    ds_read_b128 a[140:143], v5 offset:31744
    v_exp_f32_e64 v55, v55
    v_fma_f32 v52, v52, s34, s34
    v_fma_f32 v53, v53, s34, s34
    v_fma_f32 v54, v54, s34, s34
    v_mfma_f32_16x16x32_bf16 v[40:43], a[28:31], v[200:203], v[40:43]
    v_fma_f32 v55, v55, s34, s34
    v_mfma_f32_16x16x32_bf16 v[40:43], a[32:35], v[216:219], v[40:43]
    buffer_load_dwordx4 a[16:19], v4, s[16:19], s42 offen offset:3072 sc1
    v_rcp_f32 v52, v52
    v_rcp_f32 v53, v53
    v_mfma_f32_16x16x32_bf16 v[44:47], a[28:31], v[204:207], v[44:47]
    v_rcp_f32 v54, v54
    v_mfma_f32_16x16x32_bf16 v[44:47], a[32:35], v[220:223], v[44:47]
    s_waitcnt vmcnt(10)
    v_rcp_f32_e64 v55, v55
    v_mfma_f32_16x16x32_bf16 v[32:35], a[36:39], v[224:227], v[32:35]
    v_mul_f32 v52, v52, v20
    v_mul_f32 v53, v53, v21
    v_mfma_f32_16x16x32_bf16 v[32:35], a[40:43], v[240:243], v[32:35]
    v_mul_f32 v54, v54, v22
    v_mul_f32 v55, v55, v23
    v_cvt_pk_bf16_f32 v60, v52, v53
    v_mfma_f32_16x16x32_bf16 v[36:39], a[36:39], v[228:231], v[36:39]
    s_add_u32 s42, s56, 19456
    v_cvt_pk_bf16_f32 v61, v54, v55
    v_mfma_f32_16x16x32_bf16 v[36:39], a[40:43], v[244:247], v[36:39]
    buffer_load_dwordx4 a[20:23], v4, s[16:19], s42 offen offset:0 sc1
    ds_write_b64 v10, v[60:61] offset:1024
    v_fma_f32 v48, -v24, v24, s32
    v_mfma_f32_16x16x32_bf16 v[40:43], a[36:39], v[232:235], v[40:43]
    ds_read_b128 a[144:147], v5 offset:45056
    v_fma_f32 v49, -v25, v25, s32
    v_mfma_f32_16x16x32_bf16 v[40:43], a[40:43], v[248:251], v[40:43]
    buffer_load_dwordx4 a[24:27], v4, s[16:19], s42 offen offset:1024 sc1
    ds_read_b128 a[148:151], v5 offset:46080
    v_fma_f32 v50, -v26, v26, s32
    v_fma_f32 v51, -v27, v27, s32
    v_mul_f32 v48, v48, v24
    v_mfma_f32_16x16x32_bf16 v[44:47], a[36:39], v[236:239], v[44:47]
    ds_read_b128 a[152:155], v5 offset:47104
    v_mul_f32 v49, v49, v25
    v_mfma_f32_16x16x32_bf16 v[44:47], a[40:43], v[252:255], v[44:47]
    s_waitcnt vmcnt(10)
    ds_read_b128 a[156:159], v5 offset:48128
    v_mul_f32 v50, v50, v26
    v_mul_f32 v51, v51, v27
    v_exp_f32 v48, v48
    v_mfma_f32_16x16x32_bf16 v[32:35], a[44:47], a[64:67], v[32:35]
    v_exp_f32 v49, v49
    v_mfma_f32_16x16x32_bf16 v[32:35], a[48:51], a[80:83], v[32:35]
    v_exp_f32 v50, v50
    v_mfma_f32_16x16x32_bf16 v[36:39], a[44:47], a[68:71], v[36:39]
    s_add_u32 s42, s48, s12
    v_exp_f32 v51, v51
    v_mfma_f32_16x16x32_bf16 v[36:39], a[48:51], a[84:87], v[36:39]
    buffer_load_dwordx4 a[28:31], v4, s[16:19], s42 offen offset:0 sc1
    v_fma_f32 v48, v48, s34, s34
    v_fma_f32 v49, v49, s34, s34
    v_fma_f32 v50, v50, s34, s34
    v_mfma_f32_16x16x32_bf16 v[40:43], a[44:47], a[72:75], v[40:43]
    s_bfe_u32 s56, s2, 196612
    s_add_u32 s56, s5, s56
    v_fma_f32 v51, v51, s34, s34
    v_mfma_f32_16x16x32_bf16 v[40:43], a[48:51], a[88:91], v[40:43]
    buffer_load_dwordx4 a[32:35], v4, s[16:19], s42 offen offset:1024 sc1
    v_rcp_f32 v48, v48
    v_rcp_f32_e64 v49, v49
    v_mfma_f32_16x16x32_bf16 v[44:47], a[44:47], a[76:79], v[44:47]
    s_and_b32 s56, s56, 7
    v_rcp_f32 v50, v50
    v_mfma_f32_16x16x32_bf16 v[44:47], a[48:51], a[92:95], v[44:47]
    s_waitcnt vmcnt(10)
    v_rcp_f32 v51, v51
    v_mul_f32 v48, v48, v24
    v_mfma_f32_16x16x32_bf16 v[32:35], a[52:55], a[96:99], v[32:35]
    s_mul_i32 s56, s56, 86016
    ds_read_b128 a[160:163], v5 offset:61440
    v_mul_f32 v49, v49, v25
    v_mfma_f32_16x16x32_bf16 v[32:35], a[56:59], a[208:211], v[32:35]
    ds_read_b128 a[164:167], v5 offset:62464
    v_mul_f32 v50, v50, v26
    v_mul_f32 v51, v51, v27
    v_cvt_pk_bf16_f32 v58, v48, v49
    v_cvt_pk_bf16_f32 v59, v50, v51
    v_mfma_f32_16x16x32_bf16 v[36:39], a[52:55], a[100:103], v[36:39]
    s_add_u32 s56, s56, s59
    ds_read_b128 a[168:171], v5 offset:63488
    v_mfma_f32_16x16x32_bf16 v[36:39], a[56:59], a[212:215], v[36:39]
    buffer_load_dwordx4 a[36:39], v4, s[16:19], s42 offen offset:2048 sc1
    ds_read_b128 a[172:175], v5 offset:64512
    ds_write_b64 v10, v[58:59] offset:2048
    v_fma_f32 v52, -v28, v28, s32
    v_mfma_f32_16x16x32_bf16 v[40:43], a[52:55], a[104:107], v[40:43]
    v_fma_f32 v53, -v29, v29, s32
    v_fma_f32 v54, -v30, v30, s32
    v_mfma_f32_16x16x32_bf16 v[40:43], a[56:59], a[216:219], v[40:43]
    buffer_load_dwordx4 a[40:43], v4, s[16:19], s42 offen offset:3072 sc1
    v_fma_f32 v55, -v31, v31, s32
    v_mul_f32 v52, v52, v28
    v_mul_f32_e64 v53, v53, v29
    v_mfma_f32_16x16x32_bf16 v[44:47], a[52:55], a[108:111], v[44:47]
    v_mul_f32 v54, v54, v30
    v_mul_f32 v55, v55, v31
    v_mfma_f32_16x16x32_bf16 v[44:47], a[56:59], a[220:223], v[44:47]
    s_waitcnt vmcnt(10)
    v_exp_f32 v52, v52
    v_mfma_f32_16x16x32_bf16 v[32:35], a[60:63], a[224:227], v[32:35]
    v_exp_f32 v53, v53
    v_mfma_f32_16x16x32_bf16 v[32:35], a[0:3], a[240:243], v[32:35]
    v_exp_f32 v54, v54
    v_mfma_f32_16x16x32_bf16 v[36:39], a[60:63], a[228:231], v[36:39]
    s_add_u32 s42, s48, s13
    v_exp_f32 v55, v55
    v_mfma_f32_16x16x32_bf16 v[36:39], a[0:3], a[244:247], v[36:39]
    buffer_load_dwordx4 a[44:47], v4, s[16:19], s42 offen offset:0 sc1
    v_fma_f32 v52, v52, s34, s34
    v_fma_f32 v53, v53, s34, s34
    v_fma_f32 v54, v54, s34, s34
    v_fma_f32 v55, v55, s34, s34
    v_mfma_f32_16x16x32_bf16 v[40:43], a[60:63], a[232:235], v[40:43]
    v_rcp_f32 v52, v52
    v_mfma_f32_16x16x32_bf16 v[40:43], a[0:3], a[248:251], v[40:43]
    buffer_load_dwordx4 a[48:51], v4, s[16:19], s42 offen offset:1024 sc1
    v_rcp_f32 v53, v53
    v_mfma_f32_16x16x32_bf16 v[44:47], a[60:63], a[236:239], v[44:47]
    v_rcp_f32 v54, v54
    v_mfma_f32_16x16x32_bf16 v[44:47], a[0:3], a[252:255], v[44:47]
    s_waitcnt vmcnt(10) lgkmcnt(10)
    v_rcp_f32 v55, v55
    v_mul_f32 v52, v52, v28
    v_mfma_f32_16x16x32_bf16 v[32:35], a[4:7], a[112:115], v[32:35]
    v_mul_f32 v53, v53, v29
    v_mul_f32 v54, v54, v30
    v_mfma_f32_16x16x32_bf16 v[32:35], a[8:11], a[128:131], v[32:35]
    v_mul_f32_e64 v55, v55, v31
    v_cvt_pk_bf16_f32 v60, v52, v53
    v_cvt_pk_bf16_f32 v61, v54, v55
    v_mfma_f32_16x16x32_bf16 v[36:39], a[4:7], a[116:119], v[36:39]
    ds_write_b64 v10, v[60:61] offset:3072
    v_mfma_f32_16x16x32_bf16 v[36:39], a[8:11], a[132:135], v[36:39]
    s_mul_i32 s52, s6, 9
    buffer_load_dwordx4 a[52:55], v4, s[16:19], s42 offen offset:2048 sc1
    s_waitcnt lgkmcnt(0)
    s_barrier
    v_mfma_f32_16x16x32_bf16 v[40:43], a[4:7], a[120:123], v[40:43]
    s_add_u32 s52, s52, 8
    s_lshl_b32 s52, s52, 8
    ds_read_b128 a[176:179], v8 offset:0
    v_mfma_f32_16x16x32_bf16 v[40:43], a[8:11], a[136:139], v[40:43]
    s_add_u32 s52, s52, s4
    buffer_load_dwordx4 a[56:59], v4, s[16:19], s42 offen offset:3072 sc1
    ds_read_b128 a[180:183], v8 offset:1024
    v_mfma_f32_16x16x32_bf16 v[44:47], a[4:7], a[124:127], v[44:47]
    s_lshl_b32 s52, s52, 8
    s_add_u32 s52, s52, 9175040
    ds_read_b128 a[184:187], v8 offset:2048
    v_mfma_f32_16x16x32_bf16 v[44:47], a[8:11], a[140:143], v[44:47]
    s_waitcnt vmcnt(10)
    s_lshl_b32 s60, s5, 10
    ds_read_b128 a[188:191], v8 offset:3072
    v_mfma_f32_16x16x32_bf16 v[32:35], a[12:15], a[144:147], v[32:35]
    s_add_u32 s60, s60, s52
    s_lshl_b32 s61, s7, 7
    ds_read_b128 a[192:195], v8 offset:4096
    v_mfma_f32_16x16x32_bf16 v[32:35], a[16:19], a[160:163], v[32:35]
    s_add_u32 s61, s61, 16384
    ds_read_b128 a[196:199], v8 offset:5120
    v_bfe_u32 v12, v1, 3, 2
    v_mfma_f32_16x16x32_bf16 v[36:39], a[12:15], a[148:151], v[36:39]
    s_add_u32 s42, s48, s14
    ds_read_b128 a[200:203], v8 offset:6144
    v_lshlrev_b32_e64 v12, 13, v12
    v_mfma_f32_16x16x32_bf16 v[36:39], a[16:19], a[164:167], v[36:39]
    buffer_load_dwordx4 a[60:63], v4, s[16:19], s42 offen offset:0 sc1
    ds_read_b128 a[204:207], v8 offset:7168
    v_mfma_f32_16x16x32_bf16 v[40:43], a[12:15], a[152:155], v[40:43]
    v_lshrrev_b32_e64 v13, 5, v1
    v_lshl_add_u32 v12, v13, 7, v12
    v_mfma_f32_16x16x32_bf16 v[40:43], a[16:19], a[168:171], v[40:43]
    buffer_load_dwordx4 a[0:3], v4, s[16:19], s42 offen offset:1024 sc1
    v_and_b32_e64 v13, 7, v1
    v_mfma_f32_16x16x32_bf16 v[44:47], a[12:15], a[156:159], v[44:47]
    v_lshl_add_u32 v15, v13, 4, v12
    v_mfma_f32_16x16x32_bf16 v[44:47], a[16:19], a[172:175], v[44:47]
    s_waitcnt vmcnt(10) lgkmcnt(0)
    v_mfma_f32_16x16x32_bf16 v[32:35], a[20:23], a[176:179], v[32:35]
    v_mfma_f32_16x16x32_bf16 v[32:35], a[24:27], a[192:195], v[32:35]
    v_mfma_f32_16x16x32_bf16 v[36:39], a[20:23], a[180:183], v[36:39]
    v_mfma_f32_16x16x32_bf16 v[36:39], a[24:27], a[196:199], v[36:39]
    buffer_load_dwordx4 a[4:7], v4, s[16:19], s42 offen offset:2048 sc1
    v_mfma_f32_16x16x32_bf16 v[40:43], a[20:23], a[184:187], v[40:43]
    v_mfma_f32_16x16x32_bf16 v[40:43], a[24:27], a[200:203], v[40:43]
    buffer_load_dwordx4 a[8:11], v4, s[16:19], s42 offen offset:3072 sc1
    v_mfma_f32_16x16x32_bf16 v[44:47], a[20:23], a[188:191], v[44:47]
    v_mfma_f32_16x16x32_bf16 v[44:47], a[24:27], a[204:207], v[44:47]
    s_waitcnt vmcnt(11)
    v_mfma_f32_16x16x32_bf16 v[16:19], a[28:31], v[112:115], 0
    v_mfma_f32_16x16x32_bf16 v[20:23], a[28:31], v[116:119], 0
    s_add_u32 s42, s48, 16384
    v_mfma_f32_16x16x32_bf16 v[24:27], a[28:31], v[120:123], 0
    buffer_load_dwordx4 a[12:15], v4, s[16:19], s42 offen offset:0 sc1
    v_mfma_f32_16x16x32_bf16 v[28:31], a[28:31], v[124:127], 0
    s_waitcnt vmcnt(10)
    v_cvt_pk_bf16_f32 v96, v32, v33
    v_cvt_pk_bf16_f32 v97, v34, v35
    v_mfma_f32_16x16x32_bf16 v[16:19], a[32:35], v[128:131], v[16:19]
    v_cvt_pk_bf16_f32 v98, v36, v37
    v_cvt_pk_bf16_f32 v99, v38, v39
    v_mfma_f32_16x16x32_bf16 v[16:19], a[36:39], v[144:147], v[16:19]
    v_permlane16_swap_b32 v96, v98
    v_permlane16_swap_b32 v97, v99
    v_mfma_f32_16x16x32_bf16 v[20:23], a[32:35], v[132:135], v[20:23]
    v_mfma_f32_16x16x32_bf16 v[20:23], a[36:39], v[148:151], v[20:23]
    buffer_load_dwordx4 a[16:19], v4, s[16:19], s42 offen offset:1024 sc1
    v_mfma_f32_16x16x32_bf16 v[24:27], a[32:35], v[136:139], v[24:27]
    v_mfma_f32_16x16x32_bf16 v[24:27], a[36:39], v[152:155], v[24:27]
    buffer_load_dwordx4 a[20:23], v56, s[16:19], s42 offen offset:2048 sc1
    v_mfma_f32_16x16x32_bf16 v[28:31], a[32:35], v[140:143], v[28:31]
    v_mfma_f32_16x16x32_bf16 v[28:31], a[36:39], v[156:159], v[28:31]
    s_waitcnt vmcnt(10)
    buffer_store_dwordx4 v[96:99], v15, s[16:19], s60 offen sc1
    v_mfma_f32_16x16x32_bf16 v[16:19], a[40:43], v[160:163], v[16:19]
    s_add_u32 s60, s60, 32768
    v_cvt_pk_bf16_f32 v100, v40, v41
    v_cvt_pk_bf16_f32 v101, v42, v43
    v_mfma_f32_16x16x32_bf16 v[16:19], a[44:47], v[176:179], v[16:19]
    v_cvt_pk_bf16_f32 v102, v44, v45
    v_cvt_pk_bf16_f32 v103, v46, v47
    v_mfma_f32_16x16x32_bf16 v[20:23], a[40:43], v[164:167], v[20:23]
    s_add_u32 s42, s48, s15
    v_permlane16_swap_b32 v100, v102
    v_permlane16_swap_b32 v101, v103
    v_mfma_f32_16x16x32_bf16 v[20:23], a[44:47], v[180:183], v[20:23]
    buffer_load_dwordx4 a[24:27], v4, s[16:19], s42 offen offset:0 sc1
    v_mfma_f32_16x16x32_bf16 v[24:27], a[40:43], v[168:171], v[24:27]
    v_mfma_f32_16x16x32_bf16 v[24:27], a[44:47], v[184:187], v[24:27]
    buffer_load_dwordx4 a[28:31], v4, s[16:19], s42 offen offset:1024 sc1
    buffer_store_dwordx4 v[100:103], v15, s[16:19], s60 offen sc1
    s_add_u32 s60, s60, 32768
    v_mfma_f32_16x16x32_bf16 v[28:31], a[40:43], v[172:175], v[28:31]
    s_lshl_b32 s29, s5, 2
    s_add_u32 s29, s29, s4
    s_lshl_b32 s29, s29, 11
    v_mfma_f32_16x16x32_bf16 v[28:31], a[44:47], v[188:191], v[28:31]
    s_waitcnt vmcnt(12)
    s_add_u32 s30, s44, 2621440
    s_add_u32 s29, s29, s30
    v_mfma_f32_16x16x32_bf16 v[16:19], a[48:51], v[192:195], v[16:19]
    v_and_b32 v5, 31, v1
    v_lshrrev_b32 v6, 1, v3
    v_mfma_f32_16x16x32_bf16 v[16:19], a[52:55], v[208:211], v[16:19]
    v_lshlrev_b32_e64 v5, 4, v5
    v_lshl_add_u32 v5, v6, 10, v5
    v_mfma_f32_16x16x32_bf16 v[20:23], a[48:51], v[196:199], v[20:23]
    v_mfma_f32_16x16x32_bf16 v[20:23], a[52:55], v[212:215], v[20:23]
    buffer_load_dwordx4 a[32:35], v4, s[16:19], s42 offen offset:2048 sc1
    buffer_load_dwordx4 v[80:83], v5, s[16:19], s29 offen offset:0 sc1
    v_mfma_f32_16x16x32_bf16 v[24:27], a[48:51], v[200:203], v[24:27]
    v_mfma_f32_16x16x32_bf16 v[24:27], a[52:55], v[216:219], v[24:27]
    buffer_load_dwordx4 a[36:39], v4, s[16:19], s42 offen offset:3072 sc1
    buffer_load_dwordx4 v[84:87], v5, s[16:19], s29 offen offset:512 sc1
    v_mfma_f32_16x16x32_bf16 v[28:31], a[48:51], v[204:207], v[28:31]
Lpad53076_5:
    s_cbranch_execz Lpadret
    s_lshl_b32 s29, s4, 4
    s_add_u32 s29, s29, s5
    s_lshl_b32 s29, s29, 7
    v_mfma_f32_16x16x32_bf16 v[28:31], a[52:55], v[220:223], v[28:31]
    s_waitcnt vmcnt(14)
    s_add_u32 s29, s29, s30
    s_add_u32 s29, s29, 65536
    v_mfma_f32_16x16x32_bf16 v[16:19], a[56:59], v[224:227], v[16:19]
    v_and_b32_e64 v7, 7, v1
    v_bfe_u32 v8, v1, 3, 1
    v_mfma_f32_16x16x32_bf16 v[16:19], a[60:63], v[240:243], v[16:19]
    v_lshlrev_b32_e64 v5, 26, v3
    v_lshl_add_u32 v5, v8, 10, v5
    v_mfma_f32_16x16x32_bf16 v[20:23], a[56:59], v[228:231], v[20:23]
    s_add_u32 s42, s48, 19456
    v_lshl_add_u32 v5, v7, 4, v5
    v_mfma_f32_16x16x32_bf16 v[20:23], a[60:63], v[244:247], v[20:23]
    buffer_load_dwordx4 a[40:43], v4, s[16:19], s42 offen offset:0 sc1
    buffer_load_dwordx4 v[108:111], v5, s[16:19], s29 offen sc1
    v_mfma_f32_16x16x32_bf16 v[24:27], a[56:59], v[232:235], v[24:27]
    s_lshl_b32 s29, s4, 1
    v_add_u32 v6, s29, v6
    v_xor_b32_e64 v6, v6, v7
    v_mfma_f32_16x16x32_bf16 v[24:27], a[60:63], v[248:251], v[24:27]
    buffer_load_dwordx4 a[44:47], v4, s[16:19], s42 offen offset:1024 sc1
    v_lshlrev_b32_e64 v6, 4, v6
    v_mfma_f32_16x16x32_bf16 v[28:31], a[56:59], v[236:239], v[28:31]
    v_lshl_add_u32 v6, v2, 7, v6
    v_and_b32 v5, 1, v3
    v_mfma_f32_16x16x32_bf16 v[28:31], a[60:63], v[252:255], v[28:31]
    s_waitcnt vmcnt(15)
    v_lshl_add_u32 v6, v5, 3, v6
    v_add_u32 v63, 0, v6
    v_mfma_f32_16x16x32_bf16 v[16:19], a[0:3], a[64:67], v[16:19]
    v_add_u32 v8, s29, v8
    v_xor_b32 v8, v8, v7
    v_mfma_f32_16x16x32_bf16 v[16:19], a[4:7], a[80:83], v[16:19]
    v_lshlrev_b32 v8, 4, v8
    v_lshl_add_u32 v8, v7, 7, v8
    v_mfma_f32_16x16x32_bf16 v[20:23], a[0:3], a[68:71], v[20:23]
    s_add_u32 s42, s56, s12
    v_lshl_add_u32 v8, v3, 2, v8
    v_add_u32 v14, 8192, v8
    v_mfma_f32_16x16x32_bf16 v[20:23], a[4:7], a[84:87], v[20:23]
    s_lshl_b32 s29, s5, 6
    s_add_u32 s29, s29, 159744
    buffer_load_dwordx4 a[48:51], v4, s[16:19], s42 offen offset:0 sc1
    v_mfma_f32_16x16x32_bf16 v[24:27], a[0:3], a[72:75], v[24:27]
    s_bfe_u32 s48, s2, 196616
    s_add_u32 s48, s5, s48
    s_and_b32 s48, s48, 7
    v_mfma_f32_16x16x32_bf16 v[24:27], a[4:7], a[88:91], v[24:27]
    s_mul_i32 s48, s48, 86016
    s_add_u32 s48, s48, s59
    buffer_load_dwordx4 a[52:55], v4, s[16:19], s42 offen offset:1024 sc1
    v_mfma_f32_16x16x32_bf16 v[28:31], a[0:3], a[76:79], v[28:31]
    v_lshl_add_u32 v7, v7, 3, s29
    v_lshlrev_b32_e64 v8, 3, v2
    v_mfma_f32_16x16x32_bf16 v[28:31], a[4:7], a[92:95], v[28:31]
    s_waitcnt vmcnt(15)
    v_add_u32 v8, 159744, v8
    v_mfma_f32_16x16x32_bf16 v[16:19], a[8:11], a[96:99], v[16:19]
    s_nop 0
    ds_read_b64 v[88:89], v63 offset:0
    ds_read_b64 v[90:91], v63 offset:2048
    v_mfma_f32_16x16x32_bf16 v[16:19], a[12:15], a[208:211], v[16:19]
    s_nop 0
    ds_read_b64 v[92:93], v63 offset:4096
    ds_read_b64 v[94:95], v63 offset:6144
    v_mfma_f32_16x16x32_bf16 v[20:23], a[8:11], a[100:103], v[20:23]
    s_nop 0
    ds_read_b64 v[48:49], v8 offset:0
    ds_read_b64 v[50:51], v8 offset:128
    v_mfma_f32_16x16x32_bf16 v[20:23], a[12:15], a[212:215], v[20:23]
    buffer_load_dwordx4 a[56:59], v4, s[16:19], s42 offen offset:2048 sc1
    ds_read_b64 v[52:53], v8 offset:256
    v_mfma_f32_16x16x32_bf16 v[24:27], a[8:11], a[104:107], v[24:27]
    s_nop 0
    ds_read_b64 v[54:55], v8 offset:384
    ds_read_b64 v[106:107], v7
    v_mfma_f32_16x16x32_bf16 v[24:27], a[12:15], a[216:219], v[24:27]
    buffer_load_dwordx4 a[60:63], v4, s[16:19], s42 offen offset:3072 sc1
    ds_read_b32 v105, v14
    v_mfma_f32_16x16x32_bf16 v[28:31], a[8:11], a[108:111], v[28:31]
    s_bfe_u32 s27, s2, 196608
    s_add_u32 s27, s5, s27
    s_and_b32 s27, s27, 7
    v_mfma_f32_16x16x32_bf16 v[28:31], a[12:15], a[220:223], v[28:31]
    s_waitcnt vmcnt(15)
    s_lshl_b32 s60, s27, 16
    s_add_u32 s60, s60, s57
    v_mfma_f32_16x16x32_bf16 v[16:19], a[16:19], a[224:227], v[16:19]
    s_lshl_b32 s49, s27, 9
    s_add_u32 s49, s49, s58
    v_mfma_f32_16x16x32_bf16 v[16:19], a[20:23], a[240:243], v[16:19]
    s_waitcnt lgkmcnt(0)
    v_add_f32 v106, 1.0, v106
    v_lshlrev_b32 v104, 16, v105
    v_mfma_f32_16x16x32_bf16 v[20:23], a[16:19], a[228:231], v[20:23]
    s_add_u32 s42, s56, s13
    v_and_b32 v105, s41, v105
    v_fma_f32 v104, v104, v106, v107
    v_mfma_f32_16x16x32_bf16 v[20:23], a[20:23], a[244:247], v[20:23]
    buffer_load_dwordx4 a[0:3], v4, s[16:19], s42 offen offset:0 sc1
    v_fma_f32 v105, v105, v106, v107
    v_mfma_f32_16x16x32_bf16 v[24:27], a[16:19], a[232:235], v[24:27]
    v_add_f32 v48, 1.0, v48
    v_lshlrev_b32 v64, 16, v88
    v_mfma_f32_16x16x32_bf16 v[24:27], a[20:23], a[248:251], v[24:27]
    buffer_load_dwordx4 a[4:7], v4, s[16:19], s42 offen offset:1024 sc1
    v_and_b32 v65, s41, v88
    v_mfma_f32_16x16x32_bf16 v[28:31], a[16:19], a[236:239], v[28:31]
    v_lshlrev_b32 v66, 16, v89
    v_and_b32 v67, s41, v89
    v_mfma_f32_16x16x32_bf16 v[28:31], a[20:23], a[252:255], v[28:31]
    s_waitcnt vmcnt(14)
    v_fma_f32 v64, v64, v48, v49
    v_fma_f32 v65, v65, v48, v49
    v_mfma_f32_16x16x32_bf16 v[16:19], a[24:27], a[112:115], v[16:19]
    v_fma_f32 v66, v66, v48, v49
    v_fma_f32 v67, v67, v48, v49
    v_mfma_f32_16x16x32_bf16 v[16:19], a[28:31], a[128:131], v[16:19]
    v_add_f32 v50, 1.0, v50
    v_lshlrev_b32 v68, 16, v90
    v_mfma_f32_16x16x32_bf16 v[20:23], a[24:27], a[116:119], v[20:23]
    v_and_b32 v69, s41, v90
    v_lshlrev_b32 v70, 16, v91
    v_mfma_f32_16x16x32_bf16 v[20:23], a[28:31], a[132:135], v[20:23]
    buffer_load_dwordx4 a[8:11], v4, s[16:19], s42 offen offset:2048 sc1
    v_and_b32_e64 v71, s41, v91
    v_mfma_f32_16x16x32_bf16 v[24:27], a[24:27], a[120:123], v[24:27]
    v_fma_f32 v68, v68, v50, v51
    v_fma_f32 v69, v69, v50, v51
    v_mfma_f32_16x16x32_bf16 v[24:27], a[28:31], a[136:139], v[24:27]
    buffer_load_dwordx4 a[12:15], v4, s[16:19], s42 offen offset:3072 sc1
    v_fma_f32 v70, v70, v50, v51
    v_mfma_f32_16x16x32_bf16 v[28:31], a[24:27], a[124:127], v[28:31]
    v_fma_f32 v71, v71, v50, v51
    v_add_f32 v52, 1.0, v52
    v_mfma_f32_16x16x32_bf16 v[28:31], a[28:31], a[140:143], v[28:31]
    s_waitcnt vmcnt(12)
    v_lshlrev_b32 v72, 16, v92
    v_and_b32 v73, s41, v92
    v_mfma_f32_16x16x32_bf16 v[16:19], a[32:35], a[144:147], v[16:19]
    v_lshlrev_b32 v74, 16, v93
    v_and_b32 v75, s41, v93
    v_mfma_f32_16x16x32_bf16 v[16:19], a[36:39], a[160:163], v[16:19]
    v_fma_f32 v72, v72, v52, v53
    v_fma_f32 v73, v73, v52, v53
    v_mfma_f32_16x16x32_bf16 v[20:23], a[32:35], a[148:151], v[20:23]
    s_add_u32 s42, s56, s14
    v_fma_f32 v74, v74, v52, v53
    v_fma_f32 v75, v75, v52, v53
    v_mfma_f32_16x16x32_bf16 v[20:23], a[36:39], a[164:167], v[20:23]
    buffer_load_dwordx4 a[16:19], v4, s[16:19], s42 offen offset:0 sc1
    v_add_f32 v54, 1.0, v54
    v_mfma_f32_16x16x32_bf16 v[24:27], a[32:35], a[152:155], v[24:27]
    v_lshlrev_b32 v76, 16, v94
    v_and_b32 v77, s41, v94
    v_mfma_f32_16x16x32_bf16 v[24:27], a[36:39], a[168:171], v[24:27]
    buffer_load_dwordx4 a[20:23], v4, s[16:19], s42 offen offset:1024 sc1
    v_lshlrev_b32 v78, 16, v95
    v_mfma_f32_16x16x32_bf16 v[28:31], a[32:35], a[156:159], v[28:31]
    v_and_b32 v79, s41, v95
    v_fma_f32 v76, v76, v54, v55
    v_mfma_f32_16x16x32_bf16 v[28:31], a[36:39], a[172:175], v[28:31]
    s_waitcnt vmcnt(10)
    v_fma_f32 v77, v77, v54, v55
    v_fma_f32 v78, v78, v54, v55
    v_mfma_f32_16x16x32_bf16 v[16:19], a[40:43], a[176:179], v[16:19]
    v_min_u32 v9, 1, v1
    v_lshlrev_b32 v9, 30, v9
    v_mfma_f32_16x16x32_bf16 v[16:19], a[44:47], a[192:195], v[16:19]
    v_mov_b32 v10, 1
    v_fma_f32 v79, v79, v54, v55
    v_mfma_f32_16x16x32_bf16 v[20:23], a[40:43], a[180:183], v[20:23]
    v_mfma_f32_16x16x32_bf16 v[20:23], a[44:47], a[196:199], v[20:23]
    buffer_load_dwordx4 a[24:27], v4, s[16:19], s42 offen offset:2048 sc1
    buffer_atomic_add v10, v9, s[16:19], s61 offen sc1
    v_mfma_f32_16x16x32_bf16 v[24:27], a[40:43], a[184:187], v[24:27]
    v_mfma_f32_16x16x32_bf16 v[24:27], a[44:47], a[200:203], v[24:27]
    buffer_load_dwordx4 a[28:31], v4, s[16:19], s42 offen offset:3072 sc1
    v_mfma_f32_16x16x32_bf16 v[28:31], a[40:43], a[188:191], v[28:31]
    v_mfma_f32_16x16x32_bf16 v[28:31], a[44:47], a[204:207], v[28:31]
    s_waitcnt vmcnt(12)
    v_mfma_f32_16x16x32_bf16 v[32:35], a[48:51], v[112:115], 0
    v_mfma_f32_16x16x32_bf16 v[36:39], a[48:51], v[116:119], 0
    s_add_u32 s42, s56, 16384
    v_mfma_f32_16x16x32_bf16 v[40:43], a[48:51], v[120:123], 0
    buffer_load_dwordx4 a[32:35], v4, s[16:19], s42 offen offset:0 sc1
    v_mfma_f32_16x16x32_bf16 v[44:47], a[48:51], v[124:127], 0
    s_waitcnt vmcnt(11)
    v_cvt_pk_bf16_f32 v96, v16, v17
    v_cvt_pk_bf16_f32 v97, v18, v19
    v_mfma_f32_16x16x32_bf16 v[32:35], a[52:55], v[128:131], v[32:35]
    v_cvt_pk_bf16_f32 v98, v20, v21
    v_cvt_pk_bf16_f32 v99, v22, v23
    v_mfma_f32_16x16x32_bf16 v[32:35], a[56:59], v[144:147], v[32:35]
    buffer_store_dwordx4 v[96:99], v4, s[16:19], s60 offen offset:0 sc1
    v_mfma_f32_16x16x32_bf16 v[36:39], a[52:55], v[132:135], v[36:39]
    v_cvt_pk_bf16_f32 v100, v24, v25
    v_cvt_pk_bf16_f32 v101, v26, v27
    v_mfma_f32_16x16x32_bf16 v[36:39], a[56:59], v[148:151], v[36:39]
    buffer_load_dwordx4 a[36:39], v4, s[16:19], s42 offen offset:1024 sc1
    v_cvt_pk_bf16_f32 v102, v28, v29
    v_mfma_f32_16x16x32_bf16 v[40:43], a[52:55], v[136:139], v[40:43]
    v_cvt_pk_bf16_f32 v103, v30, v31
    v_mfma_f32_16x16x32_bf16 v[40:43], a[56:59], v[152:155], v[40:43]
    buffer_load_dwordx4 a[40:43], v56, s[16:19], s42 offen offset:2048 sc1
    v_mfma_f32_16x16x32_bf16 v[44:47], a[52:55], v[140:143], v[44:47]
    v_mfma_f32_16x16x32_bf16 v[44:47], a[56:59], v[156:159], v[44:47]
    s_waitcnt vmcnt(12)
    buffer_store_dwordx4 v[100:103], v4, s[16:19], s60 offen offset:1024 sc1
    v_mfma_f32_16x16x32_bf16 v[32:35], a[60:63], v[160:163], v[32:35]
    v_mfma_f32_16x16x32_bf16 v[32:35], a[0:3], v[176:179], v[32:35]
    v_mfma_f32_16x16x32_bf16 v[36:39], a[60:63], v[164:167], v[36:39]
    s_add_u32 s42, s56, s15
    v_mfma_f32_16x16x32_bf16 v[36:39], a[0:3], v[180:183], v[36:39]
    buffer_load_dwordx4 a[44:47], v4, s[16:19], s42 offen offset:0 sc1
    v_mfma_f32_16x16x32_bf16 v[40:43], a[60:63], v[168:171], v[40:43]
    v_mfma_f32_16x16x32_bf16 v[40:43], a[0:3], v[184:187], v[40:43]
    buffer_load_dwordx4 a[48:51], v4, s[16:19], s42 offen offset:1024 sc1
    v_mfma_f32_16x16x32_bf16 v[44:47], a[60:63], v[172:175], v[44:47]
    v_mfma_f32_16x16x32_bf16 v[44:47], a[0:3], v[188:191], v[44:47]
    s_waitcnt vmcnt(13)
    v_mfma_f32_16x16x32_bf16 v[32:35], a[4:7], v[192:195], v[32:35]
    v_mfma_f32_16x16x32_bf16 v[32:35], a[8:11], v[208:211], v[32:35]
    v_mfma_f32_16x16x32_bf16 v[36:39], a[4:7], v[196:199], v[36:39]
    v_mfma_f32_16x16x32_bf16 v[36:39], a[8:11], v[212:215], v[36:39]
    buffer_load_dwordx4 a[52:55], v4, s[16:19], s42 offen offset:2048 sc1
    v_mfma_f32_16x16x32_bf16 v[40:43], a[4:7], v[200:203], v[40:43]
    v_mfma_f32_16x16x32_bf16 v[40:43], a[8:11], v[216:219], v[40:43]
    buffer_load_dwordx4 a[56:59], v4, s[16:19], s42 offen offset:3072 sc1
    v_mfma_f32_16x16x32_bf16 v[44:47], a[4:7], v[204:207], v[44:47]
    v_mfma_f32_16x16x32_bf16 v[44:47], a[8:11], v[220:223], v[44:47]
    s_waitcnt vmcnt(13)
    v_mfma_f32_16x16x32_bf16 v[32:35], a[12:15], v[224:227], v[32:35]
    v_mfma_f32_16x16x32_bf16 v[32:35], a[16:19], v[240:243], v[32:35]
    v_mfma_f32_16x16x32_bf16 v[36:39], a[12:15], v[228:231], v[36:39]
    s_add_u32 s42, s56, 19456
    v_mfma_f32_16x16x32_bf16 v[36:39], a[16:19], v[244:247], v[36:39]
    buffer_load_dwordx4 a[60:63], v4, s[16:19], s42 offen offset:0 sc1
    v_permlane16_swap_b32 v80, v82
    v_mfma_f32_16x16x32_bf16 v[40:43], a[12:15], v[232:235], v[40:43]
    v_permlane16_swap_b32 v81, v83
    v_permlane16_swap_b32 v84, v86
    v_mfma_f32_16x16x32_bf16 v[40:43], a[16:19], v[248:251], v[40:43]
    buffer_load_dwordx4 a[0:3], v4, s[16:19], s42 offen offset:1024 sc1
    v_permlane16_swap_b32 v85, v87
    v_mfma_f32_16x16x32_bf16 v[44:47], a[12:15], v[236:239], v[44:47]
    v_lshlrev_b32 v48, 16, v108
    v_and_b32 v49, s41, v108
    v_mfma_f32_16x16x32_bf16 v[44:47], a[16:19], v[252:255], v[44:47]
    s_waitcnt vmcnt(13)
    v_lshlrev_b32 v50, 16, v109
    v_and_b32 v51, s41, v109
    v_mfma_f32_16x16x32_bf16 v[32:35], a[20:23], a[64:67], v[32:35]
    v_lshlrev_b32 v52, 16, v110
    v_and_b32 v53, s41, v110
    v_mfma_f32_16x16x32_bf16 v[32:35], a[24:27], a[80:83], v[32:35]
    v_lshlrev_b32 v54, 16, v111
    v_and_b32 v55, s41, v111
    v_mfma_f32_16x16x32_bf16 v[36:39], a[20:23], a[68:71], v[36:39]
    s_add_u32 s42, s48, s12
    v_lshlrev_b32 v57, 16, v80
    v_and_b32 v80, s41, v80
    v_mfma_f32_16x16x32_bf16 v[36:39], a[24:27], a[84:87], v[36:39]
    buffer_load_dwordx4 a[4:7], v4, s[16:19], s42 offen offset:0 sc1
    v_add_f32_e64 v64, v64, v57
    v_mfma_f32_16x16x32_bf16 v[40:43], a[20:23], a[72:75], v[40:43]
    s_bfe_u32 s56, s2, 196620
    s_add_u32 s56, s5, s56
    s_and_b32 s56, s56, 7
    v_mfma_f32_16x16x32_bf16 v[40:43], a[24:27], a[88:91], v[40:43]
    s_mul_i32 s56, s56, 86016
    s_add_u32 s56, s56, s59
    buffer_load_dwordx4 a[8:11], v4, s[16:19], s42 offen offset:1024 sc1
    v_mfma_f32_16x16x32_bf16 v[44:47], a[20:23], a[76:79], v[44:47]
    v_add_f32 v65, v65, v80
    v_lshlrev_b32 v57, 16, v81
    v_mfma_f32_16x16x32_bf16 v[44:47], a[24:27], a[92:95], v[44:47]
    s_waitcnt vmcnt(12)
    v_and_b32 v81, s41, v81
    v_add_f32 v66, v66, v57
    v_mfma_f32_16x16x32_bf16 v[32:35], a[28:31], a[96:99], v[32:35]
    v_add_f32 v67, v67, v81
    v_lshlrev_b32 v57, 16, v82
    v_mfma_f32_16x16x32_bf16 v[32:35], a[32:35], a[208:211], v[32:35]
    v_and_b32 v82, s41, v82
    v_add_f32 v68, v68, v57
    v_mfma_f32_16x16x32_bf16 v[36:39], a[28:31], a[100:103], v[36:39]
    v_add_f32 v69, v69, v82
    v_lshlrev_b32 v57, 16, v83
    v_mfma_f32_16x16x32_bf16 v[36:39], a[32:35], a[212:215], v[36:39]
    buffer_load_dwordx4 a[12:15], v4, s[16:19], s42 offen offset:2048 sc1
    v_and_b32_e64 v83, s41, v83
    v_mfma_f32_16x16x32_bf16 v[40:43], a[28:31], a[104:107], v[40:43]
    s_lshl_b32 s31, s7, 7
    v_add_f32 v70, v70, v57
    v_add_f32_e64 v71, v71, v83
    v_mfma_f32_16x16x32_bf16 v[40:43], a[32:35], a[216:219], v[40:43]
    s_add_u32 s31, s31, 16384
    buffer_load_dwordx4 a[16:19], v4, s[16:19], s42 offen offset:3072 sc1
    v_lshlrev_b32_e64 v57, 16, v84
    v_mfma_f32_16x16x32_bf16 v[44:47], a[28:31], a[108:111], v[44:47]
    s_bfe_u32 s27, s2, 196612
    s_add_u32 s27, s5, s27
    s_and_b32 s27, s27, 7
    v_mfma_f32_16x16x32_bf16 v[44:47], a[32:35], a[220:223], v[44:47]
    s_waitcnt vmcnt(11)
    s_lshl_b32 s60, s27, 16
    s_add_u32 s60, s60, s57
    v_mov_b32 v11, 0
    v_mfma_f32_16x16x32_bf16 v[32:35], a[36:39], a[224:227], v[32:35]
    s_lshl_b32 s61, s27, 9
    s_add_u32 s61, s61, s58
    buffer_atomic_add v11, v9, s[16:19], s31 offen sc0 sc1
    v_and_b32 v84, s41, v84
    v_mfma_f32_16x16x32_bf16 v[32:35], a[40:43], a[240:243], v[32:35]
    v_add_f32 v72, v72, v57
    v_add_f32 v73, v73, v84
    v_mfma_f32_16x16x32_bf16 v[36:39], a[36:39], a[228:231], v[36:39]
    s_add_u32 s42, s48, s13
    v_lshlrev_b32 v57, 16, v85
    v_and_b32 v85, s41, v85
    v_mfma_f32_16x16x32_bf16 v[36:39], a[40:43], a[244:247], v[36:39]
    buffer_load_dwordx4 a[20:23], v4, s[16:19], s42 offen offset:0 sc1
    v_add_f32_e64 v74, v74, v57
    v_mfma_f32_16x16x32_bf16 v[40:43], a[36:39], a[232:235], v[40:43]
    v_add_f32 v75, v75, v85
    v_lshlrev_b32 v57, 16, v86
    v_mfma_f32_16x16x32_bf16 v[40:43], a[40:43], a[248:251], v[40:43]
    buffer_load_dwordx4 a[24:27], v4, s[16:19], s42 offen offset:1024 sc1
    v_and_b32 v86, s41, v86
    v_mfma_f32_16x16x32_bf16 v[44:47], a[36:39], a[236:239], v[44:47]
    v_add_f32 v76, v76, v57
    v_add_f32 v77, v77, v86
    v_mfma_f32_16x16x32_bf16 v[44:47], a[40:43], a[252:255], v[44:47]
    s_waitcnt vmcnt(11)
    v_lshlrev_b32 v57, 16, v87
    v_and_b32 v87, s41, v87
    v_mfma_f32_16x16x32_bf16 v[32:35], a[44:47], a[112:115], v[32:35]
    v_add_f32 v78, v78, v57
    v_add_f32 v79, v79, v87
    v_mfma_f32_16x16x32_bf16 v[32:35], a[48:51], a[128:131], v[32:35]
    v_mfma_f32_16x16x32_bf16 v[36:39], a[44:47], a[116:119], v[36:39]
    v_mfma_f32_16x16x32_bf16 v[36:39], a[48:51], a[132:135], v[36:39]
    buffer_load_dwordx4 a[28:31], v4, s[16:19], s42 offen offset:2048 sc1
    v_mfma_f32_16x16x32_bf16 v[40:43], a[44:47], a[120:123], v[40:43]
    v_mfma_f32_16x16x32_bf16 v[40:43], a[48:51], a[136:139], v[40:43]
    buffer_load_dwordx4 a[32:35], v4, s[16:19], s42 offen offset:3072 sc1
    v_mfma_f32_16x16x32_bf16 v[44:47], a[44:47], a[124:127], v[44:47]
    v_mfma_f32_16x16x32_bf16 v[44:47], a[48:51], a[140:143], v[44:47]
    s_waitcnt vmcnt(11)
    v_mfma_f32_16x16x32_bf16 v[32:35], a[52:55], a[144:147], v[32:35]
    v_mfma_f32_16x16x32_bf16 v[32:35], a[56:59], a[160:163], v[32:35]
    v_mfma_f32_16x16x32_bf16 v[36:39], a[52:55], a[148:151], v[36:39]
    s_add_u32 s42, s48, s14
    v_mfma_f32_16x16x32_bf16 v[36:39], a[56:59], a[164:167], v[36:39]
    buffer_load_dwordx4 a[36:39], v4, s[16:19], s42 offen offset:0 sc1
    v_mfma_f32_16x16x32_bf16 v[40:43], a[52:55], a[152:155], v[40:43]
    v_mfma_f32_16x16x32_bf16 v[40:43], a[56:59], a[168:171], v[40:43]
    buffer_load_dwordx4 a[40:43], v4, s[16:19], s42 offen offset:1024 sc1
    v_mfma_f32_16x16x32_bf16 v[44:47], a[52:55], a[156:159], v[44:47]
    v_mfma_f32_16x16x32_bf16 v[44:47], a[56:59], a[172:175], v[44:47]
    s_waitcnt vmcnt(11)
    v_mfma_f32_16x16x32_bf16 v[32:35], a[60:63], a[176:179], v[32:35]
    v_mov_b32 v10, 2
    v_mfma_f32_16x16x32_bf16 v[32:35], a[0:3], a[192:195], v[32:35]
    buffer_atomic_add v10, v9, s[16:19], s49 offen sc1
    v_mfma_f32_16x16x32_bf16 v[36:39], a[60:63], a[180:183], v[36:39]
    v_mfma_f32_16x16x32_bf16 v[36:39], a[0:3], a[196:199], v[36:39]
    buffer_load_dwordx4 a[44:47], v4, s[16:19], s42 offen offset:2048 sc1
    v_mfma_f32_16x16x32_bf16 v[40:43], a[60:63], a[184:187], v[40:43]
    v_mfma_f32_16x16x32_bf16 v[40:43], a[0:3], a[200:203], v[40:43]
    buffer_load_dwordx4 a[48:51], v4, s[16:19], s42 offen offset:3072 sc1
    v_mfma_f32_16x16x32_bf16 v[44:47], a[60:63], a[188:191], v[44:47]
    v_mfma_f32_16x16x32_bf16 v[44:47], a[0:3], a[204:207], v[44:47]
    s_waitcnt vmcnt(13)
    v_mfma_f32_16x16x32_bf16 v[16:19], a[4:7], v[112:115], 0
    v_mfma_f32_16x16x32_bf16 v[20:23], a[4:7], v[116:119], 0
    s_add_u32 s42, s48, 16384
    v_mfma_f32_16x16x32_bf16 v[24:27], a[4:7], v[120:123], 0
    buffer_load_dwordx4 a[52:55], v4, s[16:19], s42 offen offset:0 sc1
    v_mfma_f32_16x16x32_bf16 v[28:31], a[4:7], v[124:127], 0
    s_waitcnt vmcnt(12)
    v_cvt_pk_bf16_f32 v96, v32, v33
    v_cvt_pk_bf16_f32 v97, v34, v35
    v_mfma_f32_16x16x32_bf16 v[16:19], a[8:11], v[128:131], v[16:19]
    s_lshl_b32 s28, s5, 13
    v_cvt_pk_bf16_f32 v98, v36, v37
    v_cvt_pk_bf16_f32 v99, v38, v39
    v_mfma_f32_16x16x32_bf16 v[16:19], a[12:15], v[144:147], v[16:19]
    s_add_u32 s28, s28, s52
    buffer_store_dwordx4 v[96:99], v4, s[16:19], s60 offen offset:0 sc1
    v_mfma_f32_16x16x32_bf16 v[20:23], a[8:11], v[132:135], v[20:23]
    v_cvt_pk_bf16_f32 v100, v40, v41
    v_cvt_pk_bf16_f32 v101, v42, v43
    v_mfma_f32_16x16x32_bf16 v[20:23], a[12:15], v[148:151], v[20:23]
    buffer_load_dwordx4 a[56:59], v4, s[16:19], s42 offen offset:1024 sc1
    v_cvt_pk_bf16_f32 v102, v44, v45
    v_lshlrev_b32_e64 v12, 4, v2
    v_mfma_f32_16x16x32_bf16 v[24:27], a[8:11], v[136:139], v[24:27]
    v_cvt_pk_bf16_f32 v103, v46, v47
    v_lshl_add_u32 v12, v3, 10, v12
    v_mfma_f32_16x16x32_bf16 v[24:27], a[12:15], v[152:155], v[24:27]
    buffer_load_dwordx4 a[60:63], v56, s[16:19], s42 offen offset:2048 sc1
    v_mfma_f32_16x16x32_bf16 v[28:31], a[8:11], v[140:143], v[28:31]
    v_mfma_f32_16x16x32_bf16 v[28:31], a[12:15], v[156:159], v[28:31]
    s_waitcnt vmcnt(12)
    buffer_store_dwordx4 v[100:103], v4, s[16:19], s60 offen offset:1024 sc1
    v_mfma_f32_16x16x32_bf16 v[16:19], a[16:19], v[160:163], v[16:19]
    v_mfma_f32_16x16x32_bf16 v[16:19], a[20:23], v[176:179], v[16:19]
    v_readfirstlane_b32 s53, v11
    s_nop 0
    s_add_u32 s53, s53, 1
    s_andn2_b32 s53, 8, s53
    s_cbranch_scc1 Ls55
Lb56:
    buffer_load_dwordx4 v[88:91], v12, s[16:19], s28 offen sc1
    v_mfma_f32_16x16x32_bf16 v[20:23], a[16:19], v[164:167], v[20:23]
    s_add_u32 s42, s48, s15
    v_mfma_f32_16x16x32_bf16 v[20:23], a[20:23], v[180:183], v[20:23]
    buffer_load_dwordx4 a[0:3], v4, s[16:19], s42 offen offset:0 sc1
    v_mfma_f32_16x16x32_bf16 v[24:27], a[16:19], v[168:171], v[24:27]
    v_mfma_f32_16x16x32_bf16 v[24:27], a[20:23], v[184:187], v[24:27]
    buffer_load_dwordx4 a[4:7], v4, s[16:19], s42 offen offset:1024 sc1
    v_mfma_f32_16x16x32_bf16 v[28:31], a[16:19], v[172:175], v[28:31]
    v_mfma_f32_16x16x32_bf16 v[28:31], a[20:23], v[188:191], v[28:31]
    s_waitcnt vmcnt(14)
    v_mfma_f32_16x16x32_bf16 v[16:19], a[24:27], v[192:195], v[16:19]
    v_mfma_f32_16x16x32_bf16 v[16:19], a[28:31], v[208:211], v[16:19]
    v_mfma_f32_16x16x32_bf16 v[20:23], a[24:27], v[196:199], v[20:23]
    v_mfma_f32_16x16x32_bf16 v[20:23], a[28:31], v[212:215], v[20:23]
    buffer_load_dwordx4 a[8:11], v4, s[16:19], s42 offen offset:2048 sc1
    v_mfma_f32_16x16x32_bf16 v[24:27], a[24:27], v[200:203], v[24:27]
    v_mfma_f32_16x16x32_bf16 v[24:27], a[28:31], v[216:219], v[24:27]
    buffer_load_dwordx4 a[12:15], v4, s[16:19], s42 offen offset:3072 sc1
    v_mfma_f32_16x16x32_bf16 v[28:31], a[24:27], v[204:207], v[28:31]
    v_mfma_f32_16x16x32_bf16 v[28:31], a[28:31], v[220:223], v[28:31]
    s_waitcnt vmcnt(14)
    v_mfma_f32_16x16x32_bf16 v[16:19], a[32:35], v[224:227], v[16:19]
    v_mfma_f32_16x16x32_bf16 v[16:19], a[36:39], v[240:243], v[16:19]
    v_mfma_f32_16x16x32_bf16 v[20:23], a[32:35], v[228:231], v[20:23]
    s_add_u32 s42, s48, 19456
    v_mfma_f32_16x16x32_bf16 v[20:23], a[36:39], v[244:247], v[20:23]
    buffer_load_dwordx4 a[16:19], v4, s[16:19], s42 offen offset:0 sc1
    v_mfma_f32_16x16x32_bf16 v[24:27], a[32:35], v[232:235], v[24:27]
    v_mfma_f32_16x16x32_bf16 v[24:27], a[36:39], v[248:251], v[24:27]
    buffer_load_dwordx4 a[20:23], v4, s[16:19], s42 offen offset:1024 sc1
    v_mfma_f32_16x16x32_bf16 v[28:31], a[32:35], v[236:239], v[28:31]
    v_mfma_f32_16x16x32_bf16 v[28:31], a[36:39], v[252:255], v[28:31]
    s_waitcnt vmcnt(13)
    v_mfma_f32_16x16x32_bf16 v[16:19], a[40:43], a[64:67], v[16:19]
    v_mfma_f32_16x16x32_bf16 v[16:19], a[44:47], a[80:83], v[16:19]
    v_mfma_f32_16x16x32_bf16 v[20:23], a[40:43], a[68:71], v[20:23]
    s_add_u32 s42, s56, s12
    v_mfma_f32_16x16x32_bf16 v[20:23], a[44:47], a[84:87], v[20:23]
    buffer_load_dwordx4 a[24:27], v4, s[16:19], s42 offen offset:0 sc1
    v_mfma_f32_16x16x32_bf16 v[24:27], a[40:43], a[72:75], v[24:27]
    s_bfe_u32 s48, s2, 196624
    s_add_u32 s48, s5, s48
    s_and_b32 s48, s48, 7
    v_mfma_f32_16x16x32_bf16 v[24:27], a[44:47], a[88:91], v[24:27]
    s_mul_i32 s48, s48, 86016
    s_add_u32 s48, s48, s59
    buffer_load_dwordx4 a[28:31], v4, s[16:19], s42 offen offset:1024 sc1
    v_mfma_f32_16x16x32_bf16 v[28:31], a[40:43], a[76:79], v[28:31]
    v_mfma_f32_16x16x32_bf16 v[28:31], a[44:47], a[92:95], v[28:31]
    s_waitcnt vmcnt(13)
    v_mfma_f32_16x16x32_bf16 v[16:19], a[48:51], a[96:99], v[16:19]
    v_mfma_f32_16x16x32_bf16 v[16:19], a[52:55], a[208:211], v[16:19]
    v_mfma_f32_16x16x32_bf16 v[20:23], a[48:51], a[100:103], v[20:23]
    v_mfma_f32_16x16x32_bf16 v[20:23], a[52:55], a[212:215], v[20:23]
    buffer_load_dwordx4 a[32:35], v4, s[16:19], s42 offen offset:2048 sc1
    v_mfma_f32_16x16x32_bf16 v[24:27], a[48:51], a[104:107], v[24:27]
    s_add_u32 s28, s28, 4096
    v_mov_b32 v11, 0
    v_mfma_f32_16x16x32_bf16 v[24:27], a[52:55], a[216:219], v[24:27]
    buffer_load_dwordx4 a[36:39], v4, s[16:19], s42 offen offset:3072 sc1
    buffer_atomic_add v11, v9, s[16:19], s63 offen sc0 sc1
    v_mfma_f32_16x16x32_bf16 v[28:31], a[48:51], a[108:111], v[28:31]
    s_bfe_u32 s27, s2, 196616
    s_add_u32 s27, s5, s27
    s_and_b32 s27, s27, 7
    buffer_load_dwordx4 v[92:95], v12, s[16:19], s28 offen sc1
    v_mfma_f32_16x16x32_bf16 v[28:31], a[52:55], a[220:223], v[28:31]
    s_waitcnt vmcnt(14)
    s_lshl_b32 s60, s27, 16
    s_add_u32 s60, s60, s57
    v_mfma_f32_16x16x32_bf16 v[16:19], a[56:59], a[224:227], v[16:19]
    s_lshl_b32 s49, s27, 9
    s_add_u32 s49, s49, s58
    v_mfma_f32_16x16x32_bf16 v[16:19], a[60:63], a[240:243], v[16:19]
    v_mfma_f32_16x16x32_bf16 v[20:23], a[56:59], a[228:231], v[20:23]
    s_add_u32 s42, s56, s13
    v_mfma_f32_16x16x32_bf16 v[20:23], a[60:63], a[244:247], v[20:23]
    buffer_load_dwordx4 a[40:43], v4, s[16:19], s42 offen offset:0 sc1
    v_mfma_f32_16x16x32_bf16 v[24:27], a[56:59], a[232:235], v[24:27]
    v_mfma_f32_16x16x32_bf16 v[24:27], a[60:63], a[248:251], v[24:27]
    buffer_load_dwordx4 a[44:47], v4, s[16:19], s42 offen offset:1024 sc1
    v_mfma_f32_16x16x32_bf16 v[28:31], a[56:59], a[236:239], v[28:31]
    v_mfma_f32_16x16x32_bf16 v[28:31], a[60:63], a[252:255], v[28:31]
    s_waitcnt vmcnt(12)
    v_mfma_f32_16x16x32_bf16 v[16:19], a[0:3], a[112:115], v[16:19]
    v_mfma_f32_16x16x32_bf16 v[16:19], a[4:7], a[128:131], v[16:19]
    v_mfma_f32_16x16x32_bf16 v[20:23], a[0:3], a[116:119], v[20:23]
    v_mfma_f32_16x16x32_bf16 v[20:23], a[4:7], a[132:135], v[20:23]
    buffer_load_dwordx4 a[48:51], v4, s[16:19], s42 offen offset:2048 sc1
    v_mfma_f32_16x16x32_bf16 v[24:27], a[0:3], a[120:123], v[24:27]
    v_mfma_f32_16x16x32_bf16 v[24:27], a[4:7], a[136:139], v[24:27]
    buffer_load_dwordx4 a[52:55], v4, s[16:19], s42 offen offset:3072 sc1
    v_mfma_f32_16x16x32_bf16 v[28:31], a[0:3], a[124:127], v[28:31]
    v_mfma_f32_16x16x32_bf16 v[28:31], a[4:7], a[140:143], v[28:31]
    s_waitcnt vmcnt(12)
    v_mfma_f32_16x16x32_bf16 v[16:19], a[8:11], a[144:147], v[16:19]
    v_mfma_f32_16x16x32_bf16 v[16:19], a[12:15], a[160:163], v[16:19]
    v_mfma_f32_16x16x32_bf16 v[20:23], a[8:11], a[148:151], v[20:23]
    s_add_u32 s42, s56, s14
    v_mfma_f32_16x16x32_bf16 v[20:23], a[12:15], a[164:167], v[20:23]
    buffer_load_dwordx4 a[56:59], v4, s[16:19], s42 offen offset:0 sc1
    v_mfma_f32_16x16x32_bf16 v[24:27], a[8:11], a[152:155], v[24:27]
    v_mfma_f32_16x16x32_bf16 v[24:27], a[12:15], a[168:171], v[24:27]
    buffer_load_dwordx4 a[60:63], v4, s[16:19], s42 offen offset:1024 sc1
    v_mfma_f32_16x16x32_bf16 v[28:31], a[8:11], a[156:159], v[28:31]
    v_mfma_f32_16x16x32_bf16 v[28:31], a[12:15], a[172:175], v[28:31]
    s_waitcnt vmcnt(12)
    v_mfma_f32_16x16x32_bf16 v[16:19], a[16:19], a[176:179], v[16:19]
    v_mov_b32_e64 v10, 4
    v_mfma_f32_16x16x32_bf16 v[16:19], a[20:23], a[192:195], v[16:19]
    buffer_atomic_add v10, v9, s[16:19], s61 offen sc1
    v_mfma_f32_16x16x32_bf16 v[20:23], a[16:19], a[180:183], v[20:23]
    v_mfma_f32_16x16x32_bf16 v[20:23], a[20:23], a[196:199], v[20:23]
    buffer_load_dwordx4 a[0:3], v4, s[16:19], s42 offen offset:2048 sc1
    v_mfma_f32_16x16x32_bf16 v[24:27], a[16:19], a[184:187], v[24:27]
    v_mfma_f32_16x16x32_bf16 v[24:27], a[20:23], a[200:203], v[24:27]
    buffer_load_dwordx4 a[4:7], v4, s[16:19], s42 offen offset:3072 sc1
    v_mfma_f32_16x16x32_bf16 v[28:31], a[16:19], a[188:191], v[28:31]
    v_mfma_f32_16x16x32_bf16 v[28:31], a[20:23], a[204:207], v[28:31]
    s_waitcnt vmcnt(14)
    v_mfma_f32_16x16x32_bf16 v[32:35], a[24:27], v[112:115], 0
    v_mfma_f32_16x16x32_bf16 v[36:39], a[24:27], v[116:119], 0
    s_add_u32 s42, s56, 16384
    v_mfma_f32_16x16x32_bf16 v[40:43], a[24:27], v[120:123], 0
    buffer_load_dwordx4 a[8:11], v4, s[16:19], s42 offen offset:0 sc1
    v_mfma_f32_16x16x32_bf16 v[44:47], a[24:27], v[124:127], 0
    s_waitcnt vmcnt(13)
    v_cvt_pk_bf16_f32 v96, v16, v17
    v_cvt_pk_bf16_f32 v97, v18, v19
    v_mfma_f32_16x16x32_bf16 v[32:35], a[28:31], v[128:131], v[32:35]
    s_bfe_u32 s28, s2, 196608
    v_cvt_pk_bf16_f32 v98, v20, v21
    v_cvt_pk_bf16_f32 v99, v22, v23
    v_mfma_f32_16x16x32_bf16 v[32:35], a[32:35], v[144:147], v[32:35]
    s_sub_u32 s28, s5, s28
    buffer_store_dwordx4 v[96:99], v4, s[16:19], s60 offen offset:0 sc1
    v_mfma_f32_16x16x32_bf16 v[36:39], a[28:31], v[132:135], v[36:39]
    s_and_b32 s28, s28, 7
    v_cvt_pk_bf16_f32 v100, v24, v25
    v_cvt_pk_bf16_f32 v101, v26, v27
    v_mfma_f32_16x16x32_bf16 v[36:39], a[32:35], v[148:151], v[36:39]
    s_lshl_b32 s28, s28, 13
    buffer_load_dwordx4 a[12:15], v4, s[16:19], s42 offen offset:1024 sc1
    v_cvt_pk_bf16_f32 v102, v28, v29
    v_mfma_f32_16x16x32_bf16 v[40:43], a[28:31], v[136:139], v[40:43]
    s_add_u32 s28, s28, s62
    v_cvt_pk_bf16_f32 v103, v30, v31
    v_mfma_f32_16x16x32_bf16 v[40:43], a[32:35], v[152:155], v[40:43]
    buffer_load_dwordx4 a[16:19], v56, s[16:19], s42 offen offset:2048 sc1
    v_mfma_f32_16x16x32_bf16 v[44:47], a[28:31], v[140:143], v[44:47]
    v_mfma_f32_16x16x32_bf16 v[44:47], a[32:35], v[156:159], v[44:47]
    s_waitcnt vmcnt(12)
    buffer_store_dwordx4 v[100:103], v4, s[16:19], s60 offen offset:1024 sc1
    v_mfma_f32_16x16x32_bf16 v[32:35], a[36:39], v[160:163], v[32:35]
    v_mfma_f32_16x16x32_bf16 v[32:35], a[40:43], v[176:179], v[32:35]
    v_readfirstlane_b32 s53, v11
    s_nop 0
    s_add_u32 s53, s53, 1
    s_andn2_b32 s53, 2, s53
    s_cbranch_scc1 Ls57
Lb58:
    buffer_load_dwordx4 v[80:83], v4, s[16:19], s28 offen sc1
    v_mfma_f32_16x16x32_bf16 v[36:39], a[36:39], v[164:167], v[36:39]
    s_add_u32 s42, s56, s15
    v_mfma_f32_16x16x32_bf16 v[36:39], a[40:43], v[180:183], v[36:39]
    buffer_load_dwordx4 a[20:23], v4, s[16:19], s42 offen offset:0 sc1
    v_mfma_f32_16x16x32_bf16 v[40:43], a[36:39], v[168:171], v[40:43]
    v_mfma_f32_16x16x32_bf16 v[40:43], a[40:43], v[184:187], v[40:43]
    buffer_load_dwordx4 a[24:27], v4, s[16:19], s42 offen offset:1024 sc1
    v_mfma_f32_16x16x32_bf16 v[44:47], a[36:39], v[172:175], v[44:47]
    v_mfma_f32_16x16x32_bf16 v[44:47], a[40:43], v[188:191], v[44:47]
    s_waitcnt vmcnt(14)
    v_mfma_f32_16x16x32_bf16 v[32:35], a[44:47], v[192:195], v[32:35]
    v_mfma_f32_16x16x32_bf16 v[32:35], a[48:51], v[208:211], v[32:35]
    v_mfma_f32_16x16x32_bf16 v[36:39], a[44:47], v[196:199], v[36:39]
    v_mfma_f32_16x16x32_bf16 v[36:39], a[48:51], v[212:215], v[36:39]
    buffer_load_dwordx4 a[28:31], v4, s[16:19], s42 offen offset:2048 sc1
    v_mfma_f32_16x16x32_bf16 v[40:43], a[44:47], v[200:203], v[40:43]
    v_mfma_f32_16x16x32_bf16 v[40:43], a[48:51], v[216:219], v[40:43]
    buffer_load_dwordx4 a[32:35], v4, s[16:19], s42 offen offset:3072 sc1
    v_mfma_f32_16x16x32_bf16 v[44:47], a[44:47], v[204:207], v[44:47]
Lpad53076_6:
    s_cbranch_execz Lpadret
    v_mfma_f32_16x16x32_bf16 v[44:47], a[48:51], v[220:223], v[44:47]
    s_waitcnt vmcnt(14)
    v_mfma_f32_16x16x32_bf16 v[32:35], a[52:55], v[224:227], v[32:35]
    v_mfma_f32_16x16x32_bf16 v[32:35], a[56:59], v[240:243], v[32:35]
    v_mfma_f32_16x16x32_bf16 v[36:39], a[52:55], v[228:231], v[36:39]
    s_add_u32 s42, s56, 19456
    v_mfma_f32_16x16x32_bf16 v[36:39], a[56:59], v[244:247], v[36:39]
    buffer_load_dwordx4 a[36:39], v4, s[16:19], s42 offen offset:0 sc1
    v_lshlrev_b32 v57, 16, v88
    v_mfma_f32_16x16x32_bf16 v[40:43], a[52:55], v[232:235], v[40:43]
    v_and_b32 v88, s41, v88
    v_add_f32_e64 v48, v48, v57
    v_mfma_f32_16x16x32_bf16 v[40:43], a[56:59], v[248:251], v[40:43]
    buffer_load_dwordx4 a[40:43], v4, s[16:19], s42 offen offset:1024 sc1
    v_add_f32 v49, v49, v88
    v_mfma_f32_16x16x32_bf16 v[44:47], a[52:55], v[236:239], v[44:47]
    v_lshlrev_b32 v57, 16, v89
    v_and_b32 v89, s41, v89
    v_mfma_f32_16x16x32_bf16 v[44:47], a[56:59], v[252:255], v[44:47]
    s_waitcnt vmcnt(13)
    v_add_f32 v50, v50, v57
    v_add_f32 v51, v51, v89
    v_mfma_f32_16x16x32_bf16 v[32:35], a[60:63], a[64:67], v[32:35]
    v_lshlrev_b32 v57, 16, v90
    v_and_b32 v90, s41, v90
    v_mfma_f32_16x16x32_bf16 v[32:35], a[0:3], a[80:83], v[32:35]
    v_add_f32 v52, v52, v57
    v_add_f32 v53, v53, v90
    v_mfma_f32_16x16x32_bf16 v[36:39], a[60:63], a[68:71], v[36:39]
    s_add_u32 s42, s48, s12
    v_lshlrev_b32 v57, 16, v91
    v_and_b32 v91, s41, v91
    v_mfma_f32_16x16x32_bf16 v[36:39], a[0:3], a[84:87], v[36:39]
    buffer_load_dwordx4 a[44:47], v4, s[16:19], s42 offen offset:0 sc1
    v_add_f32 v54, v54, v57
    v_mfma_f32_16x16x32_bf16 v[40:43], a[60:63], a[72:75], v[40:43]
    s_bfe_u32 s56, s2, 196628
    s_add_u32 s56, s5, s56
    v_add_f32 v55, v55, v91
    v_mfma_f32_16x16x32_bf16 v[40:43], a[0:3], a[88:91], v[40:43]
    buffer_load_dwordx4 a[48:51], v4, s[16:19], s42 offen offset:1024 sc1
    v_lshlrev_b32 v57, 16, v92
    v_mfma_f32_16x16x32_bf16 v[44:47], a[60:63], a[76:79], v[44:47]
    s_and_b32 s56, s56, 7
    v_and_b32 v92, s41, v92
    v_add_f32 v48, v48, v57
    v_mfma_f32_16x16x32_bf16 v[44:47], a[0:3], a[92:95], v[44:47]
    s_waitcnt vmcnt(13)
    v_add_f32 v49, v49, v92
    v_lshlrev_b32_e64 v57, 16, v93
    v_mfma_f32_16x16x32_bf16 v[32:35], a[4:7], a[96:99], v[32:35]
    s_mul_i32 s56, s56, 86016
    v_and_b32 v93, s41, v93
    v_add_f32 v50, v50, v57
    v_mfma_f32_16x16x32_bf16 v[32:35], a[8:11], a[208:211], v[32:35]
    s_add_u32 s56, s56, s59
    v_add_f32 v51, v51, v93
    v_lshlrev_b32 v57, 16, v94
    v_mfma_f32_16x16x32_bf16 v[36:39], a[4:7], a[100:103], v[36:39]
    v_and_b32 v94, s41, v94
    v_add_f32_e64 v52, v52, v57
    v_mfma_f32_16x16x32_bf16 v[36:39], a[8:11], a[212:215], v[36:39]
    buffer_load_dwordx4 a[52:55], v4, s[16:19], s42 offen offset:2048 sc1
    v_add_f32 v53, v53, v94
    v_mfma_f32_16x16x32_bf16 v[40:43], a[4:7], a[104:107], v[40:43]
    v_lshlrev_b32 v57, 16, v95
    v_and_b32_e64 v95, s41, v95
    v_mfma_f32_16x16x32_bf16 v[40:43], a[8:11], a[216:219], v[40:43]
    buffer_load_dwordx4 a[56:59], v4, s[16:19], s42 offen offset:3072 sc1
    v_add_f32_e64 v54, v54, v57
    v_mfma_f32_16x16x32_bf16 v[44:47], a[4:7], a[108:111], v[44:47]
    s_bfe_u32 s27, s2, 196620
    buffer_load_dwordx4 v[84:87], v4, s[16:19], s28 offen offset:1024 sc1
    v_add_f32 v55, v55, v95
    v_permlane32_swap_b32 v48, v52
    v_mfma_f32_16x16x32_bf16 v[44:47], a[8:11], a[220:223], v[44:47]
    s_waitcnt vmcnt(13)
    v_permlane32_swap_b32 v49, v53
    v_permlane32_swap_b32 v50, v54
    v_mov_b32_e64 v11, 0
    v_mfma_f32_16x16x32_bf16 v[32:35], a[12:15], a[224:227], v[32:35]
    s_add_u32 s27, s5, s27
    buffer_atomic_add v11, v9, s[16:19], s63 offen sc0 sc1
    v_permlane32_swap_b32 v51, v55
    v_add_f32 v48, v48, v52
    v_mfma_f32_16x16x32_bf16 v[32:35], a[16:19], a[240:243], v[32:35]
    s_and_b32 s27, s27, 7
    v_add_f32 v49, v49, v53
    v_add_f32 v50, v50, v54
    v_mfma_f32_16x16x32_bf16 v[36:39], a[12:15], a[228:231], v[36:39]
    s_add_u32 s42, s48, s13
    v_add_f32 v51, v51, v55
    v_permlane16_swap_b32 v48, v50
    v_mfma_f32_16x16x32_bf16 v[36:39], a[16:19], a[244:247], v[36:39]
    s_lshl_b32 s60, s27, 16
    buffer_load_dwordx4 a[60:63], v4, s[16:19], s42 offen offset:0 sc1
    v_permlane16_swap_b32 v49, v51
    v_mfma_f32_16x16x32_bf16 v[40:43], a[12:15], a[232:235], v[40:43]
    s_add_u32 s60, s60, s57
    v_add_f32 v48, v48, v50
    v_add_f32 v49, v49, v51
    v_mfma_f32_16x16x32_bf16 v[40:43], a[16:19], a[248:251], v[40:43]
    s_lshl_b32 s61, s27, 9
    buffer_load_dwordx4 a[0:3], v4, s[16:19], s42 offen offset:1024 sc1
    v_add_f32_e64 v48, v48, v104
    v_mfma_f32_16x16x32_bf16 v[44:47], a[12:15], a[236:239], v[44:47]
    s_add_u32 s61, s61, s58
    v_add_f32 v49, v49, v105
    v_cvt_pk_bf16_f32 v48, v48, v49
    v_mfma_f32_16x16x32_bf16 v[44:47], a[16:19], a[252:255], v[44:47]
    s_waitcnt vmcnt(12)
    ds_write_b32 v14, v48
    v_mfma_f32_16x16x32_bf16 v[32:35], a[20:23], a[112:115], v[32:35]
    v_mfma_f32_16x16x32_bf16 v[32:35], a[24:27], a[128:131], v[32:35]
    v_mfma_f32_16x16x32_bf16 v[36:39], a[20:23], a[116:119], v[36:39]
    v_mfma_f32_16x16x32_bf16 v[36:39], a[24:27], a[132:135], v[36:39]
    buffer_load_dwordx4 a[4:7], v4, s[16:19], s42 offen offset:2048 sc1
    v_mfma_f32_16x16x32_bf16 v[40:43], a[20:23], a[120:123], v[40:43]
    v_mfma_f32_16x16x32_bf16 v[40:43], a[24:27], a[136:139], v[40:43]
    buffer_load_dwordx4 a[8:11], v4, s[16:19], s42 offen offset:3072 sc1
    v_mfma_f32_16x16x32_bf16 v[44:47], a[20:23], a[124:127], v[44:47]
    v_mfma_f32_16x16x32_bf16 v[44:47], a[24:27], a[140:143], v[44:47]
    s_waitcnt vmcnt(12)
    v_mfma_f32_16x16x32_bf16 v[32:35], a[28:31], a[144:147], v[32:35]
    v_mfma_f32_16x16x32_bf16 v[32:35], a[32:35], a[160:163], v[32:35]
    v_mfma_f32_16x16x32_bf16 v[36:39], a[28:31], a[148:151], v[36:39]
    s_add_u32 s42, s48, s14
    v_mfma_f32_16x16x32_bf16 v[36:39], a[32:35], a[164:167], v[36:39]
    buffer_load_dwordx4 a[12:15], v4, s[16:19], s42 offen offset:0 sc1
    v_mfma_f32_16x16x32_bf16 v[40:43], a[28:31], a[152:155], v[40:43]
    v_mfma_f32_16x16x32_bf16 v[40:43], a[32:35], a[168:171], v[40:43]
    buffer_load_dwordx4 a[16:19], v4, s[16:19], s42 offen offset:1024 sc1
    v_mfma_f32_16x16x32_bf16 v[44:47], a[28:31], a[156:159], v[44:47]
    v_mfma_f32_16x16x32_bf16 v[44:47], a[32:35], a[172:175], v[44:47]
    s_waitcnt vmcnt(12)
    v_mfma_f32_16x16x32_bf16 v[32:35], a[36:39], a[176:179], v[32:35]
    v_mov_b32_e64 v10, 8
    v_mfma_f32_16x16x32_bf16 v[32:35], a[40:43], a[192:195], v[32:35]
    buffer_atomic_add v10, v9, s[16:19], s49 offen sc1
    v_mfma_f32_16x16x32_bf16 v[36:39], a[36:39], a[180:183], v[36:39]
    v_mfma_f32_16x16x32_bf16 v[36:39], a[40:43], a[196:199], v[36:39]
    buffer_load_dwordx4 a[20:23], v4, s[16:19], s42 offen offset:2048 sc1
    v_mfma_f32_16x16x32_bf16 v[40:43], a[36:39], a[184:187], v[40:43]
    v_mfma_f32_16x16x32_bf16 v[40:43], a[40:43], a[200:203], v[40:43]
    buffer_load_dwordx4 a[24:27], v4, s[16:19], s42 offen offset:3072 sc1
    v_mfma_f32_16x16x32_bf16 v[44:47], a[36:39], a[188:191], v[44:47]
    v_mfma_f32_16x16x32_bf16 v[44:47], a[40:43], a[204:207], v[44:47]
    s_waitcnt vmcnt(14)
    v_mfma_f32_16x16x32_bf16 v[16:19], a[44:47], v[112:115], 0
    v_mfma_f32_16x16x32_bf16 v[20:23], a[44:47], v[116:119], 0
    s_add_u32 s42, s48, 16384
    v_mfma_f32_16x16x32_bf16 v[24:27], a[44:47], v[120:123], 0
    buffer_load_dwordx4 a[28:31], v4, s[16:19], s42 offen offset:0 sc1
    v_mfma_f32_16x16x32_bf16 v[28:31], a[44:47], v[124:127], 0
    s_waitcnt vmcnt(13)
    v_cvt_pk_bf16_f32 v96, v32, v33
    v_cvt_pk_bf16_f32 v97, v34, v35
    v_mfma_f32_16x16x32_bf16 v[16:19], a[48:51], v[128:131], v[16:19]
    s_bfe_u32 s28, s2, 196612
    v_cvt_pk_bf16_f32 v98, v36, v37
    v_cvt_pk_bf16_f32 v99, v38, v39
    v_mfma_f32_16x16x32_bf16 v[16:19], a[52:55], v[144:147], v[16:19]
    s_sub_u32 s28, s5, s28
    buffer_store_dwordx4 v[96:99], v4, s[16:19], s60 offen offset:0 sc1
    v_mfma_f32_16x16x32_bf16 v[20:23], a[48:51], v[132:135], v[20:23]
    s_and_b32 s28, s28, 7
    v_cvt_pk_bf16_f32 v100, v40, v41
    v_cvt_pk_bf16_f32 v101, v42, v43
    v_mfma_f32_16x16x32_bf16 v[20:23], a[52:55], v[148:151], v[20:23]
    s_lshl_b32 s28, s28, 13
    buffer_load_dwordx4 a[32:35], v4, s[16:19], s42 offen offset:1024 sc1
    v_cvt_pk_bf16_f32 v102, v44, v45
    v_mfma_f32_16x16x32_bf16 v[24:27], a[48:51], v[136:139], v[24:27]
    s_add_u32 s28, s28, s62
    v_cvt_pk_bf16_f32 v103, v46, v47
    v_mfma_f32_16x16x32_bf16 v[24:27], a[52:55], v[152:155], v[24:27]
    buffer_load_dwordx4 a[36:39], v56, s[16:19], s42 offen offset:2048 sc1
    v_mfma_f32_16x16x32_bf16 v[28:31], a[48:51], v[140:143], v[28:31]
    v_mfma_f32_16x16x32_bf16 v[28:31], a[52:55], v[156:159], v[28:31]
    s_waitcnt vmcnt(12)
    buffer_store_dwordx4 v[100:103], v4, s[16:19], s60 offen offset:1024 sc1
    v_mfma_f32_16x16x32_bf16 v[16:19], a[56:59], v[160:163], v[16:19]
    v_mfma_f32_16x16x32_bf16 v[16:19], a[60:63], v[176:179], v[16:19]
    v_readfirstlane_b32 s53, v11
    s_nop 0
    s_add_u32 s53, s53, 1
    s_andn2_b32 s53, 4, s53
    s_cbranch_scc1 Ls59
Lb60:
    buffer_load_dwordx4 v[88:91], v4, s[16:19], s28 offen sc1
    v_mfma_f32_16x16x32_bf16 v[20:23], a[56:59], v[164:167], v[20:23]
    s_add_u32 s42, s48, s15
    v_mfma_f32_16x16x32_bf16 v[20:23], a[60:63], v[180:183], v[20:23]
    buffer_load_dwordx4 a[40:43], v4, s[16:19], s42 offen offset:0 sc1
    v_mfma_f32_16x16x32_bf16 v[24:27], a[56:59], v[168:171], v[24:27]
    v_mfma_f32_16x16x32_bf16 v[24:27], a[60:63], v[184:187], v[24:27]
    buffer_load_dwordx4 a[44:47], v4, s[16:19], s42 offen offset:1024 sc1
    v_mfma_f32_16x16x32_bf16 v[28:31], a[56:59], v[172:175], v[28:31]
    v_mfma_f32_16x16x32_bf16 v[28:31], a[60:63], v[188:191], v[28:31]
    s_waitcnt vmcnt(14)
    v_mfma_f32_16x16x32_bf16 v[16:19], a[0:3], v[192:195], v[16:19]
    v_mfma_f32_16x16x32_bf16 v[16:19], a[4:7], v[208:211], v[16:19]
    v_mfma_f32_16x16x32_bf16 v[20:23], a[0:3], v[196:199], v[20:23]
    v_mfma_f32_16x16x32_bf16 v[20:23], a[4:7], v[212:215], v[20:23]
    buffer_load_dwordx4 a[48:51], v4, s[16:19], s42 offen offset:2048 sc1
    v_mfma_f32_16x16x32_bf16 v[24:27], a[0:3], v[200:203], v[24:27]
    v_mfma_f32_16x16x32_bf16 v[24:27], a[4:7], v[216:219], v[24:27]
    buffer_load_dwordx4 a[52:55], v4, s[16:19], s42 offen offset:3072 sc1
    v_mfma_f32_16x16x32_bf16 v[28:31], a[0:3], v[204:207], v[28:31]
    v_mfma_f32_16x16x32_bf16 v[28:31], a[4:7], v[220:223], v[28:31]
    s_waitcnt vmcnt(14)
    v_mfma_f32_16x16x32_bf16 v[16:19], a[8:11], v[224:227], v[16:19]
    v_mfma_f32_16x16x32_bf16 v[16:19], a[12:15], v[240:243], v[16:19]
    v_mfma_f32_16x16x32_bf16 v[20:23], a[8:11], v[228:231], v[20:23]
    s_add_u32 s42, s48, 19456
    v_mfma_f32_16x16x32_bf16 v[20:23], a[12:15], v[244:247], v[20:23]
    buffer_load_dwordx4 a[56:59], v4, s[16:19], s42 offen offset:0 sc1
    v_lshlrev_b32 v57, 16, v80
    v_mfma_f32_16x16x32_bf16 v[24:27], a[8:11], v[232:235], v[24:27]
    v_and_b32 v80, s41, v80
    v_add_f32 v64, v64, v57
    v_mfma_f32_16x16x32_bf16 v[24:27], a[12:15], v[248:251], v[24:27]
    buffer_load_dwordx4 a[60:63], v4, s[16:19], s42 offen offset:1024 sc1
    v_add_f32 v65, v65, v80
    v_mfma_f32_16x16x32_bf16 v[28:31], a[8:11], v[236:239], v[28:31]
    v_lshlrev_b32 v57, 16, v81
    v_and_b32_e64 v81, s41, v81
    v_mfma_f32_16x16x32_bf16 v[28:31], a[12:15], v[252:255], v[28:31]
    s_waitcnt vmcnt(13)
    v_add_f32 v66, v66, v57
    v_add_f32 v67, v67, v81
    v_mfma_f32_16x16x32_bf16 v[16:19], a[16:19], a[64:67], v[16:19]
    v_lshlrev_b32 v57, 16, v82
    v_and_b32 v82, s41, v82
    v_mfma_f32_16x16x32_bf16 v[16:19], a[20:23], a[80:83], v[16:19]
    v_add_f32 v68, v68, v57
    v_add_f32 v69, v69, v82
    v_mfma_f32_16x16x32_bf16 v[20:23], a[16:19], a[68:71], v[20:23]
    s_add_u32 s42, s56, s12
    v_lshlrev_b32 v57, 16, v83
    v_and_b32 v83, s41, v83
    v_mfma_f32_16x16x32_bf16 v[20:23], a[20:23], a[84:87], v[20:23]
    buffer_load_dwordx4 a[0:3], v4, s[16:19], s42 offen offset:0 sc1
    v_add_f32_e64 v70, v70, v57
    v_mfma_f32_16x16x32_bf16 v[24:27], a[16:19], a[72:75], v[24:27]
    s_bfe_u32 s48, s2, 196632
    s_add_u32 s48, s5, s48
    v_add_f32 v71, v71, v83
    v_mfma_f32_16x16x32_bf16 v[24:27], a[20:23], a[88:91], v[24:27]
    buffer_load_dwordx4 a[4:7], v4, s[16:19], s42 offen offset:1024 sc1
    v_lshlrev_b32 v57, 16, v84
    v_mfma_f32_16x16x32_bf16 v[28:31], a[16:19], a[76:79], v[28:31]
    s_and_b32 s48, s48, 7
    v_and_b32 v84, s41, v84
    v_add_f32 v72, v72, v57
    v_mfma_f32_16x16x32_bf16 v[28:31], a[20:23], a[92:95], v[28:31]
    s_waitcnt vmcnt(13)
    v_add_f32 v73, v73, v84
    v_lshlrev_b32_e64 v57, 16, v85
    v_mfma_f32_16x16x32_bf16 v[16:19], a[24:27], a[96:99], v[16:19]
    s_mul_i32 s48, s48, 86016
    v_and_b32 v85, s41, v85
    v_add_f32 v74, v74, v57
    v_mfma_f32_16x16x32_bf16 v[16:19], a[28:31], a[208:211], v[16:19]
    s_add_u32 s48, s48, s59
    v_add_f32 v75, v75, v85
    v_lshlrev_b32 v57, 16, v86
    v_mfma_f32_16x16x32_bf16 v[20:23], a[24:27], a[100:103], v[20:23]
    v_and_b32 v86, s41, v86
    v_add_f32_e64 v76, v76, v57
    v_mfma_f32_16x16x32_bf16 v[20:23], a[28:31], a[212:215], v[20:23]
    buffer_load_dwordx4 a[8:11], v4, s[16:19], s42 offen offset:2048 sc1
    v_add_f32 v77, v77, v86
    v_mfma_f32_16x16x32_bf16 v[24:27], a[24:27], a[104:107], v[24:27]
    v_lshlrev_b32 v57, 16, v87
    v_and_b32_e64 v87, s41, v87
    v_mfma_f32_16x16x32_bf16 v[24:27], a[28:31], a[216:219], v[24:27]
    buffer_load_dwordx4 a[12:15], v4, s[16:19], s42 offen offset:3072 sc1
    v_add_f32_e64 v78, v78, v57
    v_mfma_f32_16x16x32_bf16 v[28:31], a[24:27], a[108:111], v[28:31]
    s_bfe_u32 s27, s2, 196624
    s_add_u32 s27, s5, s27
    buffer_load_dwordx4 v[92:95], v4, s[16:19], s28 offen offset:1024 sc1
    v_add_f32 v79, v79, v87
    v_mfma_f32_16x16x32_bf16 v[28:31], a[28:31], a[220:223], v[28:31]
    s_waitcnt vmcnt(13)
    s_and_b32 s27, s27, 7
    s_lshl_b32 s60, s27, 16
    v_mov_b32 v11, 0
    v_mfma_f32_16x16x32_bf16 v[16:19], a[32:35], a[224:227], v[16:19]
    s_add_u32 s60, s60, s57
    s_lshl_b32 s49, s27, 9
    s_add_u32 s49, s49, s58
    buffer_atomic_add v11, v9, s[16:19], s63 offen sc0 sc1
    v_mfma_f32_16x16x32_bf16 v[16:19], a[36:39], a[240:243], v[16:19]
    v_mfma_f32_16x16x32_bf16 v[20:23], a[32:35], a[228:231], v[20:23]
    s_add_u32 s42, s56, s13
    v_mfma_f32_16x16x32_bf16 v[20:23], a[36:39], a[244:247], v[20:23]
    buffer_load_dwordx4 a[16:19], v4, s[16:19], s42 offen offset:0 sc1
    v_mfma_f32_16x16x32_bf16 v[24:27], a[32:35], a[232:235], v[24:27]
    v_mfma_f32_16x16x32_bf16 v[24:27], a[36:39], a[248:251], v[24:27]
    buffer_load_dwordx4 a[20:23], v4, s[16:19], s42 offen offset:1024 sc1
    v_mfma_f32_16x16x32_bf16 v[28:31], a[32:35], a[236:239], v[28:31]
    v_mfma_f32_16x16x32_bf16 v[28:31], a[36:39], a[252:255], v[28:31]
    s_waitcnt vmcnt(12)
    v_mfma_f32_16x16x32_bf16 v[16:19], a[40:43], a[112:115], v[16:19]
    v_mfma_f32_16x16x32_bf16 v[16:19], a[44:47], a[128:131], v[16:19]
    v_mfma_f32_16x16x32_bf16 v[20:23], a[40:43], a[116:119], v[20:23]
    v_mfma_f32_16x16x32_bf16 v[20:23], a[44:47], a[132:135], v[20:23]
    buffer_load_dwordx4 a[24:27], v4, s[16:19], s42 offen offset:2048 sc1
    v_mfma_f32_16x16x32_bf16 v[24:27], a[40:43], a[120:123], v[24:27]
    v_mfma_f32_16x16x32_bf16 v[24:27], a[44:47], a[136:139], v[24:27]
    buffer_load_dwordx4 a[28:31], v4, s[16:19], s42 offen offset:3072 sc1
    v_mfma_f32_16x16x32_bf16 v[28:31], a[40:43], a[124:127], v[28:31]
    v_mfma_f32_16x16x32_bf16 v[28:31], a[44:47], a[140:143], v[28:31]
    s_waitcnt vmcnt(12)
    v_mfma_f32_16x16x32_bf16 v[16:19], a[48:51], a[144:147], v[16:19]
    v_mfma_f32_16x16x32_bf16 v[16:19], a[52:55], a[160:163], v[16:19]
    v_mfma_f32_16x16x32_bf16 v[20:23], a[48:51], a[148:151], v[20:23]
    s_add_u32 s42, s56, s14
    v_mfma_f32_16x16x32_bf16 v[20:23], a[52:55], a[164:167], v[20:23]
    buffer_load_dwordx4 a[32:35], v4, s[16:19], s42 offen offset:0 sc1
    v_mfma_f32_16x16x32_bf16 v[24:27], a[48:51], a[152:155], v[24:27]
    v_mfma_f32_16x16x32_bf16 v[24:27], a[52:55], a[168:171], v[24:27]
    buffer_load_dwordx4 a[36:39], v4, s[16:19], s42 offen offset:1024 sc1
    v_mfma_f32_16x16x32_bf16 v[28:31], a[48:51], a[156:159], v[28:31]
    v_mfma_f32_16x16x32_bf16 v[28:31], a[52:55], a[172:175], v[28:31]
    s_waitcnt vmcnt(12)
    v_mfma_f32_16x16x32_bf16 v[16:19], a[56:59], a[176:179], v[16:19]
    v_mov_b32_e64 v10, 16
    v_mfma_f32_16x16x32_bf16 v[16:19], a[60:63], a[192:195], v[16:19]
    buffer_atomic_add v10, v9, s[16:19], s61 offen sc1
    v_mfma_f32_16x16x32_bf16 v[20:23], a[56:59], a[180:183], v[20:23]
    v_mfma_f32_16x16x32_bf16 v[20:23], a[60:63], a[196:199], v[20:23]
    buffer_load_dwordx4 a[40:43], v4, s[16:19], s42 offen offset:2048 sc1
    v_mfma_f32_16x16x32_bf16 v[24:27], a[56:59], a[184:187], v[24:27]
    v_mfma_f32_16x16x32_bf16 v[24:27], a[60:63], a[200:203], v[24:27]
    buffer_load_dwordx4 a[44:47], v4, s[16:19], s42 offen offset:3072 sc1
    v_mfma_f32_16x16x32_bf16 v[28:31], a[56:59], a[188:191], v[28:31]
    v_mfma_f32_16x16x32_bf16 v[28:31], a[60:63], a[204:207], v[28:31]
    s_waitcnt vmcnt(14)
    v_mfma_f32_16x16x32_bf16 v[32:35], a[0:3], v[112:115], 0
    v_mfma_f32_16x16x32_bf16 v[36:39], a[0:3], v[116:119], 0
    s_add_u32 s42, s56, 16384
    v_mfma_f32_16x16x32_bf16 v[40:43], a[0:3], v[120:123], 0
    buffer_load_dwordx4 a[48:51], v4, s[16:19], s42 offen offset:0 sc1
    v_mfma_f32_16x16x32_bf16 v[44:47], a[0:3], v[124:127], 0
    s_waitcnt vmcnt(13)
    v_cvt_pk_bf16_f32 v96, v16, v17
    v_cvt_pk_bf16_f32 v97, v18, v19
    v_mfma_f32_16x16x32_bf16 v[32:35], a[4:7], v[128:131], v[32:35]
    s_bfe_u32 s28, s2, 196616
    v_cvt_pk_bf16_f32 v98, v20, v21
    v_cvt_pk_bf16_f32 v99, v22, v23
    v_mfma_f32_16x16x32_bf16 v[32:35], a[8:11], v[144:147], v[32:35]
    s_sub_u32 s28, s5, s28
    buffer_store_dwordx4 v[96:99], v4, s[16:19], s60 offen offset:0 sc1
    v_mfma_f32_16x16x32_bf16 v[36:39], a[4:7], v[132:135], v[36:39]
    s_and_b32 s28, s28, 7
    v_cvt_pk_bf16_f32 v100, v24, v25
    v_cvt_pk_bf16_f32 v101, v26, v27
    v_mfma_f32_16x16x32_bf16 v[36:39], a[8:11], v[148:151], v[36:39]
    s_lshl_b32 s28, s28, 13
    buffer_load_dwordx4 a[52:55], v4, s[16:19], s42 offen offset:1024 sc1
    v_cvt_pk_bf16_f32 v102, v28, v29
    v_mfma_f32_16x16x32_bf16 v[40:43], a[4:7], v[136:139], v[40:43]
    s_add_u32 s28, s28, s62
    v_cvt_pk_bf16_f32 v103, v30, v31
    v_mfma_f32_16x16x32_bf16 v[40:43], a[8:11], v[152:155], v[40:43]
    buffer_load_dwordx4 a[56:59], v56, s[16:19], s42 offen offset:2048 sc1
    v_mfma_f32_16x16x32_bf16 v[44:47], a[4:7], v[140:143], v[44:47]
    v_mfma_f32_16x16x32_bf16 v[44:47], a[8:11], v[156:159], v[44:47]
    s_waitcnt vmcnt(12)
    buffer_store_dwordx4 v[100:103], v4, s[16:19], s60 offen offset:1024 sc1
    v_mfma_f32_16x16x32_bf16 v[32:35], a[12:15], v[160:163], v[32:35]
    v_mfma_f32_16x16x32_bf16 v[32:35], a[16:19], v[176:179], v[32:35]
    v_readfirstlane_b32 s53, v11
    s_nop 0
    s_add_u32 s53, s53, 1
    s_andn2_b32 s53, 8, s53
    s_cbranch_scc1 Ls61
Lb62:
    buffer_load_dwordx4 v[80:83], v4, s[16:19], s28 offen sc1
    v_mfma_f32_16x16x32_bf16 v[36:39], a[12:15], v[164:167], v[36:39]
    s_add_u32 s42, s56, s15
    v_mfma_f32_16x16x32_bf16 v[36:39], a[16:19], v[180:183], v[36:39]
    buffer_load_dwordx4 a[60:63], v4, s[16:19], s42 offen offset:0 sc1
    v_mfma_f32_16x16x32_bf16 v[40:43], a[12:15], v[168:171], v[40:43]
    v_mfma_f32_16x16x32_bf16 v[40:43], a[16:19], v[184:187], v[40:43]
    buffer_load_dwordx4 a[0:3], v4, s[16:19], s42 offen offset:1024 sc1
    v_mfma_f32_16x16x32_bf16 v[44:47], a[12:15], v[172:175], v[44:47]
    v_mfma_f32_16x16x32_bf16 v[44:47], a[16:19], v[188:191], v[44:47]
    s_waitcnt vmcnt(14)
    v_mfma_f32_16x16x32_bf16 v[32:35], a[20:23], v[192:195], v[32:35]
    v_mfma_f32_16x16x32_bf16 v[32:35], a[24:27], v[208:211], v[32:35]
    v_mfma_f32_16x16x32_bf16 v[36:39], a[20:23], v[196:199], v[36:39]
    v_mfma_f32_16x16x32_bf16 v[36:39], a[24:27], v[212:215], v[36:39]
    buffer_load_dwordx4 a[4:7], v4, s[16:19], s42 offen offset:2048 sc1
    v_mfma_f32_16x16x32_bf16 v[40:43], a[20:23], v[200:203], v[40:43]
    v_mfma_f32_16x16x32_bf16 v[40:43], a[24:27], v[216:219], v[40:43]
    buffer_load_dwordx4 a[8:11], v4, s[16:19], s42 offen offset:3072 sc1
    v_mfma_f32_16x16x32_bf16 v[44:47], a[20:23], v[204:207], v[44:47]
    v_mfma_f32_16x16x32_bf16 v[44:47], a[24:27], v[220:223], v[44:47]
    s_waitcnt vmcnt(14)
    v_mfma_f32_16x16x32_bf16 v[32:35], a[28:31], v[224:227], v[32:35]
    v_mfma_f32_16x16x32_bf16 v[32:35], a[32:35], v[240:243], v[32:35]
    v_mfma_f32_16x16x32_bf16 v[36:39], a[28:31], v[228:231], v[36:39]
    s_add_u32 s42, s56, 19456
    v_mfma_f32_16x16x32_bf16 v[36:39], a[32:35], v[244:247], v[36:39]
    buffer_load_dwordx4 a[12:15], v4, s[16:19], s42 offen offset:0 sc1
    v_lshlrev_b32 v57, 16, v88
    v_mfma_f32_16x16x32_bf16 v[40:43], a[28:31], v[232:235], v[40:43]
    v_and_b32 v88, s41, v88
    v_add_f32 v64, v64, v57
    v_mfma_f32_16x16x32_bf16 v[40:43], a[32:35], v[248:251], v[40:43]
    buffer_load_dwordx4 a[16:19], v4, s[16:19], s42 offen offset:1024 sc1
    v_add_f32_e64 v65, v65, v88
    v_mfma_f32_16x16x32_bf16 v[44:47], a[28:31], v[236:239], v[44:47]
    v_lshlrev_b32 v57, 16, v89
    v_and_b32 v89, s41, v89
    v_mfma_f32_16x16x32_bf16 v[44:47], a[32:35], v[252:255], v[44:47]
    s_waitcnt vmcnt(13)
    v_add_f32 v66, v66, v57
    v_add_f32 v67, v67, v89
    v_mfma_f32_16x16x32_bf16 v[32:35], a[36:39], a[64:67], v[32:35]
    v_lshlrev_b32 v57, 16, v90
    v_and_b32 v90, s41, v90
    v_mfma_f32_16x16x32_bf16 v[32:35], a[40:43], a[80:83], v[32:35]
    v_add_f32 v68, v68, v57
    v_add_f32 v69, v69, v90
    v_mfma_f32_16x16x32_bf16 v[36:39], a[36:39], a[68:71], v[36:39]
    s_add_u32 s42, s48, s12
    v_lshlrev_b32 v57, 16, v91
    v_and_b32 v91, s41, v91
    v_mfma_f32_16x16x32_bf16 v[36:39], a[40:43], a[84:87], v[36:39]
    buffer_load_dwordx4 a[20:23], v4, s[16:19], s42 offen offset:0 sc1
    v_add_f32 v70, v70, v57
    v_mfma_f32_16x16x32_bf16 v[40:43], a[36:39], a[72:75], v[40:43]
    s_mov_b32 s56, s5
    s_mul_i32 s56, s56, 86016
    v_add_f32 v71, v71, v91
    v_mfma_f32_16x16x32_bf16 v[40:43], a[40:43], a[88:91], v[40:43]
    buffer_load_dwordx4 a[24:27], v4, s[16:19], s42 offen offset:1024 sc1
    v_lshlrev_b32 v57, 16, v92
    v_mfma_f32_16x16x32_bf16 v[44:47], a[36:39], a[76:79], v[44:47]
    s_add_u32 s56, s56, s59
    v_and_b32 v92, s41, v92
    v_add_f32 v72, v72, v57
    v_mfma_f32_16x16x32_bf16 v[44:47], a[40:43], a[92:95], v[44:47]
    s_waitcnt vmcnt(13)
    v_add_f32 v73, v73, v92
    v_lshlrev_b32 v57, 16, v93
    v_mfma_f32_16x16x32_bf16 v[32:35], a[44:47], a[96:99], v[32:35]
    v_and_b32 v93, s41, v93
    v_add_f32 v74, v74, v57
    v_mfma_f32_16x16x32_bf16 v[32:35], a[48:51], a[208:211], v[32:35]
    v_add_f32 v75, v75, v93
    v_lshlrev_b32 v57, 16, v94
    v_mfma_f32_16x16x32_bf16 v[36:39], a[44:47], a[100:103], v[36:39]
    v_and_b32 v94, s41, v94
    v_add_f32 v76, v76, v57
    v_mfma_f32_16x16x32_bf16 v[36:39], a[48:51], a[212:215], v[36:39]
    buffer_load_dwordx4 a[28:31], v4, s[16:19], s42 offen offset:2048 sc1
    v_add_f32 v77, v77, v94
    v_mfma_f32_16x16x32_bf16 v[40:43], a[44:47], a[104:107], v[40:43]
    v_lshlrev_b32 v57, 16, v95
    v_and_b32_e64 v95, s41, v95
    v_mfma_f32_16x16x32_bf16 v[40:43], a[48:51], a[216:219], v[40:43]
    buffer_load_dwordx4 a[32:35], v4, s[16:19], s42 offen offset:3072 sc1
    v_add_f32 v78, v78, v57
    v_mfma_f32_16x16x32_bf16 v[44:47], a[44:47], a[108:111], v[44:47]
    s_bfe_u32 s27, s2, 196628
    s_add_u32 s27, s5, s27
    buffer_load_dwordx4 v[84:87], v4, s[16:19], s28 offen offset:1024 sc1
    v_add_f32 v79, v79, v95
    v_mfma_f32_16x16x32_bf16 v[44:47], a[48:51], a[220:223], v[44:47]
    s_waitcnt vmcnt(13)
    s_and_b32 s27, s27, 7
    s_lshl_b32 s60, s27, 16
    v_mov_b32 v11, 0
    v_mfma_f32_16x16x32_bf16 v[32:35], a[52:55], a[224:227], v[32:35]
    s_add_u32 s60, s60, s57
    buffer_atomic_add v11, v9, s[16:19], s63 offen sc0 sc1
    v_mfma_f32_16x16x32_bf16 v[32:35], a[56:59], a[240:243], v[32:35]
    v_mfma_f32_16x16x32_bf16 v[36:39], a[52:55], a[228:231], v[36:39]
    s_add_u32 s42, s48, s13
    v_mfma_f32_16x16x32_bf16 v[36:39], a[56:59], a[244:247], v[36:39]
    buffer_load_dwordx4 a[36:39], v4, s[16:19], s42 offen offset:0 sc1
    v_mfma_f32_16x16x32_bf16 v[40:43], a[52:55], a[232:235], v[40:43]
    v_mfma_f32_16x16x32_bf16 v[40:43], a[56:59], a[248:251], v[40:43]
    buffer_load_dwordx4 a[40:43], v4, s[16:19], s42 offen offset:1024 sc1
    v_mfma_f32_16x16x32_bf16 v[44:47], a[52:55], a[236:239], v[44:47]
    v_mfma_f32_16x16x32_bf16 v[44:47], a[56:59], a[252:255], v[44:47]
    s_waitcnt vmcnt(12)
    v_mfma_f32_16x16x32_bf16 v[32:35], a[60:63], a[112:115], v[32:35]
    v_mfma_f32_16x16x32_bf16 v[32:35], a[0:3], a[128:131], v[32:35]
    v_mfma_f32_16x16x32_bf16 v[36:39], a[60:63], a[116:119], v[36:39]
    v_mfma_f32_16x16x32_bf16 v[36:39], a[0:3], a[132:135], v[36:39]
    buffer_load_dwordx4 a[44:47], v4, s[16:19], s42 offen offset:2048 sc1
    v_mfma_f32_16x16x32_bf16 v[40:43], a[60:63], a[120:123], v[40:43]
    v_mfma_f32_16x16x32_bf16 v[40:43], a[0:3], a[136:139], v[40:43]
    buffer_load_dwordx4 a[48:51], v4, s[16:19], s42 offen offset:3072 sc1
    v_mfma_f32_16x16x32_bf16 v[44:47], a[60:63], a[124:127], v[44:47]
    v_mfma_f32_16x16x32_bf16 v[44:47], a[0:3], a[140:143], v[44:47]
    s_waitcnt vmcnt(12)
    v_mfma_f32_16x16x32_bf16 v[32:35], a[4:7], a[144:147], v[32:35]
    v_mfma_f32_16x16x32_bf16 v[32:35], a[8:11], a[160:163], v[32:35]
    v_mfma_f32_16x16x32_bf16 v[36:39], a[4:7], a[148:151], v[36:39]
    s_add_u32 s42, s48, s14
    v_mfma_f32_16x16x32_bf16 v[36:39], a[8:11], a[164:167], v[36:39]
    buffer_load_dwordx4 a[52:55], v4, s[16:19], s42 offen offset:0 sc1
    v_mfma_f32_16x16x32_bf16 v[40:43], a[4:7], a[152:155], v[40:43]
    v_mfma_f32_16x16x32_bf16 v[40:43], a[8:11], a[168:171], v[40:43]
    buffer_load_dwordx4 a[56:59], v4, s[16:19], s42 offen offset:1024 sc1
    v_mfma_f32_16x16x32_bf16 v[44:47], a[4:7], a[156:159], v[44:47]
    v_mfma_f32_16x16x32_bf16 v[44:47], a[8:11], a[172:175], v[44:47]
    s_waitcnt vmcnt(12)
    v_mfma_f32_16x16x32_bf16 v[32:35], a[12:15], a[176:179], v[32:35]
    v_mov_b32 v10, 32
    v_mfma_f32_16x16x32_bf16 v[32:35], a[16:19], a[192:195], v[32:35]
    buffer_atomic_add v10, v9, s[16:19], s49 offen sc1
    v_mfma_f32_16x16x32_bf16 v[36:39], a[12:15], a[180:183], v[36:39]
    v_mfma_f32_16x16x32_bf16 v[36:39], a[16:19], a[196:199], v[36:39]
    buffer_load_dwordx4 a[60:63], v4, s[16:19], s42 offen offset:2048 sc1
    v_mfma_f32_16x16x32_bf16 v[40:43], a[12:15], a[184:187], v[40:43]
    v_mfma_f32_16x16x32_bf16 v[40:43], a[16:19], a[200:203], v[40:43]
    buffer_load_dwordx4 a[0:3], v4, s[16:19], s42 offen offset:3072 sc1
    v_mfma_f32_16x16x32_bf16 v[44:47], a[12:15], a[188:191], v[44:47]
    v_mfma_f32_16x16x32_bf16 v[44:47], a[16:19], a[204:207], v[44:47]
    s_waitcnt vmcnt(14)
    v_mfma_f32_16x16x32_bf16 v[16:19], a[20:23], v[112:115], 0
    v_mfma_f32_16x16x32_bf16 v[20:23], a[20:23], v[116:119], 0
    s_add_u32 s42, s48, 16384
    v_mfma_f32_16x16x32_bf16 v[24:27], a[20:23], v[120:123], 0
    buffer_load_dwordx4 a[4:7], v4, s[16:19], s42 offen offset:0 sc1
    v_mfma_f32_16x16x32_bf16 v[28:31], a[20:23], v[124:127], 0
    s_waitcnt vmcnt(13)
    v_cvt_pk_bf16_f32 v96, v32, v33
    v_cvt_pk_bf16_f32 v97, v34, v35
    v_mfma_f32_16x16x32_bf16 v[16:19], a[24:27], v[128:131], v[16:19]
    s_bfe_u32 s28, s2, 196620
    v_cvt_pk_bf16_f32 v98, v36, v37
    v_cvt_pk_bf16_f32 v99, v38, v39
    v_mfma_f32_16x16x32_bf16 v[16:19], a[28:31], v[144:147], v[16:19]
    s_sub_u32 s28, s5, s28
    buffer_store_dwordx4 v[96:99], v4, s[16:19], s60 offen offset:0 sc1
    v_mfma_f32_16x16x32_bf16 v[20:23], a[24:27], v[132:135], v[20:23]
    s_and_b32 s28, s28, 7
    v_cvt_pk_bf16_f32 v100, v40, v41
    v_cvt_pk_bf16_f32 v101, v42, v43
    v_mfma_f32_16x16x32_bf16 v[20:23], a[28:31], v[148:151], v[20:23]
    s_lshl_b32 s28, s28, 13
    buffer_load_dwordx4 a[8:11], v4, s[16:19], s42 offen offset:1024 sc1
    v_cvt_pk_bf16_f32 v102, v44, v45
    v_mfma_f32_16x16x32_bf16 v[24:27], a[24:27], v[136:139], v[24:27]
    s_add_u32 s28, s28, s62
    v_cvt_pk_bf16_f32 v103, v46, v47
    v_mfma_f32_16x16x32_bf16 v[24:27], a[28:31], v[152:155], v[24:27]
    buffer_load_dwordx4 a[12:15], v56, s[16:19], s42 offen offset:2048 sc1
    v_mfma_f32_16x16x32_bf16 v[28:31], a[24:27], v[140:143], v[28:31]
    v_mfma_f32_16x16x32_bf16 v[28:31], a[28:31], v[156:159], v[28:31]
    s_waitcnt vmcnt(12)
    buffer_store_dwordx4 v[100:103], v4, s[16:19], s60 offen offset:1024 sc1
    v_mfma_f32_16x16x32_bf16 v[16:19], a[32:35], v[160:163], v[16:19]
    v_mfma_f32_16x16x32_bf16 v[16:19], a[36:39], v[176:179], v[16:19]
    v_readfirstlane_b32 s53, v11
    s_nop 0
    s_add_u32 s53, s53, 1
    s_andn2_b32 s53, 16, s53
    s_cbranch_scc1 Ls63
Lb64:
    buffer_load_dwordx4 v[88:91], v4, s[16:19], s28 offen sc1
    v_mfma_f32_16x16x32_bf16 v[20:23], a[32:35], v[164:167], v[20:23]
    s_add_u32 s42, s48, s15
    v_mfma_f32_16x16x32_bf16 v[20:23], a[36:39], v[180:183], v[20:23]
    buffer_load_dwordx4 a[16:19], v4, s[16:19], s42 offen offset:0 sc1
    v_mfma_f32_16x16x32_bf16 v[24:27], a[32:35], v[168:171], v[24:27]
    v_mfma_f32_16x16x32_bf16 v[24:27], a[36:39], v[184:187], v[24:27]
    buffer_load_dwordx4 a[20:23], v4, s[16:19], s42 offen offset:1024 sc1
    v_mfma_f32_16x16x32_bf16 v[28:31], a[32:35], v[172:175], v[28:31]
    v_mfma_f32_16x16x32_bf16 v[28:31], a[36:39], v[188:191], v[28:31]
    s_waitcnt vmcnt(14)
    v_mfma_f32_16x16x32_bf16 v[16:19], a[40:43], v[192:195], v[16:19]
    v_mfma_f32_16x16x32_bf16 v[16:19], a[44:47], v[208:211], v[16:19]
    v_mfma_f32_16x16x32_bf16 v[20:23], a[40:43], v[196:199], v[20:23]
    v_mfma_f32_16x16x32_bf16 v[20:23], a[44:47], v[212:215], v[20:23]
    buffer_load_dwordx4 a[24:27], v4, s[16:19], s42 offen offset:2048 sc1
    v_mfma_f32_16x16x32_bf16 v[24:27], a[40:43], v[200:203], v[24:27]
    v_mfma_f32_16x16x32_bf16 v[24:27], a[44:47], v[216:219], v[24:27]
    buffer_load_dwordx4 a[28:31], v4, s[16:19], s42 offen offset:3072 sc1
    v_mfma_f32_16x16x32_bf16 v[28:31], a[40:43], v[204:207], v[28:31]
    v_mfma_f32_16x16x32_bf16 v[28:31], a[44:47], v[220:223], v[28:31]
    s_waitcnt vmcnt(14)
    v_mfma_f32_16x16x32_bf16 v[16:19], a[48:51], v[224:227], v[16:19]
    v_mfma_f32_16x16x32_bf16 v[16:19], a[52:55], v[240:243], v[16:19]
    v_mfma_f32_16x16x32_bf16 v[20:23], a[48:51], v[228:231], v[20:23]
    s_add_u32 s42, s48, 19456
    v_mfma_f32_16x16x32_bf16 v[20:23], a[52:55], v[244:247], v[20:23]
    buffer_load_dwordx4 a[32:35], v4, s[16:19], s42 offen offset:0 sc1
    v_lshlrev_b32 v57, 16, v80
    v_mfma_f32_16x16x32_bf16 v[24:27], a[48:51], v[232:235], v[24:27]
    v_and_b32 v80, s41, v80
    v_add_f32 v64, v64, v57
    v_mfma_f32_16x16x32_bf16 v[24:27], a[52:55], v[248:251], v[24:27]
    buffer_load_dwordx4 a[36:39], v4, s[16:19], s42 offen offset:1024 sc1
    v_add_f32 v65, v65, v80
    v_mfma_f32_16x16x32_bf16 v[28:31], a[48:51], v[236:239], v[28:31]
    v_lshlrev_b32 v57, 16, v81
    v_and_b32 v81, s41, v81
    v_mfma_f32_16x16x32_bf16 v[28:31], a[52:55], v[252:255], v[28:31]
    s_waitcnt vmcnt(13)
    v_add_f32 v66, v66, v57
    v_add_f32 v67, v67, v81
    v_mfma_f32_16x16x32_bf16 v[16:19], a[56:59], a[64:67], v[16:19]
    v_lshlrev_b32 v57, 16, v82
    v_and_b32 v82, s41, v82
    v_mfma_f32_16x16x32_bf16 v[16:19], a[60:63], a[80:83], v[16:19]
Lpad53076_7:
    s_cbranch_execz Lpadret
    v_add_f32 v68, v68, v57
    v_add_f32 v69, v69, v82
    v_mfma_f32_16x16x32_bf16 v[20:23], a[56:59], a[68:71], v[20:23]
    s_add_u32 s42, s56, s12
    v_lshlrev_b32 v57, 16, v83
    v_and_b32 v83, s41, v83
    v_mfma_f32_16x16x32_bf16 v[20:23], a[60:63], a[84:87], v[20:23]
    buffer_load_dwordx4 a[40:43], v4, s[16:19], s42 offen offset:0 sc1
    v_add_f32 v70, v70, v57
    v_mfma_f32_16x16x32_bf16 v[24:27], a[56:59], a[72:75], v[24:27]
    v_add_f32 v71, v71, v83
    v_mfma_f32_16x16x32_bf16 v[24:27], a[60:63], a[88:91], v[24:27]
    buffer_load_dwordx4 a[44:47], v4, s[16:19], s42 offen offset:1024 sc1
    v_lshlrev_b32 v57, 16, v84
    v_mfma_f32_16x16x32_bf16 v[28:31], a[56:59], a[76:79], v[28:31]
    v_and_b32 v84, s41, v84
    v_add_f32 v72, v72, v57
    v_mfma_f32_16x16x32_bf16 v[28:31], a[60:63], a[92:95], v[28:31]
    s_waitcnt vmcnt(13)
    v_add_f32 v73, v73, v84
    v_lshlrev_b32 v57, 16, v85
    v_mfma_f32_16x16x32_bf16 v[16:19], a[0:3], a[96:99], v[16:19]
    v_and_b32 v85, s41, v85
    v_add_f32 v74, v74, v57
    v_mfma_f32_16x16x32_bf16 v[16:19], a[4:7], a[208:211], v[16:19]
    v_add_f32 v75, v75, v85
    v_lshlrev_b32 v57, 16, v86
    v_mfma_f32_16x16x32_bf16 v[20:23], a[0:3], a[100:103], v[20:23]
    v_and_b32 v86, s41, v86
    v_add_f32 v76, v76, v57
    v_mfma_f32_16x16x32_bf16 v[20:23], a[4:7], a[212:215], v[20:23]
    buffer_load_dwordx4 a[48:51], v4, s[16:19], s42 offen offset:2048 sc1
    v_add_f32_e64 v77, v77, v86
    v_mfma_f32_16x16x32_bf16 v[24:27], a[0:3], a[104:107], v[24:27]
    v_lshlrev_b32 v57, 16, v87
    v_and_b32 v87, s41, v87
    v_mfma_f32_16x16x32_bf16 v[24:27], a[4:7], a[216:219], v[24:27]
    buffer_load_dwordx4 a[52:55], v4, s[16:19], s42 offen offset:3072 sc1
    v_add_f32 v78, v78, v57
    v_mfma_f32_16x16x32_bf16 v[28:31], a[0:3], a[108:111], v[28:31]
    s_bfe_u32 s27, s2, 196632
    s_add_u32 s27, s5, s27
    buffer_load_dwordx4 v[92:95], v4, s[16:19], s28 offen offset:1024 sc1
    v_add_f32 v79, v79, v87
    v_mfma_f32_16x16x32_bf16 v[28:31], a[4:7], a[220:223], v[28:31]
    s_waitcnt vmcnt(13)
    s_and_b32 s27, s27, 7
    s_lshl_b32 s60, s27, 16
    v_mov_b32_e64 v11, 0
    v_mfma_f32_16x16x32_bf16 v[16:19], a[8:11], a[224:227], v[16:19]
    s_add_u32 s60, s60, s57
    buffer_atomic_add v11, v9, s[16:19], s63 offen sc0 sc1
    v_mfma_f32_16x16x32_bf16 v[16:19], a[12:15], a[240:243], v[16:19]
    v_mfma_f32_16x16x32_bf16 v[20:23], a[8:11], a[228:231], v[20:23]
    s_add_u32 s42, s56, s13
    v_mfma_f32_16x16x32_bf16 v[20:23], a[12:15], a[244:247], v[20:23]
    buffer_load_dwordx4 a[56:59], v4, s[16:19], s42 offen offset:0 sc1
    v_mfma_f32_16x16x32_bf16 v[24:27], a[8:11], a[232:235], v[24:27]
    v_mfma_f32_16x16x32_bf16 v[24:27], a[12:15], a[248:251], v[24:27]
    buffer_load_dwordx4 a[60:63], v4, s[16:19], s42 offen offset:1024 sc1
    v_mfma_f32_16x16x32_bf16 v[28:31], a[8:11], a[236:239], v[28:31]
    v_mfma_f32_16x16x32_bf16 v[28:31], a[12:15], a[252:255], v[28:31]
    s_waitcnt vmcnt(12)
    v_mfma_f32_16x16x32_bf16 v[16:19], a[16:19], a[112:115], v[16:19]
    v_mfma_f32_16x16x32_bf16 v[16:19], a[20:23], a[128:131], v[16:19]
    v_mfma_f32_16x16x32_bf16 v[20:23], a[16:19], a[116:119], v[20:23]
    v_mfma_f32_16x16x32_bf16 v[20:23], a[20:23], a[132:135], v[20:23]
    buffer_load_dwordx4 a[0:3], v4, s[16:19], s42 offen offset:2048 sc1
    v_mfma_f32_16x16x32_bf16 v[24:27], a[16:19], a[120:123], v[24:27]
    v_mfma_f32_16x16x32_bf16 v[24:27], a[20:23], a[136:139], v[24:27]
    buffer_load_dwordx4 a[4:7], v4, s[16:19], s42 offen offset:3072 sc1
    v_mfma_f32_16x16x32_bf16 v[28:31], a[16:19], a[124:127], v[28:31]
    v_mfma_f32_16x16x32_bf16 v[28:31], a[20:23], a[140:143], v[28:31]
    s_waitcnt vmcnt(12)
    v_mfma_f32_16x16x32_bf16 v[16:19], a[24:27], a[144:147], v[16:19]
    v_mfma_f32_16x16x32_bf16 v[16:19], a[28:31], a[160:163], v[16:19]
    v_mfma_f32_16x16x32_bf16 v[20:23], a[24:27], a[148:151], v[20:23]
    s_add_u32 s42, s56, s14
    v_mfma_f32_16x16x32_bf16 v[20:23], a[28:31], a[164:167], v[20:23]
    buffer_load_dwordx4 a[8:11], v4, s[16:19], s42 offen offset:0 sc1
    v_mfma_f32_16x16x32_bf16 v[24:27], a[24:27], a[152:155], v[24:27]
    v_mfma_f32_16x16x32_bf16 v[24:27], a[28:31], a[168:171], v[24:27]
    buffer_load_dwordx4 a[12:15], v4, s[16:19], s42 offen offset:1024 sc1
    v_mfma_f32_16x16x32_bf16 v[28:31], a[24:27], a[156:159], v[28:31]
    v_mfma_f32_16x16x32_bf16 v[28:31], a[28:31], a[172:175], v[28:31]
    s_waitcnt vmcnt(12)
    v_mfma_f32_16x16x32_bf16 v[16:19], a[32:35], a[176:179], v[16:19]
    v_mfma_f32_16x16x32_bf16 v[16:19], a[36:39], a[192:195], v[16:19]
    v_mfma_f32_16x16x32_bf16 v[20:23], a[32:35], a[180:183], v[20:23]
    v_mfma_f32_16x16x32_bf16 v[20:23], a[36:39], a[196:199], v[20:23]
    buffer_load_dwordx4 a[16:19], v4, s[16:19], s42 offen offset:2048 sc1
    v_mfma_f32_16x16x32_bf16 v[24:27], a[32:35], a[184:187], v[24:27]
    v_mfma_f32_16x16x32_bf16 v[24:27], a[36:39], a[200:203], v[24:27]
    buffer_load_dwordx4 a[20:23], v4, s[16:19], s42 offen offset:3072 sc1
    v_mfma_f32_16x16x32_bf16 v[28:31], a[32:35], a[188:191], v[28:31]
    v_mfma_f32_16x16x32_bf16 v[28:31], a[36:39], a[204:207], v[28:31]
    s_waitcnt vmcnt(13)
    v_mfma_f32_16x16x32_bf16 v[32:35], a[40:43], v[112:115], 0
    v_mfma_f32_16x16x32_bf16 v[36:39], a[40:43], v[116:119], 0
    s_add_u32 s42, s56, 16384
    v_mfma_f32_16x16x32_bf16 v[40:43], a[40:43], v[120:123], 0
    buffer_load_dwordx4 a[24:27], v4, s[16:19], s42 offen offset:0 sc1
    v_mfma_f32_16x16x32_bf16 v[44:47], a[40:43], v[124:127], 0
    s_waitcnt vmcnt(12)
    v_cvt_pk_bf16_f32 v96, v16, v17
    v_cvt_pk_bf16_f32 v97, v18, v19
    v_mfma_f32_16x16x32_bf16 v[32:35], a[44:47], v[128:131], v[32:35]
    s_bfe_u32 s28, s2, 196624
    v_cvt_pk_bf16_f32 v98, v20, v21
    v_cvt_pk_bf16_f32 v99, v22, v23
    v_mfma_f32_16x16x32_bf16 v[32:35], a[48:51], v[144:147], v[32:35]
    s_sub_u32 s28, s5, s28
    buffer_store_dwordx4 v[96:99], v4, s[16:19], s60 offen offset:0 sc1
    v_mfma_f32_16x16x32_bf16 v[36:39], a[44:47], v[132:135], v[36:39]
    s_and_b32 s28, s28, 7
    v_cvt_pk_bf16_f32 v100, v24, v25
    v_cvt_pk_bf16_f32 v101, v26, v27
    v_mfma_f32_16x16x32_bf16 v[36:39], a[48:51], v[148:151], v[36:39]
    s_lshl_b32 s28, s28, 13
    buffer_load_dwordx4 a[28:31], v4, s[16:19], s42 offen offset:1024 sc1
    v_cvt_pk_bf16_f32 v102, v28, v29
    v_mfma_f32_16x16x32_bf16 v[40:43], a[44:47], v[136:139], v[40:43]
    s_add_u32 s28, s28, s62
    v_cvt_pk_bf16_f32 v103, v30, v31
    v_mfma_f32_16x16x32_bf16 v[40:43], a[48:51], v[152:155], v[40:43]
    buffer_load_dwordx4 a[32:35], v56, s[16:19], s42 offen offset:2048 sc1
    v_mfma_f32_16x16x32_bf16 v[44:47], a[44:47], v[140:143], v[44:47]
    v_mfma_f32_16x16x32_bf16 v[44:47], a[48:51], v[156:159], v[44:47]
    s_waitcnt vmcnt(11)
    buffer_store_dwordx4 v[100:103], v4, s[16:19], s60 offen offset:1024 sc1
    v_mfma_f32_16x16x32_bf16 v[32:35], a[52:55], v[160:163], v[32:35]
    v_mfma_f32_16x16x32_bf16 v[32:35], a[56:59], v[176:179], v[32:35]
    v_readfirstlane_b32 s53, v11
    s_nop 0
    s_add_u32 s53, s53, 1
    s_andn2_b32 s53, 32, s53
    s_cbranch_scc1 Ls65
Lb66:
    buffer_load_dwordx4 v[80:83], v4, s[16:19], s28 offen sc1
    v_mfma_f32_16x16x32_bf16 v[36:39], a[52:55], v[164:167], v[36:39]
    s_add_u32 s42, s56, s15
    v_mfma_f32_16x16x32_bf16 v[36:39], a[56:59], v[180:183], v[36:39]
    buffer_load_dwordx4 a[36:39], v4, s[16:19], s42 offen offset:0 sc1
    buffer_load_dwordx4 v[84:87], v4, s[16:19], s28 offen offset:1024 sc1
    v_mfma_f32_16x16x32_bf16 v[40:43], a[52:55], v[168:171], v[40:43]
    v_mfma_f32_16x16x32_bf16 v[40:43], a[56:59], v[184:187], v[40:43]
    buffer_load_dwordx4 a[40:43], v4, s[16:19], s42 offen offset:1024 sc1
    v_mfma_f32_16x16x32_bf16 v[44:47], a[52:55], v[172:175], v[44:47]
    s_bfe_u32 s29, s2, 196628
    s_sub_u32 s29, s5, s29
    s_and_b32 s29, s29, 7
    v_mfma_f32_16x16x32_bf16 v[44:47], a[56:59], v[188:191], v[44:47]
    s_waitcnt vmcnt(14)
    s_lshl_b32 s29, s29, 13
    s_add_u32 s29, s29, s62
    v_mfma_f32_16x16x32_bf16 v[32:35], a[60:63], v[192:195], v[32:35]
    v_mfma_f32_16x16x32_bf16 v[32:35], a[0:3], v[208:211], v[32:35]
    buffer_load_dwordx4 v[16:19], v4, s[16:19], s29 offen sc1
    buffer_load_dwordx4 v[20:23], v4, s[16:19], s29 offen offset:1024 sc1
    v_mfma_f32_16x16x32_bf16 v[36:39], a[60:63], v[196:199], v[36:39]
    v_mfma_f32_16x16x32_bf16 v[36:39], a[0:3], v[212:215], v[36:39]
    buffer_load_dwordx4 a[44:47], v4, s[16:19], s42 offen offset:2048 sc1
    v_mfma_f32_16x16x32_bf16 v[40:43], a[60:63], v[200:203], v[40:43]
    v_mfma_f32_16x16x32_bf16 v[40:43], a[0:3], v[216:219], v[40:43]
    buffer_load_dwordx4 a[48:51], v4, s[16:19], s42 offen offset:3072 sc1
    v_mfma_f32_16x16x32_bf16 v[44:47], a[60:63], v[204:207], v[44:47]
    v_mfma_f32_16x16x32_bf16 v[44:47], a[0:3], v[220:223], v[44:47]
    s_waitcnt vmcnt(16)
    v_mfma_f32_16x16x32_bf16 v[32:35], a[4:7], v[224:227], v[32:35]
    v_mfma_f32_16x16x32_bf16 v[32:35], a[8:11], v[240:243], v[32:35]
    v_mfma_f32_16x16x32_bf16 v[36:39], a[4:7], v[228:231], v[36:39]
    s_add_u32 s42, s56, 19456
    v_mfma_f32_16x16x32_bf16 v[36:39], a[8:11], v[244:247], v[36:39]
    buffer_load_dwordx4 a[52:55], v4, s[16:19], s42 offen offset:0 sc1
    v_lshlrev_b32 v57, 16, v88
    v_mfma_f32_16x16x32_bf16 v[40:43], a[4:7], v[232:235], v[40:43]
    v_and_b32 v88, s41, v88
    v_add_f32 v64, v64, v57
    v_mfma_f32_16x16x32_bf16 v[40:43], a[8:11], v[248:251], v[40:43]
    buffer_load_dwordx4 a[56:59], v4, s[16:19], s42 offen offset:1024 sc1
    v_add_f32 v65, v65, v88
    v_mfma_f32_16x16x32_bf16 v[44:47], a[4:7], v[236:239], v[44:47]
    v_lshlrev_b32 v57, 16, v89
    v_and_b32 v89, s41, v89
    v_mfma_f32_16x16x32_bf16 v[44:47], a[8:11], v[252:255], v[44:47]
    s_waitcnt vmcnt(16)
    v_add_f32 v66, v66, v57
    v_add_f32 v67, v67, v89
    v_mfma_f32_16x16x32_bf16 v[32:35], a[12:15], a[64:67], v[32:35]
    v_lshlrev_b32 v57, 16, v90
    v_and_b32 v90, s41, v90
    v_mfma_f32_16x16x32_bf16 v[32:35], a[16:19], a[80:83], v[32:35]
    v_add_f32 v68, v68, v57
    v_add_f32 v69, v69, v90
    v_mfma_f32_16x16x32_bf16 v[36:39], a[12:15], a[68:71], v[36:39]
    v_lshlrev_b32 v57, 16, v91
    v_and_b32 v91, s41, v91
    v_mfma_f32_16x16x32_bf16 v[36:39], a[16:19], a[84:87], v[36:39]
    v_add_f32 v70, v70, v57
    v_add_f32 v71, v71, v91
    v_mfma_f32_16x16x32_bf16 v[40:43], a[12:15], a[72:75], v[40:43]
    v_mfma_f32_16x16x32_bf16 v[40:43], a[16:19], a[88:91], v[40:43]
    v_lshlrev_b32 v57, 16, v92
    v_and_b32 v92, s41, v92
    v_mfma_f32_16x16x32_bf16 v[44:47], a[12:15], a[76:79], v[44:47]
    v_add_f32 v72, v72, v57
    v_add_f32 v73, v73, v92
    v_mfma_f32_16x16x32_bf16 v[44:47], a[16:19], a[92:95], v[44:47]
    s_waitcnt vmcnt(14)
    v_lshlrev_b32 v57, 16, v93
    v_and_b32 v93, s41, v93
    v_mfma_f32_16x16x32_bf16 v[32:35], a[20:23], a[96:99], v[32:35]
    v_add_f32 v74, v74, v57
    v_add_f32 v75, v75, v93
    v_mfma_f32_16x16x32_bf16 v[32:35], a[24:27], a[208:211], v[32:35]
    v_lshlrev_b32 v57, 16, v94
    v_and_b32 v94, s41, v94
    v_mfma_f32_16x16x32_bf16 v[36:39], a[20:23], a[100:103], v[36:39]
    v_add_f32 v76, v76, v57
    v_add_f32 v77, v77, v94
    v_mfma_f32_16x16x32_bf16 v[36:39], a[24:27], a[212:215], v[36:39]
    v_lshlrev_b32 v57, 16, v95
    v_and_b32 v95, s41, v95
    v_mfma_f32_16x16x32_bf16 v[40:43], a[20:23], a[104:107], v[40:43]
    v_add_f32 v78, v78, v57
    v_add_f32_e64 v79, v79, v95
    v_mfma_f32_16x16x32_bf16 v[40:43], a[24:27], a[216:219], v[40:43]
    v_mfma_f32_16x16x32_bf16 v[44:47], a[20:23], a[108:111], v[44:47]
    v_mfma_f32_16x16x32_bf16 v[44:47], a[24:27], a[220:223], v[44:47]
    s_waitcnt vmcnt(11)
    v_mfma_f32_16x16x32_bf16 v[32:35], a[28:31], a[224:227], v[32:35]
    v_mfma_f32_16x16x32_bf16 v[32:35], a[32:35], a[240:243], v[32:35]
    v_mfma_f32_16x16x32_bf16 v[36:39], a[28:31], a[228:231], v[36:39]
    v_mfma_f32_16x16x32_bf16 v[36:39], a[32:35], a[244:247], v[36:39]
    v_mfma_f32_16x16x32_bf16 v[40:43], a[28:31], a[232:235], v[40:43]
    v_mfma_f32_16x16x32_bf16 v[40:43], a[32:35], a[248:251], v[40:43]
    v_mfma_f32_16x16x32_bf16 v[44:47], a[28:31], a[236:239], v[44:47]
    v_mfma_f32_16x16x32_bf16 v[44:47], a[32:35], a[252:255], v[44:47]
    s_waitcnt vmcnt(6)
    v_mfma_f32_16x16x32_bf16 v[32:35], a[36:39], a[112:115], v[32:35]
    v_mfma_f32_16x16x32_bf16 v[32:35], a[40:43], a[128:131], v[32:35]
    v_mfma_f32_16x16x32_bf16 v[36:39], a[36:39], a[116:119], v[36:39]
    v_mfma_f32_16x16x32_bf16 v[36:39], a[40:43], a[132:135], v[36:39]
    v_mfma_f32_16x16x32_bf16 v[40:43], a[36:39], a[120:123], v[40:43]
    v_mfma_f32_16x16x32_bf16 v[40:43], a[40:43], a[136:139], v[40:43]
    v_mfma_f32_16x16x32_bf16 v[44:47], a[36:39], a[124:127], v[44:47]
    v_mfma_f32_16x16x32_bf16 v[44:47], a[40:43], a[140:143], v[44:47]
    s_waitcnt vmcnt(2)
    v_mfma_f32_16x16x32_bf16 v[32:35], a[44:47], a[144:147], v[32:35]
    v_mfma_f32_16x16x32_bf16 v[32:35], a[48:51], a[160:163], v[32:35]
    v_mfma_f32_16x16x32_bf16 v[36:39], a[44:47], a[148:151], v[36:39]
    v_mfma_f32_16x16x32_bf16 v[36:39], a[48:51], a[164:167], v[36:39]
    v_mfma_f32_16x16x32_bf16 v[40:43], a[44:47], a[152:155], v[40:43]
    v_mfma_f32_16x16x32_bf16 v[40:43], a[48:51], a[168:171], v[40:43]
    v_mfma_f32_16x16x32_bf16 v[44:47], a[44:47], a[156:159], v[44:47]
    v_mfma_f32_16x16x32_bf16 v[44:47], a[48:51], a[172:175], v[44:47]
    s_waitcnt vmcnt(0)
    v_mfma_f32_16x16x32_bf16 v[32:35], a[52:55], a[176:179], v[32:35]
    s_bfe_u32 s30, s2, 196632
    s_sub_u32 s30, s5, s30
    s_and_b32 s30, s30, 7
    v_mfma_f32_16x16x32_bf16 v[32:35], a[56:59], a[192:195], v[32:35]
    s_lshl_b32 s30, s30, 13
    s_add_u32 s30, s30, s62
    v_mfma_f32_16x16x32_bf16 v[36:39], a[52:55], a[180:183], v[36:39]
    v_mfma_f32_16x16x32_bf16 v[36:39], a[56:59], a[196:199], v[36:39]
    buffer_load_dwordx4 v[24:27], v4, s[16:19], s30 offen sc1
    buffer_load_dwordx4 v[28:31], v4, s[16:19], s30 offen offset:1024 sc1
    v_mfma_f32_16x16x32_bf16 v[40:43], a[52:55], a[184:187], v[40:43]
    v_mfma_f32_16x16x32_bf16 v[40:43], a[56:59], a[200:203], v[40:43]
    v_mfma_f32_16x16x32_bf16 v[44:47], a[52:55], a[188:191], v[44:47]
    v_mfma_f32_16x16x32_bf16 v[44:47], a[56:59], a[204:207], v[44:47]
    s_lshl_b32 s27, s4, 11
    s_add_u32 s27, s27, 0
    v_add_u32 v5, s27, v4
    v_add_u32 v6, 8192, v4
    v_dot2c_f32_bf16 v64, s38, v80
    v_dot2c_f32_bf16 v65, s39, v80
    v_dot2c_f32_bf16 v66, s38, v81
    v_dot2c_f32_bf16 v67, s39, v81
    v_dot2c_f32_bf16 v68, s38, v82
    v_dot2c_f32_bf16 v69, s39, v82
    v_dot2c_f32_bf16 v70, s38, v83
    v_dot2c_f32_bf16 v71, s39, v83
    v_dot2c_f32_bf16 v72, s38, v84
    v_dot2c_f32_bf16 v73, s39, v84
    v_dot2c_f32_bf16 v74, s38, v85
    v_dot2c_f32_bf16 v75, s39, v85
    v_dot2c_f32_bf16 v76, s38, v86
    v_dot2c_f32_bf16 v77, s39, v86
    v_dot2c_f32_bf16 v78, s38, v87
    v_dot2c_f32_bf16 v79, s39, v87
    v_pk_add_f32 v[64:65], v[64:65], v[32:33]
    v_pk_add_f32 v[66:67], v[66:67], v[34:35]
    v_pk_add_f32 v[68:69], v[68:69], v[36:37]
    v_pk_add_f32 v[70:71], v[70:71], v[38:39]
    v_pk_add_f32 v[72:73], v[72:73], v[40:41]
    v_pk_add_f32 v[74:75], v[74:75], v[42:43]
    v_pk_add_f32 v[76:77], v[76:77], v[44:45]
    v_pk_add_f32 v[78:79], v[78:79], v[46:47]
    v_max_u32 v57, v16, v20
    v_cmp_eq_u32 vcc, -1, v57
    s_cbranch_vccnz Ls67
Lb68:
    v_dot2c_f32_bf16 v64, s38, v16
    v_dot2c_f32_bf16 v65, s39, v16
    v_dot2c_f32_bf16 v66, s38, v17
    v_dot2c_f32_bf16 v67, s39, v17
    v_dot2c_f32_bf16 v68, s38, v18
    v_dot2c_f32_bf16 v69, s39, v18
    v_dot2c_f32_bf16 v70, s38, v19
    v_dot2c_f32_bf16 v71, s39, v19
    v_dot2c_f32_bf16 v72, s38, v20
    v_dot2c_f32_bf16 v73, s39, v20
    v_dot2c_f32_bf16 v74, s38, v21
    v_dot2c_f32_bf16 v75, s39, v21
    v_dot2c_f32_bf16 v76, s38, v22
    v_dot2c_f32_bf16 v77, s39, v22
    v_dot2c_f32_bf16 v78, s38, v23
    v_dot2c_f32_bf16 v79, s39, v23
    s_waitcnt vmcnt(0)
    v_max_u32 v57, v24, v28
    v_cmp_eq_u32 vcc, -1, v57
    s_cbranch_vccnz Ls69
Lb70:
    v_dot2c_f32_bf16 v64, s38, v24
    v_dot2c_f32_bf16 v65, s39, v24
    v_dot2c_f32_bf16 v66, s38, v25
    v_dot2c_f32_bf16 v67, s39, v25
    v_dot2c_f32_bf16 v68, s38, v26
    v_dot2c_f32_bf16 v69, s39, v26
    v_dot2c_f32_bf16 v70, s38, v27
    v_dot2c_f32_bf16 v71, s39, v27
    v_dot2c_f32_bf16 v72, s38, v28
    v_dot2c_f32_bf16 v73, s39, v28
    v_dot2c_f32_bf16 v74, s38, v29
    v_dot2c_f32_bf16 v75, s39, v29
    v_dot2c_f32_bf16 v76, s38, v30
    v_dot2c_f32_bf16 v77, s39, v30
    v_dot2c_f32_bf16 v78, s38, v31
    v_dot2c_f32_bf16 v79, s39, v31
    v_cvt_pk_bf16_f32 v96, v64, v65
    v_cvt_pk_bf16_f32 v97, v66, v67
    v_cvt_pk_bf16_f32 v98, v68, v69
    v_cvt_pk_bf16_f32 v99, v70, v71
    v_cvt_pk_bf16_f32 v100, v72, v73
    v_cvt_pk_bf16_f32 v101, v74, v75
    v_cvt_pk_bf16_f32 v102, v76, v77
    v_cvt_pk_bf16_f32 v103, v78, v79
    ds_write_b64 v63, v[96:97] offset:0
    ds_write_b64 v63, v[98:99] offset:2048
    ds_write_b64 v63, v[100:101] offset:4096
    ds_write_b64 v63, v[102:103] offset:6144
    s_add_u32 s27, s70, 9216
    s_waitcnt lgkmcnt(0)
    s_barrier
    ds_read_b128 v[80:83], v5
    ds_read_b128 v[84:87], v5 offset:1024
    ds_read_b128 v[88:91], v6
    s_waitcnt lgkmcnt(2)
    buffer_store_dwordx4 v[80:83], v62, s[20:23], s70 offen nt
    s_waitcnt lgkmcnt(1)
    buffer_store_dwordx4 v[84:87], v62, s[20:23], s27 offen nt
    s_waitcnt lgkmcnt(0)
    buffer_store_dwordx4 v[88:91], v62, s[20:23], s71 offen nt
Lend:
    s_endpgm
Lpad53076_8:
    s_cbranch_execz Lpadret
    s_endpgm
Ls10:
    s_sub_u32 s26, s26, 1
    s_cselect_b32 s26, 0, s26
    s_cbranch_scc1 Lb11
    global_load_dword v250, v251, s[66:67] sc1
    s_waitcnt vmcnt(0)
    v_cmp_gt_u32 vcc, 2, v250
    s_cbranch_vccnz Ls10
    s_branch Lb11
Ls17:
    s_sub_u32 s26, s26, 1
    s_cselect_b32 s26, 0, s26
    s_cbranch_scc1 Lb18
    s_mov_b32 s71, 0
    s_atomic_add s71, s[68:69], s70 glc
    s_waitcnt lgkmcnt(0)
    s_add_u32 s71, s71, 1
    s_andn2_b32 s71, s43, s71
    s_cbranch_scc1 Ls17
    s_branch Lb18
Ls36:
    s_sub_u32 s26, s26, 1
    s_cselect_b32 s26, 0, s26
    s_cbranch_scc1 Lb37
    global_load_dword v241, v242, s[66:67] sc1
    s_waitcnt vmcnt(0)
    v_cmp_gt_u32 vcc, 2, v241
    s_cbranch_vccnz Ls36
    s_branch Lb37
Ls51:
    s_sub_u32 s26, s26, 1
    s_cselect_b32 s26, 0, s26
    s_cbranch_scc1 Lb52
    s_mov_b32 s53, 0
    s_atomic_add s53, s[68:69], s30 glc
    s_waitcnt lgkmcnt(0)
    s_add_u32 s53, s53, 1
    s_andn2_b32 s53, 4, s53
    s_cbranch_scc1 Ls51
    s_branch Lb52
Ls53:
    s_sub_u32 s26, s26, 1
    s_cselect_b32 s26, 0, s26
    s_cbranch_scc1 Lb54
    s_sleep 8
    s_mov_b32 s24, 0
    s_atomic_add s24, s[68:69], s31 glc
    s_waitcnt lgkmcnt(0)
    s_add_u32 s24, s24, 1
    s_andn2_b32 s24, 64, s24
    s_cbranch_scc1 Ls53
    s_branch Lb54
Ls55:
    s_sub_u32 s26, s26, 1
    s_cselect_b32 s26, 0, s26
    s_cbranch_scc1 Lb56
    v_mov_b32 v11, 0
    buffer_atomic_add v11, v9, s[16:19], s31 offen sc0 sc1
    s_waitcnt vmcnt(0)
    v_readfirstlane_b32 s53, v11
    s_nop 0
    s_add_u32 s53, s53, 1
    s_andn2_b32 s53, 8, s53
    s_cbranch_scc1 Ls55
    s_branch Lb56
Ls57:
    s_sub_u32 s26, s26, 1
    s_cselect_b32 s26, 0, s26
    s_cbranch_scc1 Lb58
    v_mov_b32 v11, 0
    buffer_atomic_add v11, v9, s[16:19], s63 offen sc0 sc1
    s_waitcnt vmcnt(0)
    v_readfirstlane_b32 s53, v11
    s_nop 0
    s_add_u32 s53, s53, 1
    s_andn2_b32 s53, 2, s53
    s_cbranch_scc1 Ls57
    s_branch Lb58
Ls59:
    s_sub_u32 s26, s26, 1
    s_cselect_b32 s26, 0, s26
    s_cbranch_scc1 Lb60
    v_mov_b32 v11, 0
    buffer_atomic_add v11, v9, s[16:19], s63 offen sc0 sc1
    s_waitcnt vmcnt(0)
    v_readfirstlane_b32 s53, v11
    s_nop 0
    s_add_u32 s53, s53, 1
    s_andn2_b32 s53, 4, s53
    s_cbranch_scc1 Ls59
    s_branch Lb60
Ls61:
    s_sub_u32 s26, s26, 1
    s_cselect_b32 s26, 0, s26
    s_cbranch_scc1 Lb62
    v_mov_b32 v11, 0
    buffer_atomic_add v11, v9, s[16:19], s63 offen sc0 sc1
    s_waitcnt vmcnt(0)
    v_readfirstlane_b32 s53, v11
    s_nop 0
    s_add_u32 s53, s53, 1
    s_andn2_b32 s53, 8, s53
    s_cbranch_scc1 Ls61
    s_branch Lb62
Ls63:
    s_sub_u32 s26, s26, 1
    s_cselect_b32 s26, 0, s26
    s_cbranch_scc1 Lb64
    v_mov_b32 v11, 0
    buffer_atomic_add v11, v9, s[16:19], s63 offen sc0 sc1
    s_waitcnt vmcnt(0)
    v_readfirstlane_b32 s53, v11
    s_nop 0
    s_add_u32 s53, s53, 1
    s_andn2_b32 s53, 16, s53
    s_cbranch_scc1 Ls63
    s_branch Lb64
Ls65:
    s_sub_u32 s26, s26, 1
    s_cselect_b32 s26, 0, s26
    s_cbranch_scc1 Lb66
    v_mov_b32 v11, 0
    buffer_atomic_add v11, v9, s[16:19], s63 offen sc0 sc1
    s_waitcnt vmcnt(0)
    v_readfirstlane_b32 s53, v11
    s_nop 0
    s_add_u32 s53, s53, 1
    s_andn2_b32 s53, 32, s53
    s_cbranch_scc1 Ls65
    s_branch Lb66
Ls67:
    s_sub_u32 s26, s26, 1
    s_cselect_b32 s26, 0, s26
    s_cbranch_scc1 Lb68
    buffer_load_dwordx4 v[16:19], v4, s[16:19], s29 offen offset:0 sc1
    buffer_load_dwordx4 v[20:23], v4, s[16:19], s29 offen offset:1024 sc1
    s_waitcnt vmcnt(0)
    v_max_u32 v57, v16, v20
    v_cmp_eq_u32 vcc, -1, v57
    s_cbranch_vccnz Ls67
    s_branch Lb68
Ls69:
    s_sub_u32 s26, s26, 1
    s_cselect_b32 s26, 0, s26
    s_cbranch_scc1 Lb70
    buffer_load_dwordx4 v[24:27], v4, s[16:19], s30 offen offset:0 sc1
    buffer_load_dwordx4 v[28:31], v4, s[16:19], s30 offen offset:1024 sc1
    s_waitcnt vmcnt(0)
    v_max_u32 v57, v24, v28
    v_cmp_eq_u32 vcc, -1, v57
    s_cbranch_vccnz Ls69
    s_branch Lb70
.section .rodata,"a"
.p2align 6
.amdhsa_kernel parallel_sum__sliding_local_dilated__mixer_s_mlp__prompt_kernel
  .amdhsa_next_free_vgpr 512
  .amdhsa_next_free_sgpr 102
  .amdhsa_accum_offset 256
  .amdhsa_group_segment_fixed_size 0
  .amdhsa_kernarg_size 88
  .amdhsa_user_sgpr_count 2
  .amdhsa_user_sgpr_kernarg_segment_ptr 1
  .amdhsa_system_sgpr_workgroup_id_x 1
  .amdhsa_float_denorm_mode_32 3
.end_amdhsa_kernel
```
